```python
import torch

def _softmax(x, axis=-1):
    return torch.softmax(x, dim=axis)
def _gelu(x):
    return torch.nn.functional.gelu(x, approximate="tanh")
def _silu(x):
    return torch.nn.functional.silu(x)
def _sigmoid(x):
    return torch.sigmoid(x)
def _layernorm(x, axis=-1, eps=1e-5):
    m = x.mean(dim=axis, keepdim=True)
    v = x.var(dim=axis, keepdim=True, unbiased=False)
    return (x - m) / torch.sqrt(v + eps)
def _scatter_add(tgt, idx, src, axis=0):
    return tgt.clone().index_add_(axis, idx, src)
def _segment_sum(src, seg, n):
    out = torch.zeros((n,) + src.shape[1:], dtype=src.dtype)
    return out.index_add_(0, seg, src)
def _pad(x, pw):
    flat = tuple(v for pair in reversed(pw) for v in pair)
    return torch.nn.functional.pad(x, flat)

kernel_name = 'sequential_preLN__compressed_kv_cla__glu_gated_swiglu__prompt'

def setup_inputs():

    _w = (lambda a: (lambda t: t.to(torch.bfloat16) if t.is_floating_point() else t)(torch.as_tensor(a)))
    def _A_setup():
        B, H, Sq, Sk, D, M = 1, 16, 2048, 2048, 256, 448
        Dc = 4 * D
        return {
            "x": _w((lambda *s: torch.randn(*s, dtype=torch.bfloat16) * 0.05)(B, Sq, M)),
            "c_kv": _w((lambda *s: torch.randn(*s, dtype=torch.bfloat16) * 0.4)(B, Sk, Dc)),
            "w_q": _w((lambda *s: torch.randn(*s, dtype=torch.bfloat16) * 1.6)(M, H, D) * (M ** -0.5)),
            "w_uk": _w((lambda *s: torch.randn(*s, dtype=torch.bfloat16) * 1.6)(Dc, H, D) * (Dc ** -0.5)),
            "w_uv": _w((lambda *s: torch.randn(*s, dtype=torch.bfloat16) * 0.4)(Dc, H, D) * (Dc ** -0.5)),
            "w_o": _w((lambda *s: torch.randn(*s, dtype=torch.bfloat16) * 0.4)(H, D, M) * ((H * D) ** -0.5)),
        }
    _A_in = _A_setup()

    def _B_setup():
        B, S, D, F = 1, 2048, 448, 1792
        return {
            "x": _w((lambda *s: torch.randn(*s, dtype=torch.bfloat16) * 0.05)(B, S, D)),
            "w1": _w((lambda *s: torch.randn(*s, dtype=torch.bfloat16) * 0.2)(D, F) * (2.0 / D) ** 0.5),
            "w3": _w((lambda *s: torch.randn(*s, dtype=torch.bfloat16) * 0.2)(D, F) * (2.0 / D) ** 0.5),
            "w2": _w((lambda *s: torch.randn(*s, dtype=torch.bfloat16) * 0.2)(F, D) * (2.0 / F) ** 0.5),
        }
    _B_in = _B_setup()

    return {
        "A_x": _A_in["x"],
        "A_c_kv": _A_in["c_kv"],
        "A_w_q": _A_in["w_q"],
        "A_w_uk": _A_in["w_uk"],
        "A_w_uv": _A_in["w_uv"],
        "A_w_o": _A_in["w_o"],
        "B_x": _B_in["x"],
        "B_w1": _B_in["w1"],
        "B_w3": _B_in["w3"],
        "B_w2": _B_in["w2"],
    }

def reference(A_x, A_c_kv, A_w_q, A_w_uk, A_w_uv, A_w_o, B_x, B_w1, B_w3, B_w2):
    def _A_ref(x, c_kv, w_q, w_uk, w_uv, w_o):
        B, Sq, M = x.shape[0], x.shape[1], x.shape[2]
        Sk = c_kv.shape[1]
        H, D = w_q.shape[1], w_q.shape[2]
        q = torch.einsum("bqm,mhd->bhqd", x, w_q)
        k = torch.einsum("bkc,chd->bhkd", c_kv, w_uk)
        v = torch.einsum("bkc,chd->bhkd", c_kv, w_uv)
        scores = torch.einsum("bhqd,bhkd->bhqk", q, k) * (D ** -0.5)
        off = Sk - Sq
        qi = torch.arange(Sq)[:, None]
        kj = torch.arange(Sk)[None, :]
        cmask = kj <= (qi + off)
        scores = torch.where(cmask[None, None], scores, -1e9)
        p = _softmax(scores, axis=-1)
        ctx = torch.einsum("bhqk,bhkd->bhqd", p, v)
        return torch.einsum("bhqd,hdm->bqm", ctx, w_o)

    def _B_ref(x, w1, w3, w2):
        gate = torch.einsum("bsd,df->bsf", x, w1)
        up = torch.einsum("bsd,df->bsf", x, w3)
        h = _silu(gate) * up
        out = torch.einsum("bsf,fd->bsd", h, w2)
        return out

    x = A_x
    h = x + _A_ref(_layernorm(x, axis=-1), A_c_kv, A_w_q, A_w_uk, A_w_uv, A_w_o)
    h2 = h + _B_ref(_layernorm(h, axis=-1), B_w1, B_w3, B_w2)
    return h2
```

```asm
; @launch grid=(256,1,1) block=(256,1,1) lds=163840
.amdgcn_target "amdgcn-amd-amdhsa--gfx950"
.text
.globl sequential_preLN__compressed_kv_cla__glu_gated_swiglu__prompt_kernel
.p2align 8
.type sequential_preLN__compressed_kv_cla__glu_gated_swiglu__prompt_kernel,@function
sequential_preLN__compressed_kv_cla__glu_gated_swiglu__prompt_kernel:
 s_cmp_ge_u32 s2, 256
 s_cbranch_scc1 L_end
 s_load_dwordx4 s[52:55], s[0:1], 0
 s_load_dwordx2 s[56:57], s[0:1], 16
 s_load_dwordx4 s[20:23], s[0:1], 24
 s_load_dwordx2 s[100:101], s[0:1], 40
 s_load_dwordx4 s[4:7], s[0:1], 88
 s_getpc_b64 s[30:31]
L_pc0:
 v_lshrrev_b32 v1, 6, v0
 s_lshr_b32 s25, s2, 3
 s_and_b32 s38, s25, 3
 s_lshl_b32 s38, s38, 15
 v_lshlrev_b32 v16, 7, v0
 v_add_u32 v16, s38, v16
 v_min_u32 v16, L_textend-L_pc0-4, v16
 global_load_dword a255, v16, s[30:31]
 v_and_b32 v0, 63, v0
 v_readfirstlane_b32 s3, v1
 s_and_b32 s24, s2, 7
 s_and_b32 s26, s25, 1
 s_lshl_b32 s24, s24, 1
 s_add_u32 s24, s24, s26
 s_bfe_u32 s26, s25, 0x10001
 s_lshr_b32 s27, s25, 2
 s_sub_u32 s50, 15, s27
 s_cmp_eq_u32 s26, 0
 s_cselect_b32 s50, s50, s27
 s_lshl_b32 s28, s2, 3
 s_lshl_b32 s29, s3, 1
 s_add_u32 s28, s28, s29
 v_and_b32 v20, 1, v0
 v_add_u32 v20, s28, v20
 v_mul_u32_u24 v21, 896, v20
 v_lshrrev_b32 v22, 1, v0
 v_lshl_add_u32 v21, v22, 4, v21
 s_lshl_b32 s28, s27, 7
 s_lshl_b32 s29, s3, 5
 s_add_u32 s28, s28, s29
 v_lshrrev_b32 v1, 3, v0
 v_add_u32 v1, s28, v1
 v_lshlrev_b32 v1, 11, v1
 v_lshrrev_b32 v16, 4, v0
 v_and_b32 v17, 7, v0
 v_xor_b32 v17, v17, v16
 v_lshlrev_b32 v17, 4, v17
 v_xor_b32 v18, 0, v17
 v_add_u32 v18, v18, v1
 v_add_u32 v2, 0, v18
 v_xor_b32 v18, 64, v17
 v_add_u32 v18, v18, v1
 v_add_u32 v3, 15360, v18
 v_xor_b32 v18, 0, v17
 v_add_u32 v18, v18, v1
 v_add_u32 v4, 30720, v18
 v_xor_b32 v18, 64, v17
 v_add_u32 v18, v18, v1
 v_add_u32 v5, 46080, v18
 s_lshl_b32 s28, s3, 4
 v_add_u32 v1, s28, v16
 v_lshlrev_b32 v1, 13, v1
 s_lshl_b32 s28, s24, 9
 v_add_u32 v1, s28, v1
 v_and_b32 v17, 15, v0
 v_lshlrev_b32 v18, 1, v16
 v_xor_b32 v17, v17, v18
 v_lshlrev_b32 v17, 4, v17
 v_xor_b32 v18, 0, v17
 v_add_u32 v18, v18, v1
 v_add_u32 v6, 0, v18
 v_xor_b32 v18, 0, v17
 v_add_u32 v18, v18, v1
 v_add_u32 v7, 31744, v18
 v_xor_b32 v18, 128, v17
 v_add_u32 v18, v18, v1
 v_add_u32 v8, 63488, v18
 v_xor_b32 v18, 128, v17
 v_add_u32 v18, v18, v1
 v_add_u32 v9, 95232, v18
 s_lshl_b32 s32, s3, 12
 s_mov_b32 s33, 0
 s_mov_b32 s34, 0
 v_mov_b32 v28, 0
 v_mov_b32 v29, 0
 v_mov_b32 v30, 0
 v_mov_b32 v31, 0
 s_waitcnt lgkmcnt(0)
 s_mov_b32 s8, s54
 s_and_b32 s9, s55, 0xffff
 s_mov_b32 s10, 4194304
 s_mov_b32 s11, 0x00020000
 s_cmp_eq_u32 s26, 0
 s_cselect_b32 s20, s20, s22
 s_cselect_b32 s21, s21, s23
 s_mov_b32 s12, s20
 s_and_b32 s13, s21, 0xffff
 s_mov_b32 s14, 8388608
 s_mov_b32 s15, 0x00020000
 s_mov_b32 s44, s52
 s_and_b32 s45, s53, 0xffff
 s_mov_b32 s46, 1835008
 s_mov_b32 s47, 0x00020000
 buffer_load_dwordx4 v[24:27], v21, s[44:47], 0 offen
 s_mov_b32 exec_hi, 0xffff
 buffer_load_dwordx4 v[28:31], v21, s[44:47], 0 offen offset:512
 s_mov_b32 exec_hi, -1
 s_add_u32 m0, s32, 0
 s_add_u32 s35, s33, 0
 buffer_load_dwordx4 v2, s[8:11], s35 offen offset:0 lds
 buffer_load_dwordx4 v3, s[8:11], s35 offen offset:1024 lds
 buffer_load_dwordx4 v4, s[8:11], s35 offen offset:2048 lds
 buffer_load_dwordx4 v5, s[8:11], s35 offen offset:3072 lds
 s_add_u32 m0, s32, 65536
 s_add_u32 s35, s34, 0
 buffer_load_dwordx4 v6, s[12:15], s35 offen offset:0 nt lds
 buffer_load_dwordx4 v7, s[12:15], s35 offen offset:1024 nt lds
 buffer_load_dwordx4 v8, s[12:15], s35 offen offset:2048 nt lds
 buffer_load_dwordx4 v9, s[12:15], s35 offen offset:3072 nt lds
 s_mov_b32 s16, s6
 s_and_b32 s17, s7, 0xffff
 s_mov_b32 s18, 167772160
 s_mov_b32 s19, 0x00020000
 s_mov_b32 s40, s56
 s_and_b32 s41, s57, 0xffff
 s_mov_b32 s42, 3670016
 s_mov_b32 s43, 0x00020000
 s_mov_b32 s44, s100
 s_and_b32 s45, s101, 0xffff
 s_mov_b32 s46, 3670016
 s_mov_b32 s47, 0x00020000
 s_lshl_b32 s38, s50, 2
 s_add_u32 s38, s38, s3
 s_mul_i32 s30, s38, 57344
 s_lshl_b32 s31, s24, 9
 s_add_u32 s30, s30, s31
 s_add_u32 s56, s56, s30
 s_addc_u32 s57, s57, 0
 s_mul_i32 s30, s24, 229376
 s_lshl_b32 s31, s38, 7
 s_add_u32 s30, s30, s31
 s_add_u32 s100, s100, s30
 s_addc_u32 s101, s101, 0
 v_and_b32 v62, 3, v0
 v_lshlrev_b32 v60, 7, v62
 v_add_co_u32 v60, vcc, s56, v60
 v_mov_b32 v61, s57
 s_nop 0
 v_addc_co_u32 v61, vcc, 0, v61, vcc
 v_mul_u32_u24 v62, 57344, v62
 v_add_co_u32 v62, vcc, s100, v62
 v_mov_b32 v63, s101
 s_nop 0
 v_addc_co_u32 v63, vcc, 0, v63, vcc
 s_mov_b64 s[30:31], 0xf0
 v_cndmask_b32 v60, v60, v62, s[30:31]
 v_cndmask_b32 v61, v61, v63, s[30:31]
 s_load_dwordx4 s[52:55], s[0:1], 56
 s_load_dwordx2 s[56:57], s[0:1], 72
 v_lshrrev_b32 v23, 1, v20
 v_mul_u32_u24 v23, 1792, v23
 v_lshl_add_u32 v23, v0, 4, v23
 s_lshr_b32 s28, s3, 1
 s_add_u32 m0, s32, 81920
 s_add_u32 s35, s34, 256
 buffer_load_dwordx4 v6, s[12:15], s35 offen offset:0 nt lds
 s_and_b32 s29, s3, 1
 s_lshl_b32 s30, s28, 13
 v_and_b32 v1, 15, v0
 v_lshlrev_b32 v1, 7, v1
 v_add_u32 v1, s30, v1
 v_bfe_u32 v18, v0, 1, 3
 buffer_load_dwordx4 v7, s[12:15], s35 offen offset:1024 nt lds
 v_xor_b32 v17, v16, v18
 v_lshlrev_b32 v17, 4, v17
 v_add_u32 v10, v17, v1
 v_xor_b32 v11, 64, v10
 v_lshlrev_b32 v1, 3, v16
 v_bfe_u32 v17, v0, 2, 2
 buffer_load_dwordx4 v8, s[12:15], s35 offen offset:2048 nt lds
 v_add_u32 v1, v1, v17
 v_lshlrev_b32 v1, 8, v1
 v_bfe_u32 v18, v0, 4, 1
 v_lshlrev_b32 v18, 2, v18
 v_or_b32 v17, v17, v18
 v_lshlrev_b32 v17, 1, v17
 buffer_load_dwordx4 v9, s[12:15], s35 offen offset:3072 nt lds
 v_bfe_u32 v19, v0, 1, 1
 s_lshl_b32 s30, s29, 3
 v_add_u32 v19, s30, v19
 v_xor_b32 v19, v19, v17
 v_lshlrev_b32 v19, 4, v19
 v_and_b32 v18, 1, v0
 s_add_u32 m0, s32, 16384
 s_add_u32 s35, s33, 2097152
 buffer_load_dwordx4 v2, s[8:11], s35 offen offset:0 lds
 v_lshlrev_b32 v18, 3, v18
 v_add3_u32 v1, v1, v18, v19
 v_add_u32 v12, 0x10000, v1
 v_xor_b32 v13, 32, v12
 v_xor_b32 v14, 64, v12
 v_xor_b32 v15, 96, v12
 buffer_load_dwordx4 v3, s[8:11], s35 offen offset:1024 lds
 v_lshlrev_b32 v1, 4, v0
 s_lshl_b32 s58, s24, 20
 s_lshl_b32 s38, s27, 16
 s_add_u32 s58, s58, s38
 s_lshl_b32 s38, s28, 15
 s_add_u32 s58, s58, s38
 s_add_u32 s38, s26, 11
 s_lshl_b32 s38, s29, s38
 s_add_u32 s58, s58, s38
 s_lshl_b32 s38, s26, 24
 s_add_u32 s58, s58, s38
 s_cmp_eq_u32 s26, 0
 s_mov_b32 s59, 16384
 s_mov_b32 s51, 4294951936
 s_mov_b32 s39, 8192
 s_cselect_b32 s59, 1024, s59
 s_cselect_b32 s51, 7168, s51
 s_cselect_b32 s39, 4096, s39
 s_lshl_b32 s49, s24, 3
 s_add_u32 s49, s49, s27
 s_lshl_b32 s49, s49, 16
 s_lshl_b32 s38, s3, 14
 s_add_u32 s49, s49, s38
 s_add_u32 s49, s49, 33554432
 s_lshl_b32 s48, s50, 3
 s_lshl_b32 s38, s3, 1
 s_add_u32 s48, s48, s38
 s_mul_i32 s48, s48, 14336
 s_add_u32 s48, s48, 146800640
 buffer_load_dwordx4 v4, s[8:11], s35 offen offset:2048 lds
 s_lshl_b32 s22, s24, 4
 s_add_u32 s22, s22, s50
 s_lshl_b32 s22, s22, 8
 s_add_u32 s22, s22, 150994944
 v_mov_b32 v64, 0
 v_mov_b32 v65, 0
 v_mov_b32 v66, 0
 v_mov_b32 v67, 0
 s_lshl_b32 s38, s2, 2
 s_add_u32 s38, s38, s3
 s_mul_i32 s38, s38, 6
 s_sub_u32 s38, s38, 8
 buffer_load_dwordx4 v5, s[8:11], s35 offen offset:3072 lds
 v_add_u32 v56, s38, v0
 v_min_u32 v56, 5375, v56
 v_lshrrev_b32 v57, 6, v56
 v_and_b32 v56, 63, v56
 v_lshlrev_b32 v56, 7, v56
 s_waitcnt lgkmcnt(0)
 v_mov_b32 v58, s52
 v_mov_b32 v59, s53
 v_mov_b32 v62, s54
 v_mov_b32 v63, s55
 v_cmp_le_u32 vcc, 28, v57
 v_subrev_u32 v54, 28, v57
 s_nop 0
 v_cndmask_b32 v58, v58, v62, vcc
 v_cndmask_b32 v59, v59, v63, vcc
 v_cndmask_b32 v57, v57, v54, vcc
 v_mov_b32 v62, s56
 v_mov_b32 v63, s57
 v_cmp_le_u32 vcc, 28, v57
 v_subrev_u32 v54, 28, v57
 s_nop 0
 v_cndmask_b32 v58, v58, v62, vcc
 v_cndmask_b32 v59, v59, v63, vcc
 v_cndmask_b32 v57, v57, v54, vcc
 v_mul_u32_u24 v57, 57344, v57
 v_add_u32 v56, v56, v57
 v_add_co_u32 v58, vcc, v58, v56
 s_nop 1
 v_addc_co_u32 v59, vcc, 0, v59, vcc
 s_mov_b64 s[30:31], 0x3f00
 v_cndmask_b32 v60, v60, v58, s[30:31]
 v_cndmask_b32 v61, v61, v59, s[30:31]
 s_mov_b32 s52, 8192
 s_mov_b32 s53, 0
 s_waitcnt vmcnt(17)
 v_lshlrev_b32 v32, 16, v24
 v_and_b32 v33, 0xffff0000, v24
 v_lshlrev_b32 v34, 16, v25
 v_and_b32 v35, 0xffff0000, v25
 v_lshlrev_b32 v36, 16, v26
 v_and_b32 v37, 0xffff0000, v26
 v_lshlrev_b32 v38, 16, v27
 v_and_b32 v39, 0xffff0000, v27
 s_waitcnt vmcnt(16)
 v_lshlrev_b32 v40, 16, v28
 v_and_b32 v41, 0xffff0000, v28
 v_lshlrev_b32 v42, 16, v29
 v_and_b32 v43, 0xffff0000, v29
 v_lshlrev_b32 v44, 16, v30
 v_and_b32 v45, 0xffff0000, v30
 v_lshlrev_b32 v46, 16, v31
 v_and_b32 v47, 0xffff0000, v31
 v_pk_add_f32 v[48:49], v[32:33], v[34:35]
 v_pk_add_f32 v[48:49], v[48:49], v[36:37]
 v_pk_add_f32 v[48:49], v[48:49], v[38:39]
 v_pk_add_f32 v[48:49], v[48:49], v[40:41]
 v_pk_add_f32 v[48:49], v[48:49], v[42:43]
 v_pk_add_f32 v[48:49], v[48:49], v[44:45]
 v_pk_add_f32 v[48:49], v[48:49], v[46:47]
 v_add_f32 v48, v48, v49
 s_nop 1
 v_add_f32_dpp v48, v48, v48 row_ror:2 row_mask:0xf bank_mask:0xf
 s_nop 1
 v_add_f32_dpp v48, v48, v48 row_ror:4 row_mask:0xf bank_mask:0xf
 s_nop 1
 v_add_f32_dpp v48, v48, v48 row_ror:8 row_mask:0xf bank_mask:0xf
 v_mov_b32 v50, v48
 s_nop 1
 v_permlane16_swap_b32 v48, v50
 v_add_f32 v48, v48, v50
 v_mov_b32 v50, v48
 s_nop 1
 v_permlane32_swap_b32 v48, v50
 v_add_f32 v48, v48, v50
 v_mul_f32 v48, 0xbb124925, v48
 v_mov_b32 v49, v48
 v_pk_add_f32 v[32:33], v[32:33], v[48:49]
 v_pk_add_f32 v[34:35], v[34:35], v[48:49]
 v_pk_add_f32 v[36:37], v[36:37], v[48:49]
 v_pk_add_f32 v[38:39], v[38:39], v[48:49]
 s_mov_b32 exec_hi, 0xffff
 v_pk_add_f32 v[40:41], v[40:41], v[48:49]
 v_pk_add_f32 v[42:43], v[42:43], v[48:49]
 v_pk_add_f32 v[44:45], v[44:45], v[48:49]
 v_pk_add_f32 v[46:47], v[46:47], v[48:49]
 s_mov_b32 exec_hi, -1
 v_pk_mul_f32 v[50:51], v[32:33], v[32:33]
 v_pk_fma_f32 v[50:51], v[34:35], v[34:35], v[50:51]
 v_pk_fma_f32 v[50:51], v[36:37], v[36:37], v[50:51]
 v_pk_fma_f32 v[50:51], v[38:39], v[38:39], v[50:51]
 v_pk_fma_f32 v[50:51], v[40:41], v[40:41], v[50:51]
 v_pk_fma_f32 v[50:51], v[42:43], v[42:43], v[50:51]
 v_pk_fma_f32 v[50:51], v[44:45], v[44:45], v[50:51]
 v_pk_fma_f32 v[50:51], v[46:47], v[46:47], v[50:51]
 v_add_f32 v50, v50, v51
 s_nop 1
 v_add_f32_dpp v50, v50, v50 row_ror:2 row_mask:0xf bank_mask:0xf
 s_nop 1
 v_add_f32_dpp v50, v50, v50 row_ror:4 row_mask:0xf bank_mask:0xf
 s_nop 1
 v_add_f32_dpp v50, v50, v50 row_ror:8 row_mask:0xf bank_mask:0xf
 v_mov_b32 v52, v50
 s_nop 1
 v_permlane16_swap_b32 v50, v52
 v_add_f32 v50, v50, v52
 v_mov_b32 v52, v50
 s_nop 1
 v_permlane32_swap_b32 v50, v52
 v_add_f32 v50, v50, v52
 v_mov_b32 v51, 0x3727c5ac
 v_fmac_f32 v51, 0x3b124925, v50
 v_rsq_f32 v50, v51
 s_nop 0
 v_mul_f32 v50, 0x3db8aa3b, v50
 v_mov_b32 v51, v50
 v_pk_mul_f32 v[32:33], v[32:33], v[50:51]
 v_pk_mul_f32 v[34:35], v[34:35], v[50:51]
 v_pk_mul_f32 v[36:37], v[36:37], v[50:51]
 v_pk_mul_f32 v[38:39], v[38:39], v[50:51]
 v_pk_mul_f32 v[40:41], v[40:41], v[50:51]
 v_pk_mul_f32 v[42:43], v[42:43], v[50:51]
 v_pk_mul_f32 v[44:45], v[44:45], v[50:51]
 v_pk_mul_f32 v[46:47], v[46:47], v[50:51]
 v_cvt_pk_bf16_f32 v24, v32, v33
 v_cvt_pk_bf16_f32 v25, v34, v35
 v_cvt_pk_bf16_f32 v26, v36, v37
 v_cvt_pk_bf16_f32 v27, v38, v39
 v_cvt_pk_bf16_f32 v28, v40, v41
 v_cvt_pk_bf16_f32 v29, v42, v43
 v_cvt_pk_bf16_f32 v30, v44, v45
 v_cvt_pk_bf16_f32 v31, v46, v47
 s_waitcnt vmcnt(8)
 s_barrier
 ds_read_b128 a[80:83], v10 offset:0
 ds_read_b128 a[84:87], v11 offset:0
 ds_read_b128 a[88:91], v10 offset:2048
 ds_read_b128 a[92:95], v11 offset:2048
 ds_read_b128 a[96:99], v10 offset:4096
 ds_read_b128 a[100:103], v11 offset:4096
 ds_read_b128 a[104:107], v10 offset:6144
 ds_read_b128 a[108:111], v11 offset:6144
 ds_read_b64_tr_b16 a[112:113], v12 offset:0
 ds_read_b64_tr_b16 a[114:115], v12 offset:1024
 ds_read_b64_tr_b16 a[116:117], v12 offset:8192
 ds_read_b64_tr_b16 a[118:119], v12 offset:9216
 ds_read_b64_tr_b16 a[120:121], v13 offset:0
 ds_read_b64_tr_b16 a[122:123], v13 offset:1024
 ds_read_b64_tr_b16 a[124:125], v13 offset:8192
 ds_read_b64_tr_b16 a[126:127], v13 offset:9216
 ds_read_b64_tr_b16 a[128:129], v14 offset:0
 ds_read_b64_tr_b16 a[130:131], v14 offset:1024
 ds_read_b64_tr_b16 a[132:133], v14 offset:8192
 ds_read_b64_tr_b16 a[134:135], v14 offset:9216
 ds_read_b64_tr_b16 a[136:137], v15 offset:0
 ds_read_b64_tr_b16 a[138:139], v15 offset:1024
 ds_read_b64_tr_b16 a[140:141], v15 offset:8192
 ds_read_b64_tr_b16 a[142:143], v15 offset:9216
 s_mov_b32 s38, 146800640
 buffer_store_dwordx4 v[24:27], v23, s[16:19], s38 offen sc1
 s_mov_b32 s38, 146801664
 s_mov_b32 exec_hi, 0xffff
 buffer_store_dwordx4 v[28:31], v23, s[16:19], s38 offen sc1
 s_mov_b32 exec_hi, -1
 s_lshl_b32 s38, s2, 9
 s_add_u32 s38, s38, 150994944
 s_cmp_eq_u32 s3, 0
 s_cselect_b32 s38, s38, 1879048192
 s_mov_b32 exec_hi, 0
 buffer_store_dwordx4 v[64:67], v1, s[16:19], s38 offen sc1
 s_mov_b32 exec_hi, -1
 v_mov_b32 v0, v60
 v_mov_b32 v1, v61
 s_and_b32 s23, s25, 3
 s_add_u32 s23, s23, 1
 s_mov_b32 s36, 0
 s_cmp_eq_u32 s26, 0
 s_cbranch_scc0 L_firstV
L_firstK:
 s_waitcnt lgkmcnt(14)
 v_mfma_f32_16x16x32_bf16 v[16:19], a[112:115], a[80:83], 0
 s_waitcnt lgkmcnt(12)
 s_add_u32 m0, s32, 32768
 s_add_u32 s35, s33, 128
 v_mfma_f32_16x16x32_bf16 v[16:19], a[116:119], a[84:87], v[16:19]
 s_waitcnt lgkmcnt(8)
 buffer_load_dwordx4 v2, s[8:11], s35 offen offset:0 lds
 v_mfma_f32_16x16x32_bf16 v[20:23], a[124:127], a[84:87], 0
 v_mfma_f32_16x16x32_bf16 v[20:23], a[120:123], a[80:83], v[20:23]
 s_waitcnt lgkmcnt(6)
 v_mfma_f32_16x16x32_bf16 v[24:27], a[128:131], a[80:83], 0
 s_waitcnt lgkmcnt(0)
 v_mfma_f32_16x16x32_bf16 v[24:27], a[132:135], a[84:87], v[24:27]
 s_waitcnt vmcnt(8)
 s_waitcnt lgkmcnt(0)
 s_barrier
 v_mfma_f32_16x16x32_bf16 v[28:31], a[140:143], a[84:87], 0
 buffer_load_dwordx4 v3, s[8:11], s35 offen offset:1024 lds
 v_mfma_f32_16x16x32_bf16 v[28:31], a[136:139], a[80:83], v[28:31]
 ds_read_b64_tr_b16 a[32:33], v12 offset:16384
 ds_read_b64_tr_b16 a[34:35], v12 offset:17408
 v_mfma_f32_16x16x32_bf16 v[44:47], a[136:139], a[88:91], 0
 ds_read_b64_tr_b16 a[36:37], v12 offset:24576
 v_mfma_f32_16x16x32_bf16 v[44:47], a[140:143], a[92:95], v[44:47]
 ds_read_b64_tr_b16 a[38:39], v12 offset:25600
 v_mfma_f32_16x16x32_bf16 v[40:43], a[132:135], a[92:95], 0
 buffer_load_dwordx4 v4, s[8:11], s35 offen offset:2048 lds
 v_mfma_f32_16x16x32_bf16 v[40:43], a[128:131], a[88:91], v[40:43]
 ds_read_b64_tr_b16 a[40:41], v13 offset:16384
 ds_read_b64_tr_b16 a[42:43], v13 offset:17408
 v_mfma_f32_16x16x32_bf16 v[36:39], a[120:123], a[88:91], 0
 v_mfma_f32_16x16x32_bf16 v[36:39], a[124:127], a[92:95], v[36:39]
 ds_read_b64_tr_b16 a[44:45], v13 offset:24576
 v_mfma_f32_16x16x32_bf16 v[32:35], a[116:119], a[92:95], 0
 buffer_load_dwordx4 v5, s[8:11], s35 offen offset:3072 lds
 v_mfma_f32_16x16x32_bf16 v[32:35], a[112:115], a[88:91], v[32:35]
 s_add_u32 m0, s32, 98304
 s_add_u32 s35, s34, 524288
 ds_read_b64_tr_b16 a[46:47], v13 offset:25600
 v_mfma_f32_16x16x32_bf16 v[48:51], a[112:115], a[96:99], 0
 ds_read_b64_tr_b16 a[48:49], v14 offset:16384
 ds_read_b64_tr_b16 a[50:51], v14 offset:17408
 v_mfma_f32_16x16x32_bf16 v[48:51], a[116:119], a[100:103], v[48:51]
 ds_read_b64_tr_b16 a[52:53], v14 offset:24576
 v_mfma_f32_16x16x32_bf16 v[52:55], a[124:127], a[100:103], 0
 buffer_load_dwordx4 v6, s[12:15], s35 offen offset:0 nt lds
 v_mfma_f32_16x16x32_bf16 v[52:55], a[120:123], a[96:99], v[52:55]
 ds_read_b64_tr_b16 a[54:55], v14 offset:25600
 v_mfma_f32_16x16x32_bf16 v[56:59], a[128:131], a[96:99], 0
 ds_read_b64_tr_b16 a[56:57], v15 offset:16384
 v_mfma_f32_16x16x32_bf16 v[56:59], a[132:135], a[100:103], v[56:59]
 ds_read_b64_tr_b16 a[58:59], v15 offset:17408
 v_mfma_f32_16x16x32_bf16 v[60:63], a[140:143], a[100:103], 0
 buffer_load_dwordx4 v7, s[12:15], s35 offen offset:1024 nt lds
 v_mfma_f32_16x16x32_bf16 v[60:63], a[136:139], a[96:99], v[60:63]
 ds_read_b64_tr_b16 a[60:61], v15 offset:24576
 ds_read_b64_tr_b16 a[62:63], v15 offset:25600
 v_mfma_f32_16x16x32_bf16 v[76:79], a[136:139], a[104:107], 0
 v_mfma_f32_16x16x32_bf16 v[76:79], a[140:143], a[108:111], v[76:79]
 v_mfma_f32_16x16x32_bf16 v[72:75], a[132:135], a[108:111], 0
 buffer_load_dwordx4 v8, s[12:15], s35 offen offset:2048 nt lds
 v_mfma_f32_16x16x32_bf16 v[72:75], a[128:131], a[104:107], v[72:75]
 v_mfma_f32_16x16x32_bf16 v[68:71], a[120:123], a[104:107], 0
 v_mfma_f32_16x16x32_bf16 v[68:71], a[124:127], a[108:111], v[68:71]
 buffer_load_dwordx4 v9, s[12:15], s35 offen offset:3072 nt lds
 v_mfma_f32_16x16x32_bf16 v[64:67], a[116:119], a[108:111], 0
 v_mfma_f32_16x16x32_bf16 v[64:67], a[112:115], a[104:107], v[64:67]
 s_waitcnt lgkmcnt(0)
 v_mfma_f32_16x16x32_bf16 v[80:83], a[32:35], a[80:83], 0
 s_add_u32 m0, s32, 114688
 s_add_u32 s35, s34, 524544
 v_mfma_f32_16x16x32_bf16 v[80:83], a[36:39], a[84:87], v[80:83]
 buffer_load_dwordx4 v6, s[12:15], s35 offen offset:0 nt lds
 v_mfma_f32_16x16x32_bf16 v[84:87], a[44:47], a[84:87], 0
 v_mfma_f32_16x16x32_bf16 v[84:87], a[40:43], a[80:83], v[84:87]
 v_mfma_f32_16x16x32_bf16 v[88:91], a[48:51], a[80:83], 0
 v_mfma_f32_16x16x32_bf16 v[88:91], a[52:55], a[84:87], v[88:91]
 s_waitcnt vmcnt(12)
 s_waitcnt lgkmcnt(0)
 s_barrier
 v_mfma_f32_16x16x32_bf16 v[92:95], a[60:63], a[84:87], 0
 buffer_load_dwordx4 v7, s[12:15], s35 offen offset:1024 nt lds
 v_mfma_f32_16x16x32_bf16 v[92:95], a[56:59], a[80:83], v[92:95]
 ds_read_b128 a[0:3], v10 offset:16384
 v_mfma_f32_16x16x32_bf16 v[108:111], a[56:59], a[88:91], 0
 ds_read_b128 a[4:7], v11 offset:16384
 v_mfma_f32_16x16x32_bf16 v[108:111], a[60:63], a[92:95], v[108:111]
 v_mfma_f32_16x16x32_bf16 v[104:107], a[52:55], a[92:95], 0
 buffer_load_dwordx4 v8, s[12:15], s35 offen offset:2048 nt lds
 v_mfma_f32_16x16x32_bf16 v[104:107], a[48:51], a[88:91], v[104:107]
 ds_read_b128 a[8:11], v10 offset:18432
 v_mfma_f32_16x16x32_bf16 v[100:103], a[40:43], a[88:91], 0
 v_mfma_f32_16x16x32_bf16 v[100:103], a[44:47], a[92:95], v[100:103]
 ds_read_b128 a[12:15], v11 offset:18432
 v_mfma_f32_16x16x32_bf16 v[96:99], a[36:39], a[92:95], 0
 buffer_load_dwordx4 v9, s[12:15], s35 offen offset:3072 nt lds
 v_mfma_f32_16x16x32_bf16 v[96:99], a[32:35], a[88:91], v[96:99]
 s_add_u32 m0, s32, 49152
 s_add_u32 s35, s33, 2097280
 ds_read_b128 a[16:19], v10 offset:20480
 v_mfma_f32_16x16x32_bf16 v[112:115], a[32:35], a[96:99], 0
 v_mfma_f32_16x16x32_bf16 v[112:115], a[36:39], a[100:103], v[112:115]
 ds_read_b128 a[20:23], v11 offset:20480
 v_mfma_f32_16x16x32_bf16 v[116:119], a[44:47], a[100:103], 0
 buffer_load_dwordx4 v2, s[8:11], s35 offen offset:0 lds
 v_mfma_f32_16x16x32_bf16 v[116:119], a[40:43], a[96:99], v[116:119]
 v_mfma_f32_16x16x32_bf16 v[120:123], a[48:51], a[96:99], 0
 ds_read_b128 a[24:27], v10 offset:22528
 v_mfma_f32_16x16x32_bf16 v[120:123], a[52:55], a[100:103], v[120:123]
 v_mfma_f32_16x16x32_bf16 v[124:127], a[60:63], a[100:103], 0
 buffer_load_dwordx4 v3, s[8:11], s35 offen offset:1024 lds
 v_mfma_f32_16x16x32_bf16 v[124:127], a[56:59], a[96:99], v[124:127]
 ds_read_b128 a[28:31], v11 offset:22528
 v_mfma_f32_16x16x32_bf16 v[140:143], a[56:59], a[104:107], 0
 v_mfma_f32_16x16x32_bf16 v[140:143], a[60:63], a[108:111], v[140:143]
 v_mfma_f32_16x16x32_bf16 v[136:139], a[52:55], a[108:111], 0
 buffer_load_dwordx4 v4, s[8:11], s35 offen offset:2048 lds
 v_mfma_f32_16x16x32_bf16 v[136:139], a[48:51], a[104:107], v[136:139]
 v_mfma_f32_16x16x32_bf16 v[132:135], a[40:43], a[104:107], 0
 v_mfma_f32_16x16x32_bf16 v[132:135], a[44:47], a[108:111], v[132:135]
 buffer_load_dwordx4 v5, s[8:11], s35 offen offset:3072 lds
 v_mfma_f32_16x16x32_bf16 v[128:131], a[36:39], a[108:111], 0
 v_mfma_f32_16x16x32_bf16 v[128:131], a[32:35], a[104:107], v[128:131]
 s_waitcnt lgkmcnt(0)
 v_mfma_f32_16x16x32_bf16 v[208:211], a[32:35], a[0:3], 0
 s_add_u32 s33, s33, 256
 s_add_u32 s34, s34, 1048576
 v_mfma_f32_16x16x32_bf16 v[208:211], a[36:39], a[4:7], v[208:211]
 s_add_u32 m0, s32, 0
 s_add_u32 s35, s33, 0
 v_mfma_f32_16x16x32_bf16 v[212:215], a[44:47], a[4:7], 0
 buffer_load_dwordx4 v2, s[8:11], s35 offen offset:0 lds
 v_mfma_f32_16x16x32_bf16 v[212:215], a[40:43], a[0:3], v[212:215]
 v_mfma_f32_16x16x32_bf16 v[216:219], a[48:51], a[0:3], 0
 v_mfma_f32_16x16x32_bf16 v[216:219], a[52:55], a[4:7], v[216:219]
 s_waitcnt vmcnt(13)
 s_waitcnt lgkmcnt(0)
 s_barrier
 v_mfma_f32_16x16x32_bf16 v[220:223], a[60:63], a[4:7], 0
 buffer_load_dwordx4 v3, s[8:11], s35 offen offset:1024 lds
 v_mfma_f32_16x16x32_bf16 v[220:223], a[56:59], a[0:3], v[220:223]
 ds_read_b128 a[80:83], v10 offset:32768
 v_mfma_f32_16x16x32_bf16 v[236:239], a[56:59], a[8:11], 0
 ds_read_b128 a[84:87], v11 offset:32768
 v_mfma_f32_16x16x32_bf16 v[236:239], a[60:63], a[12:15], v[236:239]
 v_mfma_f32_16x16x32_bf16 v[232:235], a[52:55], a[12:15], 0
 buffer_load_dwordx4 v4, s[8:11], s35 offen offset:2048 lds
 v_mfma_f32_16x16x32_bf16 v[232:235], a[48:51], a[8:11], v[232:235]
 ds_read_b128 a[88:91], v10 offset:34816
 v_mfma_f32_16x16x32_bf16 v[228:231], a[40:43], a[8:11], 0
 v_mfma_f32_16x16x32_bf16 v[228:231], a[44:47], a[12:15], v[228:231]
 ds_read_b128 a[92:95], v11 offset:34816
 v_mfma_f32_16x16x32_bf16 v[224:227], a[36:39], a[12:15], 0
 buffer_load_dwordx4 v5, s[8:11], s35 offen offset:3072 lds
 v_mfma_f32_16x16x32_bf16 v[224:227], a[32:35], a[8:11], v[224:227]
 s_add_u32 m0, s32, 65536
 s_add_u32 s35, s34, 0
 ds_read_b128 a[96:99], v10 offset:36864
 v_mfma_f32_16x16x32_bf16 v[240:243], a[32:35], a[16:19], 0
 v_mfma_f32_16x16x32_bf16 v[240:243], a[36:39], a[20:23], v[240:243]
 ds_read_b128 a[100:103], v11 offset:36864
 v_mfma_f32_16x16x32_bf16 v[244:247], a[44:47], a[20:23], 0
 buffer_load_dwordx4 v6, s[12:15], s35 offen offset:0 nt lds
 v_mfma_f32_16x16x32_bf16 v[244:247], a[40:43], a[16:19], v[244:247]
 v_mfma_f32_16x16x32_bf16 v[248:251], a[48:51], a[16:19], 0
 ds_read_b128 a[104:107], v10 offset:38912
 v_mfma_f32_16x16x32_bf16 v[248:251], a[52:55], a[20:23], v[248:251]
 v_mfma_f32_16x16x32_bf16 v[252:255], a[60:63], a[20:23], 0
 buffer_load_dwordx4 v7, s[12:15], s35 offen offset:1024 nt lds
 v_mfma_f32_16x16x32_bf16 v[252:255], a[56:59], a[16:19], v[252:255]
 ds_read_b128 a[108:111], v11 offset:38912
 v_mfma_f32_16x16x32_bf16 a[76:79], a[56:59], a[24:27], 0
 v_mfma_f32_16x16x32_bf16 a[76:79], a[60:63], a[28:31], a[76:79]
 v_mfma_f32_16x16x32_bf16 a[72:75], a[52:55], a[28:31], 0
 buffer_load_dwordx4 v8, s[12:15], s35 offen offset:2048 nt lds
 v_mfma_f32_16x16x32_bf16 a[72:75], a[48:51], a[24:27], a[72:75]
 v_mfma_f32_16x16x32_bf16 a[68:71], a[40:43], a[24:27], 0
 v_mfma_f32_16x16x32_bf16 a[68:71], a[44:47], a[28:31], a[68:71]
 buffer_load_dwordx4 v9, s[12:15], s35 offen offset:3072 nt lds
 v_mfma_f32_16x16x32_bf16 a[64:67], a[36:39], a[28:31], 0
 v_mfma_f32_16x16x32_bf16 a[64:67], a[32:35], a[24:27], a[64:67]
 v_mfma_f32_16x16x32_bf16 v[144:147], a[112:115], a[0:3], 0
 s_add_u32 m0, s32, 81920
 s_add_u32 s35, s34, 256
 v_mfma_f32_16x16x32_bf16 v[144:147], a[116:119], a[4:7], v[144:147]
 buffer_load_dwordx4 v6, s[12:15], s35 offen offset:0 nt lds
 v_mfma_f32_16x16x32_bf16 v[148:151], a[124:127], a[4:7], 0
 v_mfma_f32_16x16x32_bf16 v[148:151], a[120:123], a[0:3], v[148:151]
 v_mfma_f32_16x16x32_bf16 v[152:155], a[128:131], a[0:3], 0
 v_mfma_f32_16x16x32_bf16 v[152:155], a[132:135], a[4:7], v[152:155]
 s_waitcnt vmcnt(17)
 s_waitcnt lgkmcnt(0)
 s_barrier
 v_mfma_f32_16x16x32_bf16 v[156:159], a[140:143], a[4:7], 0
 buffer_load_dwordx4 v7, s[12:15], s35 offen offset:1024 nt lds
 v_mfma_f32_16x16x32_bf16 v[156:159], a[136:139], a[0:3], v[156:159]
 ds_read_b64_tr_b16 a[32:33], v12 offset:32768
 ds_read_b64_tr_b16 a[34:35], v12 offset:33792
 v_mfma_f32_16x16x32_bf16 v[172:175], a[136:139], a[8:11], 0
 ds_read_b64_tr_b16 a[36:37], v12 offset:40960
 v_mfma_f32_16x16x32_bf16 v[172:175], a[140:143], a[12:15], v[172:175]
 ds_read_b64_tr_b16 a[38:39], v12 offset:41984
 v_mfma_f32_16x16x32_bf16 v[168:171], a[132:135], a[12:15], 0
 buffer_load_dwordx4 v8, s[12:15], s35 offen offset:2048 nt lds
 v_mfma_f32_16x16x32_bf16 v[168:171], a[128:131], a[8:11], v[168:171]
 ds_read_b64_tr_b16 a[40:41], v13 offset:32768
 ds_read_b64_tr_b16 a[42:43], v13 offset:33792
 v_mfma_f32_16x16x32_bf16 v[164:167], a[120:123], a[8:11], 0
 v_mfma_f32_16x16x32_bf16 v[164:167], a[124:127], a[12:15], v[164:167]
 ds_read_b64_tr_b16 a[44:45], v13 offset:40960
 v_mfma_f32_16x16x32_bf16 v[160:163], a[116:119], a[12:15], 0
 buffer_load_dwordx4 v9, s[12:15], s35 offen offset:3072 nt lds
 v_mfma_f32_16x16x32_bf16 v[160:163], a[112:115], a[8:11], v[160:163]
 s_add_u32 m0, s32, 16384
 s_add_u32 s35, s33, 2097152
 ds_read_b64_tr_b16 a[46:47], v13 offset:41984
 v_mfma_f32_16x16x32_bf16 v[176:179], a[112:115], a[16:19], 0
 ds_read_b64_tr_b16 a[48:49], v14 offset:32768
 ds_read_b64_tr_b16 a[50:51], v14 offset:33792
 v_mfma_f32_16x16x32_bf16 v[176:179], a[116:119], a[20:23], v[176:179]
 ds_read_b64_tr_b16 a[52:53], v14 offset:40960
 v_mfma_f32_16x16x32_bf16 v[180:183], a[124:127], a[20:23], 0
 buffer_load_dwordx4 v2, s[8:11], s35 offen offset:0 lds
 v_mfma_f32_16x16x32_bf16 v[180:183], a[120:123], a[16:19], v[180:183]
 ds_read_b64_tr_b16 a[54:55], v14 offset:41984
 v_mfma_f32_16x16x32_bf16 v[184:187], a[128:131], a[16:19], 0
 ds_read_b64_tr_b16 a[56:57], v15 offset:32768
 v_mfma_f32_16x16x32_bf16 v[184:187], a[132:135], a[20:23], v[184:187]
 ds_read_b64_tr_b16 a[58:59], v15 offset:33792
 v_mfma_f32_16x16x32_bf16 v[188:191], a[140:143], a[20:23], 0
 buffer_load_dwordx4 v3, s[8:11], s35 offen offset:1024 lds
 v_mfma_f32_16x16x32_bf16 v[188:191], a[136:139], a[16:19], v[188:191]
 ds_read_b64_tr_b16 a[60:61], v15 offset:40960
 ds_read_b64_tr_b16 a[62:63], v15 offset:41984
 v_mfma_f32_16x16x32_bf16 v[204:207], a[136:139], a[24:27], 0
 v_mfma_f32_16x16x32_bf16 v[204:207], a[140:143], a[28:31], v[204:207]
 v_mfma_f32_16x16x32_bf16 v[200:203], a[132:135], a[28:31], 0
 buffer_load_dwordx4 v4, s[8:11], s35 offen offset:2048 lds
 v_mfma_f32_16x16x32_bf16 v[200:203], a[128:131], a[24:27], v[200:203]
 v_mfma_f32_16x16x32_bf16 v[196:199], a[120:123], a[24:27], 0
 v_mfma_f32_16x16x32_bf16 v[196:199], a[124:127], a[28:31], v[196:199]
 buffer_load_dwordx4 v5, s[8:11], s35 offen offset:3072 lds
 v_mfma_f32_16x16x32_bf16 v[192:195], a[116:119], a[28:31], 0
 v_mfma_f32_16x16x32_bf16 v[192:195], a[112:115], a[24:27], v[192:195]
 s_waitcnt lgkmcnt(0)
 v_mfma_f32_16x16x32_bf16 v[16:19], a[32:35], a[80:83], v[16:19]
 s_add_u32 m0, s32, 32768
 s_add_u32 s35, s33, 128
 v_mfma_f32_16x16x32_bf16 v[16:19], a[36:39], a[84:87], v[16:19]
 buffer_load_dwordx4 v2, s[8:11], s35 offen offset:0 lds
 v_mfma_f32_16x16x32_bf16 v[20:23], a[44:47], a[84:87], v[20:23]
 v_mfma_f32_16x16x32_bf16 v[20:23], a[40:43], a[80:83], v[20:23]
 v_mfma_f32_16x16x32_bf16 v[24:27], a[48:51], a[80:83], v[24:27]
 v_mfma_f32_16x16x32_bf16 v[24:27], a[52:55], a[84:87], v[24:27]
 s_waitcnt vmcnt(21)
 s_waitcnt lgkmcnt(0)
 s_barrier
 v_mfma_f32_16x16x32_bf16 v[28:31], a[60:63], a[84:87], v[28:31]
 ds_read_b64_tr_b16 a[112:113], v12 offset:49152
 v_mfma_f32_16x16x32_bf16 v[28:31], a[56:59], a[80:83], v[28:31]
 ds_read_b64_tr_b16 a[114:115], v12 offset:50176
 v_mfma_f32_16x16x32_bf16 v[44:47], a[56:59], a[88:91], v[44:47]
 buffer_load_dwordx4 v3, s[8:11], s35 offen offset:1024 lds
 v_mfma_f32_16x16x32_bf16 v[44:47], a[60:63], a[92:95], v[44:47]
 ds_read_b64_tr_b16 a[116:117], v12 offset:57344
 ds_read_b64_tr_b16 a[118:119], v12 offset:58368
 v_mfma_f32_16x16x32_bf16 v[40:43], a[52:55], a[92:95], v[40:43]
 ds_read_b64_tr_b16 a[120:121], v13 offset:49152
 v_mfma_f32_16x16x32_bf16 v[40:43], a[48:51], a[88:91], v[40:43]
 ds_read_b64_tr_b16 a[122:123], v13 offset:50176
 v_mfma_f32_16x16x32_bf16 v[36:39], a[40:43], a[88:91], v[36:39]
 v_mfma_f32_16x16x32_bf16 v[36:39], a[44:47], a[92:95], v[36:39]
 ds_read_b64_tr_b16 a[124:125], v13 offset:57344
 v_mfma_f32_16x16x32_bf16 v[32:35], a[36:39], a[92:95], v[32:35]
 ds_read_b64_tr_b16 a[126:127], v13 offset:58368
 v_mfma_f32_16x16x32_bf16 v[32:35], a[32:35], a[88:91], v[32:35]
 buffer_load_dwordx4 v4, s[8:11], s35 offen offset:2048 lds
 v_mfma_f32_16x16x32_bf16 v[48:51], a[32:35], a[96:99], v[48:51]
 ds_read_b64_tr_b16 a[128:129], v14 offset:49152
 ds_read_b64_tr_b16 a[130:131], v14 offset:50176
 v_mfma_f32_16x16x32_bf16 v[48:51], a[36:39], a[100:103], v[48:51]
 ds_read_b64_tr_b16 a[132:133], v14 offset:57344
 v_mfma_f32_16x16x32_bf16 v[52:55], a[44:47], a[100:103], v[52:55]
 v_mfma_f32_16x16x32_bf16 v[52:55], a[40:43], a[96:99], v[52:55]
 ds_read_b64_tr_b16 a[134:135], v14 offset:58368
 v_mfma_f32_16x16x32_bf16 v[56:59], a[48:51], a[96:99], v[56:59]
 ds_read_b64_tr_b16 a[136:137], v15 offset:49152
 v_mfma_f32_16x16x32_bf16 v[56:59], a[52:55], a[100:103], v[56:59]
 ds_read_b64_tr_b16 a[138:139], v15 offset:50176
 v_mfma_f32_16x16x32_bf16 v[60:63], a[60:63], a[100:103], v[60:63]
 buffer_load_dwordx4 v5, s[8:11], s35 offen offset:3072 lds
 v_mfma_f32_16x16x32_bf16 v[60:63], a[56:59], a[96:99], v[60:63]
 ds_read_b64_tr_b16 a[140:141], v15 offset:57344
 ds_read_b64_tr_b16 a[142:143], v15 offset:58368
 v_mfma_f32_16x16x32_bf16 v[76:79], a[56:59], a[104:107], v[76:79]
 v_mfma_f32_16x16x32_bf16 v[76:79], a[60:63], a[108:111], v[76:79]
 v_mfma_f32_16x16x32_bf16 v[72:75], a[52:55], a[108:111], v[72:75]
 v_mfma_f32_16x16x32_bf16 v[72:75], a[48:51], a[104:107], v[72:75]
 v_mfma_f32_16x16x32_bf16 v[68:71], a[40:43], a[104:107], v[68:71]
 v_mfma_f32_16x16x32_bf16 v[68:71], a[44:47], a[108:111], v[68:71]
 v_mfma_f32_16x16x32_bf16 v[64:67], a[36:39], a[108:111], v[64:67]
 v_mfma_f32_16x16x32_bf16 v[64:67], a[32:35], a[104:107], v[64:67]
 s_waitcnt lgkmcnt(0)
 v_mfma_f32_16x16x32_bf16 v[80:83], a[112:115], a[80:83], v[80:83]
 s_add_u32 m0, s32, 98304
 s_add_u32 s35, s34, 524288
 v_mfma_f32_16x16x32_bf16 v[80:83], a[116:119], a[84:87], v[80:83]
 buffer_load_dwordx4 v6, s[12:15], s35 offen offset:0 nt lds
 v_mfma_f32_16x16x32_bf16 v[84:87], a[124:127], a[84:87], v[84:87]
 v_mfma_f32_16x16x32_bf16 v[84:87], a[120:123], a[80:83], v[84:87]
 v_mfma_f32_16x16x32_bf16 v[88:91], a[128:131], a[80:83], v[88:91]
 v_mfma_f32_16x16x32_bf16 v[88:91], a[132:135], a[84:87], v[88:91]
 s_waitcnt vmcnt(21)
 s_waitcnt lgkmcnt(0)
 s_barrier
 v_mfma_f32_16x16x32_bf16 v[92:95], a[140:143], a[84:87], v[92:95]
 ds_read_b128 a[0:3], v10 offset:49152
 v_mfma_f32_16x16x32_bf16 v[92:95], a[136:139], a[80:83], v[92:95]
 v_mfma_f32_16x16x32_bf16 v[108:111], a[136:139], a[88:91], v[108:111]
 buffer_load_dwordx4 v7, s[12:15], s35 offen offset:1024 nt lds
 v_mfma_f32_16x16x32_bf16 v[108:111], a[140:143], a[92:95], v[108:111]
 ds_read_b128 a[4:7], v11 offset:49152
 v_mfma_f32_16x16x32_bf16 v[104:107], a[132:135], a[92:95], v[104:107]
 ds_read_b128 a[8:11], v10 offset:51200
 v_mfma_f32_16x16x32_bf16 v[104:107], a[128:131], a[88:91], v[104:107]
 v_mfma_f32_16x16x32_bf16 v[100:103], a[120:123], a[88:91], v[100:103]
 v_mfma_f32_16x16x32_bf16 v[100:103], a[124:127], a[92:95], v[100:103]
 ds_read_b128 a[12:15], v11 offset:51200
 v_mfma_f32_16x16x32_bf16 v[96:99], a[116:119], a[92:95], v[96:99]
 v_mfma_f32_16x16x32_bf16 v[96:99], a[112:115], a[88:91], v[96:99]
 buffer_load_dwordx4 v8, s[12:15], s35 offen offset:2048 nt lds
 v_mfma_f32_16x16x32_bf16 v[112:115], a[112:115], a[96:99], v[112:115]
 ds_read_b128 a[16:19], v10 offset:53248
 v_mfma_f32_16x16x32_bf16 v[112:115], a[116:119], a[100:103], v[112:115]
 ds_read_b128 a[20:23], v11 offset:53248
 v_mfma_f32_16x16x32_bf16 v[116:119], a[124:127], a[100:103], v[116:119]
 v_mfma_f32_16x16x32_bf16 v[116:119], a[120:123], a[96:99], v[116:119]
 v_mfma_f32_16x16x32_bf16 v[120:123], a[128:131], a[96:99], v[120:123]
 ds_read_b128 a[24:27], v10 offset:55296
 v_mfma_f32_16x16x32_bf16 v[120:123], a[132:135], a[100:103], v[120:123]
 v_mfma_f32_16x16x32_bf16 v[124:127], a[140:143], a[100:103], v[124:127]
 buffer_load_dwordx4 v9, s[12:15], s35 offen offset:3072 nt lds
 v_mfma_f32_16x16x32_bf16 v[124:127], a[136:139], a[96:99], v[124:127]
 ds_read_b128 a[28:31], v11 offset:55296
 v_mfma_f32_16x16x32_bf16 v[140:143], a[136:139], a[104:107], v[140:143]
 v_mfma_f32_16x16x32_bf16 v[140:143], a[140:143], a[108:111], v[140:143]
 v_mfma_f32_16x16x32_bf16 v[136:139], a[132:135], a[108:111], v[136:139]
 v_mfma_f32_16x16x32_bf16 v[136:139], a[128:131], a[104:107], v[136:139]
 v_mfma_f32_16x16x32_bf16 v[132:135], a[120:123], a[104:107], v[132:135]
 v_mfma_f32_16x16x32_bf16 v[132:135], a[124:127], a[108:111], v[132:135]
 v_mfma_f32_16x16x32_bf16 v[128:131], a[116:119], a[108:111], v[128:131]
 v_mfma_f32_16x16x32_bf16 v[128:131], a[112:115], a[104:107], v[128:131]
 s_waitcnt lgkmcnt(0)
 v_mfma_f32_16x16x32_bf16 v[208:211], a[112:115], a[0:3], v[208:211]
 s_add_u32 m0, s32, 114688
 s_add_u32 s35, s34, 524544
 v_mfma_f32_16x16x32_bf16 v[208:211], a[116:119], a[4:7], v[208:211]
 buffer_load_dwordx4 v6, s[12:15], s35 offen offset:0 nt lds
 v_mfma_f32_16x16x32_bf16 v[212:215], a[124:127], a[4:7], v[212:215]
 v_mfma_f32_16x16x32_bf16 v[212:215], a[120:123], a[0:3], v[212:215]
 v_mfma_f32_16x16x32_bf16 v[216:219], a[128:131], a[0:3], v[216:219]
 v_mfma_f32_16x16x32_bf16 v[216:219], a[132:135], a[4:7], v[216:219]
 s_waitcnt vmcnt(21)
 s_waitcnt lgkmcnt(0)
 s_barrier
 v_mfma_f32_16x16x32_bf16 v[220:223], a[140:143], a[4:7], v[220:223]
 ds_read_b128 a[80:83], v10 offset:0
 v_mfma_f32_16x16x32_bf16 v[220:223], a[136:139], a[0:3], v[220:223]
 v_mfma_f32_16x16x32_bf16 v[236:239], a[136:139], a[8:11], v[236:239]
 global_load_dword a254, v[0:1], off
 v_mfma_f32_16x16x32_bf16 v[236:239], a[140:143], a[12:15], v[236:239]
 ds_read_b128 a[84:87], v11 offset:0
 v_lshl_add_u64 v[0:1], s[52:53], 0, v[0:1]
 v_mfma_f32_16x16x32_bf16 v[232:235], a[132:135], a[12:15], v[232:235]
 ds_read_b128 a[88:91], v10 offset:2048
 v_mfma_f32_16x16x32_bf16 v[232:235], a[128:131], a[8:11], v[232:235]
 v_mfma_f32_16x16x32_bf16 v[228:231], a[120:123], a[8:11], v[228:231]
 buffer_load_dwordx4 v7, s[12:15], s35 offen offset:1024 nt lds
 v_mfma_f32_16x16x32_bf16 v[228:231], a[124:127], a[12:15], v[228:231]
 ds_read_b128 a[92:95], v11 offset:2048
 v_mfma_f32_16x16x32_bf16 v[224:227], a[116:119], a[12:15], v[224:227]
 v_mfma_f32_16x16x32_bf16 v[224:227], a[112:115], a[8:11], v[224:227]
 ds_read_b128 a[96:99], v10 offset:4096
 v_mfma_f32_16x16x32_bf16 v[240:243], a[112:115], a[16:19], v[240:243]
 buffer_load_dwordx4 v8, s[12:15], s35 offen offset:2048 nt lds
 v_mfma_f32_16x16x32_bf16 v[240:243], a[116:119], a[20:23], v[240:243]
 ds_read_b128 a[100:103], v11 offset:4096
 v_mfma_f32_16x16x32_bf16 v[244:247], a[124:127], a[20:23], v[244:247]
 v_mfma_f32_16x16x32_bf16 v[244:247], a[120:123], a[16:19], v[244:247]
 v_mfma_f32_16x16x32_bf16 v[248:251], a[128:131], a[16:19], v[248:251]
 ds_read_b128 a[104:107], v10 offset:6144
 v_mfma_f32_16x16x32_bf16 v[248:251], a[132:135], a[20:23], v[248:251]
 v_mfma_f32_16x16x32_bf16 v[252:255], a[140:143], a[20:23], v[252:255]
 buffer_load_dwordx4 v9, s[12:15], s35 offen offset:3072 nt lds
 v_mfma_f32_16x16x32_bf16 v[252:255], a[136:139], a[16:19], v[252:255]
 ds_read_b128 a[108:111], v11 offset:6144
 v_mfma_f32_16x16x32_bf16 a[76:79], a[136:139], a[24:27], a[76:79]
 v_mfma_f32_16x16x32_bf16 a[76:79], a[140:143], a[28:31], a[76:79]
 v_mfma_f32_16x16x32_bf16 a[72:75], a[132:135], a[28:31], a[72:75]
 v_mfma_f32_16x16x32_bf16 a[72:75], a[128:131], a[24:27], a[72:75]
 v_mfma_f32_16x16x32_bf16 a[68:71], a[120:123], a[24:27], a[68:71]
 v_mfma_f32_16x16x32_bf16 a[68:71], a[124:127], a[28:31], a[68:71]
 v_mfma_f32_16x16x32_bf16 a[64:67], a[116:119], a[28:31], a[64:67]
 v_mfma_f32_16x16x32_bf16 a[64:67], a[112:115], a[24:27], a[64:67]
 v_mfma_f32_16x16x32_bf16 v[144:147], a[32:35], a[0:3], v[144:147]
 s_add_u32 m0, s32, 49152
 s_add_u32 s35, s33, 2097280
 v_mfma_f32_16x16x32_bf16 v[144:147], a[36:39], a[4:7], v[144:147]
 buffer_load_dwordx4 v2, s[8:11], s35 offen offset:0 lds
 v_mfma_f32_16x16x32_bf16 v[148:151], a[44:47], a[4:7], v[148:151]
 v_mfma_f32_16x16x32_bf16 v[148:151], a[40:43], a[0:3], v[148:151]
 v_mfma_f32_16x16x32_bf16 v[152:155], a[48:51], a[0:3], v[152:155]
 v_mfma_f32_16x16x32_bf16 v[152:155], a[52:55], a[4:7], v[152:155]
 s_waitcnt vmcnt(22)
 s_waitcnt lgkmcnt(0)
 s_barrier
 v_mfma_f32_16x16x32_bf16 v[156:159], a[60:63], a[4:7], v[156:159]
 ds_read_b64_tr_b16 a[112:113], v12 offset:0
 v_mfma_f32_16x16x32_bf16 v[156:159], a[56:59], a[0:3], v[156:159]
 ds_read_b64_tr_b16 a[114:115], v12 offset:1024
 v_mfma_f32_16x16x32_bf16 v[172:175], a[56:59], a[8:11], v[172:175]
 buffer_load_dwordx4 v3, s[8:11], s35 offen offset:1024 lds
 v_mfma_f32_16x16x32_bf16 v[172:175], a[60:63], a[12:15], v[172:175]
 ds_read_b64_tr_b16 a[116:117], v12 offset:8192
 ds_read_b64_tr_b16 a[118:119], v12 offset:9216
 v_mfma_f32_16x16x32_bf16 v[168:171], a[52:55], a[12:15], v[168:171]
 ds_read_b64_tr_b16 a[120:121], v13 offset:0
 v_mfma_f32_16x16x32_bf16 v[168:171], a[48:51], a[8:11], v[168:171]
 ds_read_b64_tr_b16 a[122:123], v13 offset:1024
 v_mfma_f32_16x16x32_bf16 v[164:167], a[40:43], a[8:11], v[164:167]
 v_mfma_f32_16x16x32_bf16 v[164:167], a[44:47], a[12:15], v[164:167]
 ds_read_b64_tr_b16 a[124:125], v13 offset:8192
 v_mfma_f32_16x16x32_bf16 v[160:163], a[36:39], a[12:15], v[160:163]
 ds_read_b64_tr_b16 a[126:127], v13 offset:9216
 v_mfma_f32_16x16x32_bf16 v[160:163], a[32:35], a[8:11], v[160:163]
 buffer_load_dwordx4 v4, s[8:11], s35 offen offset:2048 lds
 v_mfma_f32_16x16x32_bf16 v[176:179], a[32:35], a[16:19], v[176:179]
 ds_read_b64_tr_b16 a[128:129], v14 offset:0
 ds_read_b64_tr_b16 a[130:131], v14 offset:1024
 v_mfma_f32_16x16x32_bf16 v[176:179], a[36:39], a[20:23], v[176:179]
 ds_read_b64_tr_b16 a[132:133], v14 offset:8192
 v_mfma_f32_16x16x32_bf16 v[180:183], a[44:47], a[20:23], v[180:183]
 v_mfma_f32_16x16x32_bf16 v[180:183], a[40:43], a[16:19], v[180:183]
 ds_read_b64_tr_b16 a[134:135], v14 offset:9216
 v_mfma_f32_16x16x32_bf16 v[184:187], a[48:51], a[16:19], v[184:187]
 ds_read_b64_tr_b16 a[136:137], v15 offset:0
 v_mfma_f32_16x16x32_bf16 v[184:187], a[52:55], a[20:23], v[184:187]
 ds_read_b64_tr_b16 a[138:139], v15 offset:1024
 v_mfma_f32_16x16x32_bf16 v[188:191], a[60:63], a[20:23], v[188:191]
 buffer_load_dwordx4 v5, s[8:11], s35 offen offset:3072 lds
 v_mfma_f32_16x16x32_bf16 v[188:191], a[56:59], a[16:19], v[188:191]
 ds_read_b64_tr_b16 a[140:141], v15 offset:8192
 ds_read_b64_tr_b16 a[142:143], v15 offset:9216
 v_mfma_f32_16x16x32_bf16 v[204:207], a[56:59], a[24:27], v[204:207]
 v_mfma_f32_16x16x32_bf16 v[204:207], a[60:63], a[28:31], v[204:207]
 v_mfma_f32_16x16x32_bf16 v[200:203], a[52:55], a[28:31], v[200:203]
 v_mfma_f32_16x16x32_bf16 v[200:203], a[48:51], a[24:27], v[200:203]
 v_mfma_f32_16x16x32_bf16 v[196:199], a[40:43], a[24:27], v[196:199]
 v_mfma_f32_16x16x32_bf16 v[196:199], a[44:47], a[28:31], v[196:199]
 v_mfma_f32_16x16x32_bf16 v[192:195], a[36:39], a[28:31], v[192:195]
 s_waitcnt vmcnt(17)
 s_waitcnt lgkmcnt(0)
 s_barrier
 v_mfma_f32_16x16x32_bf16 v[192:195], a[32:35], a[24:27], v[192:195]
 s_add_u32 s33, s33, 256
 s_add_u32 s34, s34, 1048576
 .p2align 6
L_loopK:
 v_mfma_f32_16x16x32_bf16 v[16:19], a[112:115], a[80:83], v[16:19]
 ds_read_b64_tr_b16 a[32:33], v12 offset:16384
 v_mfma_f32_16x16x32_bf16 v[16:19], a[116:119], a[84:87], v[16:19]
 ds_read_b64_tr_b16 a[34:35], v12 offset:17408
 v_mfma_f32_16x16x32_bf16 v[20:23], a[124:127], a[84:87], v[20:23]
 ds_read_b64_tr_b16 a[36:37], v12 offset:24576
 v_mfma_f32_16x16x32_bf16 v[20:23], a[120:123], a[80:83], v[20:23]
 ds_read_b64_tr_b16 a[38:39], v12 offset:25600
 v_mfma_f32_16x16x32_bf16 v[24:27], a[128:131], a[80:83], v[24:27]
 ds_read_b64_tr_b16 a[40:41], v13 offset:16384
 v_mfma_f32_16x16x32_bf16 v[24:27], a[132:135], a[84:87], v[24:27]
 ds_read_b64_tr_b16 a[42:43], v13 offset:17408
 v_mfma_f32_16x16x32_bf16 v[28:31], a[140:143], a[84:87], v[28:31]
 ds_read_b64_tr_b16 a[44:45], v13 offset:24576
 v_mfma_f32_16x16x32_bf16 v[28:31], a[136:139], a[80:83], v[28:31]
 ds_read_b64_tr_b16 a[46:47], v13 offset:25600
 v_mfma_f32_16x16x32_bf16 v[44:47], a[136:139], a[88:91], v[44:47]
 ds_read_b64_tr_b16 a[48:49], v14 offset:16384
 v_mfma_f32_16x16x32_bf16 v[44:47], a[140:143], a[92:95], v[44:47]
 ds_read_b64_tr_b16 a[50:51], v14 offset:17408
 v_mfma_f32_16x16x32_bf16 v[40:43], a[132:135], a[92:95], v[40:43]
 ds_read_b64_tr_b16 a[52:53], v14 offset:24576
 v_mfma_f32_16x16x32_bf16 v[40:43], a[128:131], a[88:91], v[40:43]
 ds_read_b64_tr_b16 a[54:55], v14 offset:25600
 v_mfma_f32_16x16x32_bf16 v[36:39], a[120:123], a[88:91], v[36:39]
 ds_read_b64_tr_b16 a[56:57], v15 offset:16384
 v_mfma_f32_16x16x32_bf16 v[36:39], a[124:127], a[92:95], v[36:39]
 ds_read_b64_tr_b16 a[58:59], v15 offset:17408
 v_mfma_f32_16x16x32_bf16 v[32:35], a[116:119], a[92:95], v[32:35]
 ds_read_b64_tr_b16 a[60:61], v15 offset:24576
 v_mfma_f32_16x16x32_bf16 v[32:35], a[112:115], a[88:91], v[32:35]
 s_add_u32 m0, s32, 0
 ds_read_b64_tr_b16 a[62:63], v15 offset:25600
 v_mfma_f32_16x16x32_bf16 v[48:51], a[112:115], a[96:99], v[48:51]
 s_add_u32 s35, s33, 0
 v_mfma_f32_16x16x32_bf16 v[48:51], a[116:119], a[100:103], v[48:51]
 buffer_load_dwordx4 v2, s[8:11], s35 offen offset:0 lds
 v_mfma_f32_16x16x32_bf16 v[52:55], a[124:127], a[100:103], v[52:55]
 v_mfma_f32_16x16x32_bf16 v[52:55], a[120:123], a[96:99], v[52:55]
 v_mfma_f32_16x16x32_bf16 v[56:59], a[128:131], a[96:99], v[56:59]
 v_mfma_f32_16x16x32_bf16 v[56:59], a[132:135], a[100:103], v[56:59]
 buffer_load_dwordx4 v3, s[8:11], s35 offen offset:1024 lds
 v_mfma_f32_16x16x32_bf16 v[60:63], a[140:143], a[100:103], v[60:63]
 v_mfma_f32_16x16x32_bf16 v[60:63], a[136:139], a[96:99], v[60:63]
 v_mfma_f32_16x16x32_bf16 v[76:79], a[136:139], a[104:107], v[76:79]
 v_mfma_f32_16x16x32_bf16 v[76:79], a[140:143], a[108:111], v[76:79]
 buffer_load_dwordx4 v4, s[8:11], s35 offen offset:2048 lds
 v_mfma_f32_16x16x32_bf16 v[72:75], a[132:135], a[108:111], v[72:75]
 v_mfma_f32_16x16x32_bf16 v[72:75], a[128:131], a[104:107], v[72:75]
 v_mfma_f32_16x16x32_bf16 v[68:71], a[120:123], a[104:107], v[68:71]
 v_mfma_f32_16x16x32_bf16 v[68:71], a[124:127], a[108:111], v[68:71]
 buffer_load_dwordx4 v5, s[8:11], s35 offen offset:3072 lds
 v_mfma_f32_16x16x32_bf16 v[64:67], a[116:119], a[108:111], v[64:67]
 s_waitcnt lgkmcnt(0)
 v_mfma_f32_16x16x32_bf16 v[64:67], a[112:115], a[104:107], v[64:67]
 v_mfma_f32_16x16x32_bf16 v[80:83], a[32:35], a[80:83], v[80:83]
 ds_read_b128 a[0:3], v10 offset:16384
 v_mfma_f32_16x16x32_bf16 v[80:83], a[36:39], a[84:87], v[80:83]
 v_mfma_f32_16x16x32_bf16 v[84:87], a[44:47], a[84:87], v[84:87]
 ds_read_b128 a[4:7], v11 offset:16384
 v_mfma_f32_16x16x32_bf16 v[84:87], a[40:43], a[80:83], v[84:87]
 v_mfma_f32_16x16x32_bf16 v[88:91], a[48:51], a[80:83], v[88:91]
 ds_read_b128 a[8:11], v10 offset:18432
 v_mfma_f32_16x16x32_bf16 v[88:91], a[52:55], a[84:87], v[88:91]
 v_mfma_f32_16x16x32_bf16 v[92:95], a[60:63], a[84:87], v[92:95]
 ds_read_b128 a[12:15], v11 offset:18432
 v_mfma_f32_16x16x32_bf16 v[92:95], a[56:59], a[80:83], v[92:95]
 v_mfma_f32_16x16x32_bf16 v[108:111], a[56:59], a[88:91], v[108:111]
 ds_read_b128 a[16:19], v10 offset:20480
 v_mfma_f32_16x16x32_bf16 v[108:111], a[60:63], a[92:95], v[108:111]
 v_mfma_f32_16x16x32_bf16 v[104:107], a[52:55], a[92:95], v[104:107]
 ds_read_b128 a[20:23], v11 offset:20480
 v_mfma_f32_16x16x32_bf16 v[104:107], a[48:51], a[88:91], v[104:107]
 v_mfma_f32_16x16x32_bf16 v[100:103], a[40:43], a[88:91], v[100:103]
 ds_read_b128 a[24:27], v10 offset:22528
 v_mfma_f32_16x16x32_bf16 v[100:103], a[44:47], a[92:95], v[100:103]
 v_mfma_f32_16x16x32_bf16 v[96:99], a[36:39], a[92:95], v[96:99]
 ds_read_b128 a[28:31], v11 offset:22528
 v_mfma_f32_16x16x32_bf16 v[96:99], a[32:35], a[88:91], v[96:99]
 s_add_u32 m0, s32, 65536
 v_mfma_f32_16x16x32_bf16 v[112:115], a[32:35], a[96:99], v[112:115]
 s_add_u32 s35, s34, 0
 v_mfma_f32_16x16x32_bf16 v[112:115], a[36:39], a[100:103], v[112:115]
 buffer_load_dwordx4 v6, s[12:15], s35 offen offset:0 nt lds
 v_mfma_f32_16x16x32_bf16 v[116:119], a[44:47], a[100:103], v[116:119]
 v_mfma_f32_16x16x32_bf16 v[116:119], a[40:43], a[96:99], v[116:119]
 v_mfma_f32_16x16x32_bf16 v[120:123], a[48:51], a[96:99], v[120:123]
 v_mfma_f32_16x16x32_bf16 v[120:123], a[52:55], a[100:103], v[120:123]
 buffer_load_dwordx4 v7, s[12:15], s35 offen offset:1024 nt lds
 v_mfma_f32_16x16x32_bf16 v[124:127], a[60:63], a[100:103], v[124:127]
 v_mfma_f32_16x16x32_bf16 v[124:127], a[56:59], a[96:99], v[124:127]
 v_mfma_f32_16x16x32_bf16 v[140:143], a[56:59], a[104:107], v[140:143]
 v_mfma_f32_16x16x32_bf16 v[140:143], a[60:63], a[108:111], v[140:143]
 buffer_load_dwordx4 v8, s[12:15], s35 offen offset:2048 nt lds
 v_mfma_f32_16x16x32_bf16 v[136:139], a[52:55], a[108:111], v[136:139]
 v_mfma_f32_16x16x32_bf16 v[136:139], a[48:51], a[104:107], v[136:139]
 v_mfma_f32_16x16x32_bf16 v[132:135], a[40:43], a[104:107], v[132:135]
 v_mfma_f32_16x16x32_bf16 v[132:135], a[44:47], a[108:111], v[132:135]
 buffer_load_dwordx4 v9, s[12:15], s35 offen offset:3072 nt lds
 v_mfma_f32_16x16x32_bf16 v[128:131], a[36:39], a[108:111], v[128:131]
 s_waitcnt vmcnt(16) lgkmcnt(0)
 s_barrier
 v_mfma_f32_16x16x32_bf16 v[128:131], a[32:35], a[104:107], v[128:131]
 v_mfma_f32_16x16x32_bf16 v[208:211], a[32:35], a[0:3], v[208:211]
 ds_read_b128 a[80:83], v10 offset:32768
 v_mfma_f32_16x16x32_bf16 v[208:211], a[36:39], a[4:7], v[208:211]
 global_load_dword a254, v[0:1], off
 v_mfma_f32_16x16x32_bf16 v[212:215], a[44:47], a[4:7], v[212:215]
 ds_read_b128 a[84:87], v11 offset:32768
 v_mfma_f32_16x16x32_bf16 v[212:215], a[40:43], a[0:3], v[212:215]
 v_lshl_add_u64 v[0:1], s[52:53], 0, v[0:1]
 v_mfma_f32_16x16x32_bf16 v[216:219], a[48:51], a[0:3], v[216:219]
 ds_read_b128 a[88:91], v10 offset:34816
 v_mfma_f32_16x16x32_bf16 v[216:219], a[52:55], a[4:7], v[216:219]
 v_mfma_f32_16x16x32_bf16 v[220:223], a[60:63], a[4:7], v[220:223]
 ds_read_b128 a[92:95], v11 offset:34816
 v_mfma_f32_16x16x32_bf16 v[220:223], a[56:59], a[0:3], v[220:223]
 v_mfma_f32_16x16x32_bf16 v[236:239], a[56:59], a[8:11], v[236:239]
 ds_read_b128 a[96:99], v10 offset:36864
 v_mfma_f32_16x16x32_bf16 v[236:239], a[60:63], a[12:15], v[236:239]
 v_mfma_f32_16x16x32_bf16 v[232:235], a[52:55], a[12:15], v[232:235]
 ds_read_b128 a[100:103], v11 offset:36864
 v_mfma_f32_16x16x32_bf16 v[232:235], a[48:51], a[8:11], v[232:235]
 v_mfma_f32_16x16x32_bf16 v[228:231], a[40:43], a[8:11], v[228:231]
 ds_read_b128 a[104:107], v10 offset:38912
 v_mfma_f32_16x16x32_bf16 v[228:231], a[44:47], a[12:15], v[228:231]
 v_mfma_f32_16x16x32_bf16 v[224:227], a[36:39], a[12:15], v[224:227]
 ds_read_b128 a[108:111], v11 offset:38912
 v_mfma_f32_16x16x32_bf16 v[224:227], a[32:35], a[8:11], v[224:227]
 s_add_u32 m0, s32, 81920
 v_mfma_f32_16x16x32_bf16 v[240:243], a[32:35], a[16:19], v[240:243]
 s_add_u32 s35, s34, 256
 v_mfma_f32_16x16x32_bf16 v[240:243], a[36:39], a[20:23], v[240:243]
 buffer_load_dwordx4 v6, s[12:15], s35 offen offset:0 nt lds
 v_mfma_f32_16x16x32_bf16 v[244:247], a[44:47], a[20:23], v[244:247]
 v_mfma_f32_16x16x32_bf16 v[244:247], a[40:43], a[16:19], v[244:247]
 v_mfma_f32_16x16x32_bf16 v[248:251], a[48:51], a[16:19], v[248:251]
 v_mfma_f32_16x16x32_bf16 v[248:251], a[52:55], a[20:23], v[248:251]
 buffer_load_dwordx4 v7, s[12:15], s35 offen offset:1024 nt lds
 v_mfma_f32_16x16x32_bf16 v[252:255], a[60:63], a[20:23], v[252:255]
 v_mfma_f32_16x16x32_bf16 v[252:255], a[56:59], a[16:19], v[252:255]
 v_mfma_f32_16x16x32_bf16 a[76:79], a[56:59], a[24:27], a[76:79]
 v_mfma_f32_16x16x32_bf16 a[76:79], a[60:63], a[28:31], a[76:79]
 buffer_load_dwordx4 v8, s[12:15], s35 offen offset:2048 nt lds
 v_mfma_f32_16x16x32_bf16 a[72:75], a[52:55], a[28:31], a[72:75]
 v_mfma_f32_16x16x32_bf16 a[72:75], a[48:51], a[24:27], a[72:75]
 v_mfma_f32_16x16x32_bf16 a[68:71], a[40:43], a[24:27], a[68:71]
 v_mfma_f32_16x16x32_bf16 a[68:71], a[44:47], a[28:31], a[68:71]
 buffer_load_dwordx4 v9, s[12:15], s35 offen offset:3072 nt lds
 v_mfma_f32_16x16x32_bf16 a[64:67], a[36:39], a[28:31], a[64:67]
 s_waitcnt lgkmcnt(0)
 v_mfma_f32_16x16x32_bf16 a[64:67], a[32:35], a[24:27], a[64:67]
 v_mfma_f32_16x16x32_bf16 v[144:147], a[112:115], a[0:3], v[144:147]
 ds_read_b64_tr_b16 a[32:33], v12 offset:32768
 v_mfma_f32_16x16x32_bf16 v[144:147], a[116:119], a[4:7], v[144:147]
 ds_read_b64_tr_b16 a[34:35], v12 offset:33792
 v_mfma_f32_16x16x32_bf16 v[148:151], a[124:127], a[4:7], v[148:151]
 ds_read_b64_tr_b16 a[36:37], v12 offset:40960
 v_mfma_f32_16x16x32_bf16 v[148:151], a[120:123], a[0:3], v[148:151]
 ds_read_b64_tr_b16 a[38:39], v12 offset:41984
 v_mfma_f32_16x16x32_bf16 v[152:155], a[128:131], a[0:3], v[152:155]
 ds_read_b64_tr_b16 a[40:41], v13 offset:32768
 v_mfma_f32_16x16x32_bf16 v[152:155], a[132:135], a[4:7], v[152:155]
 ds_read_b64_tr_b16 a[42:43], v13 offset:33792
 v_mfma_f32_16x16x32_bf16 v[156:159], a[140:143], a[4:7], v[156:159]
 ds_read_b64_tr_b16 a[44:45], v13 offset:40960
 v_mfma_f32_16x16x32_bf16 v[156:159], a[136:139], a[0:3], v[156:159]
 ds_read_b64_tr_b16 a[46:47], v13 offset:41984
 v_mfma_f32_16x16x32_bf16 v[172:175], a[136:139], a[8:11], v[172:175]
 ds_read_b64_tr_b16 a[48:49], v14 offset:32768
 v_mfma_f32_16x16x32_bf16 v[172:175], a[140:143], a[12:15], v[172:175]
 ds_read_b64_tr_b16 a[50:51], v14 offset:33792
 v_mfma_f32_16x16x32_bf16 v[168:171], a[132:135], a[12:15], v[168:171]
 ds_read_b64_tr_b16 a[52:53], v14 offset:40960
 v_mfma_f32_16x16x32_bf16 v[168:171], a[128:131], a[8:11], v[168:171]
 ds_read_b64_tr_b16 a[54:55], v14 offset:41984
 v_mfma_f32_16x16x32_bf16 v[164:167], a[120:123], a[8:11], v[164:167]
 ds_read_b64_tr_b16 a[56:57], v15 offset:32768
 v_mfma_f32_16x16x32_bf16 v[164:167], a[124:127], a[12:15], v[164:167]
 ds_read_b64_tr_b16 a[58:59], v15 offset:33792
 v_mfma_f32_16x16x32_bf16 v[160:163], a[116:119], a[12:15], v[160:163]
 ds_read_b64_tr_b16 a[60:61], v15 offset:40960
 v_mfma_f32_16x16x32_bf16 v[160:163], a[112:115], a[8:11], v[160:163]
 s_add_u32 m0, s32, 16384
 ds_read_b64_tr_b16 a[62:63], v15 offset:41984
 v_mfma_f32_16x16x32_bf16 v[176:179], a[112:115], a[16:19], v[176:179]
 s_add_u32 s35, s33, 2097152
 v_mfma_f32_16x16x32_bf16 v[176:179], a[116:119], a[20:23], v[176:179]
 buffer_load_dwordx4 v2, s[8:11], s35 offen offset:0 lds
 v_mfma_f32_16x16x32_bf16 v[180:183], a[124:127], a[20:23], v[180:183]
 v_mfma_f32_16x16x32_bf16 v[180:183], a[120:123], a[16:19], v[180:183]
 v_mfma_f32_16x16x32_bf16 v[184:187], a[128:131], a[16:19], v[184:187]
 v_mfma_f32_16x16x32_bf16 v[184:187], a[132:135], a[20:23], v[184:187]
 buffer_load_dwordx4 v3, s[8:11], s35 offen offset:1024 lds
 v_mfma_f32_16x16x32_bf16 v[188:191], a[140:143], a[20:23], v[188:191]
 v_mfma_f32_16x16x32_bf16 v[188:191], a[136:139], a[16:19], v[188:191]
 v_mfma_f32_16x16x32_bf16 v[204:207], a[136:139], a[24:27], v[204:207]
 v_mfma_f32_16x16x32_bf16 v[204:207], a[140:143], a[28:31], v[204:207]
 buffer_load_dwordx4 v4, s[8:11], s35 offen offset:2048 lds
 v_mfma_f32_16x16x32_bf16 v[200:203], a[132:135], a[28:31], v[200:203]
 v_mfma_f32_16x16x32_bf16 v[200:203], a[128:131], a[24:27], v[200:203]
 v_mfma_f32_16x16x32_bf16 v[196:199], a[120:123], a[24:27], v[196:199]
 v_mfma_f32_16x16x32_bf16 v[196:199], a[124:127], a[28:31], v[196:199]
 buffer_load_dwordx4 v5, s[8:11], s35 offen offset:3072 lds
 v_mfma_f32_16x16x32_bf16 v[192:195], a[116:119], a[28:31], v[192:195]
 s_waitcnt vmcnt(16) lgkmcnt(0)
 s_barrier
 v_mfma_f32_16x16x32_bf16 v[192:195], a[112:115], a[24:27], v[192:195]
 v_mfma_f32_16x16x32_bf16 v[16:19], a[32:35], a[80:83], v[16:19]
 ds_read_b64_tr_b16 a[112:113], v12 offset:49152
 v_mfma_f32_16x16x32_bf16 v[16:19], a[36:39], a[84:87], v[16:19]
 ds_read_b64_tr_b16 a[114:115], v12 offset:50176
 v_mfma_f32_16x16x32_bf16 v[20:23], a[44:47], a[84:87], v[20:23]
 ds_read_b64_tr_b16 a[116:117], v12 offset:57344
 v_mfma_f32_16x16x32_bf16 v[20:23], a[40:43], a[80:83], v[20:23]
 ds_read_b64_tr_b16 a[118:119], v12 offset:58368
 v_mfma_f32_16x16x32_bf16 v[24:27], a[48:51], a[80:83], v[24:27]
 ds_read_b64_tr_b16 a[120:121], v13 offset:49152
 v_mfma_f32_16x16x32_bf16 v[24:27], a[52:55], a[84:87], v[24:27]
 ds_read_b64_tr_b16 a[122:123], v13 offset:50176
 v_mfma_f32_16x16x32_bf16 v[28:31], a[60:63], a[84:87], v[28:31]
 ds_read_b64_tr_b16 a[124:125], v13 offset:57344
 v_mfma_f32_16x16x32_bf16 v[28:31], a[56:59], a[80:83], v[28:31]
 ds_read_b64_tr_b16 a[126:127], v13 offset:58368
 v_mfma_f32_16x16x32_bf16 v[44:47], a[56:59], a[88:91], v[44:47]
 ds_read_b64_tr_b16 a[128:129], v14 offset:49152
 v_mfma_f32_16x16x32_bf16 v[44:47], a[60:63], a[92:95], v[44:47]
 ds_read_b64_tr_b16 a[130:131], v14 offset:50176
 v_mfma_f32_16x16x32_bf16 v[40:43], a[52:55], a[92:95], v[40:43]
 ds_read_b64_tr_b16 a[132:133], v14 offset:57344
 v_mfma_f32_16x16x32_bf16 v[40:43], a[48:51], a[88:91], v[40:43]
 ds_read_b64_tr_b16 a[134:135], v14 offset:58368
 v_mfma_f32_16x16x32_bf16 v[36:39], a[40:43], a[88:91], v[36:39]
 ds_read_b64_tr_b16 a[136:137], v15 offset:49152
 v_mfma_f32_16x16x32_bf16 v[36:39], a[44:47], a[92:95], v[36:39]
 ds_read_b64_tr_b16 a[138:139], v15 offset:50176
 v_mfma_f32_16x16x32_bf16 v[32:35], a[36:39], a[92:95], v[32:35]
 ds_read_b64_tr_b16 a[140:141], v15 offset:57344
 v_mfma_f32_16x16x32_bf16 v[32:35], a[32:35], a[88:91], v[32:35]
 s_add_u32 m0, s32, 32768
 ds_read_b64_tr_b16 a[142:143], v15 offset:58368
 v_mfma_f32_16x16x32_bf16 v[48:51], a[32:35], a[96:99], v[48:51]
 s_add_u32 s35, s33, 128
 v_mfma_f32_16x16x32_bf16 v[48:51], a[36:39], a[100:103], v[48:51]
 buffer_load_dwordx4 v2, s[8:11], s35 offen offset:0 lds
 v_mfma_f32_16x16x32_bf16 v[52:55], a[44:47], a[100:103], v[52:55]
 v_mfma_f32_16x16x32_bf16 v[52:55], a[40:43], a[96:99], v[52:55]
 v_mfma_f32_16x16x32_bf16 v[56:59], a[48:51], a[96:99], v[56:59]
 v_mfma_f32_16x16x32_bf16 v[56:59], a[52:55], a[100:103], v[56:59]
 buffer_load_dwordx4 v3, s[8:11], s35 offen offset:1024 lds
 v_mfma_f32_16x16x32_bf16 v[60:63], a[60:63], a[100:103], v[60:63]
 v_mfma_f32_16x16x32_bf16 v[60:63], a[56:59], a[96:99], v[60:63]
 v_mfma_f32_16x16x32_bf16 v[76:79], a[56:59], a[104:107], v[76:79]
 v_mfma_f32_16x16x32_bf16 v[76:79], a[60:63], a[108:111], v[76:79]
 buffer_load_dwordx4 v4, s[8:11], s35 offen offset:2048 lds
 v_mfma_f32_16x16x32_bf16 v[72:75], a[52:55], a[108:111], v[72:75]
 v_mfma_f32_16x16x32_bf16 v[72:75], a[48:51], a[104:107], v[72:75]
 v_mfma_f32_16x16x32_bf16 v[68:71], a[40:43], a[104:107], v[68:71]
 v_mfma_f32_16x16x32_bf16 v[68:71], a[44:47], a[108:111], v[68:71]
 buffer_load_dwordx4 v5, s[8:11], s35 offen offset:3072 lds
 v_mfma_f32_16x16x32_bf16 v[64:67], a[36:39], a[108:111], v[64:67]
 s_waitcnt lgkmcnt(0)
 v_mfma_f32_16x16x32_bf16 v[64:67], a[32:35], a[104:107], v[64:67]
 v_mfma_f32_16x16x32_bf16 v[80:83], a[112:115], a[80:83], v[80:83]
 ds_read_b128 a[0:3], v10 offset:49152
 v_mfma_f32_16x16x32_bf16 v[80:83], a[116:119], a[84:87], v[80:83]
 v_mfma_f32_16x16x32_bf16 v[84:87], a[124:127], a[84:87], v[84:87]
 ds_read_b128 a[4:7], v11 offset:49152
 v_mfma_f32_16x16x32_bf16 v[84:87], a[120:123], a[80:83], v[84:87]
 v_mfma_f32_16x16x32_bf16 v[88:91], a[128:131], a[80:83], v[88:91]
 ds_read_b128 a[8:11], v10 offset:51200
 v_mfma_f32_16x16x32_bf16 v[88:91], a[132:135], a[84:87], v[88:91]
 v_mfma_f32_16x16x32_bf16 v[92:95], a[140:143], a[84:87], v[92:95]
 ds_read_b128 a[12:15], v11 offset:51200
 v_mfma_f32_16x16x32_bf16 v[92:95], a[136:139], a[80:83], v[92:95]
 v_mfma_f32_16x16x32_bf16 v[108:111], a[136:139], a[88:91], v[108:111]
 ds_read_b128 a[16:19], v10 offset:53248
 v_mfma_f32_16x16x32_bf16 v[108:111], a[140:143], a[92:95], v[108:111]
 v_mfma_f32_16x16x32_bf16 v[104:107], a[132:135], a[92:95], v[104:107]
 ds_read_b128 a[20:23], v11 offset:53248
 v_mfma_f32_16x16x32_bf16 v[104:107], a[128:131], a[88:91], v[104:107]
 v_mfma_f32_16x16x32_bf16 v[100:103], a[120:123], a[88:91], v[100:103]
 ds_read_b128 a[24:27], v10 offset:55296
 v_mfma_f32_16x16x32_bf16 v[100:103], a[124:127], a[92:95], v[100:103]
 v_mfma_f32_16x16x32_bf16 v[96:99], a[116:119], a[92:95], v[96:99]
 ds_read_b128 a[28:31], v11 offset:55296
 v_mfma_f32_16x16x32_bf16 v[96:99], a[112:115], a[88:91], v[96:99]
 s_add_u32 m0, s32, 98304
 v_mfma_f32_16x16x32_bf16 v[112:115], a[112:115], a[96:99], v[112:115]
 s_add_u32 s35, s34, 524288
 v_mfma_f32_16x16x32_bf16 v[112:115], a[116:119], a[100:103], v[112:115]
 buffer_load_dwordx4 v6, s[12:15], s35 offen offset:0 nt lds
 v_mfma_f32_16x16x32_bf16 v[116:119], a[124:127], a[100:103], v[116:119]
 v_mfma_f32_16x16x32_bf16 v[116:119], a[120:123], a[96:99], v[116:119]
 v_mfma_f32_16x16x32_bf16 v[120:123], a[128:131], a[96:99], v[120:123]
 v_mfma_f32_16x16x32_bf16 v[120:123], a[132:135], a[100:103], v[120:123]
 buffer_load_dwordx4 v7, s[12:15], s35 offen offset:1024 nt lds
 v_mfma_f32_16x16x32_bf16 v[124:127], a[140:143], a[100:103], v[124:127]
 v_mfma_f32_16x16x32_bf16 v[124:127], a[136:139], a[96:99], v[124:127]
 v_mfma_f32_16x16x32_bf16 v[140:143], a[136:139], a[104:107], v[140:143]
 v_mfma_f32_16x16x32_bf16 v[140:143], a[140:143], a[108:111], v[140:143]
 buffer_load_dwordx4 v8, s[12:15], s35 offen offset:2048 nt lds
 v_mfma_f32_16x16x32_bf16 v[136:139], a[132:135], a[108:111], v[136:139]
 v_mfma_f32_16x16x32_bf16 v[136:139], a[128:131], a[104:107], v[136:139]
 v_mfma_f32_16x16x32_bf16 v[132:135], a[120:123], a[104:107], v[132:135]
 v_mfma_f32_16x16x32_bf16 v[132:135], a[124:127], a[108:111], v[132:135]
 buffer_load_dwordx4 v9, s[12:15], s35 offen offset:3072 nt lds
 v_mfma_f32_16x16x32_bf16 v[128:131], a[116:119], a[108:111], v[128:131]
 s_waitcnt vmcnt(16) lgkmcnt(0)
 s_barrier
 v_mfma_f32_16x16x32_bf16 v[128:131], a[112:115], a[104:107], v[128:131]
 v_mfma_f32_16x16x32_bf16 v[208:211], a[112:115], a[0:3], v[208:211]
 ds_read_b128 a[80:83], v10 offset:0
 v_mfma_f32_16x16x32_bf16 v[208:211], a[116:119], a[4:7], v[208:211]
 v_mfma_f32_16x16x32_bf16 v[212:215], a[124:127], a[4:7], v[212:215]
 ds_read_b128 a[84:87], v11 offset:0
 v_mfma_f32_16x16x32_bf16 v[212:215], a[120:123], a[0:3], v[212:215]
 v_mfma_f32_16x16x32_bf16 v[216:219], a[128:131], a[0:3], v[216:219]
 ds_read_b128 a[88:91], v10 offset:2048
 v_mfma_f32_16x16x32_bf16 v[216:219], a[132:135], a[4:7], v[216:219]
 v_mfma_f32_16x16x32_bf16 v[220:223], a[140:143], a[4:7], v[220:223]
 ds_read_b128 a[92:95], v11 offset:2048
 v_mfma_f32_16x16x32_bf16 v[220:223], a[136:139], a[0:3], v[220:223]
 v_mfma_f32_16x16x32_bf16 v[236:239], a[136:139], a[8:11], v[236:239]
 ds_read_b128 a[96:99], v10 offset:4096
 v_mfma_f32_16x16x32_bf16 v[236:239], a[140:143], a[12:15], v[236:239]
 v_mfma_f32_16x16x32_bf16 v[232:235], a[132:135], a[12:15], v[232:235]
 ds_read_b128 a[100:103], v11 offset:4096
 v_mfma_f32_16x16x32_bf16 v[232:235], a[128:131], a[8:11], v[232:235]
 v_mfma_f32_16x16x32_bf16 v[228:231], a[120:123], a[8:11], v[228:231]
 ds_read_b128 a[104:107], v10 offset:6144
 v_mfma_f32_16x16x32_bf16 v[228:231], a[124:127], a[12:15], v[228:231]
 v_mfma_f32_16x16x32_bf16 v[224:227], a[116:119], a[12:15], v[224:227]
 ds_read_b128 a[108:111], v11 offset:6144
 v_mfma_f32_16x16x32_bf16 v[224:227], a[112:115], a[8:11], v[224:227]
 s_add_u32 m0, s32, 114688
 v_mfma_f32_16x16x32_bf16 v[240:243], a[112:115], a[16:19], v[240:243]
 s_add_u32 s35, s34, 524544
 v_mfma_f32_16x16x32_bf16 v[240:243], a[116:119], a[20:23], v[240:243]
 buffer_load_dwordx4 v6, s[12:15], s35 offen offset:0 nt lds
 v_mfma_f32_16x16x32_bf16 v[244:247], a[124:127], a[20:23], v[244:247]
 v_mfma_f32_16x16x32_bf16 v[244:247], a[120:123], a[16:19], v[244:247]
 v_mfma_f32_16x16x32_bf16 v[248:251], a[128:131], a[16:19], v[248:251]
 v_mfma_f32_16x16x32_bf16 v[248:251], a[132:135], a[20:23], v[248:251]
 buffer_load_dwordx4 v7, s[12:15], s35 offen offset:1024 nt lds
 v_mfma_f32_16x16x32_bf16 v[252:255], a[140:143], a[20:23], v[252:255]
 v_mfma_f32_16x16x32_bf16 v[252:255], a[136:139], a[16:19], v[252:255]
 v_mfma_f32_16x16x32_bf16 a[76:79], a[136:139], a[24:27], a[76:79]
 v_mfma_f32_16x16x32_bf16 a[76:79], a[140:143], a[28:31], a[76:79]
 buffer_load_dwordx4 v8, s[12:15], s35 offen offset:2048 nt lds
 v_mfma_f32_16x16x32_bf16 a[72:75], a[132:135], a[28:31], a[72:75]
 v_mfma_f32_16x16x32_bf16 a[72:75], a[128:131], a[24:27], a[72:75]
 v_mfma_f32_16x16x32_bf16 a[68:71], a[120:123], a[24:27], a[68:71]
 v_mfma_f32_16x16x32_bf16 a[68:71], a[124:127], a[28:31], a[68:71]
 buffer_load_dwordx4 v9, s[12:15], s35 offen offset:3072 nt lds
 v_mfma_f32_16x16x32_bf16 a[64:67], a[116:119], a[28:31], a[64:67]
 s_waitcnt lgkmcnt(0)
 v_mfma_f32_16x16x32_bf16 a[64:67], a[112:115], a[24:27], a[64:67]
 v_mfma_f32_16x16x32_bf16 v[144:147], a[32:35], a[0:3], v[144:147]
 ds_read_b64_tr_b16 a[112:113], v12 offset:0
 v_mfma_f32_16x16x32_bf16 v[144:147], a[36:39], a[4:7], v[144:147]
 ds_read_b64_tr_b16 a[114:115], v12 offset:1024
 v_mfma_f32_16x16x32_bf16 v[148:151], a[44:47], a[4:7], v[148:151]
 ds_read_b64_tr_b16 a[116:117], v12 offset:8192
 v_mfma_f32_16x16x32_bf16 v[148:151], a[40:43], a[0:3], v[148:151]
 ds_read_b64_tr_b16 a[118:119], v12 offset:9216
 v_mfma_f32_16x16x32_bf16 v[152:155], a[48:51], a[0:3], v[152:155]
 ds_read_b64_tr_b16 a[120:121], v13 offset:0
 v_mfma_f32_16x16x32_bf16 v[152:155], a[52:55], a[4:7], v[152:155]
 ds_read_b64_tr_b16 a[122:123], v13 offset:1024
 v_mfma_f32_16x16x32_bf16 v[156:159], a[60:63], a[4:7], v[156:159]
 ds_read_b64_tr_b16 a[124:125], v13 offset:8192
 v_mfma_f32_16x16x32_bf16 v[156:159], a[56:59], a[0:3], v[156:159]
 ds_read_b64_tr_b16 a[126:127], v13 offset:9216
 v_mfma_f32_16x16x32_bf16 v[172:175], a[56:59], a[8:11], v[172:175]
 ds_read_b64_tr_b16 a[128:129], v14 offset:0
 v_mfma_f32_16x16x32_bf16 v[172:175], a[60:63], a[12:15], v[172:175]
 ds_read_b64_tr_b16 a[130:131], v14 offset:1024
 v_mfma_f32_16x16x32_bf16 v[168:171], a[52:55], a[12:15], v[168:171]
 ds_read_b64_tr_b16 a[132:133], v14 offset:8192
 v_mfma_f32_16x16x32_bf16 v[168:171], a[48:51], a[8:11], v[168:171]
 ds_read_b64_tr_b16 a[134:135], v14 offset:9216
 v_mfma_f32_16x16x32_bf16 v[164:167], a[40:43], a[8:11], v[164:167]
 ds_read_b64_tr_b16 a[136:137], v15 offset:0
 v_mfma_f32_16x16x32_bf16 v[164:167], a[44:47], a[12:15], v[164:167]
 ds_read_b64_tr_b16 a[138:139], v15 offset:1024
 v_mfma_f32_16x16x32_bf16 v[160:163], a[36:39], a[12:15], v[160:163]
 ds_read_b64_tr_b16 a[140:141], v15 offset:8192
 v_mfma_f32_16x16x32_bf16 v[160:163], a[32:35], a[8:11], v[160:163]
 s_add_u32 m0, s32, 49152
 ds_read_b64_tr_b16 a[142:143], v15 offset:9216
 v_mfma_f32_16x16x32_bf16 v[176:179], a[32:35], a[16:19], v[176:179]
 s_add_u32 s35, s33, 2097280
 v_mfma_f32_16x16x32_bf16 v[176:179], a[36:39], a[20:23], v[176:179]
 buffer_load_dwordx4 v2, s[8:11], s35 offen offset:0 lds
 v_mfma_f32_16x16x32_bf16 v[180:183], a[44:47], a[20:23], v[180:183]
 v_mfma_f32_16x16x32_bf16 v[180:183], a[40:43], a[16:19], v[180:183]
 v_mfma_f32_16x16x32_bf16 v[184:187], a[48:51], a[16:19], v[184:187]
 v_mfma_f32_16x16x32_bf16 v[184:187], a[52:55], a[20:23], v[184:187]
 buffer_load_dwordx4 v3, s[8:11], s35 offen offset:1024 lds
 v_mfma_f32_16x16x32_bf16 v[188:191], a[60:63], a[20:23], v[188:191]
 v_mfma_f32_16x16x32_bf16 v[188:191], a[56:59], a[16:19], v[188:191]
 v_mfma_f32_16x16x32_bf16 v[204:207], a[56:59], a[24:27], v[204:207]
 v_mfma_f32_16x16x32_bf16 v[204:207], a[60:63], a[28:31], v[204:207]
 buffer_load_dwordx4 v4, s[8:11], s35 offen offset:2048 lds
 v_mfma_f32_16x16x32_bf16 v[200:203], a[52:55], a[28:31], v[200:203]
 s_add_u32 s33, s33, 256
 v_mfma_f32_16x16x32_bf16 v[200:203], a[48:51], a[24:27], v[200:203]
 s_add_u32 s34, s34, 1048576
 v_mfma_f32_16x16x32_bf16 v[196:199], a[40:43], a[24:27], v[196:199]
 s_add_u32 s36, s36, 1
 v_mfma_f32_16x16x32_bf16 v[196:199], a[44:47], a[28:31], v[196:199]
 buffer_load_dwordx4 v5, s[8:11], s35 offen offset:3072 lds
 v_mfma_f32_16x16x32_bf16 v[192:195], a[36:39], a[28:31], v[192:195]
 s_waitcnt vmcnt(16) lgkmcnt(0)
 s_barrier
 v_mfma_f32_16x16x32_bf16 v[192:195], a[32:35], a[24:27], v[192:195]
 s_cmp_eq_u32 s36, s23
 s_cbranch_scc0 L_loopK
 s_cmp_eq_u32 s36, 5
 s_cbranch_scc0 L_hook
 global_load_dword a254, v[0:1], off
 s_lshl_b32 s38, s50, 4
 s_load_dwordx4 s[52:55], s[4:5], s38
 v_mfma_f32_16x16x32_bf16 v[16:19], a[112:115], a[80:83], v[16:19]
 ds_read_b64_tr_b16 a[32:33], v12 offset:16384
 v_mfma_f32_16x16x32_bf16 v[16:19], a[116:119], a[84:87], v[16:19]
 ds_read_b64_tr_b16 a[34:35], v12 offset:17408
 v_mfma_f32_16x16x32_bf16 v[20:23], a[124:127], a[84:87], v[20:23]
 ds_read_b64_tr_b16 a[36:37], v12 offset:24576
 v_mfma_f32_16x16x32_bf16 v[20:23], a[120:123], a[80:83], v[20:23]
 ds_read_b64_tr_b16 a[38:39], v12 offset:25600
 v_mfma_f32_16x16x32_bf16 v[24:27], a[128:131], a[80:83], v[24:27]
 ds_read_b64_tr_b16 a[40:41], v13 offset:16384
 v_mfma_f32_16x16x32_bf16 v[24:27], a[132:135], a[84:87], v[24:27]
 ds_read_b64_tr_b16 a[42:43], v13 offset:17408
 v_mfma_f32_16x16x32_bf16 v[28:31], a[140:143], a[84:87], v[28:31]
 ds_read_b64_tr_b16 a[44:45], v13 offset:24576
 v_mfma_f32_16x16x32_bf16 v[28:31], a[136:139], a[80:83], v[28:31]
 ds_read_b64_tr_b16 a[46:47], v13 offset:25600
 v_mfma_f32_16x16x32_bf16 v[44:47], a[136:139], a[88:91], v[44:47]
 ds_read_b64_tr_b16 a[48:49], v14 offset:16384
 v_mfma_f32_16x16x32_bf16 v[44:47], a[140:143], a[92:95], v[44:47]
 ds_read_b64_tr_b16 a[50:51], v14 offset:17408
 v_mfma_f32_16x16x32_bf16 v[40:43], a[132:135], a[92:95], v[40:43]
 ds_read_b64_tr_b16 a[52:53], v14 offset:24576
 v_mfma_f32_16x16x32_bf16 v[40:43], a[128:131], a[88:91], v[40:43]
 ds_read_b64_tr_b16 a[54:55], v14 offset:25600
 v_mfma_f32_16x16x32_bf16 v[36:39], a[120:123], a[88:91], v[36:39]
 ds_read_b64_tr_b16 a[56:57], v15 offset:16384
 v_mfma_f32_16x16x32_bf16 v[36:39], a[124:127], a[92:95], v[36:39]
 ds_read_b64_tr_b16 a[58:59], v15 offset:17408
 v_mfma_f32_16x16x32_bf16 v[32:35], a[116:119], a[92:95], v[32:35]
 ds_read_b64_tr_b16 a[60:61], v15 offset:24576
 v_mfma_f32_16x16x32_bf16 v[32:35], a[112:115], a[88:91], v[32:35]
 s_add_u32 m0, s32, 0
 ds_read_b64_tr_b16 a[62:63], v15 offset:25600
 v_mfma_f32_16x16x32_bf16 v[48:51], a[112:115], a[96:99], v[48:51]
 s_add_u32 s35, s33, 0
 v_mbcnt_lo_u32_b32 v1, -1, 0
 v_mfma_f32_16x16x32_bf16 v[48:51], a[116:119], a[100:103], v[48:51]
 buffer_load_dwordx4 v2, s[8:11], s35 offen offset:0 lds
 v_mfma_f32_16x16x32_bf16 v[52:55], a[124:127], a[100:103], v[52:55]
 v_mbcnt_hi_u32_b32 v1, -1, v1
 v_mfma_f32_16x16x32_bf16 v[52:55], a[120:123], a[96:99], v[52:55]
 v_bfe_u32 v0, v1, 1, 3
 v_mfma_f32_16x16x32_bf16 v[56:59], a[128:131], a[96:99], v[56:59]
 v_mul_u32_u24 v0, 1792, v0
 v_mfma_f32_16x16x32_bf16 v[56:59], a[132:135], a[100:103], v[56:59]
 buffer_load_dwordx4 v3, s[8:11], s35 offen offset:1024 lds
 v_mfma_f32_16x16x32_bf16 v[60:63], a[140:143], a[100:103], v[60:63]
 v_and_b32 v1, 0x31, v1
 v_mfma_f32_16x16x32_bf16 v[60:63], a[136:139], a[96:99], v[60:63]
 v_mul_u32_u24 v1, 9, v1
 v_mfma_f32_16x16x32_bf16 v[76:79], a[136:139], a[104:107], v[76:79]
 v_bfe_u32 v1, v1, 3, 3
 v_mfma_f32_16x16x32_bf16 v[76:79], a[140:143], a[108:111], v[76:79]
 buffer_load_dwordx4 v4, s[8:11], s35 offen offset:2048 lds
 v_mfma_f32_16x16x32_bf16 v[72:75], a[132:135], a[108:111], v[72:75]
 v_lshl_add_u32 v1, v1, 4, v0
 v_mfma_f32_16x16x32_bf16 v[72:75], a[128:131], a[104:107], v[72:75]
 v_mbcnt_lo_u32_b32 v0, -1, 0
 v_mfma_f32_16x16x32_bf16 v[68:71], a[120:123], a[104:107], v[68:71]
 s_add_u32 s36, s48, 14336
 v_mbcnt_hi_u32_b32 v0, -1, v0
 v_mfma_f32_16x16x32_bf16 v[68:71], a[124:127], a[108:111], v[68:71]
 buffer_load_dwordx4 v5, s[8:11], s35 offen offset:3072 lds
 v_mfma_f32_16x16x32_bf16 v[64:67], a[116:119], a[108:111], v[64:67]
 s_waitcnt lgkmcnt(0)
 s_and_b64 s[52:53], s[52:53], s[54:55]
 v_mfma_f32_16x16x32_bf16 v[64:67], a[112:115], a[104:107], v[64:67]
 s_and_b32 s52, s52, s53
 s_cmp_eq_u32 s52, 0x01010101
 s_cbranch_scc0 L_loopK_xspin
L_loopK_xspun:
 v_mfma_f32_16x16x32_bf16 v[80:83], a[32:35], a[80:83], v[80:83]
 ds_read_b128 a[0:3], v10 offset:16384
 v_mfma_f32_16x16x32_bf16 v[80:83], a[36:39], a[84:87], v[80:83]
 buffer_load_dwordx4 a[144:147], v1, s[16:19], s48 offen offset:0 sc1
 v_mfma_f32_16x16x32_bf16 v[84:87], a[44:47], a[84:87], v[84:87]
 ds_read_b128 a[4:7], v11 offset:16384
 v_mfma_f32_16x16x32_bf16 v[84:87], a[40:43], a[80:83], v[84:87]
 v_mfma_f32_16x16x32_bf16 v[88:91], a[48:51], a[80:83], v[88:91]
 ds_read_b128 a[8:11], v10 offset:18432
 v_mfma_f32_16x16x32_bf16 v[88:91], a[52:55], a[84:87], v[88:91]
 v_mfma_f32_16x16x32_bf16 v[92:95], a[60:63], a[84:87], v[92:95]
 ds_read_b128 a[12:15], v11 offset:18432
 v_mfma_f32_16x16x32_bf16 v[92:95], a[56:59], a[80:83], v[92:95]
 v_mfma_f32_16x16x32_bf16 v[108:111], a[56:59], a[88:91], v[108:111]
 ds_read_b128 a[16:19], v10 offset:20480
 v_mfma_f32_16x16x32_bf16 v[108:111], a[60:63], a[92:95], v[108:111]
 v_mfma_f32_16x16x32_bf16 v[104:107], a[52:55], a[92:95], v[104:107]
 ds_read_b128 a[20:23], v11 offset:20480
 v_mfma_f32_16x16x32_bf16 v[104:107], a[48:51], a[88:91], v[104:107]
 v_mfma_f32_16x16x32_bf16 v[100:103], a[40:43], a[88:91], v[100:103]
 ds_read_b128 a[24:27], v10 offset:22528
 v_mfma_f32_16x16x32_bf16 v[100:103], a[44:47], a[92:95], v[100:103]
 v_mfma_f32_16x16x32_bf16 v[96:99], a[36:39], a[92:95], v[96:99]
 ds_read_b128 a[28:31], v11 offset:22528
 v_mfma_f32_16x16x32_bf16 v[96:99], a[32:35], a[88:91], v[96:99]
 s_add_u32 m0, s32, 65536
 v_mfma_f32_16x16x32_bf16 v[112:115], a[32:35], a[96:99], v[112:115]
 s_add_u32 s35, s34, 0
 v_mfma_f32_16x16x32_bf16 v[112:115], a[36:39], a[100:103], v[112:115]
 buffer_load_dwordx4 v6, s[12:15], s35 offen offset:0 nt lds
 v_mfma_f32_16x16x32_bf16 v[116:119], a[44:47], a[100:103], v[116:119]
 v_mfma_f32_16x16x32_bf16 v[116:119], a[40:43], a[96:99], v[116:119]
 v_mfma_f32_16x16x32_bf16 v[120:123], a[48:51], a[96:99], v[120:123]
 v_mfma_f32_16x16x32_bf16 v[120:123], a[52:55], a[100:103], v[120:123]
 buffer_load_dwordx4 v7, s[12:15], s35 offen offset:1024 nt lds
 v_mfma_f32_16x16x32_bf16 v[124:127], a[60:63], a[100:103], v[124:127]
 v_mfma_f32_16x16x32_bf16 v[124:127], a[56:59], a[96:99], v[124:127]
 v_mfma_f32_16x16x32_bf16 v[140:143], a[56:59], a[104:107], v[140:143]
 v_mfma_f32_16x16x32_bf16 v[140:143], a[60:63], a[108:111], v[140:143]
 buffer_load_dwordx4 v8, s[12:15], s35 offen offset:2048 nt lds
 v_mfma_f32_16x16x32_bf16 v[136:139], a[52:55], a[108:111], v[136:139]
 v_mfma_f32_16x16x32_bf16 v[136:139], a[48:51], a[104:107], v[136:139]
 v_mfma_f32_16x16x32_bf16 v[132:135], a[40:43], a[104:107], v[132:135]
 v_mfma_f32_16x16x32_bf16 v[132:135], a[44:47], a[108:111], v[132:135]
 buffer_load_dwordx4 v9, s[12:15], s35 offen offset:3072 nt lds
 v_mfma_f32_16x16x32_bf16 v[128:131], a[36:39], a[108:111], v[128:131]
 s_waitcnt vmcnt(18)
 s_waitcnt lgkmcnt(0)
 s_barrier
 v_mfma_f32_16x16x32_bf16 v[128:131], a[32:35], a[104:107], v[128:131]
 v_mfma_f32_16x16x32_bf16 v[208:211], a[32:35], a[0:3], v[208:211]
 ds_read_b128 a[80:83], v10 offset:32768
 v_mfma_f32_16x16x32_bf16 v[208:211], a[36:39], a[4:7], v[208:211]
 buffer_load_dwordx4 a[200:203], v1, s[16:19], s36 offen offset:0 sc1
 v_mfma_f32_16x16x32_bf16 v[212:215], a[44:47], a[4:7], v[212:215]
 ds_read_b128 a[84:87], v11 offset:32768
 v_mfma_f32_16x16x32_bf16 v[212:215], a[40:43], a[0:3], v[212:215]
 v_mfma_f32_16x16x32_bf16 v[216:219], a[48:51], a[0:3], v[216:219]
 ds_read_b128 a[88:91], v10 offset:34816
 v_mfma_f32_16x16x32_bf16 v[216:219], a[52:55], a[4:7], v[216:219]
 v_mfma_f32_16x16x32_bf16 v[220:223], a[60:63], a[4:7], v[220:223]
 ds_read_b128 a[92:95], v11 offset:34816
 v_mfma_f32_16x16x32_bf16 v[220:223], a[56:59], a[0:3], v[220:223]
 v_mfma_f32_16x16x32_bf16 v[236:239], a[56:59], a[8:11], v[236:239]
 ds_read_b128 a[96:99], v10 offset:36864
 v_mfma_f32_16x16x32_bf16 v[236:239], a[60:63], a[12:15], v[236:239]
 v_mfma_f32_16x16x32_bf16 v[232:235], a[52:55], a[12:15], v[232:235]
 ds_read_b128 a[100:103], v11 offset:36864
 v_mfma_f32_16x16x32_bf16 v[232:235], a[48:51], a[8:11], v[232:235]
 v_mfma_f32_16x16x32_bf16 v[228:231], a[40:43], a[8:11], v[228:231]
 ds_read_b128 a[104:107], v10 offset:38912
 v_mfma_f32_16x16x32_bf16 v[228:231], a[44:47], a[12:15], v[228:231]
 v_mfma_f32_16x16x32_bf16 v[224:227], a[36:39], a[12:15], v[224:227]
 ds_read_b128 a[108:111], v11 offset:38912
 v_mfma_f32_16x16x32_bf16 v[224:227], a[32:35], a[8:11], v[224:227]
 s_add_u32 m0, s32, 81920
 v_mfma_f32_16x16x32_bf16 v[240:243], a[32:35], a[16:19], v[240:243]
 s_add_u32 s35, s34, 256
 v_mfma_f32_16x16x32_bf16 v[240:243], a[36:39], a[20:23], v[240:243]
 buffer_load_dwordx4 v6, s[12:15], s35 offen offset:0 nt lds
 v_mfma_f32_16x16x32_bf16 v[244:247], a[44:47], a[20:23], v[244:247]
 v_mfma_f32_16x16x32_bf16 v[244:247], a[40:43], a[16:19], v[244:247]
 v_mfma_f32_16x16x32_bf16 v[248:251], a[48:51], a[16:19], v[248:251]
 v_mfma_f32_16x16x32_bf16 v[248:251], a[52:55], a[20:23], v[248:251]
 buffer_load_dwordx4 v7, s[12:15], s35 offen offset:1024 nt lds
 v_mfma_f32_16x16x32_bf16 v[252:255], a[60:63], a[20:23], v[252:255]
 v_mfma_f32_16x16x32_bf16 v[252:255], a[56:59], a[16:19], v[252:255]
 v_mfma_f32_16x16x32_bf16 a[76:79], a[56:59], a[24:27], a[76:79]
 v_mfma_f32_16x16x32_bf16 a[76:79], a[60:63], a[28:31], a[76:79]
 buffer_load_dwordx4 v8, s[12:15], s35 offen offset:2048 nt lds
 v_mfma_f32_16x16x32_bf16 a[72:75], a[52:55], a[28:31], a[72:75]
 v_mfma_f32_16x16x32_bf16 a[72:75], a[48:51], a[24:27], a[72:75]
 v_mfma_f32_16x16x32_bf16 a[68:71], a[40:43], a[24:27], a[68:71]
 v_mfma_f32_16x16x32_bf16 a[68:71], a[44:47], a[28:31], a[68:71]
 buffer_load_dwordx4 v9, s[12:15], s35 offen offset:3072 nt lds
 v_mfma_f32_16x16x32_bf16 a[64:67], a[36:39], a[28:31], a[64:67]
 v_mfma_f32_16x16x32_bf16 a[64:67], a[32:35], a[24:27], a[64:67]
 v_mfma_f32_16x16x32_bf16 v[144:147], a[112:115], a[0:3], v[144:147]
 ds_read_b64_tr_b16 a[32:33], v12 offset:32768
 v_mfma_f32_16x16x32_bf16 v[144:147], a[116:119], a[4:7], v[144:147]
 ds_read_b64_tr_b16 a[34:35], v12 offset:33792
 buffer_load_dwordx4 a[148:151], v1, s[16:19], s48 offen offset:128 sc1
 v_mfma_f32_16x16x32_bf16 v[148:151], a[124:127], a[4:7], v[148:151]
 ds_read_b64_tr_b16 a[36:37], v12 offset:40960
 v_mfma_f32_16x16x32_bf16 v[148:151], a[120:123], a[0:3], v[148:151]
 ds_read_b64_tr_b16 a[38:39], v12 offset:41984
 v_mfma_f32_16x16x32_bf16 v[152:155], a[128:131], a[0:3], v[152:155]
 ds_read_b64_tr_b16 a[40:41], v13 offset:32768
 v_mfma_f32_16x16x32_bf16 v[152:155], a[132:135], a[4:7], v[152:155]
 ds_read_b64_tr_b16 a[42:43], v13 offset:33792
 v_mfma_f32_16x16x32_bf16 v[156:159], a[140:143], a[4:7], v[156:159]
 ds_read_b64_tr_b16 a[44:45], v13 offset:40960
 v_mfma_f32_16x16x32_bf16 v[156:159], a[136:139], a[0:3], v[156:159]
 ds_read_b64_tr_b16 a[46:47], v13 offset:41984
 v_mfma_f32_16x16x32_bf16 v[172:175], a[136:139], a[8:11], v[172:175]
 ds_read_b64_tr_b16 a[48:49], v14 offset:32768
 v_mfma_f32_16x16x32_bf16 v[172:175], a[140:143], a[12:15], v[172:175]
 ds_read_b64_tr_b16 a[50:51], v14 offset:33792
 v_mfma_f32_16x16x32_bf16 v[168:171], a[132:135], a[12:15], v[168:171]
 ds_read_b64_tr_b16 a[52:53], v14 offset:40960
 v_mfma_f32_16x16x32_bf16 v[168:171], a[128:131], a[8:11], v[168:171]
 ds_read_b64_tr_b16 a[54:55], v14 offset:41984
 v_mfma_f32_16x16x32_bf16 v[164:167], a[120:123], a[8:11], v[164:167]
 ds_read_b64_tr_b16 a[56:57], v15 offset:32768
 v_mfma_f32_16x16x32_bf16 v[164:167], a[124:127], a[12:15], v[164:167]
 ds_read_b64_tr_b16 a[58:59], v15 offset:33792
 v_mfma_f32_16x16x32_bf16 v[160:163], a[116:119], a[12:15], v[160:163]
 ds_read_b64_tr_b16 a[60:61], v15 offset:40960
 v_mfma_f32_16x16x32_bf16 v[160:163], a[112:115], a[8:11], v[160:163]
 s_add_u32 m0, s32, 16384
 ds_read_b64_tr_b16 a[62:63], v15 offset:41984
 v_mfma_f32_16x16x32_bf16 v[176:179], a[112:115], a[16:19], v[176:179]
 s_add_u32 s35, s33, 2097152
 v_mfma_f32_16x16x32_bf16 v[176:179], a[116:119], a[20:23], v[176:179]
 buffer_load_dwordx4 v2, s[8:11], s35 offen offset:0 lds
 v_mfma_f32_16x16x32_bf16 v[180:183], a[124:127], a[20:23], v[180:183]
 v_mfma_f32_16x16x32_bf16 v[180:183], a[120:123], a[16:19], v[180:183]
 v_mfma_f32_16x16x32_bf16 v[184:187], a[128:131], a[16:19], v[184:187]
 v_mfma_f32_16x16x32_bf16 v[184:187], a[132:135], a[20:23], v[184:187]
 buffer_load_dwordx4 v3, s[8:11], s35 offen offset:1024 lds
 v_mfma_f32_16x16x32_bf16 v[188:191], a[140:143], a[20:23], v[188:191]
 buffer_load_dwordx4 a[204:207], v1, s[16:19], s36 offen offset:128 sc1
 v_mfma_f32_16x16x32_bf16 v[188:191], a[136:139], a[16:19], v[188:191]
 v_mfma_f32_16x16x32_bf16 v[204:207], a[136:139], a[24:27], v[204:207]
 v_mfma_f32_16x16x32_bf16 v[204:207], a[140:143], a[28:31], v[204:207]
 buffer_load_dwordx4 v4, s[8:11], s35 offen offset:2048 lds
 v_mfma_f32_16x16x32_bf16 v[200:203], a[132:135], a[28:31], v[200:203]
 v_mfma_f32_16x16x32_bf16 v[200:203], a[128:131], a[24:27], v[200:203]
 v_mfma_f32_16x16x32_bf16 v[196:199], a[120:123], a[24:27], v[196:199]
 v_mfma_f32_16x16x32_bf16 v[196:199], a[124:127], a[28:31], v[196:199]
 buffer_load_dwordx4 v5, s[8:11], s35 offen offset:3072 lds
 v_mfma_f32_16x16x32_bf16 v[192:195], a[116:119], a[28:31], v[192:195]
 s_waitcnt vmcnt(21)
 s_waitcnt lgkmcnt(0)
 s_barrier
 v_mfma_f32_16x16x32_bf16 v[192:195], a[112:115], a[24:27], v[192:195]
 v_mfma_f32_16x16x32_bf16 v[16:19], a[32:35], a[80:83], v[16:19]
 ds_read_b64_tr_b16 a[112:113], v12 offset:49152
 v_mfma_f32_16x16x32_bf16 v[16:19], a[36:39], a[84:87], v[16:19]
 ds_read_b64_tr_b16 a[114:115], v12 offset:50176
 v_mfma_f32_16x16x32_bf16 v[20:23], a[44:47], a[84:87], v[20:23]
 ds_read_b64_tr_b16 a[116:117], v12 offset:57344
 v_mfma_f32_16x16x32_bf16 v[20:23], a[40:43], a[80:83], v[20:23]
 ds_read_b64_tr_b16 a[118:119], v12 offset:58368
 v_mfma_f32_16x16x32_bf16 v[24:27], a[48:51], a[80:83], v[24:27]
 ds_read_b64_tr_b16 a[120:121], v13 offset:49152
 v_mfma_f32_16x16x32_bf16 v[24:27], a[52:55], a[84:87], v[24:27]
 ds_read_b64_tr_b16 a[122:123], v13 offset:50176
 v_mfma_f32_16x16x32_bf16 v[28:31], a[60:63], a[84:87], v[28:31]
 ds_read_b64_tr_b16 a[124:125], v13 offset:57344
 v_mfma_f32_16x16x32_bf16 v[28:31], a[56:59], a[80:83], v[28:31]
 ds_read_b64_tr_b16 a[126:127], v13 offset:58368
 v_mfma_f32_16x16x32_bf16 v[44:47], a[56:59], a[88:91], v[44:47]
 ds_read_b64_tr_b16 a[128:129], v14 offset:49152
 v_mfma_f32_16x16x32_bf16 v[44:47], a[60:63], a[92:95], v[44:47]
 ds_read_b64_tr_b16 a[130:131], v14 offset:50176
 v_mfma_f32_16x16x32_bf16 v[40:43], a[52:55], a[92:95], v[40:43]
 ds_read_b64_tr_b16 a[132:133], v14 offset:57344
 v_mfma_f32_16x16x32_bf16 v[40:43], a[48:51], a[88:91], v[40:43]
 ds_read_b64_tr_b16 a[134:135], v14 offset:58368
 v_mfma_f32_16x16x32_bf16 v[36:39], a[40:43], a[88:91], v[36:39]
 ds_read_b64_tr_b16 a[136:137], v15 offset:49152
 v_mfma_f32_16x16x32_bf16 v[36:39], a[44:47], a[92:95], v[36:39]
 ds_read_b64_tr_b16 a[138:139], v15 offset:50176
 v_mfma_f32_16x16x32_bf16 v[32:35], a[36:39], a[92:95], v[32:35]
 ds_read_b64_tr_b16 a[140:141], v15 offset:57344
 v_mfma_f32_16x16x32_bf16 v[32:35], a[32:35], a[88:91], v[32:35]
 s_add_u32 m0, s32, 32768
 ds_read_b64_tr_b16 a[142:143], v15 offset:58368
 v_mfma_f32_16x16x32_bf16 v[48:51], a[32:35], a[96:99], v[48:51]
 s_add_u32 s35, s33, 128
 v_mfma_f32_16x16x32_bf16 v[48:51], a[36:39], a[100:103], v[48:51]
 buffer_load_dwordx4 v2, s[8:11], s35 offen offset:0 lds
 v_mfma_f32_16x16x32_bf16 v[52:55], a[44:47], a[100:103], v[52:55]
 v_mfma_f32_16x16x32_bf16 v[52:55], a[40:43], a[96:99], v[52:55]
 v_mfma_f32_16x16x32_bf16 v[56:59], a[48:51], a[96:99], v[56:59]
 v_mfma_f32_16x16x32_bf16 v[56:59], a[52:55], a[100:103], v[56:59]
 buffer_load_dwordx4 v3, s[8:11], s35 offen offset:1024 lds
 v_mfma_f32_16x16x32_bf16 v[60:63], a[60:63], a[100:103], v[60:63]
 v_mfma_f32_16x16x32_bf16 v[60:63], a[56:59], a[96:99], v[60:63]
 v_mfma_f32_16x16x32_bf16 v[76:79], a[56:59], a[104:107], v[76:79]
 v_mfma_f32_16x16x32_bf16 v[76:79], a[60:63], a[108:111], v[76:79]
 buffer_load_dwordx4 v4, s[8:11], s35 offen offset:2048 lds
 v_mfma_f32_16x16x32_bf16 v[72:75], a[52:55], a[108:111], v[72:75]
 v_mfma_f32_16x16x32_bf16 v[72:75], a[48:51], a[104:107], v[72:75]
 v_mfma_f32_16x16x32_bf16 v[68:71], a[40:43], a[104:107], v[68:71]
 v_mfma_f32_16x16x32_bf16 v[68:71], a[44:47], a[108:111], v[68:71]
 buffer_load_dwordx4 v5, s[8:11], s35 offen offset:3072 lds
 v_mfma_f32_16x16x32_bf16 v[64:67], a[36:39], a[108:111], v[64:67]
 v_mfma_f32_16x16x32_bf16 v[64:67], a[32:35], a[104:107], v[64:67]
 s_waitcnt lgkmcnt(0)
 v_mfma_f32_16x16x32_bf16 v[80:83], a[112:115], a[80:83], v[80:83]
 ds_read_b128 a[0:3], v10 offset:49152
 v_mfma_f32_16x16x32_bf16 v[80:83], a[116:119], a[84:87], v[80:83]
 buffer_load_dwordx4 a[152:155], v1, s[16:19], s48 offen offset:256 sc1
 v_mfma_f32_16x16x32_bf16 v[84:87], a[124:127], a[84:87], v[84:87]
 ds_read_b128 a[4:7], v11 offset:49152
 v_mfma_f32_16x16x32_bf16 v[84:87], a[120:123], a[80:83], v[84:87]
 v_mfma_f32_16x16x32_bf16 v[88:91], a[128:131], a[80:83], v[88:91]
 ds_read_b128 a[8:11], v10 offset:51200
 v_mfma_f32_16x16x32_bf16 v[88:91], a[132:135], a[84:87], v[88:91]
 v_mfma_f32_16x16x32_bf16 v[92:95], a[140:143], a[84:87], v[92:95]
 ds_read_b128 a[12:15], v11 offset:51200
 v_mfma_f32_16x16x32_bf16 v[92:95], a[136:139], a[80:83], v[92:95]
 v_mfma_f32_16x16x32_bf16 v[108:111], a[136:139], a[88:91], v[108:111]
 ds_read_b128 a[16:19], v10 offset:53248
 v_mfma_f32_16x16x32_bf16 v[108:111], a[140:143], a[92:95], v[108:111]
 v_mfma_f32_16x16x32_bf16 v[104:107], a[132:135], a[92:95], v[104:107]
 ds_read_b128 a[20:23], v11 offset:53248
 v_mfma_f32_16x16x32_bf16 v[104:107], a[128:131], a[88:91], v[104:107]
 v_mfma_f32_16x16x32_bf16 v[100:103], a[120:123], a[88:91], v[100:103]
 ds_read_b128 a[24:27], v10 offset:55296
 v_mfma_f32_16x16x32_bf16 v[100:103], a[124:127], a[92:95], v[100:103]
 buffer_load_dwordx4 a[208:211], v1, s[16:19], s36 offen offset:256 sc1
 v_mfma_f32_16x16x32_bf16 v[96:99], a[116:119], a[92:95], v[96:99]
 ds_read_b128 a[28:31], v11 offset:55296
 v_mfma_f32_16x16x32_bf16 v[96:99], a[112:115], a[88:91], v[96:99]
 s_add_u32 m0, s32, 98304
 v_mfma_f32_16x16x32_bf16 v[112:115], a[112:115], a[96:99], v[112:115]
 s_add_u32 s35, s34, 524288
 v_mfma_f32_16x16x32_bf16 v[112:115], a[116:119], a[100:103], v[112:115]
 buffer_load_dwordx4 v6, s[12:15], s35 offen offset:0 nt lds
 v_mfma_f32_16x16x32_bf16 v[116:119], a[124:127], a[100:103], v[116:119]
 v_mfma_f32_16x16x32_bf16 v[116:119], a[120:123], a[96:99], v[116:119]
 v_mfma_f32_16x16x32_bf16 v[120:123], a[128:131], a[96:99], v[120:123]
 v_mfma_f32_16x16x32_bf16 v[120:123], a[132:135], a[100:103], v[120:123]
 buffer_load_dwordx4 v7, s[12:15], s35 offen offset:1024 nt lds
 v_mfma_f32_16x16x32_bf16 v[124:127], a[140:143], a[100:103], v[124:127]
 v_mfma_f32_16x16x32_bf16 v[124:127], a[136:139], a[96:99], v[124:127]
 v_mfma_f32_16x16x32_bf16 v[140:143], a[136:139], a[104:107], v[140:143]
 v_mfma_f32_16x16x32_bf16 v[140:143], a[140:143], a[108:111], v[140:143]
 buffer_load_dwordx4 v8, s[12:15], s35 offen offset:2048 nt lds
 v_mfma_f32_16x16x32_bf16 v[136:139], a[132:135], a[108:111], v[136:139]
 v_mfma_f32_16x16x32_bf16 v[136:139], a[128:131], a[104:107], v[136:139]
 v_mfma_f32_16x16x32_bf16 v[132:135], a[120:123], a[104:107], v[132:135]
 v_mfma_f32_16x16x32_bf16 v[132:135], a[124:127], a[108:111], v[132:135]
 buffer_load_dwordx4 v9, s[12:15], s35 offen offset:3072 nt lds
 v_mfma_f32_16x16x32_bf16 v[128:131], a[116:119], a[108:111], v[128:131]
 s_waitcnt vmcnt(21)
 s_waitcnt lgkmcnt(0)
 s_barrier
 v_mfma_f32_16x16x32_bf16 v[128:131], a[112:115], a[104:107], v[128:131]
 v_mfma_f32_16x16x32_bf16 v[208:211], a[112:115], a[0:3], v[208:211]
 ds_read_b128 a[80:83], v10 offset:0
 v_mfma_f32_16x16x32_bf16 v[208:211], a[116:119], a[4:7], v[208:211]
 v_mfma_f32_16x16x32_bf16 v[212:215], a[124:127], a[4:7], v[212:215]
 ds_read_b128 a[84:87], v11 offset:0
 v_mfma_f32_16x16x32_bf16 v[212:215], a[120:123], a[0:3], v[212:215]
 v_mfma_f32_16x16x32_bf16 v[216:219], a[128:131], a[0:3], v[216:219]
 ds_read_b128 a[88:91], v10 offset:2048
 v_mfma_f32_16x16x32_bf16 v[216:219], a[132:135], a[4:7], v[216:219]
 v_mfma_f32_16x16x32_bf16 v[220:223], a[140:143], a[4:7], v[220:223]
 ds_read_b128 a[92:95], v11 offset:2048
 v_mfma_f32_16x16x32_bf16 v[220:223], a[136:139], a[0:3], v[220:223]
 v_mfma_f32_16x16x32_bf16 v[236:239], a[136:139], a[8:11], v[236:239]
 ds_read_b128 a[96:99], v10 offset:4096
 v_mfma_f32_16x16x32_bf16 v[236:239], a[140:143], a[12:15], v[236:239]
 buffer_load_dwordx4 a[156:159], v1, s[16:19], s48 offen offset:384 sc1
 v_mfma_f32_16x16x32_bf16 v[232:235], a[132:135], a[12:15], v[232:235]
 ds_read_b128 a[100:103], v11 offset:4096
 v_mfma_f32_16x16x32_bf16 v[232:235], a[128:131], a[8:11], v[232:235]
 v_mfma_f32_16x16x32_bf16 v[228:231], a[120:123], a[8:11], v[228:231]
 ds_read_b128 a[104:107], v10 offset:6144
 v_mfma_f32_16x16x32_bf16 v[228:231], a[124:127], a[12:15], v[228:231]
 v_mfma_f32_16x16x32_bf16 v[224:227], a[116:119], a[12:15], v[224:227]
 ds_read_b128 a[108:111], v11 offset:6144
 v_mfma_f32_16x16x32_bf16 v[224:227], a[112:115], a[8:11], v[224:227]
 s_add_u32 m0, s32, 114688
 v_mfma_f32_16x16x32_bf16 v[240:243], a[112:115], a[16:19], v[240:243]
 s_add_u32 s35, s34, 524544
 v_mfma_f32_16x16x32_bf16 v[240:243], a[116:119], a[20:23], v[240:243]
 buffer_load_dwordx4 v6, s[12:15], s35 offen offset:0 nt lds
 v_mfma_f32_16x16x32_bf16 v[244:247], a[124:127], a[20:23], v[244:247]
 v_mfma_f32_16x16x32_bf16 v[244:247], a[120:123], a[16:19], v[244:247]
 v_mfma_f32_16x16x32_bf16 v[248:251], a[128:131], a[16:19], v[248:251]
 v_mfma_f32_16x16x32_bf16 v[248:251], a[132:135], a[20:23], v[248:251]
 buffer_load_dwordx4 v7, s[12:15], s35 offen offset:1024 nt lds
 v_mfma_f32_16x16x32_bf16 v[252:255], a[140:143], a[20:23], v[252:255]
 v_mfma_f32_16x16x32_bf16 v[252:255], a[136:139], a[16:19], v[252:255]
 v_mfma_f32_16x16x32_bf16 a[76:79], a[136:139], a[24:27], a[76:79]
 v_mfma_f32_16x16x32_bf16 a[76:79], a[140:143], a[28:31], a[76:79]
 buffer_load_dwordx4 v8, s[12:15], s35 offen offset:2048 nt lds
 v_mfma_f32_16x16x32_bf16 a[72:75], a[132:135], a[28:31], a[72:75]
 v_mfma_f32_16x16x32_bf16 a[72:75], a[128:131], a[24:27], a[72:75]
 v_mfma_f32_16x16x32_bf16 a[68:71], a[120:123], a[24:27], a[68:71]
 v_mfma_f32_16x16x32_bf16 a[68:71], a[124:127], a[28:31], a[68:71]
 buffer_load_dwordx4 v9, s[12:15], s35 offen offset:3072 nt lds
 v_mfma_f32_16x16x32_bf16 a[64:67], a[116:119], a[28:31], a[64:67]
 v_mfma_f32_16x16x32_bf16 a[64:67], a[112:115], a[24:27], a[64:67]
 v_mfma_f32_16x16x32_bf16 v[144:147], a[32:35], a[0:3], v[144:147]
 ds_read_b64_tr_b16 a[112:113], v12 offset:0
 v_mfma_f32_16x16x32_bf16 v[144:147], a[36:39], a[4:7], v[144:147]
 ds_read_b64_tr_b16 a[114:115], v12 offset:1024
 v_mfma_f32_16x16x32_bf16 v[148:151], a[44:47], a[4:7], v[148:151]
 ds_read_b64_tr_b16 a[116:117], v12 offset:8192
 v_mfma_f32_16x16x32_bf16 v[148:151], a[40:43], a[0:3], v[148:151]
 ds_read_b64_tr_b16 a[118:119], v12 offset:9216
 v_mfma_f32_16x16x32_bf16 v[152:155], a[48:51], a[0:3], v[152:155]
 ds_read_b64_tr_b16 a[120:121], v13 offset:0
 v_mfma_f32_16x16x32_bf16 v[152:155], a[52:55], a[4:7], v[152:155]
 ds_read_b64_tr_b16 a[122:123], v13 offset:1024
 buffer_load_dwordx4 a[212:215], v1, s[16:19], s36 offen offset:384 sc1
 v_mfma_f32_16x16x32_bf16 v[156:159], a[60:63], a[4:7], v[156:159]
 ds_read_b64_tr_b16 a[124:125], v13 offset:8192
 v_mfma_f32_16x16x32_bf16 v[156:159], a[56:59], a[0:3], v[156:159]
 ds_read_b64_tr_b16 a[126:127], v13 offset:9216
 v_mfma_f32_16x16x32_bf16 v[172:175], a[56:59], a[8:11], v[172:175]
 ds_read_b64_tr_b16 a[128:129], v14 offset:0
 v_mfma_f32_16x16x32_bf16 v[172:175], a[60:63], a[12:15], v[172:175]
 ds_read_b64_tr_b16 a[130:131], v14 offset:1024
 v_mfma_f32_16x16x32_bf16 v[168:171], a[52:55], a[12:15], v[168:171]
 ds_read_b64_tr_b16 a[132:133], v14 offset:8192
 v_mfma_f32_16x16x32_bf16 v[168:171], a[48:51], a[8:11], v[168:171]
 ds_read_b64_tr_b16 a[134:135], v14 offset:9216
 v_mfma_f32_16x16x32_bf16 v[164:167], a[40:43], a[8:11], v[164:167]
 ds_read_b64_tr_b16 a[136:137], v15 offset:0
 v_mfma_f32_16x16x32_bf16 v[164:167], a[44:47], a[12:15], v[164:167]
 ds_read_b64_tr_b16 a[138:139], v15 offset:1024
 v_mfma_f32_16x16x32_bf16 v[160:163], a[36:39], a[12:15], v[160:163]
 ds_read_b64_tr_b16 a[140:141], v15 offset:8192
 v_mfma_f32_16x16x32_bf16 v[160:163], a[32:35], a[8:11], v[160:163]
 s_add_u32 m0, s32, 49152
 ds_read_b64_tr_b16 a[142:143], v15 offset:9216
 v_mfma_f32_16x16x32_bf16 v[176:179], a[32:35], a[16:19], v[176:179]
 s_add_u32 s35, s33, 2097280
 v_mfma_f32_16x16x32_bf16 v[176:179], a[36:39], a[20:23], v[176:179]
 buffer_load_dwordx4 v2, s[8:11], s35 offen offset:0 lds
 v_mfma_f32_16x16x32_bf16 v[180:183], a[44:47], a[20:23], v[180:183]
 v_mfma_f32_16x16x32_bf16 v[180:183], a[40:43], a[16:19], v[180:183]
 v_mfma_f32_16x16x32_bf16 v[184:187], a[48:51], a[16:19], v[184:187]
 v_mfma_f32_16x16x32_bf16 v[184:187], a[52:55], a[20:23], v[184:187]
 buffer_load_dwordx4 v3, s[8:11], s35 offen offset:1024 lds
 v_mfma_f32_16x16x32_bf16 v[188:191], a[60:63], a[20:23], v[188:191]
 v_mfma_f32_16x16x32_bf16 v[188:191], a[56:59], a[16:19], v[188:191]
 v_mfma_f32_16x16x32_bf16 v[204:207], a[56:59], a[24:27], v[204:207]
 v_mfma_f32_16x16x32_bf16 v[204:207], a[60:63], a[28:31], v[204:207]
 buffer_load_dwordx4 v4, s[8:11], s35 offen offset:2048 lds
 v_mfma_f32_16x16x32_bf16 v[200:203], a[52:55], a[28:31], v[200:203]
 v_mfma_f32_16x16x32_bf16 v[200:203], a[48:51], a[24:27], v[200:203]
 v_mfma_f32_16x16x32_bf16 v[196:199], a[40:43], a[24:27], v[196:199]
 v_mfma_f32_16x16x32_bf16 v[196:199], a[44:47], a[28:31], v[196:199]
 buffer_load_dwordx4 v5, s[8:11], s35 offen offset:3072 lds
 v_mfma_f32_16x16x32_bf16 v[192:195], a[36:39], a[28:31], v[192:195]
 s_waitcnt vmcnt(20)
 s_waitcnt lgkmcnt(0)
 s_barrier
 v_mfma_f32_16x16x32_bf16 v[192:195], a[32:35], a[24:27], v[192:195]
 v_mfma_f32_16x16x32_bf16 v[16:19], a[112:115], a[80:83], v[16:19]
 ds_read_b64_tr_b16 a[32:33], v12 offset:16384
 v_mfma_f32_16x16x32_bf16 v[16:19], a[116:119], a[84:87], v[16:19]
 s_mov_b32 s13, s39
 ds_read_b64_tr_b16 a[34:35], v12 offset:17408
 v_mfma_f32_16x16x32_bf16 v[20:23], a[124:127], a[84:87], v[20:23]
 s_mov_b32 s14, s51
 ds_read_b64_tr_b16 a[36:37], v12 offset:24576
 v_lshlrev_b32 v6, 2, v0
 v_mfma_f32_16x16x32_bf16 v[20:23], a[120:123], a[80:83], v[20:23]
 s_lshl_b32 s31, s3, 10
 s_lshl_b32 s30, s3, 3
 v_lshrrev_b32 v7, 3, v0
 v_mfma_f32_16x16x32_bf16 v[24:27], a[128:131], a[80:83], v[24:27]
 global_load_dword v3, v6, s[4:5] sc1
 v_mfma_f32_16x16x32_bf16 v[24:27], a[132:135], a[84:87], v[24:27]
 ds_read_b64_tr_b16 a[38:39], v12 offset:25600
 ds_read_b64_tr_b16 a[40:41], v13 offset:16384
 v_mfma_f32_16x16x32_bf16 v[28:31], a[140:143], a[84:87], v[28:31]
 ds_read_b64_tr_b16 a[42:43], v13 offset:17408
 v_add_u32 v7, s30, v7
 v_mfma_f32_16x16x32_bf16 v[28:31], a[136:139], a[80:83], v[28:31]
 v_lshlrev_b32 v7, 13, v7
 v_mfma_f32_16x16x32_bf16 v[44:47], a[136:139], a[88:91], v[44:47]
 s_lshl_b32 s30, s24, 9
 ds_read_b64_tr_b16 a[44:45], v13 offset:24576
 v_add_u32 v7, s30, v7
 v_mfma_f32_16x16x32_bf16 v[44:47], a[140:143], a[92:95], v[44:47]
 ds_read_b64_tr_b16 a[46:47], v13 offset:25600
 v_bfe_u32 v8, v0, 4, 1
 v_mfma_f32_16x16x32_bf16 v[40:43], a[132:135], a[92:95], v[40:43]
 s_lshl_b32 s30, s29, 1
 v_or_b32 v8, s30, v8
 v_lshlrev_b32 v8, 1, v8
 v_and_b32 v9, 7, v0
 v_xor_b32 v8, v8, v9
 v_lshl_add_u32 v2, v8, 4, v7
 v_mfma_f32_16x16x32_bf16 v[40:43], a[128:131], a[88:91], v[40:43]
 ds_read_b64_tr_b16 a[48:49], v14 offset:16384
 v_mfma_f32_16x16x32_bf16 v[36:39], a[120:123], a[88:91], v[36:39]
 s_add_u32 m0, s31, 131072
 s_mov_b32 s35, 0
 ds_read_b64_tr_b16 a[50:51], v14 offset:17408
 v_mfma_f32_16x16x32_bf16 v[36:39], a[124:127], a[92:95], v[36:39]
 buffer_load_dwordx4 v2, s[40:43], s35 offen lds
 v_mfma_f32_16x16x32_bf16 v[32:35], a[116:119], a[92:95], v[32:35]
 ds_read_b64_tr_b16 a[52:53], v14 offset:24576
 v_mfma_f32_16x16x32_bf16 v[32:35], a[112:115], a[88:91], v[32:35]
 ds_read_b64_tr_b16 a[54:55], v14 offset:25600
 v_mfma_f32_16x16x32_bf16 v[48:51], a[112:115], a[96:99], v[48:51]
 ds_read_b64_tr_b16 a[56:57], v15 offset:16384
 v_mfma_f32_16x16x32_bf16 v[48:51], a[116:119], a[100:103], v[48:51]
 s_add_u32 m0, s31, 135168
 ds_read_b64_tr_b16 a[58:59], v15 offset:17408
 v_mfma_f32_16x16x32_bf16 v[52:55], a[124:127], a[100:103], v[52:55]
 s_mov_b32 s35, 262144
 v_mfma_f32_16x16x32_bf16 v[52:55], a[120:123], a[96:99], v[52:55]
 buffer_load_dwordx4 v2, s[40:43], s35 offen lds
 v_mfma_f32_16x16x32_bf16 v[56:59], a[128:131], a[96:99], v[56:59]
 ds_read_b64_tr_b16 a[60:61], v15 offset:24576
 ds_read_b64_tr_b16 a[62:63], v15 offset:25600
 v_mfma_f32_16x16x32_bf16 v[56:59], a[132:135], a[100:103], v[56:59]
 v_mfma_f32_16x16x32_bf16 v[60:63], a[140:143], a[100:103], v[60:63]
 v_mfma_f32_16x16x32_bf16 v[60:63], a[136:139], a[96:99], v[60:63]
 s_add_u32 m0, s31, 139264
 v_mfma_f32_16x16x32_bf16 v[76:79], a[136:139], a[104:107], v[76:79]
 s_mov_b32 s35, 524288
 buffer_load_dwordx4 v2, s[40:43], s35 offen lds
 v_mfma_f32_16x16x32_bf16 v[76:79], a[140:143], a[108:111], v[76:79]
 v_mfma_f32_16x16x32_bf16 v[72:75], a[132:135], a[108:111], v[72:75]
 v_mfma_f32_16x16x32_bf16 v[72:75], a[128:131], a[104:107], v[72:75]
 v_mfma_f32_16x16x32_bf16 v[68:71], a[120:123], a[104:107], v[68:71]
 v_mfma_f32_16x16x32_bf16 v[68:71], a[124:127], a[108:111], v[68:71]
 s_add_u32 m0, s31, 143360
 v_mfma_f32_16x16x32_bf16 v[64:67], a[116:119], a[108:111], v[64:67]
 s_mov_b32 s35, 786432
 buffer_load_dwordx4 v2, s[40:43], s35 offen lds
 v_mfma_f32_16x16x32_bf16 v[64:67], a[112:115], a[104:107], v[64:67]
 s_waitcnt lgkmcnt(0)
 v_mfma_f32_16x16x32_bf16 v[80:83], a[32:35], a[80:83], v[80:83]
 ds_read_b128 a[0:3], v10 offset:16384
 v_mfma_f32_16x16x32_bf16 v[80:83], a[36:39], a[84:87], v[80:83]
 v_mfma_f32_16x16x32_bf16 v[84:87], a[44:47], a[84:87], v[84:87]
 ds_read_b128 a[4:7], v11 offset:16384
 v_mfma_f32_16x16x32_bf16 v[84:87], a[40:43], a[80:83], v[84:87]
 s_add_u32 m0, s31, 147456
 v_mfma_f32_16x16x32_bf16 v[88:91], a[48:51], a[80:83], v[88:91]
 s_mov_b32 s35, 1048576
 buffer_load_dwordx4 v2, s[40:43], s35 offen lds
 v_mfma_f32_16x16x32_bf16 v[88:91], a[52:55], a[84:87], v[88:91]
 ds_read_b128 a[8:11], v10 offset:18432
 v_mfma_f32_16x16x32_bf16 v[92:95], a[60:63], a[84:87], v[92:95]
 v_mfma_f32_16x16x32_bf16 v[92:95], a[56:59], a[80:83], v[92:95]
 v_mfma_f32_16x16x32_bf16 v[108:111], a[56:59], a[88:91], v[108:111]
 ds_read_b128 a[12:15], v11 offset:18432
 v_mfma_f32_16x16x32_bf16 v[108:111], a[60:63], a[92:95], v[108:111]
 s_add_u32 m0, s31, 151552
 v_mfma_f32_16x16x32_bf16 v[104:107], a[52:55], a[92:95], v[104:107]
 s_mov_b32 s35, 1310720
 buffer_load_dwordx4 v2, s[40:43], s35 offen lds
 v_mfma_f32_16x16x32_bf16 v[104:107], a[48:51], a[88:91], v[104:107]
 ds_read_b128 a[16:19], v10 offset:20480
 v_mfma_f32_16x16x32_bf16 v[100:103], a[40:43], a[88:91], v[100:103]
 v_mfma_f32_16x16x32_bf16 v[100:103], a[44:47], a[92:95], v[100:103]
 ds_read_b128 a[20:23], v11 offset:20480
 v_mfma_f32_16x16x32_bf16 v[96:99], a[36:39], a[92:95], v[96:99]
 v_mfma_f32_16x16x32_bf16 v[96:99], a[32:35], a[88:91], v[96:99]
 s_add_u32 m0, s31, 155648
 s_mov_b32 s35, 1572864
 v_mfma_f32_16x16x32_bf16 v[112:115], a[32:35], a[96:99], v[112:115]
 buffer_load_dwordx4 v2, s[40:43], s35 offen lds
 v_mfma_f32_16x16x32_bf16 v[112:115], a[36:39], a[100:103], v[112:115]
 ds_read_b128 a[24:27], v10 offset:22528
 v_mfma_f32_16x16x32_bf16 v[116:119], a[44:47], a[100:103], v[116:119]
 s_getpc_b64 s[20:21]
L_pcx10:
 s_add_u32 s20, s20, L_q-L_pcx10
 s_addc_u32 s21, s21, 0
 v_mfma_f32_16x16x32_bf16 v[116:119], a[40:43], a[96:99], v[116:119]
 s_lshl_b32 s38, s3, 13
 v_lshl_add_u32 v4, v0, 7, s38
 ds_read_b128 a[28:31], v11 offset:22528
 v_mfma_f32_16x16x32_bf16 v[120:123], a[48:51], a[96:99], v[120:123]
 v_mfma_f32_16x16x32_bf16 v[120:123], a[52:55], a[100:103], v[120:123]
 buffer_load_dwordx4 a[160:163], v1, s[16:19], s48 offen offset:512 sc1
 v_mfma_f32_16x16x32_bf16 v[124:127], a[60:63], a[100:103], v[124:127]
 v_min_u32 v4, L_textend-L_q-4, v4
 v_mfma_f32_16x16x32_bf16 v[124:127], a[56:59], a[96:99], v[124:127]
 v_mfma_f32_16x16x32_bf16 v[140:143], a[56:59], a[104:107], v[140:143]
 v_mfma_f32_16x16x32_bf16 v[140:143], a[60:63], a[108:111], v[140:143]
 global_load_dword v5, v4, s[20:21]
 v_mfma_f32_16x16x32_bf16 v[136:139], a[52:55], a[108:111], v[136:139]
 buffer_load_dwordx4 a[216:219], v1, s[16:19], s36 offen offset:512 sc1
 v_mfma_f32_16x16x32_bf16 v[136:139], a[48:51], a[104:107], v[136:139]
 v_mfma_f32_16x16x32_bf16 v[132:135], a[40:43], a[104:107], v[132:135]
 v_mfma_f32_16x16x32_bf16 v[132:135], a[44:47], a[108:111], v[132:135]
 v_mfma_f32_16x16x32_bf16 v[128:131], a[36:39], a[108:111], v[128:131]
 s_waitcnt vmcnt(21)
 s_waitcnt lgkmcnt(0)
 s_barrier
 v_mfma_f32_16x16x32_bf16 v[128:131], a[32:35], a[104:107], v[128:131]
 buffer_load_dwordx4 a[164:167], v1, s[16:19], s48 offen offset:640 sc1
 v_mfma_f32_16x16x32_bf16 v[208:211], a[32:35], a[0:3], v[208:211]
 ds_read_b128 a[80:83], v10 offset:32768
 v_mfma_f32_16x16x32_bf16 v[208:211], a[36:39], a[4:7], v[208:211]
 v_mfma_f32_16x16x32_bf16 v[212:215], a[44:47], a[4:7], v[212:215]
 ds_read_b128 a[84:87], v11 offset:32768
 v_mfma_f32_16x16x32_bf16 v[212:215], a[40:43], a[0:3], v[212:215]
 buffer_load_dwordx4 a[220:223], v1, s[16:19], s36 offen offset:640 sc1
 v_mfma_f32_16x16x32_bf16 v[216:219], a[48:51], a[0:3], v[216:219]
 v_mfma_f32_16x16x32_bf16 v[216:219], a[52:55], a[4:7], v[216:219]
 ds_read_b128 a[88:91], v10 offset:34816
 v_mfma_f32_16x16x32_bf16 v[220:223], a[60:63], a[4:7], v[220:223]
 v_mfma_f32_16x16x32_bf16 v[220:223], a[56:59], a[0:3], v[220:223]
 v_mfma_f32_16x16x32_bf16 v[236:239], a[56:59], a[8:11], v[236:239]
 buffer_load_dwordx4 a[168:171], v1, s[16:19], s48 offen offset:768 sc1
 v_mfma_f32_16x16x32_bf16 v[236:239], a[60:63], a[12:15], v[236:239]
 ds_read_b128 a[92:95], v11 offset:34816
 v_mfma_f32_16x16x32_bf16 v[232:235], a[52:55], a[12:15], v[232:235]
 v_mfma_f32_16x16x32_bf16 v[232:235], a[48:51], a[8:11], v[232:235]
 ds_read_b128 a[96:99], v10 offset:36864
 v_mfma_f32_16x16x32_bf16 v[228:231], a[40:43], a[8:11], v[228:231]
 buffer_load_dwordx4 a[224:227], v1, s[16:19], s36 offen offset:768 sc1
 v_mfma_f32_16x16x32_bf16 v[228:231], a[44:47], a[12:15], v[228:231]
 ds_read_b128 a[100:103], v11 offset:36864
 v_mfma_f32_16x16x32_bf16 v[224:227], a[36:39], a[12:15], v[224:227]
 v_mfma_f32_16x16x32_bf16 v[224:227], a[32:35], a[8:11], v[224:227]
 v_mfma_f32_16x16x32_bf16 v[240:243], a[32:35], a[16:19], v[240:243]
 ds_read_b128 a[104:107], v10 offset:38912
 v_mfma_f32_16x16x32_bf16 v[240:243], a[36:39], a[20:23], v[240:243]
 buffer_load_dwordx4 a[172:175], v1, s[16:19], s48 offen offset:896 sc1
 v_mfma_f32_16x16x32_bf16 v[244:247], a[44:47], a[20:23], v[244:247]
 v_mfma_f32_16x16x32_bf16 v[244:247], a[40:43], a[16:19], v[244:247]
 ds_read_b128 a[108:111], v11 offset:38912
 v_mfma_f32_16x16x32_bf16 v[248:251], a[48:51], a[16:19], v[248:251]
 v_mfma_f32_16x16x32_bf16 v[248:251], a[52:55], a[20:23], v[248:251]
 v_mfma_f32_16x16x32_bf16 v[252:255], a[60:63], a[20:23], v[252:255]
 buffer_load_dwordx4 a[228:231], v1, s[16:19], s36 offen offset:896 sc1
 v_mfma_f32_16x16x32_bf16 v[252:255], a[56:59], a[16:19], v[252:255]
 v_mfma_f32_16x16x32_bf16 a[76:79], a[56:59], a[24:27], a[76:79]
 v_mfma_f32_16x16x32_bf16 a[76:79], a[60:63], a[28:31], a[76:79]
 v_mfma_f32_16x16x32_bf16 a[72:75], a[52:55], a[28:31], a[72:75]
 v_mfma_f32_16x16x32_bf16 a[72:75], a[48:51], a[24:27], a[72:75]
 buffer_load_dwordx4 a[176:179], v1, s[16:19], s48 offen offset:1024 sc1
 v_mfma_f32_16x16x32_bf16 a[68:71], a[40:43], a[24:27], a[68:71]
 v_mfma_f32_16x16x32_bf16 a[68:71], a[44:47], a[28:31], a[68:71]
 v_mfma_f32_16x16x32_bf16 a[64:67], a[36:39], a[28:31], a[64:67]
 v_mfma_f32_16x16x32_bf16 a[64:67], a[32:35], a[24:27], a[64:67]
 buffer_load_dwordx4 a[232:235], v1, s[16:19], s36 offen offset:1024 sc1
 v_mfma_f32_16x16x32_bf16 v[144:147], a[112:115], a[0:3], v[144:147]
 ds_read_b64_tr_b16 a[32:33], v12 offset:32768
 v_mfma_f32_16x16x32_bf16 v[144:147], a[116:119], a[4:7], v[144:147]
 ds_read_b64_tr_b16 a[34:35], v12 offset:33792
 v_mfma_f32_16x16x32_bf16 v[148:151], a[124:127], a[4:7], v[148:151]
 ds_read_b64_tr_b16 a[36:37], v12 offset:40960
 v_mfma_f32_16x16x32_bf16 v[148:151], a[120:123], a[0:3], v[148:151]
 v_mfma_f32_16x16x32_bf16 v[152:155], a[128:131], a[0:3], v[152:155]
 s_add_u32 m0, s31, 65536
 ds_read_b64_tr_b16 a[38:39], v12 offset:41984
 v_mfma_f32_16x16x32_bf16 v[152:155], a[132:135], a[4:7], v[152:155]
 s_mov_b32 s35, 1835008
 buffer_load_dwordx4 v2, s[40:43], s35 offen lds
 v_mfma_f32_16x16x32_bf16 v[156:159], a[140:143], a[4:7], v[156:159]
 ds_read_b64_tr_b16 a[40:41], v13 offset:32768
 ds_read_b64_tr_b16 a[42:43], v13 offset:33792
 v_mfma_f32_16x16x32_bf16 v[156:159], a[136:139], a[0:3], v[156:159]
 v_mfma_f32_16x16x32_bf16 v[172:175], a[136:139], a[8:11], v[172:175]
 ds_read_b64_tr_b16 a[44:45], v13 offset:40960
 v_mfma_f32_16x16x32_bf16 v[172:175], a[140:143], a[12:15], v[172:175]
 ds_read_b64_tr_b16 a[46:47], v13 offset:41984
 v_mfma_f32_16x16x32_bf16 v[168:171], a[132:135], a[12:15], v[168:171]
 s_add_u32 m0, s31, 69632
 s_mov_b32 s35, 2097152
 v_mfma_f32_16x16x32_bf16 v[168:171], a[128:131], a[8:11], v[168:171]
 buffer_load_dwordx4 v2, s[40:43], s35 offen lds
 v_mfma_f32_16x16x32_bf16 v[164:167], a[120:123], a[8:11], v[164:167]
 ds_read_b64_tr_b16 a[48:49], v14 offset:32768
 ds_read_b64_tr_b16 a[50:51], v14 offset:33792
 v_mfma_f32_16x16x32_bf16 v[164:167], a[124:127], a[12:15], v[164:167]
 ds_read_b64_tr_b16 a[52:53], v14 offset:40960
 v_mfma_f32_16x16x32_bf16 v[160:163], a[116:119], a[12:15], v[160:163]
 v_mfma_f32_16x16x32_bf16 v[160:163], a[112:115], a[8:11], v[160:163]
 ds_read_b64_tr_b16 a[54:55], v14 offset:41984
 v_mfma_f32_16x16x32_bf16 v[176:179], a[112:115], a[16:19], v[176:179]
 s_add_u32 m0, s31, 73728
 s_mov_b32 s35, 2359296
 ds_read_b64_tr_b16 a[56:57], v15 offset:32768
 v_mfma_f32_16x16x32_bf16 v[176:179], a[116:119], a[20:23], v[176:179]
 buffer_load_dwordx4 v2, s[40:43], s35 offen lds
 v_mfma_f32_16x16x32_bf16 v[180:183], a[124:127], a[20:23], v[180:183]
 ds_read_b64_tr_b16 a[58:59], v15 offset:33792
 v_mfma_f32_16x16x32_bf16 v[180:183], a[120:123], a[16:19], v[180:183]
 ds_read_b64_tr_b16 a[60:61], v15 offset:40960
 v_mfma_f32_16x16x32_bf16 v[184:187], a[128:131], a[16:19], v[184:187]
 ds_read_b64_tr_b16 a[62:63], v15 offset:41984
 v_mfma_f32_16x16x32_bf16 v[184:187], a[132:135], a[20:23], v[184:187]
 v_mfma_f32_16x16x32_bf16 v[188:191], a[140:143], a[20:23], v[188:191]
 s_add_u32 m0, s31, 77824
 s_mov_b32 s35, 2621440
 v_mfma_f32_16x16x32_bf16 v[188:191], a[136:139], a[16:19], v[188:191]
 buffer_load_dwordx4 v2, s[40:43], s35 offen lds
 v_mfma_f32_16x16x32_bf16 v[204:207], a[136:139], a[24:27], v[204:207]
 v_mfma_f32_16x16x32_bf16 v[204:207], a[140:143], a[28:31], v[204:207]
 v_mfma_f32_16x16x32_bf16 v[200:203], a[132:135], a[28:31], v[200:203]
 v_mfma_f32_16x16x32_bf16 v[200:203], a[128:131], a[24:27], v[200:203]
 v_mfma_f32_16x16x32_bf16 v[196:199], a[120:123], a[24:27], v[196:199]
 s_add_u32 m0, s31, 81920
 s_mov_b32 s35, 2883584
 v_mfma_f32_16x16x32_bf16 v[196:199], a[124:127], a[28:31], v[196:199]
 buffer_load_dwordx4 v2, s[40:43], s35 offen lds
 v_mfma_f32_16x16x32_bf16 v[192:195], a[116:119], a[28:31], v[192:195]
 s_waitcnt vmcnt(24)
 s_waitcnt lgkmcnt(0)
 s_barrier
 v_mfma_f32_16x16x32_bf16 v[192:195], a[112:115], a[24:27], v[192:195]
 s_waitcnt vmcnt(23)
 v_cmp_ne_u32 vcc, 0x01010101, v3
 v_mfma_f32_16x16x32_bf16 v[16:19], a[32:35], a[80:83], v[16:19]
 ds_read_b64_tr_b16 a[112:113], v12 offset:49152
 v_mfma_f32_16x16x32_bf16 v[16:19], a[36:39], a[84:87], v[16:19]
 s_cbranch_vccnz L_loopK_spin
L_loopK_spun:
 ds_read_b64_tr_b16 a[114:115], v12 offset:50176
 v_mfma_f32_16x16x32_bf16 v[20:23], a[44:47], a[84:87], v[20:23]
 s_add_u32 m0, s31, 86016
 s_mov_b32 s35, 3145728
 ds_read_b64_tr_b16 a[116:117], v12 offset:57344
 v_mfma_f32_16x16x32_bf16 v[20:23], a[40:43], a[80:83], v[20:23]
 buffer_load_dwordx4 v2, s[40:43], s35 offen lds
 v_mfma_f32_16x16x32_bf16 v[24:27], a[48:51], a[80:83], v[24:27]
 ds_read_b64_tr_b16 a[118:119], v12 offset:58368
 v_lshrrev_b32 v8, 4, v0
 v_mfma_f32_16x16x32_bf16 v[24:27], a[52:55], a[84:87], v[24:27]
 ds_read_b64_tr_b16 a[120:121], v13 offset:49152
 v_lshlrev_b32 v8, 3, v8
 v_mfma_f32_16x16x32_bf16 v[28:31], a[60:63], a[84:87], v[28:31]
 ds_read_b64_tr_b16 a[122:123], v13 offset:50176
 v_bfe_u32 v9, v0, 2, 2
 v_mfma_f32_16x16x32_bf16 v[28:31], a[56:59], a[80:83], v[28:31]
 s_add_u32 m0, s31, 90112
 v_add_u32 v8, v8, v9
 v_mfma_f32_16x16x32_bf16 v[44:47], a[56:59], a[88:91], v[44:47]
 s_mov_b32 s35, 3407872
 ds_read_b64_tr_b16 a[124:125], v13 offset:57344
 v_lshlrev_b32 v8, 7, v8
 v_mfma_f32_16x16x32_bf16 v[44:47], a[60:63], a[92:95], v[44:47]
 buffer_load_dwordx4 v2, s[40:43], s35 offen lds
 v_mfma_f32_16x16x32_bf16 v[40:43], a[52:55], a[92:95], v[40:43]
 ds_read_b64_tr_b16 a[126:127], v13 offset:58368
 v_bfe_u32 v9, v0, 3, 2
 v_mfma_f32_16x16x32_bf16 v[40:43], a[48:51], a[88:91], v[40:43]
 ds_read_b64_tr_b16 a[128:129], v14 offset:49152
 v_lshlrev_b32 v9, 5, v9
 v_mfma_f32_16x16x32_bf16 v[36:39], a[40:43], a[88:91], v[36:39]
 ds_read_b64_tr_b16 a[130:131], v14 offset:50176
 v_add_u32 v8, v8, v9
 v_mfma_f32_16x16x32_bf16 v[36:39], a[44:47], a[92:95], v[36:39]
 buffer_load_dwordx4 a[180:183], v1, s[16:19], s48 offen offset:1152 sc1
 v_mfma_f32_16x16x32_bf16 v[32:35], a[36:39], a[92:95], v[32:35]
 ds_read_b64_tr_b16 a[132:133], v14 offset:57344
 v_and_b32 v9, 3, v0
 v_mfma_f32_16x16x32_bf16 v[32:35], a[32:35], a[88:91], v[32:35]
 ds_read_b64_tr_b16 a[134:135], v14 offset:58368
 v_lshl_add_u32 v8, v9, 3, v8
 v_mfma_f32_16x16x32_bf16 v[48:51], a[32:35], a[96:99], v[48:51]
 ds_read_b64_tr_b16 a[136:137], v15 offset:49152
 v_mfma_f32_16x16x32_bf16 v[48:51], a[36:39], a[100:103], v[48:51]
 ds_read_b64_tr_b16 a[138:139], v15 offset:50176
 v_add_u32 v4, 131072, v8
 v_mfma_f32_16x16x32_bf16 v[52:55], a[44:47], a[100:103], v[52:55]
 buffer_load_dwordx4 a[236:239], v1, s[16:19], s36 offen offset:1152 sc1
 v_mfma_f32_16x16x32_bf16 v[52:55], a[40:43], a[96:99], v[52:55]
 ds_read_b64_tr_b16 a[140:141], v15 offset:57344
 s_waitcnt vmcnt(18)
 v_xor_b32 v5, 32, v4
 v_mfma_f32_16x16x32_bf16 v[56:59], a[48:51], a[96:99], v[56:59]
 ds_read_b64_tr_b16 a[142:143], v15 offset:58368
 v_xor_b32 v6, 64, v4
 v_mfma_f32_16x16x32_bf16 v[56:59], a[52:55], a[100:103], v[56:59]
 v_xor_b32 v7, 96, v4
 v_mfma_f32_16x16x32_bf16 v[60:63], a[60:63], a[100:103], v[60:63]
 s_lshl_b32 s30, s3, 6
 v_mfma_f32_16x16x32_bf16 v[60:63], a[56:59], a[96:99], v[60:63]
 buffer_load_dwordx4 a[184:187], v1, s[16:19], s48 offen offset:1280 sc1
 v_mfma_f32_16x16x32_bf16 v[76:79], a[56:59], a[104:107], v[76:79]
 v_add_u32 v8, s30, v0
 v_lshrrev_b32 v9, 4, v8
 v_mfma_f32_16x16x32_bf16 v[76:79], a[60:63], a[108:111], v[76:79]
 v_min_u32 v9, 1, v9
 v_mfma_f32_16x16x32_bf16 v[72:75], a[52:55], a[108:111], v[72:75]
 v_mfma_f32_16x16x32_bf16 v[72:75], a[48:51], a[104:107], v[72:75]
 buffer_load_dwordx4 a[240:243], v1, s[16:19], s36 offen offset:1280 sc1
 v_mfma_f32_16x16x32_bf16 v[68:71], a[40:43], a[104:107], v[68:71]
 v_lshlrev_b32 v9, 30, v9
 v_lshl_add_u32 v3, v8, 8, v9
 v_mfma_f32_16x16x32_bf16 v[68:71], a[44:47], a[108:111], v[68:71]
 v_mfma_f32_16x16x32_bf16 v[64:67], a[36:39], a[108:111], v[64:67]
 v_mov_b32 v9, 1
 v_mfma_f32_16x16x32_bf16 v[64:67], a[32:35], a[104:107], v[64:67]
 s_waitcnt lgkmcnt(0)
 s_and_b32 s15, s22, 0xfffff000
 v_mfma_f32_16x16x32_bf16 v[80:83], a[112:115], a[80:83], v[80:83]
 buffer_load_dwordx4 a[188:191], v1, s[16:19], s48 offen offset:1408 sc1
 v_mfma_f32_16x16x32_bf16 v[80:83], a[116:119], a[84:87], v[80:83]
 ds_read_b128 a[0:3], v10 offset:49152
 v_mfma_f32_16x16x32_bf16 v[84:87], a[124:127], a[84:87], v[84:87]
 ds_read_b128 a[4:7], v11 offset:49152
 v_mfma_f32_16x16x32_bf16 v[84:87], a[120:123], a[80:83], v[84:87]
 v_cvt_pk_bf16_f32 v16, v16, v17
 v_cvt_pk_bf16_f32 v17, v18, v19
 v_mfma_f32_16x16x32_bf16 v[88:91], a[128:131], a[80:83], v[88:91]
 v_cvt_pk_bf16_f32 v18, v20, v21
 v_mfma_f32_16x16x32_bf16 v[88:91], a[132:135], a[84:87], v[88:91]
 buffer_load_dwordx4 a[244:247], v1, s[16:19], s36 offen offset:1408 sc1
 v_mfma_f32_16x16x32_bf16 v[92:95], a[140:143], a[84:87], v[92:95]
 ds_read_b128 a[8:11], v10 offset:51200
 v_cvt_pk_bf16_f32 v19, v22, v23
 v_mfma_f32_16x16x32_bf16 v[92:95], a[136:139], a[80:83], v[92:95]
 v_cvt_pk_bf16_f32 v24, v24, v25
 v_cvt_pk_bf16_f32 v25, v26, v27
 v_mfma_f32_16x16x32_bf16 v[108:111], a[136:139], a[88:91], v[108:111]
 ds_read_b128 a[12:15], v11 offset:51200
 v_cvt_pk_bf16_f32 v26, v28, v29
 v_mfma_f32_16x16x32_bf16 v[108:111], a[140:143], a[92:95], v[108:111]
 v_cvt_pk_bf16_f32 v27, v30, v31
 v_cvt_pk_bf16_f32 v32, v32, v33
 v_mfma_f32_16x16x32_bf16 v[104:107], a[132:135], a[92:95], v[104:107]
 buffer_load_dwordx4 a[192:195], v1, s[16:19], s48 offen offset:1536 sc1
 v_mfma_f32_16x16x32_bf16 v[104:107], a[128:131], a[88:91], v[104:107]
 ds_read_b128 a[16:19], v10 offset:53248
 v_cvt_pk_bf16_f32 v33, v34, v35
 v_mfma_f32_16x16x32_bf16 v[100:103], a[120:123], a[88:91], v[100:103]
 v_cvt_pk_bf16_f32 v34, v36, v37
 v_cvt_pk_bf16_f32 v35, v38, v39
 v_mfma_f32_16x16x32_bf16 v[100:103], a[124:127], a[92:95], v[100:103]
 ds_read_b128 a[20:23], v11 offset:53248
 v_cvt_pk_bf16_f32 v40, v40, v41
 v_mfma_f32_16x16x32_bf16 v[96:99], a[116:119], a[92:95], v[96:99]
 buffer_load_dwordx4 a[248:251], v1, s[16:19], s36 offen offset:1536 sc1
 v_mfma_f32_16x16x32_bf16 v[96:99], a[112:115], a[88:91], v[96:99]
 v_cvt_pk_bf16_f32 v41, v42, v43
 v_cvt_pk_bf16_f32 v42, v44, v45
 v_mfma_f32_16x16x32_bf16 v[112:115], a[112:115], a[96:99], v[112:115]
 ds_read_b128 a[24:27], v10 offset:55296
 v_cvt_pk_bf16_f32 v43, v46, v47
 v_mfma_f32_16x16x32_bf16 v[112:115], a[116:119], a[100:103], v[112:115]
 v_cvt_pk_bf16_f32 v48, v48, v49
 v_cvt_pk_bf16_f32 v49, v50, v51
 v_mfma_f32_16x16x32_bf16 v[116:119], a[124:127], a[100:103], v[116:119]
 v_cvt_pk_bf16_f32 v50, v52, v53
 v_mfma_f32_16x16x32_bf16 v[116:119], a[120:123], a[96:99], v[116:119]
 buffer_load_dwordx4 a[196:199], v1, s[16:19], s48 offen offset:1664 sc1
 v_mfma_f32_16x16x32_bf16 v[120:123], a[128:131], a[96:99], v[120:123]
 ds_read_b128 a[28:31], v11 offset:55296
 v_cvt_pk_bf16_f32 v51, v54, v55
 v_mfma_f32_16x16x32_bf16 v[120:123], a[132:135], a[100:103], v[120:123]
 v_cvt_pk_bf16_f32 v56, v56, v57
 v_cvt_pk_bf16_f32 v57, v58, v59
 v_mfma_f32_16x16x32_bf16 v[124:127], a[140:143], a[100:103], v[124:127]
 v_cvt_pk_bf16_f32 v58, v60, v61
 v_cvt_pk_bf16_f32 v59, v62, v63
 v_mfma_f32_16x16x32_bf16 v[124:127], a[136:139], a[96:99], v[124:127]
 v_cvt_pk_bf16_f32 v64, v64, v65
 v_mfma_f32_16x16x32_bf16 v[140:143], a[136:139], a[104:107], v[140:143]
 buffer_load_dwordx4 a[252:255], v1, s[16:19], s36 offen offset:1664 sc1
 v_mfma_f32_16x16x32_bf16 v[140:143], a[140:143], a[108:111], v[140:143]
 v_cvt_pk_bf16_f32 v65, v66, v67
 v_cvt_pk_bf16_f32 v66, v68, v69
 v_mfma_f32_16x16x32_bf16 v[136:139], a[132:135], a[108:111], v[136:139]
 v_cvt_pk_bf16_f32 v67, v70, v71
 v_cvt_pk_bf16_f32 v72, v72, v73
 v_mfma_f32_16x16x32_bf16 v[136:139], a[128:131], a[104:107], v[136:139]
 v_cvt_pk_bf16_f32 v73, v74, v75
 v_mfma_f32_16x16x32_bf16 v[132:135], a[120:123], a[104:107], v[132:135]
 v_cvt_pk_bf16_f32 v74, v76, v77
 v_mfma_f32_16x16x32_bf16 v[132:135], a[124:127], a[108:111], v[132:135]
 v_cvt_pk_bf16_f32 v75, v78, v79
 v_mfma_f32_16x16x32_bf16 v[128:131], a[116:119], a[108:111], v[128:131]
 s_waitcnt lgkmcnt(0)
 s_barrier
 v_lshlrev_b32 v1, 4, v0
 v_mfma_f32_16x16x32_bf16 v[128:131], a[112:115], a[104:107], v[128:131]
 v_mfma_f32_16x16x32_bf16 v[208:211], a[112:115], a[0:3], v[208:211]
 s_add_u32 m0, s31, 0
 s_mov_b32 s35, 128
 v_mfma_f32_16x16x32_bf16 v[208:211], a[116:119], a[4:7], v[208:211]
 buffer_load_dwordx4 v2, s[40:43], s35 offen lds
 v_mfma_f32_16x16x32_bf16 v[212:215], a[124:127], a[4:7], v[212:215]
 v_mfma_f32_16x16x32_bf16 v[212:215], a[120:123], a[0:3], v[212:215]
 v_cvt_pk_bf16_f32 v80, v80, v81
 v_cvt_pk_bf16_f32 v81, v82, v83
 v_mfma_f32_16x16x32_bf16 v[216:219], a[128:131], a[0:3], v[216:219]
 v_cvt_pk_bf16_f32 v82, v84, v85
 v_mfma_f32_16x16x32_bf16 v[216:219], a[132:135], a[4:7], v[216:219]
 v_cvt_pk_bf16_f32 v83, v86, v87
 v_mfma_f32_16x16x32_bf16 v[220:223], a[140:143], a[4:7], v[220:223]
 v_cvt_pk_bf16_f32 v88, v88, v89
 v_mfma_f32_16x16x32_bf16 v[220:223], a[136:139], a[0:3], v[220:223]
 v_cvt_pk_bf16_f32 v89, v90, v91
 v_mfma_f32_16x16x32_bf16 v[236:239], a[136:139], a[8:11], v[236:239]
 s_mul_i32 s37, s13, 0
 v_cvt_pk_bf16_f32 v90, v92, v93
 v_mfma_f32_16x16x32_bf16 v[236:239], a[140:143], a[12:15], v[236:239]
 s_add_u32 m0, s31, 4096
 s_mov_b32 s35, 262272
 v_cvt_pk_bf16_f32 v91, v94, v95
 v_mfma_f32_16x16x32_bf16 v[232:235], a[132:135], a[12:15], v[232:235]
 s_add_u32 s37, s37, s58
 buffer_load_dwordx4 v2, s[40:43], s35 offen lds
 v_mfma_f32_16x16x32_bf16 v[232:235], a[128:131], a[8:11], v[232:235]
 v_cvt_pk_bf16_f32 v96, v96, v97
 v_cvt_pk_bf16_f32 v97, v98, v99
 v_mfma_f32_16x16x32_bf16 v[228:231], a[120:123], a[8:11], v[228:231]
 v_cvt_pk_bf16_f32 v98, v100, v101
 v_mfma_f32_16x16x32_bf16 v[228:231], a[124:127], a[12:15], v[228:231]
 buffer_store_dwordx4 v[16:19], v1, s[16:19], s37 offen sc1
 v_mfma_f32_16x16x32_bf16 v[224:227], a[116:119], a[12:15], v[224:227]
 v_cvt_pk_bf16_f32 v99, v102, v103
 v_cvt_pk_bf16_f32 v104, v104, v105
 v_mfma_f32_16x16x32_bf16 v[224:227], a[112:115], a[8:11], v[224:227]
 v_cvt_pk_bf16_f32 v105, v106, v107
 v_mfma_f32_16x16x32_bf16 v[240:243], a[112:115], a[16:19], v[240:243]
 v_cvt_pk_bf16_f32 v106, v108, v109
 v_mfma_f32_16x16x32_bf16 v[240:243], a[116:119], a[20:23], v[240:243]
 v_cvt_pk_bf16_f32 v107, v110, v111
 v_mfma_f32_16x16x32_bf16 v[244:247], a[124:127], a[20:23], v[244:247]
 s_add_u32 m0, s31, 8192
 s_mov_b32 s35, 524416
 v_cvt_pk_bf16_f32 v112, v112, v113
 v_mfma_f32_16x16x32_bf16 v[244:247], a[120:123], a[16:19], v[244:247]
 buffer_load_dwordx4 v2, s[40:43], s35 offen lds
 v_mfma_f32_16x16x32_bf16 v[248:251], a[128:131], a[16:19], v[248:251]
 v_cvt_pk_bf16_f32 v113, v114, v115
 v_cvt_pk_bf16_f32 v114, v116, v117
 v_mfma_f32_16x16x32_bf16 v[248:251], a[132:135], a[20:23], v[248:251]
 v_cvt_pk_bf16_f32 v115, v118, v119
 v_mfma_f32_16x16x32_bf16 v[252:255], a[140:143], a[20:23], v[252:255]
 v_cvt_pk_bf16_f32 v120, v120, v121
 v_mfma_f32_16x16x32_bf16 v[252:255], a[136:139], a[16:19], v[252:255]
 v_cvt_pk_bf16_f32 v121, v122, v123
 v_mfma_f32_16x16x32_bf16 a[76:79], a[136:139], a[24:27], a[76:79]
 v_cvt_pk_bf16_f32 v122, v124, v125
 v_mfma_f32_16x16x32_bf16 a[76:79], a[140:143], a[28:31], a[76:79]
 v_cvt_pk_bf16_f32 v123, v126, v127
 v_mfma_f32_16x16x32_bf16 a[72:75], a[132:135], a[28:31], a[72:75]
 v_cvt_pk_bf16_f32 v128, v128, v129
 v_mfma_f32_16x16x32_bf16 a[72:75], a[128:131], a[24:27], a[72:75]
 s_add_u32 m0, s31, 12288
 s_mov_b32 s35, 786560
 v_cvt_pk_bf16_f32 v129, v130, v131
 v_mfma_f32_16x16x32_bf16 a[68:71], a[120:123], a[24:27], a[68:71]
 buffer_load_dwordx4 v2, s[40:43], s35 offen lds
 v_mfma_f32_16x16x32_bf16 a[68:71], a[124:127], a[28:31], a[68:71]
 v_cvt_pk_bf16_f32 v130, v132, v133
 v_cvt_pk_bf16_f32 v131, v134, v135
 v_mfma_f32_16x16x32_bf16 a[64:67], a[116:119], a[28:31], a[64:67]
 v_cvt_pk_bf16_f32 v136, v136, v137
 v_mfma_f32_16x16x32_bf16 a[64:67], a[112:115], a[24:27], a[64:67]
 v_cvt_pk_bf16_f32 v137, v138, v139
 v_mfma_f32_16x16x32_bf16 v[144:147], a[32:35], a[0:3], v[144:147]
 v_cvt_pk_bf16_f32 v138, v140, v141
 v_mfma_f32_16x16x32_bf16 v[144:147], a[36:39], a[4:7], v[144:147]
 v_cvt_pk_bf16_f32 v139, v142, v143
 v_mfma_f32_16x16x32_bf16 v[148:151], a[44:47], a[4:7], v[148:151]
 s_add_u32 s37, s37, s59
 v_mfma_f32_16x16x32_bf16 v[148:151], a[40:43], a[0:3], v[148:151]
 v_cvt_pk_bf16_f32 v208, v208, v209
 v_mfma_f32_16x16x32_bf16 v[152:155], a[48:51], a[0:3], v[152:155]
 s_add_u32 m0, s31, 16384
 s_mov_b32 s35, 1048704
 v_cvt_pk_bf16_f32 v209, v210, v211
 v_mfma_f32_16x16x32_bf16 v[152:155], a[52:55], a[4:7], v[152:155]
 buffer_load_dwordx4 v2, s[40:43], s35 offen lds
 v_mfma_f32_16x16x32_bf16 v[156:159], a[60:63], a[4:7], v[156:159]
 buffer_store_dwordx4 v[24:27], v1, s[16:19], s37 offen sc1
 v_mfma_f32_16x16x32_bf16 v[156:159], a[56:59], a[0:3], v[156:159]
 v_cvt_pk_bf16_f32 v210, v212, v213
 v_cvt_pk_bf16_f32 v211, v214, v215
 v_mfma_f32_16x16x32_bf16 v[172:175], a[56:59], a[8:11], v[172:175]
 v_cvt_pk_bf16_f32 v216, v216, v217
 v_mfma_f32_16x16x32_bf16 v[172:175], a[60:63], a[12:15], v[172:175]
 v_cvt_pk_bf16_f32 v217, v218, v219
 v_mfma_f32_16x16x32_bf16 v[168:171], a[52:55], a[12:15], v[168:171]
 v_cvt_pk_bf16_f32 v218, v220, v221
 v_mfma_f32_16x16x32_bf16 v[168:171], a[48:51], a[8:11], v[168:171]
 v_cvt_pk_bf16_f32 v219, v222, v223
 v_mfma_f32_16x16x32_bf16 v[164:167], a[40:43], a[8:11], v[164:167]
 v_cvt_pk_bf16_f32 v224, v224, v225
 v_mfma_f32_16x16x32_bf16 v[164:167], a[44:47], a[12:15], v[164:167]
 s_add_u32 m0, s31, 20480
 s_mov_b32 s35, 1310848
 v_cvt_pk_bf16_f32 v225, v226, v227
 v_mfma_f32_16x16x32_bf16 v[160:163], a[36:39], a[12:15], v[160:163]
 buffer_load_dwordx4 v2, s[40:43], s35 offen lds
 v_mfma_f32_16x16x32_bf16 v[160:163], a[32:35], a[8:11], v[160:163]
 v_cvt_pk_bf16_f32 v226, v228, v229
 v_mfma_f32_16x16x32_bf16 v[176:179], a[32:35], a[16:19], v[176:179]
 v_cvt_pk_bf16_f32 v227, v230, v231
 v_mfma_f32_16x16x32_bf16 v[176:179], a[36:39], a[20:23], v[176:179]
 s_barrier
 v_cvt_pk_bf16_f32 v232, v232, v233
 v_mfma_f32_16x16x32_bf16 v[180:183], a[44:47], a[20:23], v[180:183]
 ds_read_b64_tr_b16 a[80:81], v4 offset:0
 v_cvt_pk_bf16_f32 v233, v234, v235
 v_mfma_f32_16x16x32_bf16 v[180:183], a[40:43], a[16:19], v[180:183]
 ds_read_b64_tr_b16 a[82:83], v4 offset:512
 v_cvt_pk_bf16_f32 v234, v236, v237
 v_mfma_f32_16x16x32_bf16 v[184:187], a[48:51], a[16:19], v[184:187]
 ds_read_b64_tr_b16 a[84:85], v4 offset:4096
 v_mfma_f32_16x16x32_bf16 v[184:187], a[52:55], a[20:23], v[184:187]
 ds_read_b64_tr_b16 a[86:87], v4 offset:4608
 v_cvt_pk_bf16_f32 v235, v238, v239
 v_mfma_f32_16x16x32_bf16 v[188:191], a[60:63], a[20:23], v[188:191]
 s_add_u32 m0, s31, 24576
 s_mov_b32 s35, 1572992
 ds_read_b64_tr_b16 a[88:89], v4 offset:8192
 v_mfma_f32_16x16x32_bf16 v[188:191], a[56:59], a[16:19], v[188:191]
 buffer_load_dwordx4 v2, s[40:43], s35 offen lds
 v_mfma_f32_16x16x32_bf16 v[204:207], a[56:59], a[24:27], v[204:207]
 ds_read_b64_tr_b16 a[90:91], v4 offset:8704
 ds_read_b64_tr_b16 a[92:93], v4 offset:12288
 v_mfma_f32_16x16x32_bf16 v[204:207], a[60:63], a[28:31], v[204:207]
 ds_read_b64_tr_b16 a[94:95], v4 offset:12800
 v_cvt_pk_bf16_f32 v240, v240, v241
 v_mfma_f32_16x16x32_bf16 v[200:203], a[52:55], a[28:31], v[200:203]
 ds_read_b64_tr_b16 a[96:97], v4 offset:16384
 v_cvt_pk_bf16_f32 v241, v242, v243
 v_mfma_f32_16x16x32_bf16 v[200:203], a[48:51], a[24:27], v[200:203]
 ds_read_b64_tr_b16 a[98:99], v4 offset:16896
 v_cvt_pk_bf16_f32 v242, v244, v245
 v_mfma_f32_16x16x32_bf16 v[196:199], a[40:43], a[24:27], v[196:199]
 ds_read_b64_tr_b16 a[100:101], v4 offset:20480
 v_cvt_pk_bf16_f32 v243, v246, v247
 v_mfma_f32_16x16x32_bf16 v[196:199], a[44:47], a[28:31], v[196:199]
 ds_read_b64_tr_b16 a[102:103], v4 offset:20992
 v_cvt_pk_bf16_f32 v248, v248, v249
 v_mfma_f32_16x16x32_bf16 v[192:195], a[36:39], a[28:31], v[192:195]
 ds_read_b64_tr_b16 a[104:105], v4 offset:24576
 v_cvt_pk_bf16_f32 v249, v250, v251
 v_mfma_f32_16x16x32_bf16 v[192:195], a[32:35], a[24:27], v[192:195]
 ds_read_b64_tr_b16 a[106:107], v4 offset:25088
 v_cvt_pk_bf16_f32 v250, v252, v253
 v_cvt_pk_bf16_f32 v251, v254, v255
 s_branch L_q
L_firstV:
 s_waitcnt lgkmcnt(14)
 v_mfma_f32_16x16x32_bf16 v[16:19], a[80:83], a[112:115], 0
 s_waitcnt lgkmcnt(12)
 s_add_u32 m0, s32, 32768
 s_add_u32 s35, s33, 128
 v_mfma_f32_16x16x32_bf16 v[16:19], a[84:87], a[116:119], v[16:19]
 s_waitcnt lgkmcnt(8)
 buffer_load_dwordx4 v2, s[8:11], s35 offen offset:0 lds
 v_mfma_f32_16x16x32_bf16 v[32:35], a[84:87], a[124:127], 0
 v_mfma_f32_16x16x32_bf16 v[32:35], a[80:83], a[120:123], v[32:35]
 s_waitcnt lgkmcnt(6)
 v_mfma_f32_16x16x32_bf16 v[48:51], a[80:83], a[128:131], 0
 s_waitcnt lgkmcnt(0)
 v_mfma_f32_16x16x32_bf16 v[48:51], a[84:87], a[132:135], v[48:51]
 s_waitcnt vmcnt(8)
 s_waitcnt lgkmcnt(0)
 s_barrier
 v_mfma_f32_16x16x32_bf16 v[64:67], a[84:87], a[140:143], 0
 buffer_load_dwordx4 v3, s[8:11], s35 offen offset:1024 lds
 v_mfma_f32_16x16x32_bf16 v[64:67], a[80:83], a[136:139], v[64:67]
 ds_read_b64_tr_b16 a[32:33], v12 offset:16384
 ds_read_b64_tr_b16 a[34:35], v12 offset:17408
 v_mfma_f32_16x16x32_bf16 v[68:71], a[88:91], a[136:139], 0
 ds_read_b64_tr_b16 a[36:37], v12 offset:24576
 v_mfma_f32_16x16x32_bf16 v[68:71], a[92:95], a[140:143], v[68:71]
 ds_read_b64_tr_b16 a[38:39], v12 offset:25600
 v_mfma_f32_16x16x32_bf16 v[52:55], a[92:95], a[132:135], 0
 buffer_load_dwordx4 v4, s[8:11], s35 offen offset:2048 lds
 v_mfma_f32_16x16x32_bf16 v[52:55], a[88:91], a[128:131], v[52:55]
 ds_read_b64_tr_b16 a[40:41], v13 offset:16384
 ds_read_b64_tr_b16 a[42:43], v13 offset:17408
 v_mfma_f32_16x16x32_bf16 v[36:39], a[88:91], a[120:123], 0
 v_mfma_f32_16x16x32_bf16 v[36:39], a[92:95], a[124:127], v[36:39]
 ds_read_b64_tr_b16 a[44:45], v13 offset:24576
 v_mfma_f32_16x16x32_bf16 v[20:23], a[92:95], a[116:119], 0
 buffer_load_dwordx4 v5, s[8:11], s35 offen offset:3072 lds
 v_mfma_f32_16x16x32_bf16 v[20:23], a[88:91], a[112:115], v[20:23]
 s_add_u32 m0, s32, 98304
 s_add_u32 s35, s34, 524288
 ds_read_b64_tr_b16 a[46:47], v13 offset:25600
 v_mfma_f32_16x16x32_bf16 v[24:27], a[96:99], a[112:115], 0
 ds_read_b64_tr_b16 a[48:49], v14 offset:16384
 ds_read_b64_tr_b16 a[50:51], v14 offset:17408
 v_mfma_f32_16x16x32_bf16 v[24:27], a[100:103], a[116:119], v[24:27]
 ds_read_b64_tr_b16 a[52:53], v14 offset:24576
 v_mfma_f32_16x16x32_bf16 v[40:43], a[100:103], a[124:127], 0
 buffer_load_dwordx4 v6, s[12:15], s35 offen offset:0 nt lds
 v_mfma_f32_16x16x32_bf16 v[40:43], a[96:99], a[120:123], v[40:43]
 ds_read_b64_tr_b16 a[54:55], v14 offset:25600
 v_mfma_f32_16x16x32_bf16 v[56:59], a[96:99], a[128:131], 0
 ds_read_b64_tr_b16 a[56:57], v15 offset:16384
 v_mfma_f32_16x16x32_bf16 v[56:59], a[100:103], a[132:135], v[56:59]
 ds_read_b64_tr_b16 a[58:59], v15 offset:17408
 v_mfma_f32_16x16x32_bf16 v[72:75], a[100:103], a[140:143], 0
 buffer_load_dwordx4 v7, s[12:15], s35 offen offset:1024 nt lds
 v_mfma_f32_16x16x32_bf16 v[72:75], a[96:99], a[136:139], v[72:75]
 ds_read_b64_tr_b16 a[60:61], v15 offset:24576
 ds_read_b64_tr_b16 a[62:63], v15 offset:25600
 v_mfma_f32_16x16x32_bf16 v[76:79], a[104:107], a[136:139], 0
 v_mfma_f32_16x16x32_bf16 v[76:79], a[108:111], a[140:143], v[76:79]
 v_mfma_f32_16x16x32_bf16 v[60:63], a[108:111], a[132:135], 0
 buffer_load_dwordx4 v8, s[12:15], s35 offen offset:2048 nt lds
 v_mfma_f32_16x16x32_bf16 v[60:63], a[104:107], a[128:131], v[60:63]
 v_mfma_f32_16x16x32_bf16 v[44:47], a[104:107], a[120:123], 0
 v_mfma_f32_16x16x32_bf16 v[44:47], a[108:111], a[124:127], v[44:47]
 buffer_load_dwordx4 v9, s[12:15], s35 offen offset:3072 nt lds
 v_mfma_f32_16x16x32_bf16 v[28:31], a[108:111], a[116:119], 0
 v_mfma_f32_16x16x32_bf16 v[28:31], a[104:107], a[112:115], v[28:31]
 s_waitcnt lgkmcnt(0)
 v_mfma_f32_16x16x32_bf16 v[80:83], a[80:83], a[32:35], 0
 s_add_u32 m0, s32, 114688
 s_add_u32 s35, s34, 524544
 v_mfma_f32_16x16x32_bf16 v[80:83], a[84:87], a[36:39], v[80:83]
 buffer_load_dwordx4 v6, s[12:15], s35 offen offset:0 nt lds
 v_mfma_f32_16x16x32_bf16 v[96:99], a[84:87], a[44:47], 0
 v_mfma_f32_16x16x32_bf16 v[96:99], a[80:83], a[40:43], v[96:99]
 v_mfma_f32_16x16x32_bf16 v[112:115], a[80:83], a[48:51], 0
 v_mfma_f32_16x16x32_bf16 v[112:115], a[84:87], a[52:55], v[112:115]
 s_waitcnt vmcnt(12)
 s_waitcnt lgkmcnt(0)
 s_barrier
 v_mfma_f32_16x16x32_bf16 v[128:131], a[84:87], a[60:63], 0
 buffer_load_dwordx4 v7, s[12:15], s35 offen offset:1024 nt lds
 v_mfma_f32_16x16x32_bf16 v[128:131], a[80:83], a[56:59], v[128:131]
 ds_read_b128 a[0:3], v10 offset:16384
 v_mfma_f32_16x16x32_bf16 v[132:135], a[88:91], a[56:59], 0
 ds_read_b128 a[4:7], v11 offset:16384
 v_mfma_f32_16x16x32_bf16 v[132:135], a[92:95], a[60:63], v[132:135]
 v_mfma_f32_16x16x32_bf16 v[116:119], a[92:95], a[52:55], 0
 buffer_load_dwordx4 v8, s[12:15], s35 offen offset:2048 nt lds
 v_mfma_f32_16x16x32_bf16 v[116:119], a[88:91], a[48:51], v[116:119]
 ds_read_b128 a[8:11], v10 offset:18432
 v_mfma_f32_16x16x32_bf16 v[100:103], a[88:91], a[40:43], 0
 v_mfma_f32_16x16x32_bf16 v[100:103], a[92:95], a[44:47], v[100:103]
 ds_read_b128 a[12:15], v11 offset:18432
 v_mfma_f32_16x16x32_bf16 v[84:87], a[92:95], a[36:39], 0
 buffer_load_dwordx4 v9, s[12:15], s35 offen offset:3072 nt lds
 v_mfma_f32_16x16x32_bf16 v[84:87], a[88:91], a[32:35], v[84:87]
 s_add_u32 m0, s32, 49152
 s_add_u32 s35, s33, 2097280
 ds_read_b128 a[16:19], v10 offset:20480
 v_mfma_f32_16x16x32_bf16 v[88:91], a[96:99], a[32:35], 0
 v_mfma_f32_16x16x32_bf16 v[88:91], a[100:103], a[36:39], v[88:91]
 ds_read_b128 a[20:23], v11 offset:20480
 v_mfma_f32_16x16x32_bf16 v[104:107], a[100:103], a[44:47], 0
 buffer_load_dwordx4 v2, s[8:11], s35 offen offset:0 lds
 v_mfma_f32_16x16x32_bf16 v[104:107], a[96:99], a[40:43], v[104:107]
 v_mfma_f32_16x16x32_bf16 v[120:123], a[96:99], a[48:51], 0
 ds_read_b128 a[24:27], v10 offset:22528
 v_mfma_f32_16x16x32_bf16 v[120:123], a[100:103], a[52:55], v[120:123]
 v_mfma_f32_16x16x32_bf16 v[136:139], a[100:103], a[60:63], 0
 buffer_load_dwordx4 v3, s[8:11], s35 offen offset:1024 lds
 v_mfma_f32_16x16x32_bf16 v[136:139], a[96:99], a[56:59], v[136:139]
 ds_read_b128 a[28:31], v11 offset:22528
 v_mfma_f32_16x16x32_bf16 v[140:143], a[104:107], a[56:59], 0
 v_mfma_f32_16x16x32_bf16 v[140:143], a[108:111], a[60:63], v[140:143]
 v_mfma_f32_16x16x32_bf16 v[124:127], a[108:111], a[52:55], 0
 buffer_load_dwordx4 v4, s[8:11], s35 offen offset:2048 lds
 v_mfma_f32_16x16x32_bf16 v[124:127], a[104:107], a[48:51], v[124:127]
 v_mfma_f32_16x16x32_bf16 v[108:111], a[104:107], a[40:43], 0
 v_mfma_f32_16x16x32_bf16 v[108:111], a[108:111], a[44:47], v[108:111]
 buffer_load_dwordx4 v5, s[8:11], s35 offen offset:3072 lds
 v_mfma_f32_16x16x32_bf16 v[92:95], a[108:111], a[36:39], 0
 v_mfma_f32_16x16x32_bf16 v[92:95], a[104:107], a[32:35], v[92:95]
 s_waitcnt lgkmcnt(0)
 v_mfma_f32_16x16x32_bf16 v[208:211], a[0:3], a[32:35], 0
 s_add_u32 s33, s33, 256
 s_add_u32 s34, s34, 1048576
 v_mfma_f32_16x16x32_bf16 v[208:211], a[4:7], a[36:39], v[208:211]
 s_add_u32 m0, s32, 0
 s_add_u32 s35, s33, 0
 v_mfma_f32_16x16x32_bf16 v[224:227], a[4:7], a[44:47], 0
 buffer_load_dwordx4 v2, s[8:11], s35 offen offset:0 lds
 v_mfma_f32_16x16x32_bf16 v[224:227], a[0:3], a[40:43], v[224:227]
 v_mfma_f32_16x16x32_bf16 v[240:243], a[0:3], a[48:51], 0
 v_mfma_f32_16x16x32_bf16 v[240:243], a[4:7], a[52:55], v[240:243]
 s_waitcnt vmcnt(13)
 s_waitcnt lgkmcnt(0)
 s_barrier
 v_mfma_f32_16x16x32_bf16 a[64:67], a[4:7], a[60:63], 0
 buffer_load_dwordx4 v3, s[8:11], s35 offen offset:1024 lds
 v_mfma_f32_16x16x32_bf16 a[64:67], a[0:3], a[56:59], a[64:67]
 ds_read_b128 a[80:83], v10 offset:32768
 v_mfma_f32_16x16x32_bf16 a[68:71], a[8:11], a[56:59], 0
 ds_read_b128 a[84:87], v11 offset:32768
 v_mfma_f32_16x16x32_bf16 a[68:71], a[12:15], a[60:63], a[68:71]
 v_mfma_f32_16x16x32_bf16 v[244:247], a[12:15], a[52:55], 0
 buffer_load_dwordx4 v4, s[8:11], s35 offen offset:2048 lds
 v_mfma_f32_16x16x32_bf16 v[244:247], a[8:11], a[48:51], v[244:247]
 ds_read_b128 a[88:91], v10 offset:34816
 v_mfma_f32_16x16x32_bf16 v[228:231], a[8:11], a[40:43], 0
 v_mfma_f32_16x16x32_bf16 v[228:231], a[12:15], a[44:47], v[228:231]
 ds_read_b128 a[92:95], v11 offset:34816
 v_mfma_f32_16x16x32_bf16 v[212:215], a[12:15], a[36:39], 0
 buffer_load_dwordx4 v5, s[8:11], s35 offen offset:3072 lds
 v_mfma_f32_16x16x32_bf16 v[212:215], a[8:11], a[32:35], v[212:215]
 s_add_u32 m0, s32, 65536
 s_add_u32 s35, s34, 0
 ds_read_b128 a[96:99], v10 offset:36864
 v_mfma_f32_16x16x32_bf16 v[216:219], a[16:19], a[32:35], 0
 v_mfma_f32_16x16x32_bf16 v[216:219], a[20:23], a[36:39], v[216:219]
 ds_read_b128 a[100:103], v11 offset:36864
 v_mfma_f32_16x16x32_bf16 v[232:235], a[20:23], a[44:47], 0
 buffer_load_dwordx4 v6, s[12:15], s35 offen offset:0 nt lds
 v_mfma_f32_16x16x32_bf16 v[232:235], a[16:19], a[40:43], v[232:235]
 v_mfma_f32_16x16x32_bf16 v[248:251], a[16:19], a[48:51], 0
 ds_read_b128 a[104:107], v10 offset:38912
 v_mfma_f32_16x16x32_bf16 v[248:251], a[20:23], a[52:55], v[248:251]
 v_mfma_f32_16x16x32_bf16 a[72:75], a[20:23], a[60:63], 0
 buffer_load_dwordx4 v7, s[12:15], s35 offen offset:1024 nt lds
 v_mfma_f32_16x16x32_bf16 a[72:75], a[16:19], a[56:59], a[72:75]
 ds_read_b128 a[108:111], v11 offset:38912
 v_mfma_f32_16x16x32_bf16 a[76:79], a[24:27], a[56:59], 0
 v_mfma_f32_16x16x32_bf16 a[76:79], a[28:31], a[60:63], a[76:79]
 v_mfma_f32_16x16x32_bf16 v[252:255], a[28:31], a[52:55], 0
 buffer_load_dwordx4 v8, s[12:15], s35 offen offset:2048 nt lds
 v_mfma_f32_16x16x32_bf16 v[252:255], a[24:27], a[48:51], v[252:255]
 v_mfma_f32_16x16x32_bf16 v[236:239], a[24:27], a[40:43], 0
 v_mfma_f32_16x16x32_bf16 v[236:239], a[28:31], a[44:47], v[236:239]
 buffer_load_dwordx4 v9, s[12:15], s35 offen offset:3072 nt lds
 v_mfma_f32_16x16x32_bf16 v[220:223], a[28:31], a[36:39], 0
 v_mfma_f32_16x16x32_bf16 v[220:223], a[24:27], a[32:35], v[220:223]
 v_mfma_f32_16x16x32_bf16 v[144:147], a[0:3], a[112:115], 0
 s_add_u32 m0, s32, 81920
 s_add_u32 s35, s34, 256
 v_mfma_f32_16x16x32_bf16 v[144:147], a[4:7], a[116:119], v[144:147]
 buffer_load_dwordx4 v6, s[12:15], s35 offen offset:0 nt lds
 v_mfma_f32_16x16x32_bf16 v[160:163], a[4:7], a[124:127], 0
 v_mfma_f32_16x16x32_bf16 v[160:163], a[0:3], a[120:123], v[160:163]
 v_mfma_f32_16x16x32_bf16 v[176:179], a[0:3], a[128:131], 0
 v_mfma_f32_16x16x32_bf16 v[176:179], a[4:7], a[132:135], v[176:179]
 s_waitcnt vmcnt(17)
 s_waitcnt lgkmcnt(0)
 s_barrier
 v_mfma_f32_16x16x32_bf16 v[192:195], a[4:7], a[140:143], 0
 buffer_load_dwordx4 v7, s[12:15], s35 offen offset:1024 nt lds
 v_mfma_f32_16x16x32_bf16 v[192:195], a[0:3], a[136:139], v[192:195]
 ds_read_b64_tr_b16 a[32:33], v12 offset:32768
 ds_read_b64_tr_b16 a[34:35], v12 offset:33792
 v_mfma_f32_16x16x32_bf16 v[196:199], a[8:11], a[136:139], 0
 ds_read_b64_tr_b16 a[36:37], v12 offset:40960
 v_mfma_f32_16x16x32_bf16 v[196:199], a[12:15], a[140:143], v[196:199]
 ds_read_b64_tr_b16 a[38:39], v12 offset:41984
 v_mfma_f32_16x16x32_bf16 v[180:183], a[12:15], a[132:135], 0
 buffer_load_dwordx4 v8, s[12:15], s35 offen offset:2048 nt lds
 v_mfma_f32_16x16x32_bf16 v[180:183], a[8:11], a[128:131], v[180:183]
 ds_read_b64_tr_b16 a[40:41], v13 offset:32768
 ds_read_b64_tr_b16 a[42:43], v13 offset:33792
 v_mfma_f32_16x16x32_bf16 v[164:167], a[8:11], a[120:123], 0
 v_mfma_f32_16x16x32_bf16 v[164:167], a[12:15], a[124:127], v[164:167]
 ds_read_b64_tr_b16 a[44:45], v13 offset:40960
 v_mfma_f32_16x16x32_bf16 v[148:151], a[12:15], a[116:119], 0
 buffer_load_dwordx4 v9, s[12:15], s35 offen offset:3072 nt lds
 v_mfma_f32_16x16x32_bf16 v[148:151], a[8:11], a[112:115], v[148:151]
 s_add_u32 m0, s32, 16384
 s_add_u32 s35, s33, 2097152
 ds_read_b64_tr_b16 a[46:47], v13 offset:41984
 v_mfma_f32_16x16x32_bf16 v[152:155], a[16:19], a[112:115], 0
 ds_read_b64_tr_b16 a[48:49], v14 offset:32768
 ds_read_b64_tr_b16 a[50:51], v14 offset:33792
 v_mfma_f32_16x16x32_bf16 v[152:155], a[20:23], a[116:119], v[152:155]
 ds_read_b64_tr_b16 a[52:53], v14 offset:40960
 v_mfma_f32_16x16x32_bf16 v[168:171], a[20:23], a[124:127], 0
 buffer_load_dwordx4 v2, s[8:11], s35 offen offset:0 lds
 v_mfma_f32_16x16x32_bf16 v[168:171], a[16:19], a[120:123], v[168:171]
 ds_read_b64_tr_b16 a[54:55], v14 offset:41984
 v_mfma_f32_16x16x32_bf16 v[184:187], a[16:19], a[128:131], 0
 ds_read_b64_tr_b16 a[56:57], v15 offset:32768
 v_mfma_f32_16x16x32_bf16 v[184:187], a[20:23], a[132:135], v[184:187]
 ds_read_b64_tr_b16 a[58:59], v15 offset:33792
 v_mfma_f32_16x16x32_bf16 v[200:203], a[20:23], a[140:143], 0
 buffer_load_dwordx4 v3, s[8:11], s35 offen offset:1024 lds
 v_mfma_f32_16x16x32_bf16 v[200:203], a[16:19], a[136:139], v[200:203]
 ds_read_b64_tr_b16 a[60:61], v15 offset:40960
 ds_read_b64_tr_b16 a[62:63], v15 offset:41984
 v_mfma_f32_16x16x32_bf16 v[204:207], a[24:27], a[136:139], 0
 v_mfma_f32_16x16x32_bf16 v[204:207], a[28:31], a[140:143], v[204:207]
 v_mfma_f32_16x16x32_bf16 v[188:191], a[28:31], a[132:135], 0
 buffer_load_dwordx4 v4, s[8:11], s35 offen offset:2048 lds
 v_mfma_f32_16x16x32_bf16 v[188:191], a[24:27], a[128:131], v[188:191]
 v_mfma_f32_16x16x32_bf16 v[172:175], a[24:27], a[120:123], 0
 v_mfma_f32_16x16x32_bf16 v[172:175], a[28:31], a[124:127], v[172:175]
 buffer_load_dwordx4 v5, s[8:11], s35 offen offset:3072 lds
 v_mfma_f32_16x16x32_bf16 v[156:159], a[28:31], a[116:119], 0
 v_mfma_f32_16x16x32_bf16 v[156:159], a[24:27], a[112:115], v[156:159]
 s_waitcnt lgkmcnt(0)
 v_mfma_f32_16x16x32_bf16 v[16:19], a[80:83], a[32:35], v[16:19]
 s_add_u32 m0, s32, 32768
 s_add_u32 s35, s33, 128
 v_mfma_f32_16x16x32_bf16 v[16:19], a[84:87], a[36:39], v[16:19]
 buffer_load_dwordx4 v2, s[8:11], s35 offen offset:0 lds
 v_mfma_f32_16x16x32_bf16 v[32:35], a[84:87], a[44:47], v[32:35]
 v_mfma_f32_16x16x32_bf16 v[32:35], a[80:83], a[40:43], v[32:35]
 v_mfma_f32_16x16x32_bf16 v[48:51], a[80:83], a[48:51], v[48:51]
 v_mfma_f32_16x16x32_bf16 v[48:51], a[84:87], a[52:55], v[48:51]
 s_waitcnt vmcnt(21)
 s_waitcnt lgkmcnt(0)
 s_barrier
 v_mfma_f32_16x16x32_bf16 v[64:67], a[84:87], a[60:63], v[64:67]
 ds_read_b64_tr_b16 a[112:113], v12 offset:49152
 v_mfma_f32_16x16x32_bf16 v[64:67], a[80:83], a[56:59], v[64:67]
 ds_read_b64_tr_b16 a[114:115], v12 offset:50176
 v_mfma_f32_16x16x32_bf16 v[68:71], a[88:91], a[56:59], v[68:71]
 buffer_load_dwordx4 v3, s[8:11], s35 offen offset:1024 lds
 v_mfma_f32_16x16x32_bf16 v[68:71], a[92:95], a[60:63], v[68:71]
 ds_read_b64_tr_b16 a[116:117], v12 offset:57344
 ds_read_b64_tr_b16 a[118:119], v12 offset:58368
 v_mfma_f32_16x16x32_bf16 v[52:55], a[92:95], a[52:55], v[52:55]
 ds_read_b64_tr_b16 a[120:121], v13 offset:49152
 v_mfma_f32_16x16x32_bf16 v[52:55], a[88:91], a[48:51], v[52:55]
 ds_read_b64_tr_b16 a[122:123], v13 offset:50176
 v_mfma_f32_16x16x32_bf16 v[36:39], a[88:91], a[40:43], v[36:39]
 v_mfma_f32_16x16x32_bf16 v[36:39], a[92:95], a[44:47], v[36:39]
 ds_read_b64_tr_b16 a[124:125], v13 offset:57344
 v_mfma_f32_16x16x32_bf16 v[20:23], a[92:95], a[36:39], v[20:23]
 ds_read_b64_tr_b16 a[126:127], v13 offset:58368
 v_mfma_f32_16x16x32_bf16 v[20:23], a[88:91], a[32:35], v[20:23]
 buffer_load_dwordx4 v4, s[8:11], s35 offen offset:2048 lds
 v_mfma_f32_16x16x32_bf16 v[24:27], a[96:99], a[32:35], v[24:27]
 ds_read_b64_tr_b16 a[128:129], v14 offset:49152
 ds_read_b64_tr_b16 a[130:131], v14 offset:50176
 v_mfma_f32_16x16x32_bf16 v[24:27], a[100:103], a[36:39], v[24:27]
 ds_read_b64_tr_b16 a[132:133], v14 offset:57344
 v_mfma_f32_16x16x32_bf16 v[40:43], a[100:103], a[44:47], v[40:43]
 v_mfma_f32_16x16x32_bf16 v[40:43], a[96:99], a[40:43], v[40:43]
 ds_read_b64_tr_b16 a[134:135], v14 offset:58368
 v_mfma_f32_16x16x32_bf16 v[56:59], a[96:99], a[48:51], v[56:59]
 ds_read_b64_tr_b16 a[136:137], v15 offset:49152
 v_mfma_f32_16x16x32_bf16 v[56:59], a[100:103], a[52:55], v[56:59]
 ds_read_b64_tr_b16 a[138:139], v15 offset:50176
 v_mfma_f32_16x16x32_bf16 v[72:75], a[100:103], a[60:63], v[72:75]
 buffer_load_dwordx4 v5, s[8:11], s35 offen offset:3072 lds
 v_mfma_f32_16x16x32_bf16 v[72:75], a[96:99], a[56:59], v[72:75]
 ds_read_b64_tr_b16 a[140:141], v15 offset:57344
 ds_read_b64_tr_b16 a[142:143], v15 offset:58368
 v_mfma_f32_16x16x32_bf16 v[76:79], a[104:107], a[56:59], v[76:79]
 v_mfma_f32_16x16x32_bf16 v[76:79], a[108:111], a[60:63], v[76:79]
 v_mfma_f32_16x16x32_bf16 v[60:63], a[108:111], a[52:55], v[60:63]
 v_mfma_f32_16x16x32_bf16 v[60:63], a[104:107], a[48:51], v[60:63]
 v_mfma_f32_16x16x32_bf16 v[44:47], a[104:107], a[40:43], v[44:47]
 v_mfma_f32_16x16x32_bf16 v[44:47], a[108:111], a[44:47], v[44:47]
 v_mfma_f32_16x16x32_bf16 v[28:31], a[108:111], a[36:39], v[28:31]
 v_mfma_f32_16x16x32_bf16 v[28:31], a[104:107], a[32:35], v[28:31]
 s_waitcnt lgkmcnt(0)
 v_mfma_f32_16x16x32_bf16 v[80:83], a[80:83], a[112:115], v[80:83]
 s_add_u32 m0, s32, 98304
 s_add_u32 s35, s34, 524288
 v_mfma_f32_16x16x32_bf16 v[80:83], a[84:87], a[116:119], v[80:83]
 buffer_load_dwordx4 v6, s[12:15], s35 offen offset:0 nt lds
 v_mfma_f32_16x16x32_bf16 v[96:99], a[84:87], a[124:127], v[96:99]
 v_mfma_f32_16x16x32_bf16 v[96:99], a[80:83], a[120:123], v[96:99]
 v_mfma_f32_16x16x32_bf16 v[112:115], a[80:83], a[128:131], v[112:115]
 v_mfma_f32_16x16x32_bf16 v[112:115], a[84:87], a[132:135], v[112:115]
 s_waitcnt vmcnt(21)
 s_waitcnt lgkmcnt(0)
 s_barrier
 v_mfma_f32_16x16x32_bf16 v[128:131], a[84:87], a[140:143], v[128:131]
 ds_read_b128 a[0:3], v10 offset:49152
 v_mfma_f32_16x16x32_bf16 v[128:131], a[80:83], a[136:139], v[128:131]
 v_mfma_f32_16x16x32_bf16 v[132:135], a[88:91], a[136:139], v[132:135]
 buffer_load_dwordx4 v7, s[12:15], s35 offen offset:1024 nt lds
 v_mfma_f32_16x16x32_bf16 v[132:135], a[92:95], a[140:143], v[132:135]
 ds_read_b128 a[4:7], v11 offset:49152
 v_mfma_f32_16x16x32_bf16 v[116:119], a[92:95], a[132:135], v[116:119]
 ds_read_b128 a[8:11], v10 offset:51200
 v_mfma_f32_16x16x32_bf16 v[116:119], a[88:91], a[128:131], v[116:119]
 v_mfma_f32_16x16x32_bf16 v[100:103], a[88:91], a[120:123], v[100:103]
 v_mfma_f32_16x16x32_bf16 v[100:103], a[92:95], a[124:127], v[100:103]
 ds_read_b128 a[12:15], v11 offset:51200
 v_mfma_f32_16x16x32_bf16 v[84:87], a[92:95], a[116:119], v[84:87]
 v_mfma_f32_16x16x32_bf16 v[84:87], a[88:91], a[112:115], v[84:87]
 buffer_load_dwordx4 v8, s[12:15], s35 offen offset:2048 nt lds
 v_mfma_f32_16x16x32_bf16 v[88:91], a[96:99], a[112:115], v[88:91]
 ds_read_b128 a[16:19], v10 offset:53248
 v_mfma_f32_16x16x32_bf16 v[88:91], a[100:103], a[116:119], v[88:91]
 ds_read_b128 a[20:23], v11 offset:53248
 v_mfma_f32_16x16x32_bf16 v[104:107], a[100:103], a[124:127], v[104:107]
 v_mfma_f32_16x16x32_bf16 v[104:107], a[96:99], a[120:123], v[104:107]
 v_mfma_f32_16x16x32_bf16 v[120:123], a[96:99], a[128:131], v[120:123]
 ds_read_b128 a[24:27], v10 offset:55296
 v_mfma_f32_16x16x32_bf16 v[120:123], a[100:103], a[132:135], v[120:123]
 v_mfma_f32_16x16x32_bf16 v[136:139], a[100:103], a[140:143], v[136:139]
 buffer_load_dwordx4 v9, s[12:15], s35 offen offset:3072 nt lds
 v_mfma_f32_16x16x32_bf16 v[136:139], a[96:99], a[136:139], v[136:139]
 ds_read_b128 a[28:31], v11 offset:55296
 v_mfma_f32_16x16x32_bf16 v[140:143], a[104:107], a[136:139], v[140:143]
 v_mfma_f32_16x16x32_bf16 v[140:143], a[108:111], a[140:143], v[140:143]
 v_mfma_f32_16x16x32_bf16 v[124:127], a[108:111], a[132:135], v[124:127]
 v_mfma_f32_16x16x32_bf16 v[124:127], a[104:107], a[128:131], v[124:127]
 v_mfma_f32_16x16x32_bf16 v[108:111], a[104:107], a[120:123], v[108:111]
 v_mfma_f32_16x16x32_bf16 v[108:111], a[108:111], a[124:127], v[108:111]
 v_mfma_f32_16x16x32_bf16 v[92:95], a[108:111], a[116:119], v[92:95]
 v_mfma_f32_16x16x32_bf16 v[92:95], a[104:107], a[112:115], v[92:95]
 s_waitcnt lgkmcnt(0)
 v_mfma_f32_16x16x32_bf16 v[208:211], a[0:3], a[112:115], v[208:211]
 s_add_u32 m0, s32, 114688
 s_add_u32 s35, s34, 524544
 v_mfma_f32_16x16x32_bf16 v[208:211], a[4:7], a[116:119], v[208:211]
 buffer_load_dwordx4 v6, s[12:15], s35 offen offset:0 nt lds
 v_mfma_f32_16x16x32_bf16 v[224:227], a[4:7], a[124:127], v[224:227]
 v_mfma_f32_16x16x32_bf16 v[224:227], a[0:3], a[120:123], v[224:227]
 v_mfma_f32_16x16x32_bf16 v[240:243], a[0:3], a[128:131], v[240:243]
 v_mfma_f32_16x16x32_bf16 v[240:243], a[4:7], a[132:135], v[240:243]
 s_waitcnt vmcnt(21)
 s_waitcnt lgkmcnt(0)
 s_barrier
 v_mfma_f32_16x16x32_bf16 a[64:67], a[4:7], a[140:143], a[64:67]
 ds_read_b128 a[80:83], v10 offset:0
 v_mfma_f32_16x16x32_bf16 a[64:67], a[0:3], a[136:139], a[64:67]
 v_mfma_f32_16x16x32_bf16 a[68:71], a[8:11], a[136:139], a[68:71]
 global_load_dword a254, v[0:1], off
 v_mfma_f32_16x16x32_bf16 a[68:71], a[12:15], a[140:143], a[68:71]
 ds_read_b128 a[84:87], v11 offset:0
 v_lshl_add_u64 v[0:1], s[52:53], 0, v[0:1]
 v_mfma_f32_16x16x32_bf16 v[244:247], a[12:15], a[132:135], v[244:247]
 ds_read_b128 a[88:91], v10 offset:2048
 v_mfma_f32_16x16x32_bf16 v[244:247], a[8:11], a[128:131], v[244:247]
 v_mfma_f32_16x16x32_bf16 v[228:231], a[8:11], a[120:123], v[228:231]
 buffer_load_dwordx4 v7, s[12:15], s35 offen offset:1024 nt lds
 v_mfma_f32_16x16x32_bf16 v[228:231], a[12:15], a[124:127], v[228:231]
 ds_read_b128 a[92:95], v11 offset:2048
 v_mfma_f32_16x16x32_bf16 v[212:215], a[12:15], a[116:119], v[212:215]
 v_mfma_f32_16x16x32_bf16 v[212:215], a[8:11], a[112:115], v[212:215]
 ds_read_b128 a[96:99], v10 offset:4096
 v_mfma_f32_16x16x32_bf16 v[216:219], a[16:19], a[112:115], v[216:219]
 buffer_load_dwordx4 v8, s[12:15], s35 offen offset:2048 nt lds
 v_mfma_f32_16x16x32_bf16 v[216:219], a[20:23], a[116:119], v[216:219]
 ds_read_b128 a[100:103], v11 offset:4096
 v_mfma_f32_16x16x32_bf16 v[232:235], a[20:23], a[124:127], v[232:235]
 v_mfma_f32_16x16x32_bf16 v[232:235], a[16:19], a[120:123], v[232:235]
 v_mfma_f32_16x16x32_bf16 v[248:251], a[16:19], a[128:131], v[248:251]
 ds_read_b128 a[104:107], v10 offset:6144
 v_mfma_f32_16x16x32_bf16 v[248:251], a[20:23], a[132:135], v[248:251]
 v_mfma_f32_16x16x32_bf16 a[72:75], a[20:23], a[140:143], a[72:75]
 buffer_load_dwordx4 v9, s[12:15], s35 offen offset:3072 nt lds
 v_mfma_f32_16x16x32_bf16 a[72:75], a[16:19], a[136:139], a[72:75]
 ds_read_b128 a[108:111], v11 offset:6144
 v_mfma_f32_16x16x32_bf16 a[76:79], a[24:27], a[136:139], a[76:79]
 v_mfma_f32_16x16x32_bf16 a[76:79], a[28:31], a[140:143], a[76:79]
 v_mfma_f32_16x16x32_bf16 v[252:255], a[28:31], a[132:135], v[252:255]
 v_mfma_f32_16x16x32_bf16 v[252:255], a[24:27], a[128:131], v[252:255]
 v_mfma_f32_16x16x32_bf16 v[236:239], a[24:27], a[120:123], v[236:239]
 v_mfma_f32_16x16x32_bf16 v[236:239], a[28:31], a[124:127], v[236:239]
 v_mfma_f32_16x16x32_bf16 v[220:223], a[28:31], a[116:119], v[220:223]
 v_mfma_f32_16x16x32_bf16 v[220:223], a[24:27], a[112:115], v[220:223]
 v_mfma_f32_16x16x32_bf16 v[144:147], a[0:3], a[32:35], v[144:147]
 s_add_u32 m0, s32, 49152
 s_add_u32 s35, s33, 2097280
 v_mfma_f32_16x16x32_bf16 v[144:147], a[4:7], a[36:39], v[144:147]
 buffer_load_dwordx4 v2, s[8:11], s35 offen offset:0 lds
 v_mfma_f32_16x16x32_bf16 v[160:163], a[4:7], a[44:47], v[160:163]
 v_mfma_f32_16x16x32_bf16 v[160:163], a[0:3], a[40:43], v[160:163]
 v_mfma_f32_16x16x32_bf16 v[176:179], a[0:3], a[48:51], v[176:179]
 v_mfma_f32_16x16x32_bf16 v[176:179], a[4:7], a[52:55], v[176:179]
 s_waitcnt vmcnt(22)
 s_waitcnt lgkmcnt(0)
 s_barrier
 v_mfma_f32_16x16x32_bf16 v[192:195], a[4:7], a[60:63], v[192:195]
 ds_read_b64_tr_b16 a[112:113], v12 offset:0
 v_mfma_f32_16x16x32_bf16 v[192:195], a[0:3], a[56:59], v[192:195]
 ds_read_b64_tr_b16 a[114:115], v12 offset:1024
 v_mfma_f32_16x16x32_bf16 v[196:199], a[8:11], a[56:59], v[196:199]
 buffer_load_dwordx4 v3, s[8:11], s35 offen offset:1024 lds
 v_mfma_f32_16x16x32_bf16 v[196:199], a[12:15], a[60:63], v[196:199]
 ds_read_b64_tr_b16 a[116:117], v12 offset:8192
 ds_read_b64_tr_b16 a[118:119], v12 offset:9216
 v_mfma_f32_16x16x32_bf16 v[180:183], a[12:15], a[52:55], v[180:183]
 ds_read_b64_tr_b16 a[120:121], v13 offset:0
 v_mfma_f32_16x16x32_bf16 v[180:183], a[8:11], a[48:51], v[180:183]
 ds_read_b64_tr_b16 a[122:123], v13 offset:1024
 v_mfma_f32_16x16x32_bf16 v[164:167], a[8:11], a[40:43], v[164:167]
 v_mfma_f32_16x16x32_bf16 v[164:167], a[12:15], a[44:47], v[164:167]
 ds_read_b64_tr_b16 a[124:125], v13 offset:8192
 v_mfma_f32_16x16x32_bf16 v[148:151], a[12:15], a[36:39], v[148:151]
 ds_read_b64_tr_b16 a[126:127], v13 offset:9216
 v_mfma_f32_16x16x32_bf16 v[148:151], a[8:11], a[32:35], v[148:151]
 buffer_load_dwordx4 v4, s[8:11], s35 offen offset:2048 lds
 v_mfma_f32_16x16x32_bf16 v[152:155], a[16:19], a[32:35], v[152:155]
 ds_read_b64_tr_b16 a[128:129], v14 offset:0
 ds_read_b64_tr_b16 a[130:131], v14 offset:1024
 v_mfma_f32_16x16x32_bf16 v[152:155], a[20:23], a[36:39], v[152:155]
 ds_read_b64_tr_b16 a[132:133], v14 offset:8192
 v_mfma_f32_16x16x32_bf16 v[168:171], a[20:23], a[44:47], v[168:171]
 v_mfma_f32_16x16x32_bf16 v[168:171], a[16:19], a[40:43], v[168:171]
 ds_read_b64_tr_b16 a[134:135], v14 offset:9216
 v_mfma_f32_16x16x32_bf16 v[184:187], a[16:19], a[48:51], v[184:187]
 ds_read_b64_tr_b16 a[136:137], v15 offset:0
 v_mfma_f32_16x16x32_bf16 v[184:187], a[20:23], a[52:55], v[184:187]
 ds_read_b64_tr_b16 a[138:139], v15 offset:1024
 v_mfma_f32_16x16x32_bf16 v[200:203], a[20:23], a[60:63], v[200:203]
 buffer_load_dwordx4 v5, s[8:11], s35 offen offset:3072 lds
 v_mfma_f32_16x16x32_bf16 v[200:203], a[16:19], a[56:59], v[200:203]
 ds_read_b64_tr_b16 a[140:141], v15 offset:8192
 ds_read_b64_tr_b16 a[142:143], v15 offset:9216
 v_mfma_f32_16x16x32_bf16 v[204:207], a[24:27], a[56:59], v[204:207]
 v_mfma_f32_16x16x32_bf16 v[204:207], a[28:31], a[60:63], v[204:207]
 v_mfma_f32_16x16x32_bf16 v[188:191], a[28:31], a[52:55], v[188:191]
 v_mfma_f32_16x16x32_bf16 v[188:191], a[24:27], a[48:51], v[188:191]
 v_mfma_f32_16x16x32_bf16 v[172:175], a[24:27], a[40:43], v[172:175]
 v_mfma_f32_16x16x32_bf16 v[172:175], a[28:31], a[44:47], v[172:175]
 v_mfma_f32_16x16x32_bf16 v[156:159], a[28:31], a[36:39], v[156:159]
 s_waitcnt vmcnt(17)
 s_waitcnt lgkmcnt(0)
 s_barrier
 v_mfma_f32_16x16x32_bf16 v[156:159], a[24:27], a[32:35], v[156:159]
 s_add_u32 s33, s33, 256
 s_add_u32 s34, s34, 1048576
 .p2align 6
L_loopV:
 v_mfma_f32_16x16x32_bf16 v[16:19], a[80:83], a[112:115], v[16:19]
 ds_read_b64_tr_b16 a[32:33], v12 offset:16384
 v_mfma_f32_16x16x32_bf16 v[16:19], a[84:87], a[116:119], v[16:19]
 ds_read_b64_tr_b16 a[34:35], v12 offset:17408
 v_mfma_f32_16x16x32_bf16 v[32:35], a[84:87], a[124:127], v[32:35]
 ds_read_b64_tr_b16 a[36:37], v12 offset:24576
 v_mfma_f32_16x16x32_bf16 v[32:35], a[80:83], a[120:123], v[32:35]
 ds_read_b64_tr_b16 a[38:39], v12 offset:25600
 v_mfma_f32_16x16x32_bf16 v[48:51], a[80:83], a[128:131], v[48:51]
 ds_read_b64_tr_b16 a[40:41], v13 offset:16384
 v_mfma_f32_16x16x32_bf16 v[48:51], a[84:87], a[132:135], v[48:51]
 ds_read_b64_tr_b16 a[42:43], v13 offset:17408
 v_mfma_f32_16x16x32_bf16 v[64:67], a[84:87], a[140:143], v[64:67]
 ds_read_b64_tr_b16 a[44:45], v13 offset:24576
 v_mfma_f32_16x16x32_bf16 v[64:67], a[80:83], a[136:139], v[64:67]
 ds_read_b64_tr_b16 a[46:47], v13 offset:25600
 v_mfma_f32_16x16x32_bf16 v[68:71], a[88:91], a[136:139], v[68:71]
 ds_read_b64_tr_b16 a[48:49], v14 offset:16384
 v_mfma_f32_16x16x32_bf16 v[68:71], a[92:95], a[140:143], v[68:71]
 ds_read_b64_tr_b16 a[50:51], v14 offset:17408
 v_mfma_f32_16x16x32_bf16 v[52:55], a[92:95], a[132:135], v[52:55]
 ds_read_b64_tr_b16 a[52:53], v14 offset:24576
 v_mfma_f32_16x16x32_bf16 v[52:55], a[88:91], a[128:131], v[52:55]
 ds_read_b64_tr_b16 a[54:55], v14 offset:25600
 v_mfma_f32_16x16x32_bf16 v[36:39], a[88:91], a[120:123], v[36:39]
 ds_read_b64_tr_b16 a[56:57], v15 offset:16384
 v_mfma_f32_16x16x32_bf16 v[36:39], a[92:95], a[124:127], v[36:39]
 ds_read_b64_tr_b16 a[58:59], v15 offset:17408
 v_mfma_f32_16x16x32_bf16 v[20:23], a[92:95], a[116:119], v[20:23]
 ds_read_b64_tr_b16 a[60:61], v15 offset:24576
 v_mfma_f32_16x16x32_bf16 v[20:23], a[88:91], a[112:115], v[20:23]
 s_add_u32 m0, s32, 0
 ds_read_b64_tr_b16 a[62:63], v15 offset:25600
 v_mfma_f32_16x16x32_bf16 v[24:27], a[96:99], a[112:115], v[24:27]
 s_add_u32 s35, s33, 0
 v_mfma_f32_16x16x32_bf16 v[24:27], a[100:103], a[116:119], v[24:27]
 buffer_load_dwordx4 v2, s[8:11], s35 offen offset:0 lds
 v_mfma_f32_16x16x32_bf16 v[40:43], a[100:103], a[124:127], v[40:43]
 v_mfma_f32_16x16x32_bf16 v[40:43], a[96:99], a[120:123], v[40:43]
 v_mfma_f32_16x16x32_bf16 v[56:59], a[96:99], a[128:131], v[56:59]
 v_mfma_f32_16x16x32_bf16 v[56:59], a[100:103], a[132:135], v[56:59]
 buffer_load_dwordx4 v3, s[8:11], s35 offen offset:1024 lds
 v_mfma_f32_16x16x32_bf16 v[72:75], a[100:103], a[140:143], v[72:75]
 v_mfma_f32_16x16x32_bf16 v[72:75], a[96:99], a[136:139], v[72:75]
 v_mfma_f32_16x16x32_bf16 v[76:79], a[104:107], a[136:139], v[76:79]
 v_mfma_f32_16x16x32_bf16 v[76:79], a[108:111], a[140:143], v[76:79]
 buffer_load_dwordx4 v4, s[8:11], s35 offen offset:2048 lds
 v_mfma_f32_16x16x32_bf16 v[60:63], a[108:111], a[132:135], v[60:63]
 v_mfma_f32_16x16x32_bf16 v[60:63], a[104:107], a[128:131], v[60:63]
 v_mfma_f32_16x16x32_bf16 v[44:47], a[104:107], a[120:123], v[44:47]
 v_mfma_f32_16x16x32_bf16 v[44:47], a[108:111], a[124:127], v[44:47]
 buffer_load_dwordx4 v5, s[8:11], s35 offen offset:3072 lds
 v_mfma_f32_16x16x32_bf16 v[28:31], a[108:111], a[116:119], v[28:31]
 s_waitcnt lgkmcnt(0)
 v_mfma_f32_16x16x32_bf16 v[28:31], a[104:107], a[112:115], v[28:31]
 v_mfma_f32_16x16x32_bf16 v[80:83], a[80:83], a[32:35], v[80:83]
 ds_read_b128 a[0:3], v10 offset:16384
 v_mfma_f32_16x16x32_bf16 v[80:83], a[84:87], a[36:39], v[80:83]
 v_mfma_f32_16x16x32_bf16 v[96:99], a[84:87], a[44:47], v[96:99]
 ds_read_b128 a[4:7], v11 offset:16384
 v_mfma_f32_16x16x32_bf16 v[96:99], a[80:83], a[40:43], v[96:99]
 v_mfma_f32_16x16x32_bf16 v[112:115], a[80:83], a[48:51], v[112:115]
 ds_read_b128 a[8:11], v10 offset:18432
 v_mfma_f32_16x16x32_bf16 v[112:115], a[84:87], a[52:55], v[112:115]
 v_mfma_f32_16x16x32_bf16 v[128:131], a[84:87], a[60:63], v[128:131]
 ds_read_b128 a[12:15], v11 offset:18432
 v_mfma_f32_16x16x32_bf16 v[128:131], a[80:83], a[56:59], v[128:131]
 v_mfma_f32_16x16x32_bf16 v[132:135], a[88:91], a[56:59], v[132:135]
 ds_read_b128 a[16:19], v10 offset:20480
 v_mfma_f32_16x16x32_bf16 v[132:135], a[92:95], a[60:63], v[132:135]
 v_mfma_f32_16x16x32_bf16 v[116:119], a[92:95], a[52:55], v[116:119]
 ds_read_b128 a[20:23], v11 offset:20480
 v_mfma_f32_16x16x32_bf16 v[116:119], a[88:91], a[48:51], v[116:119]
 v_mfma_f32_16x16x32_bf16 v[100:103], a[88:91], a[40:43], v[100:103]
 ds_read_b128 a[24:27], v10 offset:22528
 v_mfma_f32_16x16x32_bf16 v[100:103], a[92:95], a[44:47], v[100:103]
 v_mfma_f32_16x16x32_bf16 v[84:87], a[92:95], a[36:39], v[84:87]
 ds_read_b128 a[28:31], v11 offset:22528
 v_mfma_f32_16x16x32_bf16 v[84:87], a[88:91], a[32:35], v[84:87]
 s_add_u32 m0, s32, 65536
 v_mfma_f32_16x16x32_bf16 v[88:91], a[96:99], a[32:35], v[88:91]
 s_add_u32 s35, s34, 0
 v_mfma_f32_16x16x32_bf16 v[88:91], a[100:103], a[36:39], v[88:91]
 buffer_load_dwordx4 v6, s[12:15], s35 offen offset:0 nt lds
 v_mfma_f32_16x16x32_bf16 v[104:107], a[100:103], a[44:47], v[104:107]
 v_mfma_f32_16x16x32_bf16 v[104:107], a[96:99], a[40:43], v[104:107]
 v_mfma_f32_16x16x32_bf16 v[120:123], a[96:99], a[48:51], v[120:123]
 v_mfma_f32_16x16x32_bf16 v[120:123], a[100:103], a[52:55], v[120:123]
 buffer_load_dwordx4 v7, s[12:15], s35 offen offset:1024 nt lds
 v_mfma_f32_16x16x32_bf16 v[136:139], a[100:103], a[60:63], v[136:139]
 v_mfma_f32_16x16x32_bf16 v[136:139], a[96:99], a[56:59], v[136:139]
 v_mfma_f32_16x16x32_bf16 v[140:143], a[104:107], a[56:59], v[140:143]
 v_mfma_f32_16x16x32_bf16 v[140:143], a[108:111], a[60:63], v[140:143]
 buffer_load_dwordx4 v8, s[12:15], s35 offen offset:2048 nt lds
 v_mfma_f32_16x16x32_bf16 v[124:127], a[108:111], a[52:55], v[124:127]
 v_mfma_f32_16x16x32_bf16 v[124:127], a[104:107], a[48:51], v[124:127]
 v_mfma_f32_16x16x32_bf16 v[108:111], a[104:107], a[40:43], v[108:111]
 v_mfma_f32_16x16x32_bf16 v[108:111], a[108:111], a[44:47], v[108:111]
 buffer_load_dwordx4 v9, s[12:15], s35 offen offset:3072 nt lds
 v_mfma_f32_16x16x32_bf16 v[92:95], a[108:111], a[36:39], v[92:95]
 s_waitcnt vmcnt(16) lgkmcnt(0)
 s_barrier
 v_mfma_f32_16x16x32_bf16 v[92:95], a[104:107], a[32:35], v[92:95]
 v_mfma_f32_16x16x32_bf16 v[208:211], a[0:3], a[32:35], v[208:211]
 ds_read_b128 a[80:83], v10 offset:32768
 v_mfma_f32_16x16x32_bf16 v[208:211], a[4:7], a[36:39], v[208:211]
 global_load_dword a254, v[0:1], off
 v_mfma_f32_16x16x32_bf16 v[224:227], a[4:7], a[44:47], v[224:227]
 ds_read_b128 a[84:87], v11 offset:32768
 v_mfma_f32_16x16x32_bf16 v[224:227], a[0:3], a[40:43], v[224:227]
 v_lshl_add_u64 v[0:1], s[52:53], 0, v[0:1]
 v_mfma_f32_16x16x32_bf16 v[240:243], a[0:3], a[48:51], v[240:243]
 ds_read_b128 a[88:91], v10 offset:34816
 v_mfma_f32_16x16x32_bf16 v[240:243], a[4:7], a[52:55], v[240:243]
 v_mfma_f32_16x16x32_bf16 a[64:67], a[4:7], a[60:63], a[64:67]
 ds_read_b128 a[92:95], v11 offset:34816
 v_mfma_f32_16x16x32_bf16 a[64:67], a[0:3], a[56:59], a[64:67]
 v_mfma_f32_16x16x32_bf16 a[68:71], a[8:11], a[56:59], a[68:71]
 ds_read_b128 a[96:99], v10 offset:36864
 v_mfma_f32_16x16x32_bf16 a[68:71], a[12:15], a[60:63], a[68:71]
 v_mfma_f32_16x16x32_bf16 v[244:247], a[12:15], a[52:55], v[244:247]
 ds_read_b128 a[100:103], v11 offset:36864
 v_mfma_f32_16x16x32_bf16 v[244:247], a[8:11], a[48:51], v[244:247]
 v_mfma_f32_16x16x32_bf16 v[228:231], a[8:11], a[40:43], v[228:231]
 ds_read_b128 a[104:107], v10 offset:38912
 v_mfma_f32_16x16x32_bf16 v[228:231], a[12:15], a[44:47], v[228:231]
 v_mfma_f32_16x16x32_bf16 v[212:215], a[12:15], a[36:39], v[212:215]
 ds_read_b128 a[108:111], v11 offset:38912
 v_mfma_f32_16x16x32_bf16 v[212:215], a[8:11], a[32:35], v[212:215]
 s_add_u32 m0, s32, 81920
 v_mfma_f32_16x16x32_bf16 v[216:219], a[16:19], a[32:35], v[216:219]
 s_add_u32 s35, s34, 256
 v_mfma_f32_16x16x32_bf16 v[216:219], a[20:23], a[36:39], v[216:219]
 buffer_load_dwordx4 v6, s[12:15], s35 offen offset:0 nt lds
 v_mfma_f32_16x16x32_bf16 v[232:235], a[20:23], a[44:47], v[232:235]
 v_mfma_f32_16x16x32_bf16 v[232:235], a[16:19], a[40:43], v[232:235]
 v_mfma_f32_16x16x32_bf16 v[248:251], a[16:19], a[48:51], v[248:251]
 v_mfma_f32_16x16x32_bf16 v[248:251], a[20:23], a[52:55], v[248:251]
 buffer_load_dwordx4 v7, s[12:15], s35 offen offset:1024 nt lds
 v_mfma_f32_16x16x32_bf16 a[72:75], a[20:23], a[60:63], a[72:75]
 v_mfma_f32_16x16x32_bf16 a[72:75], a[16:19], a[56:59], a[72:75]
 v_mfma_f32_16x16x32_bf16 a[76:79], a[24:27], a[56:59], a[76:79]
 v_mfma_f32_16x16x32_bf16 a[76:79], a[28:31], a[60:63], a[76:79]
 buffer_load_dwordx4 v8, s[12:15], s35 offen offset:2048 nt lds
 v_mfma_f32_16x16x32_bf16 v[252:255], a[28:31], a[52:55], v[252:255]
 v_mfma_f32_16x16x32_bf16 v[252:255], a[24:27], a[48:51], v[252:255]
 v_mfma_f32_16x16x32_bf16 v[236:239], a[24:27], a[40:43], v[236:239]
 v_mfma_f32_16x16x32_bf16 v[236:239], a[28:31], a[44:47], v[236:239]
 buffer_load_dwordx4 v9, s[12:15], s35 offen offset:3072 nt lds
 v_mfma_f32_16x16x32_bf16 v[220:223], a[28:31], a[36:39], v[220:223]
 s_waitcnt lgkmcnt(0)
 v_mfma_f32_16x16x32_bf16 v[220:223], a[24:27], a[32:35], v[220:223]
 v_mfma_f32_16x16x32_bf16 v[144:147], a[0:3], a[112:115], v[144:147]
 ds_read_b64_tr_b16 a[32:33], v12 offset:32768
 v_mfma_f32_16x16x32_bf16 v[144:147], a[4:7], a[116:119], v[144:147]
 ds_read_b64_tr_b16 a[34:35], v12 offset:33792
 v_mfma_f32_16x16x32_bf16 v[160:163], a[4:7], a[124:127], v[160:163]
 ds_read_b64_tr_b16 a[36:37], v12 offset:40960
 v_mfma_f32_16x16x32_bf16 v[160:163], a[0:3], a[120:123], v[160:163]
 ds_read_b64_tr_b16 a[38:39], v12 offset:41984
 v_mfma_f32_16x16x32_bf16 v[176:179], a[0:3], a[128:131], v[176:179]
 ds_read_b64_tr_b16 a[40:41], v13 offset:32768
 v_mfma_f32_16x16x32_bf16 v[176:179], a[4:7], a[132:135], v[176:179]
 ds_read_b64_tr_b16 a[42:43], v13 offset:33792
 v_mfma_f32_16x16x32_bf16 v[192:195], a[4:7], a[140:143], v[192:195]
 ds_read_b64_tr_b16 a[44:45], v13 offset:40960
 v_mfma_f32_16x16x32_bf16 v[192:195], a[0:3], a[136:139], v[192:195]
 ds_read_b64_tr_b16 a[46:47], v13 offset:41984
 v_mfma_f32_16x16x32_bf16 v[196:199], a[8:11], a[136:139], v[196:199]
 ds_read_b64_tr_b16 a[48:49], v14 offset:32768
 v_mfma_f32_16x16x32_bf16 v[196:199], a[12:15], a[140:143], v[196:199]
 ds_read_b64_tr_b16 a[50:51], v14 offset:33792
 v_mfma_f32_16x16x32_bf16 v[180:183], a[12:15], a[132:135], v[180:183]
 ds_read_b64_tr_b16 a[52:53], v14 offset:40960
 v_mfma_f32_16x16x32_bf16 v[180:183], a[8:11], a[128:131], v[180:183]
 ds_read_b64_tr_b16 a[54:55], v14 offset:41984
 v_mfma_f32_16x16x32_bf16 v[164:167], a[8:11], a[120:123], v[164:167]
 ds_read_b64_tr_b16 a[56:57], v15 offset:32768
 v_mfma_f32_16x16x32_bf16 v[164:167], a[12:15], a[124:127], v[164:167]
 ds_read_b64_tr_b16 a[58:59], v15 offset:33792
 v_mfma_f32_16x16x32_bf16 v[148:151], a[12:15], a[116:119], v[148:151]
 ds_read_b64_tr_b16 a[60:61], v15 offset:40960
 v_mfma_f32_16x16x32_bf16 v[148:151], a[8:11], a[112:115], v[148:151]
 s_add_u32 m0, s32, 16384
 ds_read_b64_tr_b16 a[62:63], v15 offset:41984
 v_mfma_f32_16x16x32_bf16 v[152:155], a[16:19], a[112:115], v[152:155]
 s_add_u32 s35, s33, 2097152
 v_mfma_f32_16x16x32_bf16 v[152:155], a[20:23], a[116:119], v[152:155]
 buffer_load_dwordx4 v2, s[8:11], s35 offen offset:0 lds
 v_mfma_f32_16x16x32_bf16 v[168:171], a[20:23], a[124:127], v[168:171]
 v_mfma_f32_16x16x32_bf16 v[168:171], a[16:19], a[120:123], v[168:171]
 v_mfma_f32_16x16x32_bf16 v[184:187], a[16:19], a[128:131], v[184:187]
 v_mfma_f32_16x16x32_bf16 v[184:187], a[20:23], a[132:135], v[184:187]
 buffer_load_dwordx4 v3, s[8:11], s35 offen offset:1024 lds
 v_mfma_f32_16x16x32_bf16 v[200:203], a[20:23], a[140:143], v[200:203]
 v_mfma_f32_16x16x32_bf16 v[200:203], a[16:19], a[136:139], v[200:203]
 v_mfma_f32_16x16x32_bf16 v[204:207], a[24:27], a[136:139], v[204:207]
 v_mfma_f32_16x16x32_bf16 v[204:207], a[28:31], a[140:143], v[204:207]
 buffer_load_dwordx4 v4, s[8:11], s35 offen offset:2048 lds
 v_mfma_f32_16x16x32_bf16 v[188:191], a[28:31], a[132:135], v[188:191]
 v_mfma_f32_16x16x32_bf16 v[188:191], a[24:27], a[128:131], v[188:191]
 v_mfma_f32_16x16x32_bf16 v[172:175], a[24:27], a[120:123], v[172:175]
 v_mfma_f32_16x16x32_bf16 v[172:175], a[28:31], a[124:127], v[172:175]
 buffer_load_dwordx4 v5, s[8:11], s35 offen offset:3072 lds
 v_mfma_f32_16x16x32_bf16 v[156:159], a[28:31], a[116:119], v[156:159]
 s_waitcnt vmcnt(16) lgkmcnt(0)
 s_barrier
 v_mfma_f32_16x16x32_bf16 v[156:159], a[24:27], a[112:115], v[156:159]
 v_mfma_f32_16x16x32_bf16 v[16:19], a[80:83], a[32:35], v[16:19]
 ds_read_b64_tr_b16 a[112:113], v12 offset:49152
 v_mfma_f32_16x16x32_bf16 v[16:19], a[84:87], a[36:39], v[16:19]
 ds_read_b64_tr_b16 a[114:115], v12 offset:50176
 v_mfma_f32_16x16x32_bf16 v[32:35], a[84:87], a[44:47], v[32:35]
 ds_read_b64_tr_b16 a[116:117], v12 offset:57344
 v_mfma_f32_16x16x32_bf16 v[32:35], a[80:83], a[40:43], v[32:35]
 ds_read_b64_tr_b16 a[118:119], v12 offset:58368
 v_mfma_f32_16x16x32_bf16 v[48:51], a[80:83], a[48:51], v[48:51]
 ds_read_b64_tr_b16 a[120:121], v13 offset:49152
 v_mfma_f32_16x16x32_bf16 v[48:51], a[84:87], a[52:55], v[48:51]
 ds_read_b64_tr_b16 a[122:123], v13 offset:50176
 v_mfma_f32_16x16x32_bf16 v[64:67], a[84:87], a[60:63], v[64:67]
 ds_read_b64_tr_b16 a[124:125], v13 offset:57344
 v_mfma_f32_16x16x32_bf16 v[64:67], a[80:83], a[56:59], v[64:67]
 ds_read_b64_tr_b16 a[126:127], v13 offset:58368
 v_mfma_f32_16x16x32_bf16 v[68:71], a[88:91], a[56:59], v[68:71]
 ds_read_b64_tr_b16 a[128:129], v14 offset:49152
 v_mfma_f32_16x16x32_bf16 v[68:71], a[92:95], a[60:63], v[68:71]
 ds_read_b64_tr_b16 a[130:131], v14 offset:50176
 v_mfma_f32_16x16x32_bf16 v[52:55], a[92:95], a[52:55], v[52:55]
 ds_read_b64_tr_b16 a[132:133], v14 offset:57344
 v_mfma_f32_16x16x32_bf16 v[52:55], a[88:91], a[48:51], v[52:55]
 ds_read_b64_tr_b16 a[134:135], v14 offset:58368
 v_mfma_f32_16x16x32_bf16 v[36:39], a[88:91], a[40:43], v[36:39]
 ds_read_b64_tr_b16 a[136:137], v15 offset:49152
 v_mfma_f32_16x16x32_bf16 v[36:39], a[92:95], a[44:47], v[36:39]
 ds_read_b64_tr_b16 a[138:139], v15 offset:50176
 v_mfma_f32_16x16x32_bf16 v[20:23], a[92:95], a[36:39], v[20:23]
 ds_read_b64_tr_b16 a[140:141], v15 offset:57344
 v_mfma_f32_16x16x32_bf16 v[20:23], a[88:91], a[32:35], v[20:23]
 s_add_u32 m0, s32, 32768
 ds_read_b64_tr_b16 a[142:143], v15 offset:58368
 v_mfma_f32_16x16x32_bf16 v[24:27], a[96:99], a[32:35], v[24:27]
 s_add_u32 s35, s33, 128
 v_mfma_f32_16x16x32_bf16 v[24:27], a[100:103], a[36:39], v[24:27]
 buffer_load_dwordx4 v2, s[8:11], s35 offen offset:0 lds
 v_mfma_f32_16x16x32_bf16 v[40:43], a[100:103], a[44:47], v[40:43]
 v_mfma_f32_16x16x32_bf16 v[40:43], a[96:99], a[40:43], v[40:43]
 v_mfma_f32_16x16x32_bf16 v[56:59], a[96:99], a[48:51], v[56:59]
 v_mfma_f32_16x16x32_bf16 v[56:59], a[100:103], a[52:55], v[56:59]
 buffer_load_dwordx4 v3, s[8:11], s35 offen offset:1024 lds
 v_mfma_f32_16x16x32_bf16 v[72:75], a[100:103], a[60:63], v[72:75]
 v_mfma_f32_16x16x32_bf16 v[72:75], a[96:99], a[56:59], v[72:75]
 v_mfma_f32_16x16x32_bf16 v[76:79], a[104:107], a[56:59], v[76:79]
 v_mfma_f32_16x16x32_bf16 v[76:79], a[108:111], a[60:63], v[76:79]
 buffer_load_dwordx4 v4, s[8:11], s35 offen offset:2048 lds
 v_mfma_f32_16x16x32_bf16 v[60:63], a[108:111], a[52:55], v[60:63]
 v_mfma_f32_16x16x32_bf16 v[60:63], a[104:107], a[48:51], v[60:63]
 v_mfma_f32_16x16x32_bf16 v[44:47], a[104:107], a[40:43], v[44:47]
 v_mfma_f32_16x16x32_bf16 v[44:47], a[108:111], a[44:47], v[44:47]
 buffer_load_dwordx4 v5, s[8:11], s35 offen offset:3072 lds
 v_mfma_f32_16x16x32_bf16 v[28:31], a[108:111], a[36:39], v[28:31]
 s_waitcnt lgkmcnt(0)
 v_mfma_f32_16x16x32_bf16 v[28:31], a[104:107], a[32:35], v[28:31]
 v_mfma_f32_16x16x32_bf16 v[80:83], a[80:83], a[112:115], v[80:83]
 ds_read_b128 a[0:3], v10 offset:49152
 v_mfma_f32_16x16x32_bf16 v[80:83], a[84:87], a[116:119], v[80:83]
 v_mfma_f32_16x16x32_bf16 v[96:99], a[84:87], a[124:127], v[96:99]
 ds_read_b128 a[4:7], v11 offset:49152
 v_mfma_f32_16x16x32_bf16 v[96:99], a[80:83], a[120:123], v[96:99]
 v_mfma_f32_16x16x32_bf16 v[112:115], a[80:83], a[128:131], v[112:115]
 ds_read_b128 a[8:11], v10 offset:51200
 v_mfma_f32_16x16x32_bf16 v[112:115], a[84:87], a[132:135], v[112:115]
 v_mfma_f32_16x16x32_bf16 v[128:131], a[84:87], a[140:143], v[128:131]
 ds_read_b128 a[12:15], v11 offset:51200
 v_mfma_f32_16x16x32_bf16 v[128:131], a[80:83], a[136:139], v[128:131]
 v_mfma_f32_16x16x32_bf16 v[132:135], a[88:91], a[136:139], v[132:135]
 ds_read_b128 a[16:19], v10 offset:53248
 v_mfma_f32_16x16x32_bf16 v[132:135], a[92:95], a[140:143], v[132:135]
 v_mfma_f32_16x16x32_bf16 v[116:119], a[92:95], a[132:135], v[116:119]
 ds_read_b128 a[20:23], v11 offset:53248
 v_mfma_f32_16x16x32_bf16 v[116:119], a[88:91], a[128:131], v[116:119]
 v_mfma_f32_16x16x32_bf16 v[100:103], a[88:91], a[120:123], v[100:103]
 ds_read_b128 a[24:27], v10 offset:55296
 v_mfma_f32_16x16x32_bf16 v[100:103], a[92:95], a[124:127], v[100:103]
 v_mfma_f32_16x16x32_bf16 v[84:87], a[92:95], a[116:119], v[84:87]
 ds_read_b128 a[28:31], v11 offset:55296
 v_mfma_f32_16x16x32_bf16 v[84:87], a[88:91], a[112:115], v[84:87]
 s_add_u32 m0, s32, 98304
 v_mfma_f32_16x16x32_bf16 v[88:91], a[96:99], a[112:115], v[88:91]
 s_add_u32 s35, s34, 524288
 v_mfma_f32_16x16x32_bf16 v[88:91], a[100:103], a[116:119], v[88:91]
 buffer_load_dwordx4 v6, s[12:15], s35 offen offset:0 nt lds
 v_mfma_f32_16x16x32_bf16 v[104:107], a[100:103], a[124:127], v[104:107]
 v_mfma_f32_16x16x32_bf16 v[104:107], a[96:99], a[120:123], v[104:107]
 v_mfma_f32_16x16x32_bf16 v[120:123], a[96:99], a[128:131], v[120:123]
 v_mfma_f32_16x16x32_bf16 v[120:123], a[100:103], a[132:135], v[120:123]
 buffer_load_dwordx4 v7, s[12:15], s35 offen offset:1024 nt lds
 v_mfma_f32_16x16x32_bf16 v[136:139], a[100:103], a[140:143], v[136:139]
 v_mfma_f32_16x16x32_bf16 v[136:139], a[96:99], a[136:139], v[136:139]
 v_mfma_f32_16x16x32_bf16 v[140:143], a[104:107], a[136:139], v[140:143]
 v_mfma_f32_16x16x32_bf16 v[140:143], a[108:111], a[140:143], v[140:143]
 buffer_load_dwordx4 v8, s[12:15], s35 offen offset:2048 nt lds
 v_mfma_f32_16x16x32_bf16 v[124:127], a[108:111], a[132:135], v[124:127]
 v_mfma_f32_16x16x32_bf16 v[124:127], a[104:107], a[128:131], v[124:127]
 v_mfma_f32_16x16x32_bf16 v[108:111], a[104:107], a[120:123], v[108:111]
 v_mfma_f32_16x16x32_bf16 v[108:111], a[108:111], a[124:127], v[108:111]
 buffer_load_dwordx4 v9, s[12:15], s35 offen offset:3072 nt lds
 v_mfma_f32_16x16x32_bf16 v[92:95], a[108:111], a[116:119], v[92:95]
 s_waitcnt vmcnt(16) lgkmcnt(0)
 s_barrier
 v_mfma_f32_16x16x32_bf16 v[92:95], a[104:107], a[112:115], v[92:95]
 v_mfma_f32_16x16x32_bf16 v[208:211], a[0:3], a[112:115], v[208:211]
 ds_read_b128 a[80:83], v10 offset:0
 v_mfma_f32_16x16x32_bf16 v[208:211], a[4:7], a[116:119], v[208:211]
 v_mfma_f32_16x16x32_bf16 v[224:227], a[4:7], a[124:127], v[224:227]
 ds_read_b128 a[84:87], v11 offset:0
 v_mfma_f32_16x16x32_bf16 v[224:227], a[0:3], a[120:123], v[224:227]
 v_mfma_f32_16x16x32_bf16 v[240:243], a[0:3], a[128:131], v[240:243]
 ds_read_b128 a[88:91], v10 offset:2048
 v_mfma_f32_16x16x32_bf16 v[240:243], a[4:7], a[132:135], v[240:243]
 v_mfma_f32_16x16x32_bf16 a[64:67], a[4:7], a[140:143], a[64:67]
 ds_read_b128 a[92:95], v11 offset:2048
 v_mfma_f32_16x16x32_bf16 a[64:67], a[0:3], a[136:139], a[64:67]
 v_mfma_f32_16x16x32_bf16 a[68:71], a[8:11], a[136:139], a[68:71]
 ds_read_b128 a[96:99], v10 offset:4096
 v_mfma_f32_16x16x32_bf16 a[68:71], a[12:15], a[140:143], a[68:71]
 v_mfma_f32_16x16x32_bf16 v[244:247], a[12:15], a[132:135], v[244:247]
 ds_read_b128 a[100:103], v11 offset:4096
 v_mfma_f32_16x16x32_bf16 v[244:247], a[8:11], a[128:131], v[244:247]
 v_mfma_f32_16x16x32_bf16 v[228:231], a[8:11], a[120:123], v[228:231]
 ds_read_b128 a[104:107], v10 offset:6144
 v_mfma_f32_16x16x32_bf16 v[228:231], a[12:15], a[124:127], v[228:231]
 v_mfma_f32_16x16x32_bf16 v[212:215], a[12:15], a[116:119], v[212:215]
 ds_read_b128 a[108:111], v11 offset:6144
 v_mfma_f32_16x16x32_bf16 v[212:215], a[8:11], a[112:115], v[212:215]
 s_add_u32 m0, s32, 114688
 v_mfma_f32_16x16x32_bf16 v[216:219], a[16:19], a[112:115], v[216:219]
 s_add_u32 s35, s34, 524544
 v_mfma_f32_16x16x32_bf16 v[216:219], a[20:23], a[116:119], v[216:219]
 buffer_load_dwordx4 v6, s[12:15], s35 offen offset:0 nt lds
 v_mfma_f32_16x16x32_bf16 v[232:235], a[20:23], a[124:127], v[232:235]
 v_mfma_f32_16x16x32_bf16 v[232:235], a[16:19], a[120:123], v[232:235]
 v_mfma_f32_16x16x32_bf16 v[248:251], a[16:19], a[128:131], v[248:251]
 v_mfma_f32_16x16x32_bf16 v[248:251], a[20:23], a[132:135], v[248:251]
 buffer_load_dwordx4 v7, s[12:15], s35 offen offset:1024 nt lds
 v_mfma_f32_16x16x32_bf16 a[72:75], a[20:23], a[140:143], a[72:75]
 v_mfma_f32_16x16x32_bf16 a[72:75], a[16:19], a[136:139], a[72:75]
 v_mfma_f32_16x16x32_bf16 a[76:79], a[24:27], a[136:139], a[76:79]
 v_mfma_f32_16x16x32_bf16 a[76:79], a[28:31], a[140:143], a[76:79]
 buffer_load_dwordx4 v8, s[12:15], s35 offen offset:2048 nt lds
 v_mfma_f32_16x16x32_bf16 v[252:255], a[28:31], a[132:135], v[252:255]
 v_mfma_f32_16x16x32_bf16 v[252:255], a[24:27], a[128:131], v[252:255]
 v_mfma_f32_16x16x32_bf16 v[236:239], a[24:27], a[120:123], v[236:239]
 v_mfma_f32_16x16x32_bf16 v[236:239], a[28:31], a[124:127], v[236:239]
 buffer_load_dwordx4 v9, s[12:15], s35 offen offset:3072 nt lds
 v_mfma_f32_16x16x32_bf16 v[220:223], a[28:31], a[116:119], v[220:223]
 s_waitcnt lgkmcnt(0)
 v_mfma_f32_16x16x32_bf16 v[220:223], a[24:27], a[112:115], v[220:223]
 v_mfma_f32_16x16x32_bf16 v[144:147], a[0:3], a[32:35], v[144:147]
 ds_read_b64_tr_b16 a[112:113], v12 offset:0
 v_mfma_f32_16x16x32_bf16 v[144:147], a[4:7], a[36:39], v[144:147]
 ds_read_b64_tr_b16 a[114:115], v12 offset:1024
 v_mfma_f32_16x16x32_bf16 v[160:163], a[4:7], a[44:47], v[160:163]
 ds_read_b64_tr_b16 a[116:117], v12 offset:8192
 v_mfma_f32_16x16x32_bf16 v[160:163], a[0:3], a[40:43], v[160:163]
 ds_read_b64_tr_b16 a[118:119], v12 offset:9216
 v_mfma_f32_16x16x32_bf16 v[176:179], a[0:3], a[48:51], v[176:179]
 ds_read_b64_tr_b16 a[120:121], v13 offset:0
 v_mfma_f32_16x16x32_bf16 v[176:179], a[4:7], a[52:55], v[176:179]
 ds_read_b64_tr_b16 a[122:123], v13 offset:1024
 v_mfma_f32_16x16x32_bf16 v[192:195], a[4:7], a[60:63], v[192:195]
 ds_read_b64_tr_b16 a[124:125], v13 offset:8192
 v_mfma_f32_16x16x32_bf16 v[192:195], a[0:3], a[56:59], v[192:195]
 ds_read_b64_tr_b16 a[126:127], v13 offset:9216
 v_mfma_f32_16x16x32_bf16 v[196:199], a[8:11], a[56:59], v[196:199]
 ds_read_b64_tr_b16 a[128:129], v14 offset:0
 v_mfma_f32_16x16x32_bf16 v[196:199], a[12:15], a[60:63], v[196:199]
 ds_read_b64_tr_b16 a[130:131], v14 offset:1024
 v_mfma_f32_16x16x32_bf16 v[180:183], a[12:15], a[52:55], v[180:183]
 ds_read_b64_tr_b16 a[132:133], v14 offset:8192
 v_mfma_f32_16x16x32_bf16 v[180:183], a[8:11], a[48:51], v[180:183]
 ds_read_b64_tr_b16 a[134:135], v14 offset:9216
 v_mfma_f32_16x16x32_bf16 v[164:167], a[8:11], a[40:43], v[164:167]
 ds_read_b64_tr_b16 a[136:137], v15 offset:0
 v_mfma_f32_16x16x32_bf16 v[164:167], a[12:15], a[44:47], v[164:167]
 ds_read_b64_tr_b16 a[138:139], v15 offset:1024
 v_mfma_f32_16x16x32_bf16 v[148:151], a[12:15], a[36:39], v[148:151]
 ds_read_b64_tr_b16 a[140:141], v15 offset:8192
 v_mfma_f32_16x16x32_bf16 v[148:151], a[8:11], a[32:35], v[148:151]
 s_add_u32 m0, s32, 49152
 ds_read_b64_tr_b16 a[142:143], v15 offset:9216
 v_mfma_f32_16x16x32_bf16 v[152:155], a[16:19], a[32:35], v[152:155]
 s_add_u32 s35, s33, 2097280
 v_mfma_f32_16x16x32_bf16 v[152:155], a[20:23], a[36:39], v[152:155]
 buffer_load_dwordx4 v2, s[8:11], s35 offen offset:0 lds
 v_mfma_f32_16x16x32_bf16 v[168:171], a[20:23], a[44:47], v[168:171]
 v_mfma_f32_16x16x32_bf16 v[168:171], a[16:19], a[40:43], v[168:171]
 v_mfma_f32_16x16x32_bf16 v[184:187], a[16:19], a[48:51], v[184:187]
 v_mfma_f32_16x16x32_bf16 v[184:187], a[20:23], a[52:55], v[184:187]
 buffer_load_dwordx4 v3, s[8:11], s35 offen offset:1024 lds
 v_mfma_f32_16x16x32_bf16 v[200:203], a[20:23], a[60:63], v[200:203]
 v_mfma_f32_16x16x32_bf16 v[200:203], a[16:19], a[56:59], v[200:203]
 v_mfma_f32_16x16x32_bf16 v[204:207], a[24:27], a[56:59], v[204:207]
 v_mfma_f32_16x16x32_bf16 v[204:207], a[28:31], a[60:63], v[204:207]
 buffer_load_dwordx4 v4, s[8:11], s35 offen offset:2048 lds
 v_mfma_f32_16x16x32_bf16 v[188:191], a[28:31], a[52:55], v[188:191]
 s_add_u32 s33, s33, 256
 v_mfma_f32_16x16x32_bf16 v[188:191], a[24:27], a[48:51], v[188:191]
 s_add_u32 s34, s34, 1048576
 v_mfma_f32_16x16x32_bf16 v[172:175], a[24:27], a[40:43], v[172:175]
 s_add_u32 s36, s36, 1
 v_mfma_f32_16x16x32_bf16 v[172:175], a[28:31], a[44:47], v[172:175]
 buffer_load_dwordx4 v5, s[8:11], s35 offen offset:3072 lds
 v_mfma_f32_16x16x32_bf16 v[156:159], a[28:31], a[36:39], v[156:159]
 s_waitcnt vmcnt(16) lgkmcnt(0)
 s_barrier
 v_mfma_f32_16x16x32_bf16 v[156:159], a[24:27], a[32:35], v[156:159]
 s_cmp_eq_u32 s36, s23
 s_cbranch_scc0 L_loopV
 s_cmp_eq_u32 s36, 5
 s_cbranch_scc0 L_hook
 global_load_dword a254, v[0:1], off
 s_lshl_b32 s38, s50, 4
 s_load_dwordx4 s[52:55], s[4:5], s38
 v_mfma_f32_16x16x32_bf16 v[16:19], a[80:83], a[112:115], v[16:19]
 ds_read_b64_tr_b16 a[32:33], v12 offset:16384
 v_mfma_f32_16x16x32_bf16 v[16:19], a[84:87], a[116:119], v[16:19]
 ds_read_b64_tr_b16 a[34:35], v12 offset:17408
 v_mfma_f32_16x16x32_bf16 v[32:35], a[84:87], a[124:127], v[32:35]
 ds_read_b64_tr_b16 a[36:37], v12 offset:24576
 v_mfma_f32_16x16x32_bf16 v[32:35], a[80:83], a[120:123], v[32:35]
 ds_read_b64_tr_b16 a[38:39], v12 offset:25600
 v_mfma_f32_16x16x32_bf16 v[48:51], a[80:83], a[128:131], v[48:51]
 ds_read_b64_tr_b16 a[40:41], v13 offset:16384
 v_mfma_f32_16x16x32_bf16 v[48:51], a[84:87], a[132:135], v[48:51]
 ds_read_b64_tr_b16 a[42:43], v13 offset:17408
 v_mfma_f32_16x16x32_bf16 v[64:67], a[84:87], a[140:143], v[64:67]
 ds_read_b64_tr_b16 a[44:45], v13 offset:24576
 v_mfma_f32_16x16x32_bf16 v[64:67], a[80:83], a[136:139], v[64:67]
 ds_read_b64_tr_b16 a[46:47], v13 offset:25600
 v_mfma_f32_16x16x32_bf16 v[68:71], a[88:91], a[136:139], v[68:71]
 ds_read_b64_tr_b16 a[48:49], v14 offset:16384
 v_mfma_f32_16x16x32_bf16 v[68:71], a[92:95], a[140:143], v[68:71]
 ds_read_b64_tr_b16 a[50:51], v14 offset:17408
 v_mfma_f32_16x16x32_bf16 v[52:55], a[92:95], a[132:135], v[52:55]
 ds_read_b64_tr_b16 a[52:53], v14 offset:24576
 v_mfma_f32_16x16x32_bf16 v[52:55], a[88:91], a[128:131], v[52:55]
 ds_read_b64_tr_b16 a[54:55], v14 offset:25600
 v_mfma_f32_16x16x32_bf16 v[36:39], a[88:91], a[120:123], v[36:39]
 ds_read_b64_tr_b16 a[56:57], v15 offset:16384
 v_mfma_f32_16x16x32_bf16 v[36:39], a[92:95], a[124:127], v[36:39]
 ds_read_b64_tr_b16 a[58:59], v15 offset:17408
 v_mfma_f32_16x16x32_bf16 v[20:23], a[92:95], a[116:119], v[20:23]
 ds_read_b64_tr_b16 a[60:61], v15 offset:24576
 v_mfma_f32_16x16x32_bf16 v[20:23], a[88:91], a[112:115], v[20:23]
 s_add_u32 m0, s32, 0
 ds_read_b64_tr_b16 a[62:63], v15 offset:25600
 v_mfma_f32_16x16x32_bf16 v[24:27], a[96:99], a[112:115], v[24:27]
 s_add_u32 s35, s33, 0
 v_mbcnt_lo_u32_b32 v1, -1, 0
 v_mfma_f32_16x16x32_bf16 v[24:27], a[100:103], a[116:119], v[24:27]
 buffer_load_dwordx4 v2, s[8:11], s35 offen offset:0 lds
 v_mfma_f32_16x16x32_bf16 v[40:43], a[100:103], a[124:127], v[40:43]
 v_mbcnt_hi_u32_b32 v1, -1, v1
 v_mfma_f32_16x16x32_bf16 v[40:43], a[96:99], a[120:123], v[40:43]
 v_bfe_u32 v0, v1, 1, 3
 v_mfma_f32_16x16x32_bf16 v[56:59], a[96:99], a[128:131], v[56:59]
 v_mul_u32_u24 v0, 1792, v0
 v_mfma_f32_16x16x32_bf16 v[56:59], a[100:103], a[132:135], v[56:59]
 buffer_load_dwordx4 v3, s[8:11], s35 offen offset:1024 lds
 v_mfma_f32_16x16x32_bf16 v[72:75], a[100:103], a[140:143], v[72:75]
 v_and_b32 v1, 0x31, v1
 v_mfma_f32_16x16x32_bf16 v[72:75], a[96:99], a[136:139], v[72:75]
 v_mul_u32_u24 v1, 9, v1
 v_mfma_f32_16x16x32_bf16 v[76:79], a[104:107], a[136:139], v[76:79]
 v_bfe_u32 v1, v1, 3, 3
 v_mfma_f32_16x16x32_bf16 v[76:79], a[108:111], a[140:143], v[76:79]
 buffer_load_dwordx4 v4, s[8:11], s35 offen offset:2048 lds
 v_mfma_f32_16x16x32_bf16 v[60:63], a[108:111], a[132:135], v[60:63]
 v_lshl_add_u32 v1, v1, 4, v0
 v_mfma_f32_16x16x32_bf16 v[60:63], a[104:107], a[128:131], v[60:63]
 v_mbcnt_lo_u32_b32 v0, -1, 0
 v_mfma_f32_16x16x32_bf16 v[44:47], a[104:107], a[120:123], v[44:47]
 s_add_u32 s36, s48, 14336
 v_mbcnt_hi_u32_b32 v0, -1, v0
 v_mfma_f32_16x16x32_bf16 v[44:47], a[108:111], a[124:127], v[44:47]
 buffer_load_dwordx4 v5, s[8:11], s35 offen offset:3072 lds
 v_mfma_f32_16x16x32_bf16 v[28:31], a[108:111], a[116:119], v[28:31]
 s_waitcnt lgkmcnt(0)
 s_and_b64 s[52:53], s[52:53], s[54:55]
 v_mfma_f32_16x16x32_bf16 v[28:31], a[104:107], a[112:115], v[28:31]
 s_and_b32 s52, s52, s53
 s_cmp_eq_u32 s52, 0x01010101
 s_cbranch_scc0 L_loopV_xspin
L_loopV_xspun:
 v_mfma_f32_16x16x32_bf16 v[80:83], a[80:83], a[32:35], v[80:83]
 ds_read_b128 a[0:3], v10 offset:16384
 v_mfma_f32_16x16x32_bf16 v[80:83], a[84:87], a[36:39], v[80:83]
 buffer_load_dwordx4 a[144:147], v1, s[16:19], s48 offen offset:0 sc1
 v_mfma_f32_16x16x32_bf16 v[96:99], a[84:87], a[44:47], v[96:99]
 ds_read_b128 a[4:7], v11 offset:16384
 v_mfma_f32_16x16x32_bf16 v[96:99], a[80:83], a[40:43], v[96:99]
 v_mfma_f32_16x16x32_bf16 v[112:115], a[80:83], a[48:51], v[112:115]
 ds_read_b128 a[8:11], v10 offset:18432
 v_mfma_f32_16x16x32_bf16 v[112:115], a[84:87], a[52:55], v[112:115]
 v_mfma_f32_16x16x32_bf16 v[128:131], a[84:87], a[60:63], v[128:131]
 ds_read_b128 a[12:15], v11 offset:18432
 v_mfma_f32_16x16x32_bf16 v[128:131], a[80:83], a[56:59], v[128:131]
 v_mfma_f32_16x16x32_bf16 v[132:135], a[88:91], a[56:59], v[132:135]
 ds_read_b128 a[16:19], v10 offset:20480
 v_mfma_f32_16x16x32_bf16 v[132:135], a[92:95], a[60:63], v[132:135]
 v_mfma_f32_16x16x32_bf16 v[116:119], a[92:95], a[52:55], v[116:119]
 ds_read_b128 a[20:23], v11 offset:20480
 v_mfma_f32_16x16x32_bf16 v[116:119], a[88:91], a[48:51], v[116:119]
 v_mfma_f32_16x16x32_bf16 v[100:103], a[88:91], a[40:43], v[100:103]
 ds_read_b128 a[24:27], v10 offset:22528
 v_mfma_f32_16x16x32_bf16 v[100:103], a[92:95], a[44:47], v[100:103]
 v_mfma_f32_16x16x32_bf16 v[84:87], a[92:95], a[36:39], v[84:87]
 ds_read_b128 a[28:31], v11 offset:22528
 v_mfma_f32_16x16x32_bf16 v[84:87], a[88:91], a[32:35], v[84:87]
 s_add_u32 m0, s32, 65536
 v_mfma_f32_16x16x32_bf16 v[88:91], a[96:99], a[32:35], v[88:91]
 s_add_u32 s35, s34, 0
 v_mfma_f32_16x16x32_bf16 v[88:91], a[100:103], a[36:39], v[88:91]
 buffer_load_dwordx4 v6, s[12:15], s35 offen offset:0 nt lds
 v_mfma_f32_16x16x32_bf16 v[104:107], a[100:103], a[44:47], v[104:107]
 v_mfma_f32_16x16x32_bf16 v[104:107], a[96:99], a[40:43], v[104:107]
 v_mfma_f32_16x16x32_bf16 v[120:123], a[96:99], a[48:51], v[120:123]
 v_mfma_f32_16x16x32_bf16 v[120:123], a[100:103], a[52:55], v[120:123]
 buffer_load_dwordx4 v7, s[12:15], s35 offen offset:1024 nt lds
 v_mfma_f32_16x16x32_bf16 v[136:139], a[100:103], a[60:63], v[136:139]
 v_mfma_f32_16x16x32_bf16 v[136:139], a[96:99], a[56:59], v[136:139]
 v_mfma_f32_16x16x32_bf16 v[140:143], a[104:107], a[56:59], v[140:143]
 v_mfma_f32_16x16x32_bf16 v[140:143], a[108:111], a[60:63], v[140:143]
 buffer_load_dwordx4 v8, s[12:15], s35 offen offset:2048 nt lds
 v_mfma_f32_16x16x32_bf16 v[124:127], a[108:111], a[52:55], v[124:127]
 v_mfma_f32_16x16x32_bf16 v[124:127], a[104:107], a[48:51], v[124:127]
 v_mfma_f32_16x16x32_bf16 v[108:111], a[104:107], a[40:43], v[108:111]
 v_mfma_f32_16x16x32_bf16 v[108:111], a[108:111], a[44:47], v[108:111]
 buffer_load_dwordx4 v9, s[12:15], s35 offen offset:3072 nt lds
 v_mfma_f32_16x16x32_bf16 v[92:95], a[108:111], a[36:39], v[92:95]
 s_waitcnt vmcnt(18)
 s_waitcnt lgkmcnt(0)
 s_barrier
 v_mfma_f32_16x16x32_bf16 v[92:95], a[104:107], a[32:35], v[92:95]
 v_mfma_f32_16x16x32_bf16 v[208:211], a[0:3], a[32:35], v[208:211]
 ds_read_b128 a[80:83], v10 offset:32768
 v_mfma_f32_16x16x32_bf16 v[208:211], a[4:7], a[36:39], v[208:211]
 buffer_load_dwordx4 a[200:203], v1, s[16:19], s36 offen offset:0 sc1
 v_mfma_f32_16x16x32_bf16 v[224:227], a[4:7], a[44:47], v[224:227]
 ds_read_b128 a[84:87], v11 offset:32768
 v_mfma_f32_16x16x32_bf16 v[224:227], a[0:3], a[40:43], v[224:227]
 v_mfma_f32_16x16x32_bf16 v[240:243], a[0:3], a[48:51], v[240:243]
 ds_read_b128 a[88:91], v10 offset:34816
 v_mfma_f32_16x16x32_bf16 v[240:243], a[4:7], a[52:55], v[240:243]
 v_mfma_f32_16x16x32_bf16 a[64:67], a[4:7], a[60:63], a[64:67]
 ds_read_b128 a[92:95], v11 offset:34816
 v_mfma_f32_16x16x32_bf16 a[64:67], a[0:3], a[56:59], a[64:67]
 v_mfma_f32_16x16x32_bf16 a[68:71], a[8:11], a[56:59], a[68:71]
 ds_read_b128 a[96:99], v10 offset:36864
 v_mfma_f32_16x16x32_bf16 a[68:71], a[12:15], a[60:63], a[68:71]
 v_mfma_f32_16x16x32_bf16 v[244:247], a[12:15], a[52:55], v[244:247]
 ds_read_b128 a[100:103], v11 offset:36864
 v_mfma_f32_16x16x32_bf16 v[244:247], a[8:11], a[48:51], v[244:247]
 v_mfma_f32_16x16x32_bf16 v[228:231], a[8:11], a[40:43], v[228:231]
 ds_read_b128 a[104:107], v10 offset:38912
 v_mfma_f32_16x16x32_bf16 v[228:231], a[12:15], a[44:47], v[228:231]
 v_mfma_f32_16x16x32_bf16 v[212:215], a[12:15], a[36:39], v[212:215]
 ds_read_b128 a[108:111], v11 offset:38912
 v_mfma_f32_16x16x32_bf16 v[212:215], a[8:11], a[32:35], v[212:215]
 s_add_u32 m0, s32, 81920
 v_mfma_f32_16x16x32_bf16 v[216:219], a[16:19], a[32:35], v[216:219]
 s_add_u32 s35, s34, 256
 v_mfma_f32_16x16x32_bf16 v[216:219], a[20:23], a[36:39], v[216:219]
 buffer_load_dwordx4 v6, s[12:15], s35 offen offset:0 nt lds
 v_mfma_f32_16x16x32_bf16 v[232:235], a[20:23], a[44:47], v[232:235]
 v_mfma_f32_16x16x32_bf16 v[232:235], a[16:19], a[40:43], v[232:235]
 v_mfma_f32_16x16x32_bf16 v[248:251], a[16:19], a[48:51], v[248:251]
 v_mfma_f32_16x16x32_bf16 v[248:251], a[20:23], a[52:55], v[248:251]
 buffer_load_dwordx4 v7, s[12:15], s35 offen offset:1024 nt lds
 v_mfma_f32_16x16x32_bf16 a[72:75], a[20:23], a[60:63], a[72:75]
 v_mfma_f32_16x16x32_bf16 a[72:75], a[16:19], a[56:59], a[72:75]
 v_mfma_f32_16x16x32_bf16 a[76:79], a[24:27], a[56:59], a[76:79]
 v_mfma_f32_16x16x32_bf16 a[76:79], a[28:31], a[60:63], a[76:79]
 buffer_load_dwordx4 v8, s[12:15], s35 offen offset:2048 nt lds
 v_mfma_f32_16x16x32_bf16 v[252:255], a[28:31], a[52:55], v[252:255]
 v_mfma_f32_16x16x32_bf16 v[252:255], a[24:27], a[48:51], v[252:255]
 v_mfma_f32_16x16x32_bf16 v[236:239], a[24:27], a[40:43], v[236:239]
 v_mfma_f32_16x16x32_bf16 v[236:239], a[28:31], a[44:47], v[236:239]
 buffer_load_dwordx4 v9, s[12:15], s35 offen offset:3072 nt lds
 v_mfma_f32_16x16x32_bf16 v[220:223], a[28:31], a[36:39], v[220:223]
 v_mfma_f32_16x16x32_bf16 v[220:223], a[24:27], a[32:35], v[220:223]
 v_mfma_f32_16x16x32_bf16 v[144:147], a[0:3], a[112:115], v[144:147]
 ds_read_b64_tr_b16 a[32:33], v12 offset:32768
 v_mfma_f32_16x16x32_bf16 v[144:147], a[4:7], a[116:119], v[144:147]
 ds_read_b64_tr_b16 a[34:35], v12 offset:33792
 buffer_load_dwordx4 a[148:151], v1, s[16:19], s48 offen offset:128 sc1
 v_mfma_f32_16x16x32_bf16 v[160:163], a[4:7], a[124:127], v[160:163]
 ds_read_b64_tr_b16 a[36:37], v12 offset:40960
 v_mfma_f32_16x16x32_bf16 v[160:163], a[0:3], a[120:123], v[160:163]
 ds_read_b64_tr_b16 a[38:39], v12 offset:41984
 v_mfma_f32_16x16x32_bf16 v[176:179], a[0:3], a[128:131], v[176:179]
 ds_read_b64_tr_b16 a[40:41], v13 offset:32768
 v_mfma_f32_16x16x32_bf16 v[176:179], a[4:7], a[132:135], v[176:179]
 ds_read_b64_tr_b16 a[42:43], v13 offset:33792
 v_mfma_f32_16x16x32_bf16 v[192:195], a[4:7], a[140:143], v[192:195]
 ds_read_b64_tr_b16 a[44:45], v13 offset:40960
 v_mfma_f32_16x16x32_bf16 v[192:195], a[0:3], a[136:139], v[192:195]
 ds_read_b64_tr_b16 a[46:47], v13 offset:41984
 v_mfma_f32_16x16x32_bf16 v[196:199], a[8:11], a[136:139], v[196:199]
 ds_read_b64_tr_b16 a[48:49], v14 offset:32768
 v_mfma_f32_16x16x32_bf16 v[196:199], a[12:15], a[140:143], v[196:199]
 ds_read_b64_tr_b16 a[50:51], v14 offset:33792
 v_mfma_f32_16x16x32_bf16 v[180:183], a[12:15], a[132:135], v[180:183]
 ds_read_b64_tr_b16 a[52:53], v14 offset:40960
 v_mfma_f32_16x16x32_bf16 v[180:183], a[8:11], a[128:131], v[180:183]
 ds_read_b64_tr_b16 a[54:55], v14 offset:41984
 v_mfma_f32_16x16x32_bf16 v[164:167], a[8:11], a[120:123], v[164:167]
 ds_read_b64_tr_b16 a[56:57], v15 offset:32768
 v_mfma_f32_16x16x32_bf16 v[164:167], a[12:15], a[124:127], v[164:167]
 ds_read_b64_tr_b16 a[58:59], v15 offset:33792
 v_mfma_f32_16x16x32_bf16 v[148:151], a[12:15], a[116:119], v[148:151]
 ds_read_b64_tr_b16 a[60:61], v15 offset:40960
 v_mfma_f32_16x16x32_bf16 v[148:151], a[8:11], a[112:115], v[148:151]
 s_add_u32 m0, s32, 16384
 ds_read_b64_tr_b16 a[62:63], v15 offset:41984
 v_mfma_f32_16x16x32_bf16 v[152:155], a[16:19], a[112:115], v[152:155]
 s_add_u32 s35, s33, 2097152
 v_mfma_f32_16x16x32_bf16 v[152:155], a[20:23], a[116:119], v[152:155]
 buffer_load_dwordx4 v2, s[8:11], s35 offen offset:0 lds
 v_mfma_f32_16x16x32_bf16 v[168:171], a[20:23], a[124:127], v[168:171]
 v_mfma_f32_16x16x32_bf16 v[168:171], a[16:19], a[120:123], v[168:171]
 v_mfma_f32_16x16x32_bf16 v[184:187], a[16:19], a[128:131], v[184:187]
 v_mfma_f32_16x16x32_bf16 v[184:187], a[20:23], a[132:135], v[184:187]
 buffer_load_dwordx4 v3, s[8:11], s35 offen offset:1024 lds
 v_mfma_f32_16x16x32_bf16 v[200:203], a[20:23], a[140:143], v[200:203]
 buffer_load_dwordx4 a[204:207], v1, s[16:19], s36 offen offset:128 sc1
 v_mfma_f32_16x16x32_bf16 v[200:203], a[16:19], a[136:139], v[200:203]
 v_mfma_f32_16x16x32_bf16 v[204:207], a[24:27], a[136:139], v[204:207]
 v_mfma_f32_16x16x32_bf16 v[204:207], a[28:31], a[140:143], v[204:207]
 buffer_load_dwordx4 v4, s[8:11], s35 offen offset:2048 lds
 v_mfma_f32_16x16x32_bf16 v[188:191], a[28:31], a[132:135], v[188:191]
 v_mfma_f32_16x16x32_bf16 v[188:191], a[24:27], a[128:131], v[188:191]
 v_mfma_f32_16x16x32_bf16 v[172:175], a[24:27], a[120:123], v[172:175]
 v_mfma_f32_16x16x32_bf16 v[172:175], a[28:31], a[124:127], v[172:175]
 buffer_load_dwordx4 v5, s[8:11], s35 offen offset:3072 lds
 v_mfma_f32_16x16x32_bf16 v[156:159], a[28:31], a[116:119], v[156:159]
 s_waitcnt vmcnt(21)
 s_waitcnt lgkmcnt(0)
 s_barrier
 v_mfma_f32_16x16x32_bf16 v[156:159], a[24:27], a[112:115], v[156:159]
 v_mfma_f32_16x16x32_bf16 v[16:19], a[80:83], a[32:35], v[16:19]
 ds_read_b64_tr_b16 a[112:113], v12 offset:49152
 v_mfma_f32_16x16x32_bf16 v[16:19], a[84:87], a[36:39], v[16:19]
 ds_read_b64_tr_b16 a[114:115], v12 offset:50176
 v_mfma_f32_16x16x32_bf16 v[32:35], a[84:87], a[44:47], v[32:35]
 ds_read_b64_tr_b16 a[116:117], v12 offset:57344
 v_mfma_f32_16x16x32_bf16 v[32:35], a[80:83], a[40:43], v[32:35]
 ds_read_b64_tr_b16 a[118:119], v12 offset:58368
 v_mfma_f32_16x16x32_bf16 v[48:51], a[80:83], a[48:51], v[48:51]
 ds_read_b64_tr_b16 a[120:121], v13 offset:49152
 v_mfma_f32_16x16x32_bf16 v[48:51], a[84:87], a[52:55], v[48:51]
 ds_read_b64_tr_b16 a[122:123], v13 offset:50176
 v_mfma_f32_16x16x32_bf16 v[64:67], a[84:87], a[60:63], v[64:67]
 ds_read_b64_tr_b16 a[124:125], v13 offset:57344
 v_mfma_f32_16x16x32_bf16 v[64:67], a[80:83], a[56:59], v[64:67]
 ds_read_b64_tr_b16 a[126:127], v13 offset:58368
 v_mfma_f32_16x16x32_bf16 v[68:71], a[88:91], a[56:59], v[68:71]
 ds_read_b64_tr_b16 a[128:129], v14 offset:49152
 v_mfma_f32_16x16x32_bf16 v[68:71], a[92:95], a[60:63], v[68:71]
 ds_read_b64_tr_b16 a[130:131], v14 offset:50176
 v_mfma_f32_16x16x32_bf16 v[52:55], a[92:95], a[52:55], v[52:55]
 ds_read_b64_tr_b16 a[132:133], v14 offset:57344
 v_mfma_f32_16x16x32_bf16 v[52:55], a[88:91], a[48:51], v[52:55]
 ds_read_b64_tr_b16 a[134:135], v14 offset:58368
 v_mfma_f32_16x16x32_bf16 v[36:39], a[88:91], a[40:43], v[36:39]
 ds_read_b64_tr_b16 a[136:137], v15 offset:49152
 v_mfma_f32_16x16x32_bf16 v[36:39], a[92:95], a[44:47], v[36:39]
 ds_read_b64_tr_b16 a[138:139], v15 offset:50176
 v_mfma_f32_16x16x32_bf16 v[20:23], a[92:95], a[36:39], v[20:23]
 ds_read_b64_tr_b16 a[140:141], v15 offset:57344
 v_mfma_f32_16x16x32_bf16 v[20:23], a[88:91], a[32:35], v[20:23]
 s_add_u32 m0, s32, 32768
 ds_read_b64_tr_b16 a[142:143], v15 offset:58368
 v_mfma_f32_16x16x32_bf16 v[24:27], a[96:99], a[32:35], v[24:27]
 s_add_u32 s35, s33, 128
 v_mfma_f32_16x16x32_bf16 v[24:27], a[100:103], a[36:39], v[24:27]
 buffer_load_dwordx4 v2, s[8:11], s35 offen offset:0 lds
 v_mfma_f32_16x16x32_bf16 v[40:43], a[100:103], a[44:47], v[40:43]
 v_mfma_f32_16x16x32_bf16 v[40:43], a[96:99], a[40:43], v[40:43]
 v_mfma_f32_16x16x32_bf16 v[56:59], a[96:99], a[48:51], v[56:59]
 v_mfma_f32_16x16x32_bf16 v[56:59], a[100:103], a[52:55], v[56:59]
 buffer_load_dwordx4 v3, s[8:11], s35 offen offset:1024 lds
 v_mfma_f32_16x16x32_bf16 v[72:75], a[100:103], a[60:63], v[72:75]
 v_mfma_f32_16x16x32_bf16 v[72:75], a[96:99], a[56:59], v[72:75]
 v_mfma_f32_16x16x32_bf16 v[76:79], a[104:107], a[56:59], v[76:79]
 v_mfma_f32_16x16x32_bf16 v[76:79], a[108:111], a[60:63], v[76:79]
 buffer_load_dwordx4 v4, s[8:11], s35 offen offset:2048 lds
 v_mfma_f32_16x16x32_bf16 v[60:63], a[108:111], a[52:55], v[60:63]
 v_mfma_f32_16x16x32_bf16 v[60:63], a[104:107], a[48:51], v[60:63]
 v_mfma_f32_16x16x32_bf16 v[44:47], a[104:107], a[40:43], v[44:47]
 v_mfma_f32_16x16x32_bf16 v[44:47], a[108:111], a[44:47], v[44:47]
 buffer_load_dwordx4 v5, s[8:11], s35 offen offset:3072 lds
 v_mfma_f32_16x16x32_bf16 v[28:31], a[108:111], a[36:39], v[28:31]
 v_mfma_f32_16x16x32_bf16 v[28:31], a[104:107], a[32:35], v[28:31]
 s_waitcnt lgkmcnt(0)
 v_mfma_f32_16x16x32_bf16 v[80:83], a[80:83], a[112:115], v[80:83]
 ds_read_b128 a[0:3], v10 offset:49152
 v_mfma_f32_16x16x32_bf16 v[80:83], a[84:87], a[116:119], v[80:83]
 buffer_load_dwordx4 a[152:155], v1, s[16:19], s48 offen offset:256 sc1
 v_mfma_f32_16x16x32_bf16 v[96:99], a[84:87], a[124:127], v[96:99]
 ds_read_b128 a[4:7], v11 offset:49152
 v_mfma_f32_16x16x32_bf16 v[96:99], a[80:83], a[120:123], v[96:99]
 v_mfma_f32_16x16x32_bf16 v[112:115], a[80:83], a[128:131], v[112:115]
 ds_read_b128 a[8:11], v10 offset:51200
 v_mfma_f32_16x16x32_bf16 v[112:115], a[84:87], a[132:135], v[112:115]
 v_mfma_f32_16x16x32_bf16 v[128:131], a[84:87], a[140:143], v[128:131]
 ds_read_b128 a[12:15], v11 offset:51200
 v_mfma_f32_16x16x32_bf16 v[128:131], a[80:83], a[136:139], v[128:131]
 v_mfma_f32_16x16x32_bf16 v[132:135], a[88:91], a[136:139], v[132:135]
 ds_read_b128 a[16:19], v10 offset:53248
 v_mfma_f32_16x16x32_bf16 v[132:135], a[92:95], a[140:143], v[132:135]
 v_mfma_f32_16x16x32_bf16 v[116:119], a[92:95], a[132:135], v[116:119]
 ds_read_b128 a[20:23], v11 offset:53248
 v_mfma_f32_16x16x32_bf16 v[116:119], a[88:91], a[128:131], v[116:119]
 v_mfma_f32_16x16x32_bf16 v[100:103], a[88:91], a[120:123], v[100:103]
 ds_read_b128 a[24:27], v10 offset:55296
 v_mfma_f32_16x16x32_bf16 v[100:103], a[92:95], a[124:127], v[100:103]
 buffer_load_dwordx4 a[208:211], v1, s[16:19], s36 offen offset:256 sc1
 v_mfma_f32_16x16x32_bf16 v[84:87], a[92:95], a[116:119], v[84:87]
 ds_read_b128 a[28:31], v11 offset:55296
 v_mfma_f32_16x16x32_bf16 v[84:87], a[88:91], a[112:115], v[84:87]
 s_add_u32 m0, s32, 98304
 v_mfma_f32_16x16x32_bf16 v[88:91], a[96:99], a[112:115], v[88:91]
 s_add_u32 s35, s34, 524288
 v_mfma_f32_16x16x32_bf16 v[88:91], a[100:103], a[116:119], v[88:91]
 buffer_load_dwordx4 v6, s[12:15], s35 offen offset:0 nt lds
 v_mfma_f32_16x16x32_bf16 v[104:107], a[100:103], a[124:127], v[104:107]
 v_mfma_f32_16x16x32_bf16 v[104:107], a[96:99], a[120:123], v[104:107]
 v_mfma_f32_16x16x32_bf16 v[120:123], a[96:99], a[128:131], v[120:123]
 v_mfma_f32_16x16x32_bf16 v[120:123], a[100:103], a[132:135], v[120:123]
 buffer_load_dwordx4 v7, s[12:15], s35 offen offset:1024 nt lds
 v_mfma_f32_16x16x32_bf16 v[136:139], a[100:103], a[140:143], v[136:139]
 v_mfma_f32_16x16x32_bf16 v[136:139], a[96:99], a[136:139], v[136:139]
 v_mfma_f32_16x16x32_bf16 v[140:143], a[104:107], a[136:139], v[140:143]
 v_mfma_f32_16x16x32_bf16 v[140:143], a[108:111], a[140:143], v[140:143]
 buffer_load_dwordx4 v8, s[12:15], s35 offen offset:2048 nt lds
 v_mfma_f32_16x16x32_bf16 v[124:127], a[108:111], a[132:135], v[124:127]
 v_mfma_f32_16x16x32_bf16 v[124:127], a[104:107], a[128:131], v[124:127]
 v_mfma_f32_16x16x32_bf16 v[108:111], a[104:107], a[120:123], v[108:111]
 v_mfma_f32_16x16x32_bf16 v[108:111], a[108:111], a[124:127], v[108:111]
 buffer_load_dwordx4 v9, s[12:15], s35 offen offset:3072 nt lds
 v_mfma_f32_16x16x32_bf16 v[92:95], a[108:111], a[116:119], v[92:95]
 s_waitcnt vmcnt(21)
 s_waitcnt lgkmcnt(0)
 s_barrier
 v_mfma_f32_16x16x32_bf16 v[92:95], a[104:107], a[112:115], v[92:95]
 v_mfma_f32_16x16x32_bf16 v[208:211], a[0:3], a[112:115], v[208:211]
 ds_read_b128 a[80:83], v10 offset:0
 v_mfma_f32_16x16x32_bf16 v[208:211], a[4:7], a[116:119], v[208:211]
 v_mfma_f32_16x16x32_bf16 v[224:227], a[4:7], a[124:127], v[224:227]
 ds_read_b128 a[84:87], v11 offset:0
 v_mfma_f32_16x16x32_bf16 v[224:227], a[0:3], a[120:123], v[224:227]
 v_mfma_f32_16x16x32_bf16 v[240:243], a[0:3], a[128:131], v[240:243]
 ds_read_b128 a[88:91], v10 offset:2048
 v_mfma_f32_16x16x32_bf16 v[240:243], a[4:7], a[132:135], v[240:243]
 v_mfma_f32_16x16x32_bf16 a[64:67], a[4:7], a[140:143], a[64:67]
 ds_read_b128 a[92:95], v11 offset:2048
 v_mfma_f32_16x16x32_bf16 a[64:67], a[0:3], a[136:139], a[64:67]
 v_mfma_f32_16x16x32_bf16 a[68:71], a[8:11], a[136:139], a[68:71]
 ds_read_b128 a[96:99], v10 offset:4096
 v_mfma_f32_16x16x32_bf16 a[68:71], a[12:15], a[140:143], a[68:71]
 buffer_load_dwordx4 a[156:159], v1, s[16:19], s48 offen offset:384 sc1
 v_mfma_f32_16x16x32_bf16 v[244:247], a[12:15], a[132:135], v[244:247]
 ds_read_b128 a[100:103], v11 offset:4096
 v_mfma_f32_16x16x32_bf16 v[244:247], a[8:11], a[128:131], v[244:247]
 v_mfma_f32_16x16x32_bf16 v[228:231], a[8:11], a[120:123], v[228:231]
 ds_read_b128 a[104:107], v10 offset:6144
 v_mfma_f32_16x16x32_bf16 v[228:231], a[12:15], a[124:127], v[228:231]
 v_mfma_f32_16x16x32_bf16 v[212:215], a[12:15], a[116:119], v[212:215]
 ds_read_b128 a[108:111], v11 offset:6144
 v_mfma_f32_16x16x32_bf16 v[212:215], a[8:11], a[112:115], v[212:215]
 s_add_u32 m0, s32, 114688
 v_mfma_f32_16x16x32_bf16 v[216:219], a[16:19], a[112:115], v[216:219]
 s_add_u32 s35, s34, 524544
 v_mfma_f32_16x16x32_bf16 v[216:219], a[20:23], a[116:119], v[216:219]
 buffer_load_dwordx4 v6, s[12:15], s35 offen offset:0 nt lds
 v_mfma_f32_16x16x32_bf16 v[232:235], a[20:23], a[124:127], v[232:235]
 v_mfma_f32_16x16x32_bf16 v[232:235], a[16:19], a[120:123], v[232:235]
 v_mfma_f32_16x16x32_bf16 v[248:251], a[16:19], a[128:131], v[248:251]
 v_mfma_f32_16x16x32_bf16 v[248:251], a[20:23], a[132:135], v[248:251]
 buffer_load_dwordx4 v7, s[12:15], s35 offen offset:1024 nt lds
 v_mfma_f32_16x16x32_bf16 a[72:75], a[20:23], a[140:143], a[72:75]
 v_mfma_f32_16x16x32_bf16 a[72:75], a[16:19], a[136:139], a[72:75]
 v_mfma_f32_16x16x32_bf16 a[76:79], a[24:27], a[136:139], a[76:79]
 v_mfma_f32_16x16x32_bf16 a[76:79], a[28:31], a[140:143], a[76:79]
 buffer_load_dwordx4 v8, s[12:15], s35 offen offset:2048 nt lds
 v_mfma_f32_16x16x32_bf16 v[252:255], a[28:31], a[132:135], v[252:255]
 v_mfma_f32_16x16x32_bf16 v[252:255], a[24:27], a[128:131], v[252:255]
 v_mfma_f32_16x16x32_bf16 v[236:239], a[24:27], a[120:123], v[236:239]
 v_mfma_f32_16x16x32_bf16 v[236:239], a[28:31], a[124:127], v[236:239]
 buffer_load_dwordx4 v9, s[12:15], s35 offen offset:3072 nt lds
 v_mfma_f32_16x16x32_bf16 v[220:223], a[28:31], a[116:119], v[220:223]
 v_mfma_f32_16x16x32_bf16 v[220:223], a[24:27], a[112:115], v[220:223]
 v_mfma_f32_16x16x32_bf16 v[144:147], a[0:3], a[32:35], v[144:147]
 ds_read_b64_tr_b16 a[112:113], v12 offset:0
 v_mfma_f32_16x16x32_bf16 v[144:147], a[4:7], a[36:39], v[144:147]
 ds_read_b64_tr_b16 a[114:115], v12 offset:1024
 v_mfma_f32_16x16x32_bf16 v[160:163], a[4:7], a[44:47], v[160:163]
 ds_read_b64_tr_b16 a[116:117], v12 offset:8192
 v_mfma_f32_16x16x32_bf16 v[160:163], a[0:3], a[40:43], v[160:163]
 ds_read_b64_tr_b16 a[118:119], v12 offset:9216
 v_mfma_f32_16x16x32_bf16 v[176:179], a[0:3], a[48:51], v[176:179]
 ds_read_b64_tr_b16 a[120:121], v13 offset:0
 v_mfma_f32_16x16x32_bf16 v[176:179], a[4:7], a[52:55], v[176:179]
 ds_read_b64_tr_b16 a[122:123], v13 offset:1024
 buffer_load_dwordx4 a[212:215], v1, s[16:19], s36 offen offset:384 sc1
 v_mfma_f32_16x16x32_bf16 v[192:195], a[4:7], a[60:63], v[192:195]
 ds_read_b64_tr_b16 a[124:125], v13 offset:8192
 v_mfma_f32_16x16x32_bf16 v[192:195], a[0:3], a[56:59], v[192:195]
 ds_read_b64_tr_b16 a[126:127], v13 offset:9216
 v_mfma_f32_16x16x32_bf16 v[196:199], a[8:11], a[56:59], v[196:199]
 ds_read_b64_tr_b16 a[128:129], v14 offset:0
 v_mfma_f32_16x16x32_bf16 v[196:199], a[12:15], a[60:63], v[196:199]
 ds_read_b64_tr_b16 a[130:131], v14 offset:1024
 v_mfma_f32_16x16x32_bf16 v[180:183], a[12:15], a[52:55], v[180:183]
 ds_read_b64_tr_b16 a[132:133], v14 offset:8192
 v_mfma_f32_16x16x32_bf16 v[180:183], a[8:11], a[48:51], v[180:183]
 ds_read_b64_tr_b16 a[134:135], v14 offset:9216
 v_mfma_f32_16x16x32_bf16 v[164:167], a[8:11], a[40:43], v[164:167]
 ds_read_b64_tr_b16 a[136:137], v15 offset:0
 v_mfma_f32_16x16x32_bf16 v[164:167], a[12:15], a[44:47], v[164:167]
 ds_read_b64_tr_b16 a[138:139], v15 offset:1024
 v_mfma_f32_16x16x32_bf16 v[148:151], a[12:15], a[36:39], v[148:151]
 ds_read_b64_tr_b16 a[140:141], v15 offset:8192
 v_mfma_f32_16x16x32_bf16 v[148:151], a[8:11], a[32:35], v[148:151]
 s_add_u32 m0, s32, 49152
 ds_read_b64_tr_b16 a[142:143], v15 offset:9216
 v_mfma_f32_16x16x32_bf16 v[152:155], a[16:19], a[32:35], v[152:155]
 s_add_u32 s35, s33, 2097280
 v_mfma_f32_16x16x32_bf16 v[152:155], a[20:23], a[36:39], v[152:155]
 buffer_load_dwordx4 v2, s[8:11], s35 offen offset:0 lds
 v_mfma_f32_16x16x32_bf16 v[168:171], a[20:23], a[44:47], v[168:171]
 v_mfma_f32_16x16x32_bf16 v[168:171], a[16:19], a[40:43], v[168:171]
 v_mfma_f32_16x16x32_bf16 v[184:187], a[16:19], a[48:51], v[184:187]
 v_mfma_f32_16x16x32_bf16 v[184:187], a[20:23], a[52:55], v[184:187]
 buffer_load_dwordx4 v3, s[8:11], s35 offen offset:1024 lds
 v_mfma_f32_16x16x32_bf16 v[200:203], a[20:23], a[60:63], v[200:203]
 v_mfma_f32_16x16x32_bf16 v[200:203], a[16:19], a[56:59], v[200:203]
 v_mfma_f32_16x16x32_bf16 v[204:207], a[24:27], a[56:59], v[204:207]
 v_mfma_f32_16x16x32_bf16 v[204:207], a[28:31], a[60:63], v[204:207]
 buffer_load_dwordx4 v4, s[8:11], s35 offen offset:2048 lds
 v_mfma_f32_16x16x32_bf16 v[188:191], a[28:31], a[52:55], v[188:191]
 v_mfma_f32_16x16x32_bf16 v[188:191], a[24:27], a[48:51], v[188:191]
 v_mfma_f32_16x16x32_bf16 v[172:175], a[24:27], a[40:43], v[172:175]
 v_mfma_f32_16x16x32_bf16 v[172:175], a[28:31], a[44:47], v[172:175]
 buffer_load_dwordx4 v5, s[8:11], s35 offen offset:3072 lds
 v_mfma_f32_16x16x32_bf16 v[156:159], a[28:31], a[36:39], v[156:159]
 s_waitcnt vmcnt(20)
 s_waitcnt lgkmcnt(0)
 s_barrier
 v_mfma_f32_16x16x32_bf16 v[156:159], a[24:27], a[32:35], v[156:159]
 v_mfma_f32_16x16x32_bf16 v[16:19], a[80:83], a[112:115], v[16:19]
 ds_read_b64_tr_b16 a[32:33], v12 offset:16384
 v_mfma_f32_16x16x32_bf16 v[16:19], a[84:87], a[116:119], v[16:19]
 s_mov_b32 s13, s39
 ds_read_b64_tr_b16 a[34:35], v12 offset:17408
 v_mfma_f32_16x16x32_bf16 v[32:35], a[84:87], a[124:127], v[32:35]
 s_mov_b32 s14, s51
 ds_read_b64_tr_b16 a[36:37], v12 offset:24576
 v_lshlrev_b32 v6, 2, v0
 v_mfma_f32_16x16x32_bf16 v[32:35], a[80:83], a[120:123], v[32:35]
 s_lshl_b32 s31, s3, 10
 s_lshl_b32 s30, s3, 3
 v_lshrrev_b32 v7, 3, v0
 v_mfma_f32_16x16x32_bf16 v[48:51], a[80:83], a[128:131], v[48:51]
 global_load_dword v3, v6, s[4:5] sc1
 v_mfma_f32_16x16x32_bf16 v[48:51], a[84:87], a[132:135], v[48:51]
 ds_read_b64_tr_b16 a[38:39], v12 offset:25600
 ds_read_b64_tr_b16 a[40:41], v13 offset:16384
 v_mfma_f32_16x16x32_bf16 v[64:67], a[84:87], a[140:143], v[64:67]
 ds_read_b64_tr_b16 a[42:43], v13 offset:17408
 v_add_u32 v7, s30, v7
 v_mfma_f32_16x16x32_bf16 v[64:67], a[80:83], a[136:139], v[64:67]
 v_lshlrev_b32 v7, 13, v7
 v_mfma_f32_16x16x32_bf16 v[68:71], a[88:91], a[136:139], v[68:71]
 s_lshl_b32 s30, s24, 9
 ds_read_b64_tr_b16 a[44:45], v13 offset:24576
 v_add_u32 v7, s30, v7
 v_mfma_f32_16x16x32_bf16 v[68:71], a[92:95], a[140:143], v[68:71]
 ds_read_b64_tr_b16 a[46:47], v13 offset:25600
 v_bfe_u32 v8, v0, 4, 1
 v_mfma_f32_16x16x32_bf16 v[52:55], a[92:95], a[132:135], v[52:55]
 s_lshl_b32 s30, s29, 1
 v_or_b32 v8, s30, v8
 v_lshlrev_b32 v8, 1, v8
 v_and_b32 v9, 7, v0
 v_xor_b32 v8, v8, v9
 v_lshl_add_u32 v2, v8, 4, v7
 v_mfma_f32_16x16x32_bf16 v[52:55], a[88:91], a[128:131], v[52:55]
 ds_read_b64_tr_b16 a[48:49], v14 offset:16384
 v_mfma_f32_16x16x32_bf16 v[36:39], a[88:91], a[120:123], v[36:39]
 s_add_u32 m0, s31, 131072
 s_mov_b32 s35, 0
 ds_read_b64_tr_b16 a[50:51], v14 offset:17408
 v_mfma_f32_16x16x32_bf16 v[36:39], a[92:95], a[124:127], v[36:39]
 buffer_load_dwordx4 v2, s[40:43], s35 offen lds
 v_mfma_f32_16x16x32_bf16 v[20:23], a[92:95], a[116:119], v[20:23]
 ds_read_b64_tr_b16 a[52:53], v14 offset:24576
 v_mfma_f32_16x16x32_bf16 v[20:23], a[88:91], a[112:115], v[20:23]
 ds_read_b64_tr_b16 a[54:55], v14 offset:25600
 v_mfma_f32_16x16x32_bf16 v[24:27], a[96:99], a[112:115], v[24:27]
 ds_read_b64_tr_b16 a[56:57], v15 offset:16384
 v_mfma_f32_16x16x32_bf16 v[24:27], a[100:103], a[116:119], v[24:27]
 s_add_u32 m0, s31, 135168
 ds_read_b64_tr_b16 a[58:59], v15 offset:17408
 v_mfma_f32_16x16x32_bf16 v[40:43], a[100:103], a[124:127], v[40:43]
 s_mov_b32 s35, 262144
 v_mfma_f32_16x16x32_bf16 v[40:43], a[96:99], a[120:123], v[40:43]
 buffer_load_dwordx4 v2, s[40:43], s35 offen lds
 v_mfma_f32_16x16x32_bf16 v[56:59], a[96:99], a[128:131], v[56:59]
 ds_read_b64_tr_b16 a[60:61], v15 offset:24576
 ds_read_b64_tr_b16 a[62:63], v15 offset:25600
 v_mfma_f32_16x16x32_bf16 v[56:59], a[100:103], a[132:135], v[56:59]
 v_mfma_f32_16x16x32_bf16 v[72:75], a[100:103], a[140:143], v[72:75]
 v_mfma_f32_16x16x32_bf16 v[72:75], a[96:99], a[136:139], v[72:75]
 s_add_u32 m0, s31, 139264
 v_mfma_f32_16x16x32_bf16 v[76:79], a[104:107], a[136:139], v[76:79]
 s_mov_b32 s35, 524288
 buffer_load_dwordx4 v2, s[40:43], s35 offen lds
 v_mfma_f32_16x16x32_bf16 v[76:79], a[108:111], a[140:143], v[76:79]
 v_mfma_f32_16x16x32_bf16 v[60:63], a[108:111], a[132:135], v[60:63]
 v_mfma_f32_16x16x32_bf16 v[60:63], a[104:107], a[128:131], v[60:63]
 v_mfma_f32_16x16x32_bf16 v[44:47], a[104:107], a[120:123], v[44:47]
 v_mfma_f32_16x16x32_bf16 v[44:47], a[108:111], a[124:127], v[44:47]
 s_add_u32 m0, s31, 143360
 v_mfma_f32_16x16x32_bf16 v[28:31], a[108:111], a[116:119], v[28:31]
 s_mov_b32 s35, 786432
 buffer_load_dwordx4 v2, s[40:43], s35 offen lds
 v_mfma_f32_16x16x32_bf16 v[28:31], a[104:107], a[112:115], v[28:31]
 s_waitcnt lgkmcnt(0)
 v_mfma_f32_16x16x32_bf16 v[80:83], a[80:83], a[32:35], v[80:83]
 ds_read_b128 a[0:3], v10 offset:16384
 v_mfma_f32_16x16x32_bf16 v[80:83], a[84:87], a[36:39], v[80:83]
 v_mfma_f32_16x16x32_bf16 v[96:99], a[84:87], a[44:47], v[96:99]
 ds_read_b128 a[4:7], v11 offset:16384
 v_mfma_f32_16x16x32_bf16 v[96:99], a[80:83], a[40:43], v[96:99]
 s_add_u32 m0, s31, 147456
 v_mfma_f32_16x16x32_bf16 v[112:115], a[80:83], a[48:51], v[112:115]
 s_mov_b32 s35, 1048576
 buffer_load_dwordx4 v2, s[40:43], s35 offen lds
 v_mfma_f32_16x16x32_bf16 v[112:115], a[84:87], a[52:55], v[112:115]
 ds_read_b128 a[8:11], v10 offset:18432
 v_mfma_f32_16x16x32_bf16 v[128:131], a[84:87], a[60:63], v[128:131]
 v_mfma_f32_16x16x32_bf16 v[128:131], a[80:83], a[56:59], v[128:131]
 v_mfma_f32_16x16x32_bf16 v[132:135], a[88:91], a[56:59], v[132:135]
 ds_read_b128 a[12:15], v11 offset:18432
 v_mfma_f32_16x16x32_bf16 v[132:135], a[92:95], a[60:63], v[132:135]
 s_add_u32 m0, s31, 151552
 v_mfma_f32_16x16x32_bf16 v[116:119], a[92:95], a[52:55], v[116:119]
 s_mov_b32 s35, 1310720
 buffer_load_dwordx4 v2, s[40:43], s35 offen lds
 v_mfma_f32_16x16x32_bf16 v[116:119], a[88:91], a[48:51], v[116:119]
 ds_read_b128 a[16:19], v10 offset:20480
 v_mfma_f32_16x16x32_bf16 v[100:103], a[88:91], a[40:43], v[100:103]
 v_mfma_f32_16x16x32_bf16 v[100:103], a[92:95], a[44:47], v[100:103]
 ds_read_b128 a[20:23], v11 offset:20480
 v_mfma_f32_16x16x32_bf16 v[84:87], a[92:95], a[36:39], v[84:87]
 v_mfma_f32_16x16x32_bf16 v[84:87], a[88:91], a[32:35], v[84:87]
 s_add_u32 m0, s31, 155648
 s_mov_b32 s35, 1572864
 v_mfma_f32_16x16x32_bf16 v[88:91], a[96:99], a[32:35], v[88:91]
 buffer_load_dwordx4 v2, s[40:43], s35 offen lds
 v_mfma_f32_16x16x32_bf16 v[88:91], a[100:103], a[36:39], v[88:91]
 ds_read_b128 a[24:27], v10 offset:22528
 v_mfma_f32_16x16x32_bf16 v[104:107], a[100:103], a[44:47], v[104:107]
 s_getpc_b64 s[20:21]
L_pcx11:
 s_add_u32 s20, s20, L_q-L_pcx11
 s_addc_u32 s21, s21, 0
 v_mfma_f32_16x16x32_bf16 v[104:107], a[96:99], a[40:43], v[104:107]
 s_lshl_b32 s38, s3, 13
 v_lshl_add_u32 v4, v0, 7, s38
 ds_read_b128 a[28:31], v11 offset:22528
 v_mfma_f32_16x16x32_bf16 v[120:123], a[96:99], a[48:51], v[120:123]
 v_mfma_f32_16x16x32_bf16 v[120:123], a[100:103], a[52:55], v[120:123]
 buffer_load_dwordx4 a[160:163], v1, s[16:19], s48 offen offset:512 sc1
 v_mfma_f32_16x16x32_bf16 v[136:139], a[100:103], a[60:63], v[136:139]
 v_min_u32 v4, L_textend-L_q-4, v4
 v_mfma_f32_16x16x32_bf16 v[136:139], a[96:99], a[56:59], v[136:139]
 v_mfma_f32_16x16x32_bf16 v[140:143], a[104:107], a[56:59], v[140:143]
 v_mfma_f32_16x16x32_bf16 v[140:143], a[108:111], a[60:63], v[140:143]
 global_load_dword v5, v4, s[20:21]
 v_mfma_f32_16x16x32_bf16 v[124:127], a[108:111], a[52:55], v[124:127]
 buffer_load_dwordx4 a[216:219], v1, s[16:19], s36 offen offset:512 sc1
 v_mfma_f32_16x16x32_bf16 v[124:127], a[104:107], a[48:51], v[124:127]
 v_mfma_f32_16x16x32_bf16 v[108:111], a[104:107], a[40:43], v[108:111]
 v_mfma_f32_16x16x32_bf16 v[108:111], a[108:111], a[44:47], v[108:111]
 v_mfma_f32_16x16x32_bf16 v[92:95], a[108:111], a[36:39], v[92:95]
 s_waitcnt vmcnt(21)
 s_waitcnt lgkmcnt(0)
 s_barrier
 v_mfma_f32_16x16x32_bf16 v[92:95], a[104:107], a[32:35], v[92:95]
 buffer_load_dwordx4 a[164:167], v1, s[16:19], s48 offen offset:640 sc1
 v_mfma_f32_16x16x32_bf16 v[208:211], a[0:3], a[32:35], v[208:211]
 ds_read_b128 a[80:83], v10 offset:32768
 v_mfma_f32_16x16x32_bf16 v[208:211], a[4:7], a[36:39], v[208:211]
 v_mfma_f32_16x16x32_bf16 v[224:227], a[4:7], a[44:47], v[224:227]
 ds_read_b128 a[84:87], v11 offset:32768
 v_mfma_f32_16x16x32_bf16 v[224:227], a[0:3], a[40:43], v[224:227]
 buffer_load_dwordx4 a[220:223], v1, s[16:19], s36 offen offset:640 sc1
 v_mfma_f32_16x16x32_bf16 v[240:243], a[0:3], a[48:51], v[240:243]
 v_mfma_f32_16x16x32_bf16 v[240:243], a[4:7], a[52:55], v[240:243]
 ds_read_b128 a[88:91], v10 offset:34816
 v_mfma_f32_16x16x32_bf16 a[64:67], a[4:7], a[60:63], a[64:67]
 v_mfma_f32_16x16x32_bf16 a[64:67], a[0:3], a[56:59], a[64:67]
 v_mfma_f32_16x16x32_bf16 a[68:71], a[8:11], a[56:59], a[68:71]
 buffer_load_dwordx4 a[168:171], v1, s[16:19], s48 offen offset:768 sc1
 v_mfma_f32_16x16x32_bf16 a[68:71], a[12:15], a[60:63], a[68:71]
 ds_read_b128 a[92:95], v11 offset:34816
 v_mfma_f32_16x16x32_bf16 v[244:247], a[12:15], a[52:55], v[244:247]
 v_mfma_f32_16x16x32_bf16 v[244:247], a[8:11], a[48:51], v[244:247]
 ds_read_b128 a[96:99], v10 offset:36864
 v_mfma_f32_16x16x32_bf16 v[228:231], a[8:11], a[40:43], v[228:231]
 buffer_load_dwordx4 a[224:227], v1, s[16:19], s36 offen offset:768 sc1
 v_mfma_f32_16x16x32_bf16 v[228:231], a[12:15], a[44:47], v[228:231]
 ds_read_b128 a[100:103], v11 offset:36864
 v_mfma_f32_16x16x32_bf16 v[212:215], a[12:15], a[36:39], v[212:215]
 v_mfma_f32_16x16x32_bf16 v[212:215], a[8:11], a[32:35], v[212:215]
 v_mfma_f32_16x16x32_bf16 v[216:219], a[16:19], a[32:35], v[216:219]
 ds_read_b128 a[104:107], v10 offset:38912
 v_mfma_f32_16x16x32_bf16 v[216:219], a[20:23], a[36:39], v[216:219]
 buffer_load_dwordx4 a[172:175], v1, s[16:19], s48 offen offset:896 sc1
 v_mfma_f32_16x16x32_bf16 v[232:235], a[20:23], a[44:47], v[232:235]
 v_mfma_f32_16x16x32_bf16 v[232:235], a[16:19], a[40:43], v[232:235]
 ds_read_b128 a[108:111], v11 offset:38912
 v_mfma_f32_16x16x32_bf16 v[248:251], a[16:19], a[48:51], v[248:251]
 v_mfma_f32_16x16x32_bf16 v[248:251], a[20:23], a[52:55], v[248:251]
 v_mfma_f32_16x16x32_bf16 a[72:75], a[20:23], a[60:63], a[72:75]
 buffer_load_dwordx4 a[228:231], v1, s[16:19], s36 offen offset:896 sc1
 v_mfma_f32_16x16x32_bf16 a[72:75], a[16:19], a[56:59], a[72:75]
 v_mfma_f32_16x16x32_bf16 a[76:79], a[24:27], a[56:59], a[76:79]
 v_mfma_f32_16x16x32_bf16 a[76:79], a[28:31], a[60:63], a[76:79]
 v_mfma_f32_16x16x32_bf16 v[252:255], a[28:31], a[52:55], v[252:255]
 v_mfma_f32_16x16x32_bf16 v[252:255], a[24:27], a[48:51], v[252:255]
 buffer_load_dwordx4 a[176:179], v1, s[16:19], s48 offen offset:1024 sc1
 v_mfma_f32_16x16x32_bf16 v[236:239], a[24:27], a[40:43], v[236:239]
 v_mfma_f32_16x16x32_bf16 v[236:239], a[28:31], a[44:47], v[236:239]
 v_mfma_f32_16x16x32_bf16 v[220:223], a[28:31], a[36:39], v[220:223]
 v_mfma_f32_16x16x32_bf16 v[220:223], a[24:27], a[32:35], v[220:223]
 buffer_load_dwordx4 a[232:235], v1, s[16:19], s36 offen offset:1024 sc1
 v_mfma_f32_16x16x32_bf16 v[144:147], a[0:3], a[112:115], v[144:147]
 ds_read_b64_tr_b16 a[32:33], v12 offset:32768
 v_mfma_f32_16x16x32_bf16 v[144:147], a[4:7], a[116:119], v[144:147]
 ds_read_b64_tr_b16 a[34:35], v12 offset:33792
 v_mfma_f32_16x16x32_bf16 v[160:163], a[4:7], a[124:127], v[160:163]
 ds_read_b64_tr_b16 a[36:37], v12 offset:40960
 v_mfma_f32_16x16x32_bf16 v[160:163], a[0:3], a[120:123], v[160:163]
 v_mfma_f32_16x16x32_bf16 v[176:179], a[0:3], a[128:131], v[176:179]
 s_add_u32 m0, s31, 65536
 ds_read_b64_tr_b16 a[38:39], v12 offset:41984
 v_mfma_f32_16x16x32_bf16 v[176:179], a[4:7], a[132:135], v[176:179]
 s_mov_b32 s35, 1835008
 buffer_load_dwordx4 v2, s[40:43], s35 offen lds
 v_mfma_f32_16x16x32_bf16 v[192:195], a[4:7], a[140:143], v[192:195]
 ds_read_b64_tr_b16 a[40:41], v13 offset:32768
 ds_read_b64_tr_b16 a[42:43], v13 offset:33792
 v_mfma_f32_16x16x32_bf16 v[192:195], a[0:3], a[136:139], v[192:195]
 v_mfma_f32_16x16x32_bf16 v[196:199], a[8:11], a[136:139], v[196:199]
 ds_read_b64_tr_b16 a[44:45], v13 offset:40960
 v_mfma_f32_16x16x32_bf16 v[196:199], a[12:15], a[140:143], v[196:199]
 ds_read_b64_tr_b16 a[46:47], v13 offset:41984
 v_mfma_f32_16x16x32_bf16 v[180:183], a[12:15], a[132:135], v[180:183]
 s_add_u32 m0, s31, 69632
 s_mov_b32 s35, 2097152
 v_mfma_f32_16x16x32_bf16 v[180:183], a[8:11], a[128:131], v[180:183]
 buffer_load_dwordx4 v2, s[40:43], s35 offen lds
 v_mfma_f32_16x16x32_bf16 v[164:167], a[8:11], a[120:123], v[164:167]
 ds_read_b64_tr_b16 a[48:49], v14 offset:32768
 ds_read_b64_tr_b16 a[50:51], v14 offset:33792
 v_mfma_f32_16x16x32_bf16 v[164:167], a[12:15], a[124:127], v[164:167]
 ds_read_b64_tr_b16 a[52:53], v14 offset:40960
 v_mfma_f32_16x16x32_bf16 v[148:151], a[12:15], a[116:119], v[148:151]
 v_mfma_f32_16x16x32_bf16 v[148:151], a[8:11], a[112:115], v[148:151]
 ds_read_b64_tr_b16 a[54:55], v14 offset:41984
 v_mfma_f32_16x16x32_bf16 v[152:155], a[16:19], a[112:115], v[152:155]
 s_add_u32 m0, s31, 73728
 s_mov_b32 s35, 2359296
 ds_read_b64_tr_b16 a[56:57], v15 offset:32768
 v_mfma_f32_16x16x32_bf16 v[152:155], a[20:23], a[116:119], v[152:155]
 buffer_load_dwordx4 v2, s[40:43], s35 offen lds
 v_mfma_f32_16x16x32_bf16 v[168:171], a[20:23], a[124:127], v[168:171]
 ds_read_b64_tr_b16 a[58:59], v15 offset:33792
 v_mfma_f32_16x16x32_bf16 v[168:171], a[16:19], a[120:123], v[168:171]
 ds_read_b64_tr_b16 a[60:61], v15 offset:40960
 v_mfma_f32_16x16x32_bf16 v[184:187], a[16:19], a[128:131], v[184:187]
 ds_read_b64_tr_b16 a[62:63], v15 offset:41984
 v_mfma_f32_16x16x32_bf16 v[184:187], a[20:23], a[132:135], v[184:187]
 v_mfma_f32_16x16x32_bf16 v[200:203], a[20:23], a[140:143], v[200:203]
 s_add_u32 m0, s31, 77824
 s_mov_b32 s35, 2621440
 v_mfma_f32_16x16x32_bf16 v[200:203], a[16:19], a[136:139], v[200:203]
 buffer_load_dwordx4 v2, s[40:43], s35 offen lds
 v_mfma_f32_16x16x32_bf16 v[204:207], a[24:27], a[136:139], v[204:207]
 v_mfma_f32_16x16x32_bf16 v[204:207], a[28:31], a[140:143], v[204:207]
 v_mfma_f32_16x16x32_bf16 v[188:191], a[28:31], a[132:135], v[188:191]
 v_mfma_f32_16x16x32_bf16 v[188:191], a[24:27], a[128:131], v[188:191]
 v_mfma_f32_16x16x32_bf16 v[172:175], a[24:27], a[120:123], v[172:175]
 s_add_u32 m0, s31, 81920
 s_mov_b32 s35, 2883584
 v_mfma_f32_16x16x32_bf16 v[172:175], a[28:31], a[124:127], v[172:175]
 buffer_load_dwordx4 v2, s[40:43], s35 offen lds
 v_mfma_f32_16x16x32_bf16 v[156:159], a[28:31], a[116:119], v[156:159]
 s_waitcnt vmcnt(24)
 s_waitcnt lgkmcnt(0)
 s_barrier
 v_mfma_f32_16x16x32_bf16 v[156:159], a[24:27], a[112:115], v[156:159]
 s_waitcnt vmcnt(23)
 v_cmp_ne_u32 vcc, 0x01010101, v3
 v_mfma_f32_16x16x32_bf16 v[16:19], a[80:83], a[32:35], v[16:19]
 ds_read_b64_tr_b16 a[112:113], v12 offset:49152
 v_mfma_f32_16x16x32_bf16 v[16:19], a[84:87], a[36:39], v[16:19]
 s_cbranch_vccnz L_loopV_spin
L_loopV_spun:
 ds_read_b64_tr_b16 a[114:115], v12 offset:50176
 v_mfma_f32_16x16x32_bf16 v[32:35], a[84:87], a[44:47], v[32:35]
 s_add_u32 m0, s31, 86016
 s_mov_b32 s35, 3145728
 ds_read_b64_tr_b16 a[116:117], v12 offset:57344
 v_mfma_f32_16x16x32_bf16 v[32:35], a[80:83], a[40:43], v[32:35]
 buffer_load_dwordx4 v2, s[40:43], s35 offen lds
 v_mfma_f32_16x16x32_bf16 v[48:51], a[80:83], a[48:51], v[48:51]
 ds_read_b64_tr_b16 a[118:119], v12 offset:58368
 v_lshrrev_b32 v8, 4, v0
 v_mfma_f32_16x16x32_bf16 v[48:51], a[84:87], a[52:55], v[48:51]
 ds_read_b64_tr_b16 a[120:121], v13 offset:49152
 v_lshlrev_b32 v8, 3, v8
 v_mfma_f32_16x16x32_bf16 v[64:67], a[84:87], a[60:63], v[64:67]
 ds_read_b64_tr_b16 a[122:123], v13 offset:50176
 v_bfe_u32 v9, v0, 2, 2
 v_mfma_f32_16x16x32_bf16 v[64:67], a[80:83], a[56:59], v[64:67]
 s_add_u32 m0, s31, 90112
 v_add_u32 v8, v8, v9
 v_mfma_f32_16x16x32_bf16 v[68:71], a[88:91], a[56:59], v[68:71]
 s_mov_b32 s35, 3407872
 ds_read_b64_tr_b16 a[124:125], v13 offset:57344
 v_lshlrev_b32 v8, 7, v8
 v_mfma_f32_16x16x32_bf16 v[68:71], a[92:95], a[60:63], v[68:71]
 buffer_load_dwordx4 v2, s[40:43], s35 offen lds
 v_mfma_f32_16x16x32_bf16 v[52:55], a[92:95], a[52:55], v[52:55]
 ds_read_b64_tr_b16 a[126:127], v13 offset:58368
 v_bfe_u32 v9, v0, 3, 2
 v_mfma_f32_16x16x32_bf16 v[52:55], a[88:91], a[48:51], v[52:55]
 ds_read_b64_tr_b16 a[128:129], v14 offset:49152
 v_lshlrev_b32 v9, 5, v9
 v_mfma_f32_16x16x32_bf16 v[36:39], a[88:91], a[40:43], v[36:39]
 ds_read_b64_tr_b16 a[130:131], v14 offset:50176
 v_add_u32 v8, v8, v9
 v_mfma_f32_16x16x32_bf16 v[36:39], a[92:95], a[44:47], v[36:39]
 buffer_load_dwordx4 a[180:183], v1, s[16:19], s48 offen offset:1152 sc1
 v_mfma_f32_16x16x32_bf16 v[20:23], a[92:95], a[36:39], v[20:23]
 ds_read_b64_tr_b16 a[132:133], v14 offset:57344
 v_and_b32 v9, 3, v0
 v_mfma_f32_16x16x32_bf16 v[20:23], a[88:91], a[32:35], v[20:23]
 ds_read_b64_tr_b16 a[134:135], v14 offset:58368
 v_lshl_add_u32 v8, v9, 3, v8
 v_mfma_f32_16x16x32_bf16 v[24:27], a[96:99], a[32:35], v[24:27]
 ds_read_b64_tr_b16 a[136:137], v15 offset:49152
 v_mfma_f32_16x16x32_bf16 v[24:27], a[100:103], a[36:39], v[24:27]
 ds_read_b64_tr_b16 a[138:139], v15 offset:50176
 v_add_u32 v4, 131072, v8
 v_mfma_f32_16x16x32_bf16 v[40:43], a[100:103], a[44:47], v[40:43]
 buffer_load_dwordx4 a[236:239], v1, s[16:19], s36 offen offset:1152 sc1
 v_mfma_f32_16x16x32_bf16 v[40:43], a[96:99], a[40:43], v[40:43]
 ds_read_b64_tr_b16 a[140:141], v15 offset:57344
 s_waitcnt vmcnt(18)
 v_xor_b32 v5, 32, v4
 v_mfma_f32_16x16x32_bf16 v[56:59], a[96:99], a[48:51], v[56:59]
 ds_read_b64_tr_b16 a[142:143], v15 offset:58368
 v_xor_b32 v6, 64, v4
 v_mfma_f32_16x16x32_bf16 v[56:59], a[100:103], a[52:55], v[56:59]
 v_xor_b32 v7, 96, v4
 v_mfma_f32_16x16x32_bf16 v[72:75], a[100:103], a[60:63], v[72:75]
 s_lshl_b32 s30, s3, 6
 v_mfma_f32_16x16x32_bf16 v[72:75], a[96:99], a[56:59], v[72:75]
 buffer_load_dwordx4 a[184:187], v1, s[16:19], s48 offen offset:1280 sc1
 v_mfma_f32_16x16x32_bf16 v[76:79], a[104:107], a[56:59], v[76:79]
 v_add_u32 v8, s30, v0
 v_lshrrev_b32 v9, 4, v8
 v_mfma_f32_16x16x32_bf16 v[76:79], a[108:111], a[60:63], v[76:79]
 v_min_u32 v9, 1, v9
 v_mfma_f32_16x16x32_bf16 v[60:63], a[108:111], a[52:55], v[60:63]
 v_mfma_f32_16x16x32_bf16 v[60:63], a[104:107], a[48:51], v[60:63]
 buffer_load_dwordx4 a[240:243], v1, s[16:19], s36 offen offset:1280 sc1
 v_mfma_f32_16x16x32_bf16 v[44:47], a[104:107], a[40:43], v[44:47]
 v_lshlrev_b32 v9, 30, v9
 v_lshl_add_u32 v3, v8, 8, v9
 v_mfma_f32_16x16x32_bf16 v[44:47], a[108:111], a[44:47], v[44:47]
 v_mfma_f32_16x16x32_bf16 v[28:31], a[108:111], a[36:39], v[28:31]
 v_mov_b32 v9, 1
 v_mfma_f32_16x16x32_bf16 v[28:31], a[104:107], a[32:35], v[28:31]
 s_waitcnt lgkmcnt(0)
 s_and_b32 s15, s22, 0xfffff000
 v_mfma_f32_16x16x32_bf16 v[80:83], a[80:83], a[112:115], v[80:83]
 buffer_load_dwordx4 a[188:191], v1, s[16:19], s48 offen offset:1408 sc1
 v_mfma_f32_16x16x32_bf16 v[80:83], a[84:87], a[116:119], v[80:83]
 ds_read_b128 a[0:3], v10 offset:49152
 v_mfma_f32_16x16x32_bf16 v[96:99], a[84:87], a[124:127], v[96:99]
 ds_read_b128 a[4:7], v11 offset:49152
 v_mfma_f32_16x16x32_bf16 v[96:99], a[80:83], a[120:123], v[96:99]
 v_cvt_pk_bf16_f32 v16, v16, v17
 v_cvt_pk_bf16_f32 v17, v18, v19
 v_mfma_f32_16x16x32_bf16 v[112:115], a[80:83], a[128:131], v[112:115]
 v_cvt_pk_bf16_f32 v18, v20, v21
 v_mfma_f32_16x16x32_bf16 v[112:115], a[84:87], a[132:135], v[112:115]
 buffer_load_dwordx4 a[244:247], v1, s[16:19], s36 offen offset:1408 sc1
 v_mfma_f32_16x16x32_bf16 v[128:131], a[84:87], a[140:143], v[128:131]
 ds_read_b128 a[8:11], v10 offset:51200
 v_cvt_pk_bf16_f32 v19, v22, v23
 v_mfma_f32_16x16x32_bf16 v[128:131], a[80:83], a[136:139], v[128:131]
 v_cvt_pk_bf16_f32 v24, v24, v25
 v_cvt_pk_bf16_f32 v25, v26, v27
 v_mfma_f32_16x16x32_bf16 v[132:135], a[88:91], a[136:139], v[132:135]
 ds_read_b128 a[12:15], v11 offset:51200
 v_cvt_pk_bf16_f32 v26, v28, v29
 v_mfma_f32_16x16x32_bf16 v[132:135], a[92:95], a[140:143], v[132:135]
 v_cvt_pk_bf16_f32 v27, v30, v31
 v_cvt_pk_bf16_f32 v32, v32, v33
 v_mfma_f32_16x16x32_bf16 v[116:119], a[92:95], a[132:135], v[116:119]
 buffer_load_dwordx4 a[192:195], v1, s[16:19], s48 offen offset:1536 sc1
 v_mfma_f32_16x16x32_bf16 v[116:119], a[88:91], a[128:131], v[116:119]
 ds_read_b128 a[16:19], v10 offset:53248
 v_cvt_pk_bf16_f32 v33, v34, v35
 v_mfma_f32_16x16x32_bf16 v[100:103], a[88:91], a[120:123], v[100:103]
 v_cvt_pk_bf16_f32 v34, v36, v37
 v_cvt_pk_bf16_f32 v35, v38, v39
 v_mfma_f32_16x16x32_bf16 v[100:103], a[92:95], a[124:127], v[100:103]
 ds_read_b128 a[20:23], v11 offset:53248
 v_cvt_pk_bf16_f32 v40, v40, v41
 v_mfma_f32_16x16x32_bf16 v[84:87], a[92:95], a[116:119], v[84:87]
 buffer_load_dwordx4 a[248:251], v1, s[16:19], s36 offen offset:1536 sc1
 v_mfma_f32_16x16x32_bf16 v[84:87], a[88:91], a[112:115], v[84:87]
 v_cvt_pk_bf16_f32 v41, v42, v43
 v_cvt_pk_bf16_f32 v42, v44, v45
 v_mfma_f32_16x16x32_bf16 v[88:91], a[96:99], a[112:115], v[88:91]
 ds_read_b128 a[24:27], v10 offset:55296
 v_cvt_pk_bf16_f32 v43, v46, v47
 v_mfma_f32_16x16x32_bf16 v[88:91], a[100:103], a[116:119], v[88:91]
 v_cvt_pk_bf16_f32 v48, v48, v49
 v_cvt_pk_bf16_f32 v49, v50, v51
 v_mfma_f32_16x16x32_bf16 v[104:107], a[100:103], a[124:127], v[104:107]
 v_cvt_pk_bf16_f32 v50, v52, v53
 v_mfma_f32_16x16x32_bf16 v[104:107], a[96:99], a[120:123], v[104:107]
 buffer_load_dwordx4 a[196:199], v1, s[16:19], s48 offen offset:1664 sc1
 v_mfma_f32_16x16x32_bf16 v[120:123], a[96:99], a[128:131], v[120:123]
 ds_read_b128 a[28:31], v11 offset:55296
 v_cvt_pk_bf16_f32 v51, v54, v55
 v_mfma_f32_16x16x32_bf16 v[120:123], a[100:103], a[132:135], v[120:123]
 v_cvt_pk_bf16_f32 v56, v56, v57
 v_cvt_pk_bf16_f32 v57, v58, v59
 v_mfma_f32_16x16x32_bf16 v[136:139], a[100:103], a[140:143], v[136:139]
 v_cvt_pk_bf16_f32 v58, v60, v61
 v_cvt_pk_bf16_f32 v59, v62, v63
 v_mfma_f32_16x16x32_bf16 v[136:139], a[96:99], a[136:139], v[136:139]
 v_cvt_pk_bf16_f32 v64, v64, v65
 v_mfma_f32_16x16x32_bf16 v[140:143], a[104:107], a[136:139], v[140:143]
 buffer_load_dwordx4 a[252:255], v1, s[16:19], s36 offen offset:1664 sc1
 v_mfma_f32_16x16x32_bf16 v[140:143], a[108:111], a[140:143], v[140:143]
 v_cvt_pk_bf16_f32 v65, v66, v67
 v_cvt_pk_bf16_f32 v66, v68, v69
 v_mfma_f32_16x16x32_bf16 v[124:127], a[108:111], a[132:135], v[124:127]
 v_cvt_pk_bf16_f32 v67, v70, v71
 v_cvt_pk_bf16_f32 v72, v72, v73
 v_mfma_f32_16x16x32_bf16 v[124:127], a[104:107], a[128:131], v[124:127]
 v_cvt_pk_bf16_f32 v73, v74, v75
 v_mfma_f32_16x16x32_bf16 v[108:111], a[104:107], a[120:123], v[108:111]
 v_cvt_pk_bf16_f32 v74, v76, v77
 v_mfma_f32_16x16x32_bf16 v[108:111], a[108:111], a[124:127], v[108:111]
 v_cvt_pk_bf16_f32 v75, v78, v79
 v_mfma_f32_16x16x32_bf16 v[92:95], a[108:111], a[116:119], v[92:95]
 s_waitcnt lgkmcnt(0)
 s_barrier
 v_lshlrev_b32 v1, 4, v0
 v_mfma_f32_16x16x32_bf16 v[92:95], a[104:107], a[112:115], v[92:95]
 v_mfma_f32_16x16x32_bf16 v[208:211], a[0:3], a[112:115], v[208:211]
 s_add_u32 m0, s31, 0
 s_mov_b32 s35, 128
 v_mfma_f32_16x16x32_bf16 v[208:211], a[4:7], a[116:119], v[208:211]
 buffer_load_dwordx4 v2, s[40:43], s35 offen lds
 v_mfma_f32_16x16x32_bf16 v[224:227], a[4:7], a[124:127], v[224:227]
 v_mfma_f32_16x16x32_bf16 v[224:227], a[0:3], a[120:123], v[224:227]
 v_cvt_pk_bf16_f32 v80, v80, v81
 v_cvt_pk_bf16_f32 v81, v82, v83
 v_mfma_f32_16x16x32_bf16 v[240:243], a[0:3], a[128:131], v[240:243]
 v_cvt_pk_bf16_f32 v82, v84, v85
 v_mfma_f32_16x16x32_bf16 v[240:243], a[4:7], a[132:135], v[240:243]
 v_cvt_pk_bf16_f32 v83, v86, v87
 v_mfma_f32_16x16x32_bf16 a[64:67], a[4:7], a[140:143], a[64:67]
 v_cvt_pk_bf16_f32 v88, v88, v89
 v_mfma_f32_16x16x32_bf16 a[64:67], a[0:3], a[136:139], a[64:67]
 v_cvt_pk_bf16_f32 v89, v90, v91
 v_mfma_f32_16x16x32_bf16 a[68:71], a[8:11], a[136:139], a[68:71]
 s_mul_i32 s37, s13, 0
 v_cvt_pk_bf16_f32 v90, v92, v93
 v_mfma_f32_16x16x32_bf16 a[68:71], a[12:15], a[140:143], a[68:71]
 s_add_u32 m0, s31, 4096
 s_mov_b32 s35, 262272
 v_cvt_pk_bf16_f32 v91, v94, v95
 v_mfma_f32_16x16x32_bf16 v[244:247], a[12:15], a[132:135], v[244:247]
 s_add_u32 s37, s37, s58
 buffer_load_dwordx4 v2, s[40:43], s35 offen lds
 v_mfma_f32_16x16x32_bf16 v[244:247], a[8:11], a[128:131], v[244:247]
 v_cvt_pk_bf16_f32 v96, v96, v97
 v_cvt_pk_bf16_f32 v97, v98, v99
 v_mfma_f32_16x16x32_bf16 v[228:231], a[8:11], a[120:123], v[228:231]
 v_cvt_pk_bf16_f32 v98, v100, v101
 v_mfma_f32_16x16x32_bf16 v[228:231], a[12:15], a[124:127], v[228:231]
 buffer_store_dwordx4 v[16:19], v1, s[16:19], s37 offen sc1
 v_mfma_f32_16x16x32_bf16 v[212:215], a[12:15], a[116:119], v[212:215]
 v_cvt_pk_bf16_f32 v99, v102, v103
 v_cvt_pk_bf16_f32 v104, v104, v105
 v_mfma_f32_16x16x32_bf16 v[212:215], a[8:11], a[112:115], v[212:215]
 v_cvt_pk_bf16_f32 v105, v106, v107
 v_mfma_f32_16x16x32_bf16 v[216:219], a[16:19], a[112:115], v[216:219]
 v_cvt_pk_bf16_f32 v106, v108, v109
 v_mfma_f32_16x16x32_bf16 v[216:219], a[20:23], a[116:119], v[216:219]
 v_cvt_pk_bf16_f32 v107, v110, v111
 v_mfma_f32_16x16x32_bf16 v[232:235], a[20:23], a[124:127], v[232:235]
 s_add_u32 m0, s31, 8192
 s_mov_b32 s35, 524416
 v_cvt_pk_bf16_f32 v112, v112, v113
 v_mfma_f32_16x16x32_bf16 v[232:235], a[16:19], a[120:123], v[232:235]
 buffer_load_dwordx4 v2, s[40:43], s35 offen lds
 v_mfma_f32_16x16x32_bf16 v[248:251], a[16:19], a[128:131], v[248:251]
 v_cvt_pk_bf16_f32 v113, v114, v115
 v_cvt_pk_bf16_f32 v114, v116, v117
 v_mfma_f32_16x16x32_bf16 v[248:251], a[20:23], a[132:135], v[248:251]
 v_cvt_pk_bf16_f32 v115, v118, v119
 v_mfma_f32_16x16x32_bf16 a[72:75], a[20:23], a[140:143], a[72:75]
 v_cvt_pk_bf16_f32 v120, v120, v121
 v_mfma_f32_16x16x32_bf16 a[72:75], a[16:19], a[136:139], a[72:75]
 v_cvt_pk_bf16_f32 v121, v122, v123
 v_mfma_f32_16x16x32_bf16 a[76:79], a[24:27], a[136:139], a[76:79]
 v_cvt_pk_bf16_f32 v122, v124, v125
 v_mfma_f32_16x16x32_bf16 a[76:79], a[28:31], a[140:143], a[76:79]
 v_cvt_pk_bf16_f32 v123, v126, v127
 v_mfma_f32_16x16x32_bf16 v[252:255], a[28:31], a[132:135], v[252:255]
 v_cvt_pk_bf16_f32 v128, v128, v129
 v_mfma_f32_16x16x32_bf16 v[252:255], a[24:27], a[128:131], v[252:255]
 s_add_u32 m0, s31, 12288
 s_mov_b32 s35, 786560
 v_cvt_pk_bf16_f32 v129, v130, v131
 v_mfma_f32_16x16x32_bf16 v[236:239], a[24:27], a[120:123], v[236:239]
 buffer_load_dwordx4 v2, s[40:43], s35 offen lds
 v_mfma_f32_16x16x32_bf16 v[236:239], a[28:31], a[124:127], v[236:239]
 v_cvt_pk_bf16_f32 v130, v132, v133
 v_cvt_pk_bf16_f32 v131, v134, v135
 v_mfma_f32_16x16x32_bf16 v[220:223], a[28:31], a[116:119], v[220:223]
 v_cvt_pk_bf16_f32 v136, v136, v137
 v_mfma_f32_16x16x32_bf16 v[220:223], a[24:27], a[112:115], v[220:223]
 v_cvt_pk_bf16_f32 v137, v138, v139
 v_mfma_f32_16x16x32_bf16 v[144:147], a[0:3], a[32:35], v[144:147]
 v_cvt_pk_bf16_f32 v138, v140, v141
 v_mfma_f32_16x16x32_bf16 v[144:147], a[4:7], a[36:39], v[144:147]
 v_cvt_pk_bf16_f32 v139, v142, v143
 v_mfma_f32_16x16x32_bf16 v[160:163], a[4:7], a[44:47], v[160:163]
 s_add_u32 s37, s37, s59
 v_mfma_f32_16x16x32_bf16 v[160:163], a[0:3], a[40:43], v[160:163]
 v_cvt_pk_bf16_f32 v208, v208, v209
 v_mfma_f32_16x16x32_bf16 v[176:179], a[0:3], a[48:51], v[176:179]
 s_add_u32 m0, s31, 16384
 s_mov_b32 s35, 1048704
 v_cvt_pk_bf16_f32 v209, v210, v211
 v_mfma_f32_16x16x32_bf16 v[176:179], a[4:7], a[52:55], v[176:179]
 buffer_load_dwordx4 v2, s[40:43], s35 offen lds
 v_mfma_f32_16x16x32_bf16 v[192:195], a[4:7], a[60:63], v[192:195]
 buffer_store_dwordx4 v[24:27], v1, s[16:19], s37 offen sc1
 v_mfma_f32_16x16x32_bf16 v[192:195], a[0:3], a[56:59], v[192:195]
 v_cvt_pk_bf16_f32 v210, v212, v213
 v_cvt_pk_bf16_f32 v211, v214, v215
 v_mfma_f32_16x16x32_bf16 v[196:199], a[8:11], a[56:59], v[196:199]
 v_cvt_pk_bf16_f32 v216, v216, v217
 v_mfma_f32_16x16x32_bf16 v[196:199], a[12:15], a[60:63], v[196:199]
 v_cvt_pk_bf16_f32 v217, v218, v219
 v_mfma_f32_16x16x32_bf16 v[180:183], a[12:15], a[52:55], v[180:183]
 v_cvt_pk_bf16_f32 v218, v220, v221
 v_mfma_f32_16x16x32_bf16 v[180:183], a[8:11], a[48:51], v[180:183]
 v_cvt_pk_bf16_f32 v219, v222, v223
 v_mfma_f32_16x16x32_bf16 v[164:167], a[8:11], a[40:43], v[164:167]
 v_cvt_pk_bf16_f32 v224, v224, v225
 v_mfma_f32_16x16x32_bf16 v[164:167], a[12:15], a[44:47], v[164:167]
 s_add_u32 m0, s31, 20480
 s_mov_b32 s35, 1310848
 v_cvt_pk_bf16_f32 v225, v226, v227
 v_mfma_f32_16x16x32_bf16 v[148:151], a[12:15], a[36:39], v[148:151]
 buffer_load_dwordx4 v2, s[40:43], s35 offen lds
 v_mfma_f32_16x16x32_bf16 v[148:151], a[8:11], a[32:35], v[148:151]
 v_cvt_pk_bf16_f32 v226, v228, v229
 v_mfma_f32_16x16x32_bf16 v[152:155], a[16:19], a[32:35], v[152:155]
 v_cvt_pk_bf16_f32 v227, v230, v231
 v_mfma_f32_16x16x32_bf16 v[152:155], a[20:23], a[36:39], v[152:155]
 s_barrier
 v_cvt_pk_bf16_f32 v232, v232, v233
 v_mfma_f32_16x16x32_bf16 v[168:171], a[20:23], a[44:47], v[168:171]
 ds_read_b64_tr_b16 a[80:81], v4 offset:0
 v_cvt_pk_bf16_f32 v233, v234, v235
 v_mfma_f32_16x16x32_bf16 v[168:171], a[16:19], a[40:43], v[168:171]
 ds_read_b64_tr_b16 a[82:83], v4 offset:512
 v_cvt_pk_bf16_f32 v234, v236, v237
 v_mfma_f32_16x16x32_bf16 v[184:187], a[16:19], a[48:51], v[184:187]
 ds_read_b64_tr_b16 a[84:85], v4 offset:4096
 v_mfma_f32_16x16x32_bf16 v[184:187], a[20:23], a[52:55], v[184:187]
 ds_read_b64_tr_b16 a[86:87], v4 offset:4608
 v_cvt_pk_bf16_f32 v235, v238, v239
 v_mfma_f32_16x16x32_bf16 v[200:203], a[20:23], a[60:63], v[200:203]
 s_add_u32 m0, s31, 24576
 s_mov_b32 s35, 1572992
 ds_read_b64_tr_b16 a[88:89], v4 offset:8192
 v_mfma_f32_16x16x32_bf16 v[200:203], a[16:19], a[56:59], v[200:203]
 buffer_load_dwordx4 v2, s[40:43], s35 offen lds
 v_mfma_f32_16x16x32_bf16 v[204:207], a[24:27], a[56:59], v[204:207]
 ds_read_b64_tr_b16 a[90:91], v4 offset:8704
 ds_read_b64_tr_b16 a[92:93], v4 offset:12288
 v_mfma_f32_16x16x32_bf16 v[204:207], a[28:31], a[60:63], v[204:207]
 ds_read_b64_tr_b16 a[94:95], v4 offset:12800
 v_cvt_pk_bf16_f32 v240, v240, v241
 v_mfma_f32_16x16x32_bf16 v[188:191], a[28:31], a[52:55], v[188:191]
 ds_read_b64_tr_b16 a[96:97], v4 offset:16384
 v_cvt_pk_bf16_f32 v241, v242, v243
 v_mfma_f32_16x16x32_bf16 v[188:191], a[24:27], a[48:51], v[188:191]
 ds_read_b64_tr_b16 a[98:99], v4 offset:16896
 v_cvt_pk_bf16_f32 v242, v244, v245
 v_mfma_f32_16x16x32_bf16 v[172:175], a[24:27], a[40:43], v[172:175]
 ds_read_b64_tr_b16 a[100:101], v4 offset:20480
 v_cvt_pk_bf16_f32 v243, v246, v247
 v_mfma_f32_16x16x32_bf16 v[172:175], a[28:31], a[44:47], v[172:175]
 ds_read_b64_tr_b16 a[102:103], v4 offset:20992
 v_cvt_pk_bf16_f32 v248, v248, v249
 v_mfma_f32_16x16x32_bf16 v[156:159], a[28:31], a[36:39], v[156:159]
 ds_read_b64_tr_b16 a[104:105], v4 offset:24576
 v_cvt_pk_bf16_f32 v249, v250, v251
 v_mfma_f32_16x16x32_bf16 v[156:159], a[24:27], a[32:35], v[156:159]
 ds_read_b64_tr_b16 a[106:107], v4 offset:25088
 v_cvt_pk_bf16_f32 v250, v252, v253
 v_cvt_pk_bf16_f32 v251, v254, v255
L_q:
 s_waitcnt lgkmcnt(5)
 v_mfma_f32_16x16x32_bf16 v[20:23], a[80:83], a[144:147], 0
 ds_read_b64_tr_b16 a[112:113], v5 offset:0
 ds_read_b64_tr_b16 a[114:115], v5 offset:512
 v_mfma_f32_16x16x32_bf16 v[20:23], a[84:87], a[148:151], v[20:23]
 ds_read_b64_tr_b16 a[116:117], v5 offset:4096
 v_mfma_f32_16x16x32_bf16 v[20:23], a[88:91], a[152:155], v[20:23]
 s_add_u32 m0, s31, 98304
 s_mov_b32 s35, 1835136
 ds_read_b64_tr_b16 a[118:119], v5 offset:4608
 v_mfma_f32_16x16x32_bf16 v[20:23], a[92:95], a[156:159], v[20:23]
 s_waitcnt lgkmcnt(5)
 s_add_u32 s37, s37, s14
 buffer_load_dwordx4 v2, s[40:43], s35 offen lds
 v_mfma_f32_16x16x32_bf16 v[20:23], a[96:99], a[160:163], v[20:23]
 ds_read_b64_tr_b16 a[120:121], v5 offset:8192
 ds_read_b64_tr_b16 a[122:123], v5 offset:8704
 s_waitcnt vmcnt(34)
 v_mfma_f32_16x16x32_bf16 v[20:23], a[100:103], a[164:167], v[20:23]
 ds_read_b64_tr_b16 a[124:125], v5 offset:12288
 v_accvgpr_read_b32 v212, a64
 s_waitcnt vmcnt(32) lgkmcnt(5)
 v_mfma_f32_16x16x32_bf16 v[20:23], a[104:107], a[168:171], v[20:23]
 ds_read_b64_tr_b16 a[126:127], v5 offset:12800
 ds_read_b64_tr_b16 a[128:129], v5 offset:16384
 v_mfma_f32_16x16x32_bf16 v[28:31], a[80:83], a[200:203], 0
 s_add_u32 m0, s31, 102400
 s_mov_b32 s35, 2097280
 ds_read_b64_tr_b16 a[130:131], v5 offset:16896
 v_mfma_f32_16x16x32_bf16 v[28:31], a[84:87], a[204:207], v[28:31]
 buffer_load_dwordx4 v2, s[40:43], s35 offen lds
 v_mfma_f32_16x16x32_bf16 v[28:31], a[88:91], a[208:211], v[28:31]
 ds_read_b64_tr_b16 a[132:133], v5 offset:20480
 ds_read_b64_tr_b16 a[134:135], v5 offset:20992
 v_mfma_f32_16x16x32_bf16 v[28:31], a[92:95], a[212:215], v[28:31]
 ds_read_b64_tr_b16 a[136:137], v5 offset:24576
 v_accvgpr_read_b32 v213, a65
 v_mfma_f32_16x16x32_bf16 v[28:31], a[96:99], a[216:219], v[28:31]
 buffer_store_dwordx4 v[32:35], v1, s[16:19], s37 offen sc1
 ds_read_b64_tr_b16 a[138:139], v5 offset:25088
 v_mfma_f32_16x16x32_bf16 v[28:31], a[100:103], a[220:223], v[28:31]
 s_add_u32 m0, s31, 106496
 v_accvgpr_read_b32 v214, a66
 v_accvgpr_read_b32 v215, a67
 s_waitcnt vmcnt(33)
 v_mfma_f32_16x16x32_bf16 v[28:31], a[104:107], a[224:227], v[28:31]
 s_mov_b32 s35, 2359424
 buffer_load_dwordx4 v2, s[40:43], s35 offen lds
 v_mfma_f32_16x16x32_bf16 v[36:39], a[112:115], a[144:147], 0
 s_waitcnt lgkmcnt(2)
 ds_read_b64_tr_b16 a[80:81], v6 offset:0
 ds_read_b64_tr_b16 a[82:83], v6 offset:512
 v_mfma_f32_16x16x32_bf16 v[36:39], a[116:119], a[148:151], v[36:39]
 ds_read_b64_tr_b16 a[84:85], v6 offset:4096
 v_accvgpr_read_b32 v220, a68
 v_mfma_f32_16x16x32_bf16 v[36:39], a[120:123], a[152:155], v[36:39]
 s_add_u32 s37, s37, s59
 ds_read_b64_tr_b16 a[86:87], v6 offset:4608
 v_accvgpr_read_b32 v221, a69
 v_mfma_f32_16x16x32_bf16 v[36:39], a[124:127], a[156:159], v[36:39]
 ds_read_b64_tr_b16 a[88:89], v6 offset:8192
 v_accvgpr_read_b32 v222, a70
 v_mfma_f32_16x16x32_bf16 v[36:39], a[128:131], a[160:163], v[36:39]
 s_add_u32 m0, s31, 110592
 s_mov_b32 s35, 2621568
 ds_read_b64_tr_b16 a[90:91], v6 offset:8704
 v_mfma_f32_16x16x32_bf16 v[36:39], a[132:135], a[164:167], v[36:39]
 s_waitcnt lgkmcnt(4)
 buffer_load_dwordx4 v2, s[40:43], s35 offen lds
 v_mfma_f32_16x16x32_bf16 v[36:39], a[136:139], a[168:171], v[36:39]
 ds_read_b64_tr_b16 a[92:93], v6 offset:12288
 ds_read_b64_tr_b16 a[94:95], v6 offset:12800
 v_mfma_f32_16x16x32_bf16 v[44:47], a[112:115], a[200:203], 0
 ds_read_b64_tr_b16 a[96:97], v6 offset:16384
 ds_read_b64_tr_b16 a[98:99], v6 offset:16896
 v_mfma_f32_16x16x32_bf16 v[44:47], a[116:119], a[204:207], v[44:47]
 ds_read_b64_tr_b16 a[100:101], v6 offset:20480
 v_accvgpr_read_b32 v223, a71
 v_mfma_f32_16x16x32_bf16 v[44:47], a[120:123], a[208:211], v[44:47]
 s_add_u32 m0, s31, 114688
 ds_read_b64_tr_b16 a[102:103], v6 offset:20992
 v_cvt_pk_bf16_f32 v212, v212, v213
 v_mfma_f32_16x16x32_bf16 v[44:47], a[124:127], a[212:215], v[44:47]
 s_mov_b32 s35, 2883712
 buffer_load_dwordx4 v2, s[40:43], s35 offen lds
 v_mfma_f32_16x16x32_bf16 v[44:47], a[128:131], a[216:219], v[44:47]
 ds_read_b64_tr_b16 a[104:105], v6 offset:24576
 ds_read_b64_tr_b16 a[106:107], v6 offset:25088
 v_mfma_f32_16x16x32_bf16 v[44:47], a[132:135], a[220:223], v[44:47]
 v_cvt_pk_bf16_f32 v213, v214, v215
 v_cvt_pk_bf16_f32 v214, v220, v221
 v_mfma_f32_16x16x32_bf16 v[44:47], a[136:139], a[224:227], v[44:47]
 v_cvt_pk_bf16_f32 v215, v222, v223
 v_accvgpr_read_b32 v228, a72
 v_mfma_f32_16x16x32_bf16 v[52:55], a[80:83], a[144:147], 0
 s_waitcnt lgkmcnt(2)
 ds_read_b64_tr_b16 a[112:113], v7 offset:0
 ds_read_b64_tr_b16 a[114:115], v7 offset:512
 v_mfma_f32_16x16x32_bf16 v[52:55], a[84:87], a[148:151], v[52:55]
 s_add_u32 m0, s31, 118784
 s_mov_b32 s35, 3145856
 ds_read_b64_tr_b16 a[116:117], v7 offset:4096
 v_mfma_f32_16x16x32_bf16 v[52:55], a[88:91], a[152:155], v[52:55]
 buffer_load_dwordx4 v2, s[40:43], s35 offen lds
 v_mfma_f32_16x16x32_bf16 v[52:55], a[92:95], a[156:159], v[52:55]
 ds_read_b64_tr_b16 a[118:119], v7 offset:4608
 ds_read_b64_tr_b16 a[120:121], v7 offset:8192
 v_mfma_f32_16x16x32_bf16 v[52:55], a[96:99], a[160:163], v[52:55]
 ds_read_b64_tr_b16 a[122:123], v7 offset:8704
 v_accvgpr_read_b32 v229, a73
 v_mfma_f32_16x16x32_bf16 v[52:55], a[100:103], a[164:167], v[52:55]
 s_waitcnt lgkmcnt(4)
 ds_read_b64_tr_b16 a[124:125], v7 offset:12288
 v_accvgpr_read_b32 v230, a74
 v_mfma_f32_16x16x32_bf16 v[52:55], a[104:107], a[168:171], v[52:55]
 s_add_u32 m0, s31, 122880
 ds_read_b64_tr_b16 a[126:127], v7 offset:12800
 ds_read_b64_tr_b16 a[128:129], v7 offset:16384
 v_mfma_f32_16x16x32_bf16 v[60:63], a[80:83], a[200:203], 0
 s_mov_b32 s35, 3408000
 buffer_load_dwordx4 v2, s[40:43], s35 offen lds
 v_mfma_f32_16x16x32_bf16 v[60:63], a[84:87], a[204:207], v[60:63]
 ds_read_b64_tr_b16 a[130:131], v7 offset:16896
 ds_read_b64_tr_b16 a[132:133], v7 offset:20480
 v_mfma_f32_16x16x32_bf16 v[60:63], a[88:91], a[208:211], v[60:63]
 ds_read_b64_tr_b16 a[134:135], v7 offset:20992
 v_accvgpr_read_b32 v231, a75
 v_mfma_f32_16x16x32_bf16 v[60:63], a[92:95], a[212:215], v[60:63]
 ds_read_b64_tr_b16 a[136:137], v7 offset:24576
 v_accvgpr_read_b32 v236, a76
 v_mfma_f32_16x16x32_bf16 v[60:63], a[96:99], a[216:219], v[60:63]
 buffer_store_dwordx4 v[40:43], v1, s[16:19], s37 offen sc1
 ds_read_b64_tr_b16 a[138:139], v7 offset:25088
 v_mfma_f32_16x16x32_bf16 v[60:63], a[100:103], a[220:223], v[60:63]
 s_add_u32 s37, s37, s14
 v_add_u32 v4, 0xffff0000, v4
 v_accvgpr_read_b32 v237, a77
 v_mfma_f32_16x16x32_bf16 v[60:63], a[104:107], a[224:227], v[60:63]
 s_waitcnt vmcnt(28)
 s_barrier
 v_accvgpr_read_b32 v238, a78
 v_mfma_f32_16x16x32_bf16 v[68:71], a[112:115], a[144:147], 0
 s_waitcnt lgkmcnt(2)
 ds_read_b64_tr_b16 a[80:81], v4 offset:0
 ds_read_b64_tr_b16 a[82:83], v4 offset:512
 v_mfma_f32_16x16x32_bf16 v[68:71], a[116:119], a[148:151], v[68:71]
 ds_read_b64_tr_b16 a[84:85], v4 offset:4096
 v_accvgpr_read_b32 v239, a79
 v_mfma_f32_16x16x32_bf16 v[68:71], a[120:123], a[152:155], v[68:71]
 ds_read_b64_tr_b16 a[86:87], v4 offset:4608
 v_cvt_pk_bf16_f32 v228, v228, v229
 v_mfma_f32_16x16x32_bf16 v[68:71], a[124:127], a[156:159], v[68:71]
 ds_read_b64_tr_b16 a[88:89], v4 offset:8192
 v_cvt_pk_bf16_f32 v229, v230, v231
 v_mfma_f32_16x16x32_bf16 v[68:71], a[128:131], a[160:163], v[68:71]
 ds_read_b64_tr_b16 a[90:91], v4 offset:8704
 v_cvt_pk_bf16_f32 v230, v236, v237
 v_mfma_f32_16x16x32_bf16 v[68:71], a[132:135], a[164:167], v[68:71]
 s_waitcnt lgkmcnt(4)
 buffer_store_dwordx4 v[48:51], v1, s[16:19], s37 offen sc1
 v_mfma_f32_16x16x32_bf16 v[68:71], a[136:139], a[168:171], v[68:71]
 s_add_u32 s37, s37, s59
 ds_read_b64_tr_b16 a[92:93], v4 offset:12288
 ds_read_b64_tr_b16 a[94:95], v4 offset:12800
 v_mfma_f32_16x16x32_bf16 v[76:79], a[112:115], a[200:203], 0
 buffer_store_dwordx4 v[56:59], v1, s[16:19], s37 offen sc1
 v_mfma_f32_16x16x32_bf16 v[76:79], a[116:119], a[204:207], v[76:79]
 ds_read_b64_tr_b16 a[96:97], v4 offset:16384
 ds_read_b64_tr_b16 a[98:99], v4 offset:16896
 v_mfma_f32_16x16x32_bf16 v[76:79], a[120:123], a[208:211], v[76:79]
 ds_read_b64_tr_b16 a[100:101], v4 offset:20480
 ds_read_b64_tr_b16 a[102:103], v4 offset:20992
 v_mfma_f32_16x16x32_bf16 v[76:79], a[124:127], a[212:215], v[76:79]
 ds_read_b64_tr_b16 a[104:105], v4 offset:24576
 v_cvt_pk_bf16_f32 v231, v238, v239
 v_mfma_f32_16x16x32_bf16 v[76:79], a[128:131], a[216:219], v[76:79]
 ds_read_b64_tr_b16 a[106:107], v4 offset:25088
 v_cvt_pk_bf16_f32 v144, v144, v145
 v_mfma_f32_16x16x32_bf16 v[76:79], a[132:135], a[220:223], v[76:79]
 v_add_u32 v5, 0xffff0000, v5
 v_cvt_pk_bf16_f32 v145, v146, v147
 v_mfma_f32_16x16x32_bf16 v[76:79], a[136:139], a[224:227], v[76:79]
 v_cvt_pk_bf16_f32 v146, v148, v149
 v_mfma_f32_16x16x32_bf16 v[20:23], a[80:83], a[172:175], v[20:23]
 s_waitcnt lgkmcnt(2)
 s_add_u32 m0, s31, 32768
 s_mov_b32 s35, 256
 ds_read_b64_tr_b16 a[112:113], v5 offset:0
 v_mfma_f32_16x16x32_bf16 v[20:23], a[84:87], a[176:179], v[20:23]
 buffer_load_dwordx4 v2, s[40:43], s35 offen lds
 v_cvt_pk_bf16_f32 v147, v150, v151
 s_waitcnt vmcnt(30)
 v_mfma_f32_16x16x32_bf16 v[20:23], a[88:91], a[180:183], v[20:23]
 ds_read_b64_tr_b16 a[114:115], v5 offset:512
 ds_read_b64_tr_b16 a[116:117], v5 offset:4096
 v_cvt_pk_bf16_f32 v152, v152, v153
 s_waitcnt vmcnt(28)
 v_mfma_f32_16x16x32_bf16 v[20:23], a[92:95], a[184:187], v[20:23]
 ds_read_b64_tr_b16 a[118:119], v5 offset:4608
 ds_read_b64_tr_b16 a[120:121], v5 offset:8192
 v_cvt_pk_bf16_f32 v153, v154, v155
 s_waitcnt vmcnt(26)
 v_mfma_f32_16x16x32_bf16 v[20:23], a[96:99], a[188:191], v[20:23]
 s_add_u32 m0, s31, 36864
 s_add_u32 s37, s37, s14
 ds_read_b64_tr_b16 a[122:123], v5 offset:8704
 s_waitcnt vmcnt(24)
 v_mfma_f32_16x16x32_bf16 v[20:23], a[100:103], a[192:195], v[20:23]
 s_mov_b32 s35, 262400
 buffer_load_dwordx4 v2, s[40:43], s35 offen lds
 s_waitcnt vmcnt(23) lgkmcnt(5)
 v_mfma_f32_16x16x32_bf16 v[20:23], a[104:107], a[196:199], v[20:23]
 ds_read_b64_tr_b16 a[124:125], v5 offset:12288
 ds_read_b64_tr_b16 a[126:127], v5 offset:12800
 v_mfma_f32_16x16x32_bf16 v[28:31], a[80:83], a[228:231], v[28:31]
 buffer_store_dwordx4 v[64:67], v1, s[16:19], s37 offen sc1
 v_mfma_f32_16x16x32_bf16 v[28:31], a[84:87], a[232:235], v[28:31]
 ds_read_b64_tr_b16 a[128:129], v5 offset:16384
 ds_read_b64_tr_b16 a[130:131], v5 offset:16896
 v_mfma_f32_16x16x32_bf16 v[28:31], a[88:91], a[236:239], v[28:31]
 s_add_u32 m0, s31, 40960
 ds_read_b64_tr_b16 a[132:133], v5 offset:20480
 ds_read_b64_tr_b16 a[134:135], v5 offset:20992
 v_mfma_f32_16x16x32_bf16 v[28:31], a[92:95], a[240:243], v[28:31]
 s_mov_b32 s35, 524544
 buffer_load_dwordx4 v2, s[40:43], s35 offen lds
 v_mfma_f32_16x16x32_bf16 v[28:31], a[96:99], a[244:247], v[28:31]
 ds_read_b64_tr_b16 a[136:137], v5 offset:24576
 ds_read_b64_tr_b16 a[138:139], v5 offset:25088
 v_mfma_f32_16x16x32_bf16 v[28:31], a[100:103], a[248:251], v[28:31]
 v_add_u32 v6, 0xffff0000, v6
 v_cvt_pk_bf16_f32 v154, v156, v157
 s_waitcnt vmcnt(24)
 v_mfma_f32_16x16x32_bf16 v[28:31], a[104:107], a[252:255], v[28:31]
 s_waitcnt lgkmcnt(4)
 v_cvt_pk_bf16_f32 v155, v158, v159
 v_cvt_pk_bf16_f32 v160, v160, v161
 v_mfma_f32_16x16x32_bf16 v[36:39], a[112:115], a[172:175], v[36:39]
 s_add_u32 m0, s31, 45056
 ds_read_b64_tr_b16 a[80:81], v6 offset:0
 ds_read_b64_tr_b16 a[82:83], v6 offset:512
 v_mfma_f32_16x16x32_bf16 v[36:39], a[116:119], a[176:179], v[36:39]
 s_mov_b32 s35, 786688
 buffer_load_dwordx4 v2, s[40:43], s35 offen lds
 v_mfma_f32_16x16x32_bf16 v[36:39], a[120:123], a[180:183], v[36:39]
 ds_read_b64_tr_b16 a[84:85], v6 offset:4096
 ds_read_b64_tr_b16 a[86:87], v6 offset:4608
 v_mfma_f32_16x16x32_bf16 v[36:39], a[124:127], a[184:187], v[36:39]
 ds_read_b64_tr_b16 a[88:89], v6 offset:8192
 v_cvt_pk_bf16_f32 v161, v162, v163
 v_mfma_f32_16x16x32_bf16 v[36:39], a[128:131], a[188:191], v[36:39]
 s_waitcnt lgkmcnt(5)
 ds_read_b64_tr_b16 a[90:91], v6 offset:8704
 v_cvt_pk_bf16_f32 v162, v164, v165
 v_mfma_f32_16x16x32_bf16 v[36:39], a[132:135], a[192:195], v[36:39]
 s_add_u32 m0, s31, 49152
 s_mov_b32 s35, 1048832
 ds_read_b64_tr_b16 a[92:93], v6 offset:12288
 v_mfma_f32_16x16x32_bf16 v[36:39], a[136:139], a[196:199], v[36:39]
 s_add_u32 s37, s37, s59
 buffer_load_dwordx4 v2, s[40:43], s35 offen lds
 v_mfma_f32_16x16x32_bf16 v[44:47], a[112:115], a[228:231], v[44:47]
 ds_read_b64_tr_b16 a[94:95], v6 offset:12800
 ds_read_b64_tr_b16 a[96:97], v6 offset:16384
 v_mfma_f32_16x16x32_bf16 v[44:47], a[116:119], a[232:235], v[44:47]
 ds_read_b64_tr_b16 a[98:99], v6 offset:16896
 ds_read_b64_tr_b16 a[100:101], v6 offset:20480
 v_mfma_f32_16x16x32_bf16 v[44:47], a[120:123], a[236:239], v[44:47]
 ds_read_b64_tr_b16 a[102:103], v6 offset:20992
 v_cvt_pk_bf16_f32 v163, v166, v167
 v_cvt_pk_bf16_f32 v168, v168, v169
 v_mfma_f32_16x16x32_bf16 v[44:47], a[124:127], a[240:243], v[44:47]
 s_add_u32 m0, s31, 53248
 s_mov_b32 s35, 1310976
 ds_read_b64_tr_b16 a[104:105], v6 offset:24576
 v_mfma_f32_16x16x32_bf16 v[44:47], a[128:131], a[244:247], v[44:47]
 buffer_load_dwordx4 v2, s[40:43], s35 offen lds
 ds_read_b64_tr_b16 a[106:107], v6 offset:25088
 v_mfma_f32_16x16x32_bf16 v[44:47], a[132:135], a[248:251], v[44:47]
 v_add_u32 v7, 0xffff0000, v7
 v_cvt_pk_bf16_f32 v169, v170, v171
 v_mfma_f32_16x16x32_bf16 v[44:47], a[136:139], a[252:255], v[44:47]
 s_waitcnt lgkmcnt(3)
 v_cvt_pk_bf16_f32 v170, v172, v173
 v_cvt_pk_bf16_f32 v171, v174, v175
 v_mfma_f32_16x16x32_bf16 v[52:55], a[80:83], a[172:175], v[52:55]
 ds_read_b64_tr_b16 a[112:113], v7 offset:0
 ds_read_b64_tr_b16 a[114:115], v7 offset:512
 v_mfma_f32_16x16x32_bf16 v[52:55], a[84:87], a[176:179], v[52:55]
 s_add_u32 m0, s31, 57344
 s_mov_b32 s35, 1573120
 ds_read_b64_tr_b16 a[116:117], v7 offset:4096
 v_mfma_f32_16x16x32_bf16 v[52:55], a[88:91], a[180:183], v[52:55]
 buffer_load_dwordx4 v2, s[40:43], s35 offen lds
 v_mfma_f32_16x16x32_bf16 v[52:55], a[92:95], a[184:187], v[52:55]
 ds_read_b64_tr_b16 a[118:119], v7 offset:4608
 ds_read_b64_tr_b16 a[120:121], v7 offset:8192
 v_mfma_f32_16x16x32_bf16 v[52:55], a[96:99], a[188:191], v[52:55]
 s_waitcnt lgkmcnt(5)
 ds_read_b64_tr_b16 a[122:123], v7 offset:8704
 v_cvt_pk_bf16_f32 v176, v176, v177
 v_mfma_f32_16x16x32_bf16 v[52:55], a[100:103], a[192:195], v[52:55]
 ds_read_b64_tr_b16 a[124:125], v7 offset:12288
 v_cvt_pk_bf16_f32 v177, v178, v179
 v_mfma_f32_16x16x32_bf16 v[52:55], a[104:107], a[196:199], v[52:55]
 buffer_store_dwordx4 v[72:75], v1, s[16:19], s37 offen sc1
 v_mfma_f32_16x16x32_bf16 v[60:63], a[80:83], a[228:231], v[60:63]
 s_mul_i32 s37, s13, 1
 ds_read_b64_tr_b16 a[126:127], v7 offset:12800
 ds_read_b64_tr_b16 a[128:129], v7 offset:16384
 v_mfma_f32_16x16x32_bf16 v[60:63], a[84:87], a[232:235], v[60:63]
 s_add_u32 s37, s37, s58
 ds_read_b64_tr_b16 a[130:131], v7 offset:16896
 ds_read_b64_tr_b16 a[132:133], v7 offset:20480
 v_mfma_f32_16x16x32_bf16 v[60:63], a[88:91], a[236:239], v[60:63]
 ds_read_b64_tr_b16 a[134:135], v7 offset:20992
 v_cvt_pk_bf16_f32 v178, v180, v181
 v_mfma_f32_16x16x32_bf16 v[60:63], a[92:95], a[240:243], v[60:63]
 ds_read_b64_tr_b16 a[136:137], v7 offset:24576
 v_cvt_pk_bf16_f32 v179, v182, v183
 v_mfma_f32_16x16x32_bf16 v[60:63], a[96:99], a[244:247], v[60:63]
 ds_read_b64_tr_b16 a[138:139], v7 offset:25088
 v_cvt_pk_bf16_f32 v184, v184, v185
 v_mfma_f32_16x16x32_bf16 v[60:63], a[100:103], a[248:251], v[60:63]
 v_add_u32 v4, 0xffff0000, v4
 v_cvt_pk_bf16_f32 v185, v186, v187
 v_mfma_f32_16x16x32_bf16 v[60:63], a[104:107], a[252:255], v[60:63]
 s_waitcnt vmcnt(20)
 s_barrier
 v_cvt_pk_bf16_f32 v186, v188, v189
 s_waitcnt lgkmcnt(3)
 v_mfma_f32_16x16x32_bf16 v[68:71], a[112:115], a[172:175], v[68:71]
 buffer_store_dwordx4 v[80:83], v1, s[16:19], s37 offen sc1
 v_mfma_f32_16x16x32_bf16 v[68:71], a[116:119], a[176:179], v[68:71]
 ds_read_b64_tr_b16 a[80:81], v4 offset:0
 ds_read_b64_tr_b16 a[82:83], v4 offset:512
 v_mfma_f32_16x16x32_bf16 v[68:71], a[120:123], a[180:183], v[68:71]
 ds_read_b64_tr_b16 a[84:85], v4 offset:4096
 ds_read_b64_tr_b16 a[86:87], v4 offset:4608
 v_mfma_f32_16x16x32_bf16 v[68:71], a[124:127], a[184:187], v[68:71]
 ds_read_b64_tr_b16 a[88:89], v4 offset:8192
 v_cvt_pk_bf16_f32 v187, v190, v191
 v_mfma_f32_16x16x32_bf16 v[68:71], a[128:131], a[188:191], v[68:71]
 s_waitcnt lgkmcnt(5)
 ds_read_b64_tr_b16 a[90:91], v4 offset:8704
 v_cvt_pk_bf16_f32 v192, v192, v193
 v_mfma_f32_16x16x32_bf16 v[68:71], a[132:135], a[192:195], v[68:71]
 ds_read_b64_tr_b16 a[92:93], v4 offset:12288
 v_cvt_pk_bf16_f32 v193, v194, v195
 v_mfma_f32_16x16x32_bf16 v[68:71], a[136:139], a[196:199], v[68:71]
 ds_read_b64_tr_b16 a[94:95], v4 offset:12800
 ds_read_b64_tr_b16 a[96:97], v4 offset:16384
 v_mfma_f32_16x16x32_bf16 v[76:79], a[112:115], a[228:231], v[76:79]
 ds_read_b64_tr_b16 a[98:99], v4 offset:16896
 v_cvt_pk_bf16_f32 v194, v196, v197
 v_mfma_f32_16x16x32_bf16 v[76:79], a[116:119], a[232:235], v[76:79]
 s_add_u32 s37, s37, s59
 ds_read_b64_tr_b16 a[100:101], v4 offset:20480
 v_cvt_pk_bf16_f32 v195, v198, v199
 v_mfma_f32_16x16x32_bf16 v[76:79], a[120:123], a[236:239], v[76:79]
 ds_read_b64_tr_b16 a[102:103], v4 offset:20992
 v_cvt_pk_bf16_f32 v200, v200, v201
 v_mfma_f32_16x16x32_bf16 v[76:79], a[124:127], a[240:243], v[76:79]
 buffer_store_dwordx4 v[88:91], v1, s[16:19], s37 offen sc1
 v_mfma_f32_16x16x32_bf16 v[76:79], a[128:131], a[244:247], v[76:79]
 ds_read_b64_tr_b16 a[104:105], v4 offset:24576
 ds_read_b64_tr_b16 a[106:107], v4 offset:25088
 v_mfma_f32_16x16x32_bf16 v[76:79], a[132:135], a[248:251], v[76:79]
 v_add_u32 v5, 0xffff0000, v5
 v_cvt_pk_bf16_f32 v201, v202, v203
 v_mfma_f32_16x16x32_bf16 v[76:79], a[136:139], a[252:255], v[76:79]
 s_waitcnt lgkmcnt(3)
 v_cvt_pk_bf16_f32 v202, v204, v205
 v_cvt_pk_bf16_f32 v203, v206, v207
 v_mfma_f32_16x16x32_bf16 v[84:87], a[80:83], a[144:147], 0
 s_add_u32 m0, s31, 131072
 s_mov_b32 s35, 1835264
 ds_read_b64_tr_b16 a[112:113], v5 offset:0
 v_mfma_f32_16x16x32_bf16 v[84:87], a[84:87], a[148:151], v[84:87]
 buffer_load_dwordx4 v2, s[40:43], s35 offen lds
 v_mfma_f32_16x16x32_bf16 v[84:87], a[88:91], a[152:155], v[84:87]
 ds_read_b64_tr_b16 a[114:115], v5 offset:512
 ds_read_b64_tr_b16 a[116:117], v5 offset:4096
 v_mfma_f32_16x16x32_bf16 v[84:87], a[92:95], a[156:159], v[84:87]
 ds_read_b64_tr_b16 a[118:119], v5 offset:4608
 ds_read_b64_tr_b16 a[120:121], v5 offset:8192
 v_mfma_f32_16x16x32_bf16 v[84:87], a[96:99], a[160:163], v[84:87]
 s_waitcnt lgkmcnt(5)
 s_add_u32 m0, s31, 135168
 s_mov_b32 s35, 2097408
 ds_read_b64_tr_b16 a[122:123], v5 offset:8704
 v_mfma_f32_16x16x32_bf16 v[84:87], a[100:103], a[164:167], v[84:87]
 buffer_load_dwordx4 v2, s[40:43], s35 offen lds
 v_mfma_f32_16x16x32_bf16 v[84:87], a[104:107], a[168:171], v[84:87]
 ds_read_b64_tr_b16 a[124:125], v5 offset:12288
 ds_read_b64_tr_b16 a[126:127], v5 offset:12800
 v_mfma_f32_16x16x32_bf16 v[92:95], a[80:83], a[200:203], 0
 ds_read_b64_tr_b16 a[128:129], v5 offset:16384
 ds_read_b64_tr_b16 a[130:131], v5 offset:16896
 v_mfma_f32_16x16x32_bf16 v[92:95], a[84:87], a[204:207], v[92:95]
 s_add_u32 m0, s31, 139264
 ds_read_b64_tr_b16 a[132:133], v5 offset:20480
 v_cvt_pk_bf16_f32 v20, v20, v21
 v_mfma_f32_16x16x32_bf16 v[92:95], a[88:91], a[208:211], v[92:95]
 s_mov_b32 s35, 2359552
 buffer_load_dwordx4 v2, s[40:43], s35 offen lds
 v_mfma_f32_16x16x32_bf16 v[92:95], a[92:95], a[212:215], v[92:95]
 s_add_u32 s37, s37, s14
 ds_read_b64_tr_b16 a[134:135], v5 offset:20992
 ds_read_b64_tr_b16 a[136:137], v5 offset:24576
 v_mfma_f32_16x16x32_bf16 v[92:95], a[96:99], a[216:219], v[92:95]
 ds_read_b64_tr_b16 a[138:139], v5 offset:25088
 v_cvt_pk_bf16_f32 v21, v22, v23
 v_mfma_f32_16x16x32_bf16 v[92:95], a[100:103], a[220:223], v[92:95]
 s_add_u32 m0, s31, 143360
 v_add_u32 v6, 0xffff0000, v6
 v_cvt_pk_bf16_f32 v22, v36, v37
 v_mfma_f32_16x16x32_bf16 v[92:95], a[104:107], a[224:227], v[92:95]
 s_waitcnt lgkmcnt(3)
 s_mov_b32 s35, 2621696
 buffer_load_dwordx4 v2, s[40:43], s35 offen lds
 v_mfma_f32_16x16x32_bf16 v[100:103], a[112:115], a[144:147], 0
 ds_read_b64_tr_b16 a[80:81], v6 offset:0
 ds_read_b64_tr_b16 a[82:83], v6 offset:512
 v_mfma_f32_16x16x32_bf16 v[100:103], a[116:119], a[148:151], v[100:103]
 ds_read_b64_tr_b16 a[84:85], v6 offset:4096
 v_cvt_pk_bf16_f32 v23, v38, v39
 v_mfma_f32_16x16x32_bf16 v[100:103], a[120:123], a[152:155], v[100:103]
 ds_read_b64_tr_b16 a[86:87], v6 offset:4608
 v_accvgpr_write_b32 a0, v20
 v_mfma_f32_16x16x32_bf16 v[100:103], a[124:127], a[156:159], v[100:103]
 s_add_u32 m0, s31, 147456
 s_mov_b32 s35, 2883840
 ds_read_b64_tr_b16 a[88:89], v6 offset:8192
 v_mfma_f32_16x16x32_bf16 v[100:103], a[128:131], a[160:163], v[100:103]
 s_waitcnt lgkmcnt(5)
 buffer_load_dwordx4 v2, s[40:43], s35 offen lds
 v_mfma_f32_16x16x32_bf16 v[100:103], a[132:135], a[164:167], v[100:103]
 ds_read_b64_tr_b16 a[90:91], v6 offset:8704
 ds_read_b64_tr_b16 a[92:93], v6 offset:12288
 v_mfma_f32_16x16x32_bf16 v[100:103], a[136:139], a[168:171], v[100:103]
 ds_read_b64_tr_b16 a[94:95], v6 offset:12800
 ds_read_b64_tr_b16 a[96:97], v6 offset:16384
 v_mfma_f32_16x16x32_bf16 v[108:111], a[112:115], a[200:203], 0
 s_add_u32 m0, s31, 151552
 s_mov_b32 s35, 3145984
 ds_read_b64_tr_b16 a[98:99], v6 offset:16896
 v_mfma_f32_16x16x32_bf16 v[108:111], a[116:119], a[204:207], v[108:111]
 buffer_load_dwordx4 v2, s[40:43], s35 offen lds
 v_mfma_f32_16x16x32_bf16 v[108:111], a[120:123], a[208:211], v[108:111]
 ds_read_b64_tr_b16 a[100:101], v6 offset:20480
 ds_read_b64_tr_b16 a[102:103], v6 offset:20992
 v_mfma_f32_16x16x32_bf16 v[108:111], a[124:127], a[212:215], v[108:111]
 ds_read_b64_tr_b16 a[104:105], v6 offset:24576
 v_accvgpr_write_b32 a1, v21
 v_mfma_f32_16x16x32_bf16 v[108:111], a[128:131], a[216:219], v[108:111]
 s_add_u32 m0, s31, 155648
 ds_read_b64_tr_b16 a[106:107], v6 offset:25088
 v_accvgpr_write_b32 a2, v22
 v_mfma_f32_16x16x32_bf16 v[108:111], a[132:135], a[220:223], v[108:111]
 s_mov_b32 s35, 3408128
 v_add_u32 v7, 0xffff0000, v7
 v_accvgpr_write_b32 a3, v23
 v_mfma_f32_16x16x32_bf16 v[108:111], a[136:139], a[224:227], v[108:111]
 s_waitcnt lgkmcnt(4)
 buffer_load_dwordx4 v2, s[40:43], s35 offen lds
 v_mfma_f32_16x16x32_bf16 v[116:119], a[80:83], a[144:147], 0
 ds_read_b64_tr_b16 a[112:113], v7 offset:0
 ds_read_b64_tr_b16 a[114:115], v7 offset:512
 v_mfma_f32_16x16x32_bf16 v[116:119], a[84:87], a[148:151], v[116:119]
 ds_read_b64_tr_b16 a[116:117], v7 offset:4096
 v_cvt_pk_bf16_f32 v28, v28, v29
 v_mfma_f32_16x16x32_bf16 v[116:119], a[88:91], a[152:155], v[116:119]
 ds_read_b64_tr_b16 a[118:119], v7 offset:4608
 v_mfma_f32_16x16x32_bf16 v[116:119], a[92:95], a[156:159], v[116:119]
 buffer_store_dwordx4 v[96:99], v1, s[16:19], s37 offen sc1
 v_mfma_f32_16x16x32_bf16 v[116:119], a[96:99], a[160:163], v[116:119]
 s_waitcnt lgkmcnt(4)
 s_add_u32 s37, s37, s59
 ds_read_b64_tr_b16 a[120:121], v7 offset:8192
 ds_read_b64_tr_b16 a[122:123], v7 offset:8704
 v_mfma_f32_16x16x32_bf16 v[116:119], a[100:103], a[164:167], v[116:119]
 ds_read_b64_tr_b16 a[124:125], v7 offset:12288
 v_cvt_pk_bf16_f32 v29, v30, v31
 v_mfma_f32_16x16x32_bf16 v[116:119], a[104:107], a[168:171], v[116:119]
 ds_read_b64_tr_b16 a[126:127], v7 offset:12800
 ds_read_b64_tr_b16 a[128:129], v7 offset:16384
 v_mfma_f32_16x16x32_bf16 v[124:127], a[80:83], a[200:203], 0
 ds_read_b64_tr_b16 a[130:131], v7 offset:16896
 v_mfma_f32_16x16x32_bf16 v[124:127], a[84:87], a[204:207], v[124:127]
 ds_read_b64_tr_b16 a[132:133], v7 offset:20480
 v_cvt_pk_bf16_f32 v30, v44, v45
 v_mfma_f32_16x16x32_bf16 v[124:127], a[88:91], a[208:211], v[124:127]
 ds_read_b64_tr_b16 a[134:135], v7 offset:20992
 v_mfma_f32_16x16x32_bf16 v[124:127], a[92:95], a[212:215], v[124:127]
 ds_read_b64_tr_b16 a[136:137], v7 offset:24576
 v_mfma_f32_16x16x32_bf16 v[124:127], a[96:99], a[216:219], v[124:127]
 buffer_store_dwordx4 v[104:107], v1, s[16:19], s37 offen sc1
 ds_read_b64_tr_b16 a[138:139], v7 offset:25088
 v_mfma_f32_16x16x32_bf16 v[124:127], a[100:103], a[220:223], v[124:127]
 s_add_u32 s37, s37, s14
 v_add_u32 v4, 0x18000, v4
 v_cvt_pk_bf16_f32 v31, v46, v47
 v_mfma_f32_16x16x32_bf16 v[124:127], a[104:107], a[224:227], v[124:127]
 s_waitcnt vmcnt(23)
 s_barrier
 s_waitcnt lgkmcnt(3)
 v_mfma_f32_16x16x32_bf16 v[132:135], a[112:115], a[144:147], 0
 ds_read_b64_tr_b16 a[80:81], v4 offset:0
 ds_read_b64_tr_b16 a[82:83], v4 offset:512
 v_mfma_f32_16x16x32_bf16 v[132:135], a[116:119], a[148:151], v[132:135]
 ds_read_b64_tr_b16 a[84:85], v4 offset:4096
 v_accvgpr_write_b32 a32, v28
 v_mfma_f32_16x16x32_bf16 v[132:135], a[120:123], a[152:155], v[132:135]
 ds_read_b64_tr_b16 a[86:87], v4 offset:4608
 v_mfma_f32_16x16x32_bf16 v[132:135], a[124:127], a[156:159], v[132:135]
 ds_read_b64_tr_b16 a[88:89], v4 offset:8192
 v_mfma_f32_16x16x32_bf16 v[132:135], a[128:131], a[160:163], v[132:135]
 s_waitcnt lgkmcnt(5)
 ds_read_b64_tr_b16 a[90:91], v4 offset:8704
 v_accvgpr_write_b32 a33, v29
 v_mfma_f32_16x16x32_bf16 v[132:135], a[132:135], a[164:167], v[132:135]
 buffer_store_dwordx4 v[112:115], v1, s[16:19], s37 offen sc1
 v_mfma_f32_16x16x32_bf16 v[132:135], a[136:139], a[168:171], v[132:135]
 ds_read_b64_tr_b16 a[92:93], v4 offset:12288
 ds_read_b64_tr_b16 a[94:95], v4 offset:12800
 v_mfma_f32_16x16x32_bf16 v[140:143], a[112:115], a[200:203], 0
 ds_read_b64_tr_b16 a[96:97], v4 offset:16384
 ds_read_b64_tr_b16 a[98:99], v4 offset:16896
 v_mfma_f32_16x16x32_bf16 v[140:143], a[116:119], a[204:207], v[140:143]
 ds_read_b64_tr_b16 a[100:101], v4 offset:20480
 v_accvgpr_write_b32 a34, v30
 v_mfma_f32_16x16x32_bf16 v[140:143], a[120:123], a[208:211], v[140:143]
 ds_read_b64_tr_b16 a[102:103], v4 offset:20992
 v_mfma_f32_16x16x32_bf16 v[140:143], a[124:127], a[212:215], v[140:143]
 ds_read_b64_tr_b16 a[104:105], v4 offset:24576
 v_mfma_f32_16x16x32_bf16 v[140:143], a[128:131], a[216:219], v[140:143]
 s_add_u32 s37, s37, s59
 ds_read_b64_tr_b16 a[106:107], v4 offset:25088
 v_accvgpr_write_b32 a35, v31
 v_mfma_f32_16x16x32_bf16 v[140:143], a[132:135], a[220:223], v[140:143]
 v_add_u32 v5, 0x18000, v5
 v_mfma_f32_16x16x32_bf16 v[140:143], a[136:139], a[224:227], v[140:143]
 s_waitcnt lgkmcnt(3)
 buffer_store_dwordx4 v[120:123], v1, s[16:19], s37 offen sc1
 v_mfma_f32_16x16x32_bf16 v[84:87], a[80:83], a[172:175], v[84:87]
 s_add_u32 m0, s31, 65536
 s_mov_b32 s35, 384
 ds_read_b64_tr_b16 a[112:113], v5 offset:0
 v_mfma_f32_16x16x32_bf16 v[84:87], a[84:87], a[176:179], v[84:87]
 buffer_load_dwordx4 v2, s[40:43], s35 offen lds
 v_mfma_f32_16x16x32_bf16 v[84:87], a[88:91], a[180:183], v[84:87]
 ds_read_b64_tr_b16 a[114:115], v5 offset:512
 ds_read_b64_tr_b16 a[116:117], v5 offset:4096
 v_mfma_f32_16x16x32_bf16 v[84:87], a[92:95], a[184:187], v[84:87]
 ds_read_b64_tr_b16 a[118:119], v5 offset:4608
 ds_read_b64_tr_b16 a[120:121], v5 offset:8192
 v_mfma_f32_16x16x32_bf16 v[84:87], a[96:99], a[188:191], v[84:87]
 s_waitcnt lgkmcnt(5)
 s_add_u32 m0, s31, 69632
 s_mov_b32 s35, 262528
 ds_read_b64_tr_b16 a[122:123], v5 offset:8704
 v_mfma_f32_16x16x32_bf16 v[84:87], a[100:103], a[192:195], v[84:87]
 buffer_load_dwordx4 v2, s[40:43], s35 offen lds
 v_mfma_f32_16x16x32_bf16 v[84:87], a[104:107], a[196:199], v[84:87]
 ds_read_b64_tr_b16 a[124:125], v5 offset:12288
 ds_read_b64_tr_b16 a[126:127], v5 offset:12800
 v_mfma_f32_16x16x32_bf16 v[92:95], a[80:83], a[228:231], v[92:95]
 ds_read_b64_tr_b16 a[128:129], v5 offset:16384
 ds_read_b64_tr_b16 a[130:131], v5 offset:16896
 v_mfma_f32_16x16x32_bf16 v[92:95], a[84:87], a[232:235], v[92:95]
 s_add_u32 m0, s31, 73728
 ds_read_b64_tr_b16 a[132:133], v5 offset:20480
 v_cvt_pk_bf16_f32 v52, v52, v53
 v_mfma_f32_16x16x32_bf16 v[92:95], a[88:91], a[236:239], v[92:95]
 s_mov_b32 s35, 524672
 buffer_load_dwordx4 v2, s[40:43], s35 offen lds
 v_mfma_f32_16x16x32_bf16 v[92:95], a[92:95], a[240:243], v[92:95]
 ds_read_b64_tr_b16 a[134:135], v5 offset:20992
 ds_read_b64_tr_b16 a[136:137], v5 offset:24576
 v_mfma_f32_16x16x32_bf16 v[92:95], a[96:99], a[244:247], v[92:95]
 ds_read_b64_tr_b16 a[138:139], v5 offset:25088
 v_cvt_pk_bf16_f32 v53, v54, v55
 v_mfma_f32_16x16x32_bf16 v[92:95], a[100:103], a[248:251], v[92:95]
 s_add_u32 m0, s31, 77824
 v_add_u32 v6, 0x18000, v6
 v_cvt_pk_bf16_f32 v54, v68, v69
 v_mfma_f32_16x16x32_bf16 v[92:95], a[104:107], a[252:255], v[92:95]
 s_waitcnt lgkmcnt(3)
 s_mov_b32 s35, 786816
 buffer_load_dwordx4 v2, s[40:43], s35 offen lds
 v_mfma_f32_16x16x32_bf16 v[100:103], a[112:115], a[172:175], v[100:103]
 s_add_u32 s37, s37, s14
 ds_read_b64_tr_b16 a[80:81], v6 offset:0
 ds_read_b64_tr_b16 a[82:83], v6 offset:512
 v_mfma_f32_16x16x32_bf16 v[100:103], a[116:119], a[176:179], v[100:103]
 ds_read_b64_tr_b16 a[84:85], v6 offset:4096
 v_cvt_pk_bf16_f32 v55, v70, v71
 v_mfma_f32_16x16x32_bf16 v[100:103], a[120:123], a[180:183], v[100:103]
 ds_read_b64_tr_b16 a[86:87], v6 offset:4608
 v_accvgpr_write_b32 a4, v52
 v_mfma_f32_16x16x32_bf16 v[100:103], a[124:127], a[184:187], v[100:103]
 s_add_u32 m0, s31, 81920
 s_mov_b32 s35, 1048960
 ds_read_b64_tr_b16 a[88:89], v6 offset:8192
 v_mfma_f32_16x16x32_bf16 v[100:103], a[128:131], a[188:191], v[100:103]
 s_waitcnt lgkmcnt(5)
 buffer_load_dwordx4 v2, s[40:43], s35 offen lds
 v_mfma_f32_16x16x32_bf16 v[100:103], a[132:135], a[192:195], v[100:103]
 ds_read_b64_tr_b16 a[90:91], v6 offset:8704
 ds_read_b64_tr_b16 a[92:93], v6 offset:12288
 v_mfma_f32_16x16x32_bf16 v[100:103], a[136:139], a[196:199], v[100:103]
 ds_read_b64_tr_b16 a[94:95], v6 offset:12800
 ds_read_b64_tr_b16 a[96:97], v6 offset:16384
 v_mfma_f32_16x16x32_bf16 v[108:111], a[112:115], a[228:231], v[108:111]
 s_add_u32 m0, s31, 86016
 s_mov_b32 s35, 1311104
 ds_read_b64_tr_b16 a[98:99], v6 offset:16896
 v_mfma_f32_16x16x32_bf16 v[108:111], a[116:119], a[232:235], v[108:111]
 buffer_load_dwordx4 v2, s[40:43], s35 offen lds
 v_mfma_f32_16x16x32_bf16 v[108:111], a[120:123], a[236:239], v[108:111]
 ds_read_b64_tr_b16 a[100:101], v6 offset:20480
 ds_read_b64_tr_b16 a[102:103], v6 offset:20992
 v_mfma_f32_16x16x32_bf16 v[108:111], a[124:127], a[240:243], v[108:111]
 ds_read_b64_tr_b16 a[104:105], v6 offset:24576
 v_accvgpr_write_b32 a5, v53
 v_mfma_f32_16x16x32_bf16 v[108:111], a[128:131], a[244:247], v[108:111]
 s_add_u32 m0, s31, 90112
 ds_read_b64_tr_b16 a[106:107], v6 offset:25088
 v_accvgpr_write_b32 a6, v54
 v_mfma_f32_16x16x32_bf16 v[108:111], a[132:135], a[248:251], v[108:111]
 s_mov_b32 s35, 1573248
 v_add_u32 v7, 0x18000, v7
 v_accvgpr_write_b32 a7, v55
 v_mfma_f32_16x16x32_bf16 v[108:111], a[136:139], a[252:255], v[108:111]
 s_waitcnt lgkmcnt(4)
 buffer_load_dwordx4 v2, s[40:43], s35 offen lds
 v_mfma_f32_16x16x32_bf16 v[116:119], a[80:83], a[172:175], v[116:119]
 ds_read_b64_tr_b16 a[112:113], v7 offset:0
 ds_read_b64_tr_b16 a[114:115], v7 offset:512
 v_mfma_f32_16x16x32_bf16 v[116:119], a[84:87], a[176:179], v[116:119]
 ds_read_b64_tr_b16 a[116:117], v7 offset:4096
 v_cvt_pk_bf16_f32 v60, v60, v61
 v_mfma_f32_16x16x32_bf16 v[116:119], a[88:91], a[180:183], v[116:119]
 ds_read_b64_tr_b16 a[118:119], v7 offset:4608
 v_cvt_pk_bf16_f32 v61, v62, v63
 v_mfma_f32_16x16x32_bf16 v[116:119], a[92:95], a[184:187], v[116:119]
 buffer_store_dwordx4 v[128:131], v1, s[16:19], s37 offen sc1
 v_mfma_f32_16x16x32_bf16 v[116:119], a[96:99], a[188:191], v[116:119]
 s_waitcnt lgkmcnt(4)
 s_add_u32 s37, s37, s59
 ds_read_b64_tr_b16 a[120:121], v7 offset:8192
 ds_read_b64_tr_b16 a[122:123], v7 offset:8704
 v_mfma_f32_16x16x32_bf16 v[116:119], a[100:103], a[192:195], v[116:119]
 ds_read_b64_tr_b16 a[124:125], v7 offset:12288
 v_cvt_pk_bf16_f32 v62, v76, v77
 v_mfma_f32_16x16x32_bf16 v[116:119], a[104:107], a[196:199], v[116:119]
 ds_read_b64_tr_b16 a[126:127], v7 offset:12800
 ds_read_b64_tr_b16 a[128:129], v7 offset:16384
 v_mfma_f32_16x16x32_bf16 v[124:127], a[80:83], a[228:231], v[124:127]
 ds_read_b64_tr_b16 a[130:131], v7 offset:16896
 v_mfma_f32_16x16x32_bf16 v[124:127], a[84:87], a[232:235], v[124:127]
 ds_read_b64_tr_b16 a[132:133], v7 offset:20480
 v_mfma_f32_16x16x32_bf16 v[124:127], a[88:91], a[236:239], v[124:127]
 ds_read_b64_tr_b16 a[134:135], v7 offset:20992
 v_cvt_pk_bf16_f32 v63, v78, v79
 v_mfma_f32_16x16x32_bf16 v[124:127], a[92:95], a[240:243], v[124:127]
 ds_read_b64_tr_b16 a[136:137], v7 offset:24576
 v_mfma_f32_16x16x32_bf16 v[124:127], a[96:99], a[244:247], v[124:127]
 buffer_store_dwordx4 v[136:139], v1, s[16:19], s37 offen sc1
 ds_read_b64_tr_b16 a[138:139], v7 offset:25088
 v_mfma_f32_16x16x32_bf16 v[124:127], a[100:103], a[248:251], v[124:127]
 v_add_u32 v4, 0xffff0000, v4
 v_accvgpr_write_b32 a36, v60
 v_mfma_f32_16x16x32_bf16 v[124:127], a[104:107], a[252:255], v[124:127]
 s_waitcnt vmcnt(23)
 s_barrier
 s_waitcnt lgkmcnt(3)
 v_mfma_f32_16x16x32_bf16 v[132:135], a[112:115], a[172:175], v[132:135]
 ds_read_b64_tr_b16 a[80:81], v4 offset:0
 ds_read_b64_tr_b16 a[82:83], v4 offset:512
 v_mfma_f32_16x16x32_bf16 v[132:135], a[116:119], a[176:179], v[132:135]
 ds_read_b64_tr_b16 a[84:85], v4 offset:4096
 v_accvgpr_write_b32 a37, v61
 v_mfma_f32_16x16x32_bf16 v[132:135], a[120:123], a[180:183], v[132:135]
 ds_read_b64_tr_b16 a[86:87], v4 offset:4608
 v_mfma_f32_16x16x32_bf16 v[132:135], a[124:127], a[184:187], v[132:135]
 ds_read_b64_tr_b16 a[88:89], v4 offset:8192
 v_mfma_f32_16x16x32_bf16 v[132:135], a[128:131], a[188:191], v[132:135]
 s_waitcnt lgkmcnt(5)
 ds_read_b64_tr_b16 a[90:91], v4 offset:8704
 v_mfma_f32_16x16x32_bf16 v[132:135], a[132:135], a[192:195], v[132:135]
 ds_read_b64_tr_b16 a[92:93], v4 offset:12288
 v_accvgpr_write_b32 a38, v62
 v_mfma_f32_16x16x32_bf16 v[132:135], a[136:139], a[196:199], v[132:135]
 ds_read_b64_tr_b16 a[94:95], v4 offset:12800
 ds_read_b64_tr_b16 a[96:97], v4 offset:16384
 v_mfma_f32_16x16x32_bf16 v[140:143], a[112:115], a[228:231], v[140:143]
 ds_read_b64_tr_b16 a[98:99], v4 offset:16896
 v_mfma_f32_16x16x32_bf16 v[140:143], a[116:119], a[232:235], v[140:143]
 ds_read_b64_tr_b16 a[100:101], v4 offset:20480
 v_accvgpr_write_b32 a39, v63
 v_mfma_f32_16x16x32_bf16 v[140:143], a[120:123], a[236:239], v[140:143]
 ds_read_b64_tr_b16 a[102:103], v4 offset:20992
 v_mfma_f32_16x16x32_bf16 v[140:143], a[124:127], a[240:243], v[140:143]
 ds_read_b64_tr_b16 a[104:105], v4 offset:24576
 v_mfma_f32_16x16x32_bf16 v[140:143], a[128:131], a[244:247], v[140:143]
 ds_read_b64_tr_b16 a[106:107], v4 offset:25088
 v_mfma_f32_16x16x32_bf16 v[140:143], a[132:135], a[248:251], v[140:143]
 v_add_u32 v5, 0xffff0000, v5
 v_mfma_f32_16x16x32_bf16 v[140:143], a[136:139], a[252:255], v[140:143]
 s_waitcnt lgkmcnt(3)
 v_mfma_f32_16x16x32_bf16 v[20:23], a[80:83], a[144:147], 0
 s_add_u32 m0, s31, 0
 s_mov_b32 s35, 1835392
 ds_read_b64_tr_b16 a[112:113], v5 offset:0
 v_mfma_f32_16x16x32_bf16 v[20:23], a[84:87], a[148:151], v[20:23]
 buffer_load_dwordx4 v2, s[40:43], s35 offen lds
 v_mfma_f32_16x16x32_bf16 v[20:23], a[88:91], a[152:155], v[20:23]
 ds_read_b64_tr_b16 a[114:115], v5 offset:512
 ds_read_b64_tr_b16 a[116:117], v5 offset:4096
 v_mfma_f32_16x16x32_bf16 v[20:23], a[92:95], a[156:159], v[20:23]
 ds_read_b64_tr_b16 a[118:119], v5 offset:4608
 ds_read_b64_tr_b16 a[120:121], v5 offset:8192
 v_mfma_f32_16x16x32_bf16 v[20:23], a[96:99], a[160:163], v[20:23]
 s_waitcnt lgkmcnt(5)
 s_add_u32 m0, s31, 4096
 s_mov_b32 s35, 2097536
 ds_read_b64_tr_b16 a[122:123], v5 offset:8704
 v_mfma_f32_16x16x32_bf16 v[20:23], a[100:103], a[164:167], v[20:23]
 buffer_load_dwordx4 v2, s[40:43], s35 offen lds
 v_mfma_f32_16x16x32_bf16 v[20:23], a[104:107], a[168:171], v[20:23]
 ds_read_b64_tr_b16 a[124:125], v5 offset:12288
 ds_read_b64_tr_b16 a[126:127], v5 offset:12800
 v_mfma_f32_16x16x32_bf16 v[28:31], a[80:83], a[200:203], 0
 ds_read_b64_tr_b16 a[128:129], v5 offset:16384
 ds_read_b64_tr_b16 a[130:131], v5 offset:16896
 v_mfma_f32_16x16x32_bf16 v[28:31], a[84:87], a[204:207], v[28:31]
 s_add_u32 m0, s31, 8192
 ds_read_b64_tr_b16 a[132:133], v5 offset:20480
 v_cvt_pk_bf16_f32 v84, v84, v85
 v_mfma_f32_16x16x32_bf16 v[28:31], a[88:91], a[208:211], v[28:31]
 s_mov_b32 s35, 2359680
 buffer_load_dwordx4 v2, s[40:43], s35 offen lds
 v_mfma_f32_16x16x32_bf16 v[28:31], a[92:95], a[212:215], v[28:31]
 ds_read_b64_tr_b16 a[134:135], v5 offset:20992
 ds_read_b64_tr_b16 a[136:137], v5 offset:24576
 v_mfma_f32_16x16x32_bf16 v[28:31], a[96:99], a[216:219], v[28:31]
 ds_read_b64_tr_b16 a[138:139], v5 offset:25088
 v_cvt_pk_bf16_f32 v85, v86, v87
 v_mfma_f32_16x16x32_bf16 v[28:31], a[100:103], a[220:223], v[28:31]
 s_add_u32 m0, s31, 12288
 v_add_u32 v6, 0xffff0000, v6
 v_cvt_pk_bf16_f32 v86, v100, v101
 v_mfma_f32_16x16x32_bf16 v[28:31], a[104:107], a[224:227], v[28:31]
 s_waitcnt lgkmcnt(3)
 s_mov_b32 s35, 2621824
 buffer_load_dwordx4 v2, s[40:43], s35 offen lds
 v_mfma_f32_16x16x32_bf16 v[36:39], a[112:115], a[144:147], 0
 ds_read_b64_tr_b16 a[80:81], v6 offset:0
 ds_read_b64_tr_b16 a[82:83], v6 offset:512
 v_mfma_f32_16x16x32_bf16 v[36:39], a[116:119], a[148:151], v[36:39]
 ds_read_b64_tr_b16 a[84:85], v6 offset:4096
 v_cvt_pk_bf16_f32 v87, v102, v103
 v_mfma_f32_16x16x32_bf16 v[36:39], a[120:123], a[152:155], v[36:39]
 ds_read_b64_tr_b16 a[86:87], v6 offset:4608
 v_accvgpr_write_b32 a8, v84
 v_mfma_f32_16x16x32_bf16 v[36:39], a[124:127], a[156:159], v[36:39]
 s_add_u32 m0, s31, 16384
 s_mov_b32 s35, 2883968
 ds_read_b64_tr_b16 a[88:89], v6 offset:8192
 v_mfma_f32_16x16x32_bf16 v[36:39], a[128:131], a[160:163], v[36:39]
 s_waitcnt lgkmcnt(5)
 buffer_load_dwordx4 v2, s[40:43], s35 offen lds
 v_mfma_f32_16x16x32_bf16 v[36:39], a[132:135], a[164:167], v[36:39]
 ds_read_b64_tr_b16 a[90:91], v6 offset:8704
 ds_read_b64_tr_b16 a[92:93], v6 offset:12288
 v_mfma_f32_16x16x32_bf16 v[36:39], a[136:139], a[168:171], v[36:39]
 ds_read_b64_tr_b16 a[94:95], v6 offset:12800
 ds_read_b64_tr_b16 a[96:97], v6 offset:16384
 v_mfma_f32_16x16x32_bf16 v[44:47], a[112:115], a[200:203], 0
 s_add_u32 m0, s31, 20480
 s_mov_b32 s35, 3146112
 ds_read_b64_tr_b16 a[98:99], v6 offset:16896
 v_mfma_f32_16x16x32_bf16 v[44:47], a[116:119], a[204:207], v[44:47]
 buffer_load_dwordx4 v2, s[40:43], s35 offen lds
 v_mfma_f32_16x16x32_bf16 v[44:47], a[120:123], a[208:211], v[44:47]
 ds_read_b64_tr_b16 a[100:101], v6 offset:20480
 ds_read_b64_tr_b16 a[102:103], v6 offset:20992
 v_mfma_f32_16x16x32_bf16 v[44:47], a[124:127], a[212:215], v[44:47]
 ds_read_b64_tr_b16 a[104:105], v6 offset:24576
 v_accvgpr_write_b32 a9, v85
 v_mfma_f32_16x16x32_bf16 v[44:47], a[128:131], a[216:219], v[44:47]
 s_add_u32 m0, s31, 24576
 ds_read_b64_tr_b16 a[106:107], v6 offset:25088
 v_accvgpr_write_b32 a10, v86
 v_mfma_f32_16x16x32_bf16 v[44:47], a[132:135], a[220:223], v[44:47]
 s_mov_b32 s35, 3408256
 v_add_u32 v7, 0xffff0000, v7
 v_accvgpr_write_b32 a11, v87
 v_mfma_f32_16x16x32_bf16 v[44:47], a[136:139], a[224:227], v[44:47]
 s_waitcnt lgkmcnt(4)
 buffer_load_dwordx4 v2, s[40:43], s35 offen lds
 v_mfma_f32_16x16x32_bf16 v[52:55], a[80:83], a[144:147], 0
 ds_read_b64_tr_b16 a[112:113], v7 offset:0
 ds_read_b64_tr_b16 a[114:115], v7 offset:512
 v_mfma_f32_16x16x32_bf16 v[52:55], a[84:87], a[148:151], v[52:55]
 ds_read_b64_tr_b16 a[116:117], v7 offset:4096
 v_cvt_pk_bf16_f32 v92, v92, v93
 v_mfma_f32_16x16x32_bf16 v[52:55], a[88:91], a[152:155], v[52:55]
 ds_read_b64_tr_b16 a[118:119], v7 offset:4608
 v_mfma_f32_16x16x32_bf16 v[52:55], a[92:95], a[156:159], v[52:55]
 ds_read_b64_tr_b16 a[120:121], v7 offset:8192
 v_mfma_f32_16x16x32_bf16 v[52:55], a[96:99], a[160:163], v[52:55]
 s_waitcnt lgkmcnt(5)
 ds_read_b64_tr_b16 a[122:123], v7 offset:8704
 v_mfma_f32_16x16x32_bf16 v[52:55], a[100:103], a[164:167], v[52:55]
 ds_read_b64_tr_b16 a[124:125], v7 offset:12288
 v_cvt_pk_bf16_f32 v93, v94, v95
 v_mfma_f32_16x16x32_bf16 v[52:55], a[104:107], a[168:171], v[52:55]
 ds_read_b64_tr_b16 a[126:127], v7 offset:12800
 ds_read_b64_tr_b16 a[128:129], v7 offset:16384
 v_mfma_f32_16x16x32_bf16 v[60:63], a[80:83], a[200:203], 0
 ds_read_b64_tr_b16 a[130:131], v7 offset:16896
 v_mfma_f32_16x16x32_bf16 v[60:63], a[84:87], a[204:207], v[60:63]
 ds_read_b64_tr_b16 a[132:133], v7 offset:20480
 v_cvt_pk_bf16_f32 v94, v108, v109
 v_mfma_f32_16x16x32_bf16 v[60:63], a[88:91], a[208:211], v[60:63]
 ds_read_b64_tr_b16 a[134:135], v7 offset:20992
 v_mfma_f32_16x16x32_bf16 v[60:63], a[92:95], a[212:215], v[60:63]
 ds_read_b64_tr_b16 a[136:137], v7 offset:24576
 v_mfma_f32_16x16x32_bf16 v[60:63], a[96:99], a[216:219], v[60:63]
 s_cmp_eq_u32 s26, 0
 s_cselect_b32 s41, s49, 1879048192
 ds_read_b64_tr_b16 a[138:139], v7 offset:25088
 v_mfma_f32_16x16x32_bf16 v[60:63], a[100:103], a[220:223], v[60:63]
 v_add_u32 v4, 0x18000, v4
 v_cvt_pk_bf16_f32 v95, v110, v111
 v_mfma_f32_16x16x32_bf16 v[60:63], a[104:107], a[224:227], v[60:63]
 s_waitcnt vmcnt(7)
 s_barrier
 s_waitcnt lgkmcnt(3)
 v_mfma_f32_16x16x32_bf16 v[68:71], a[112:115], a[144:147], 0
 buffer_atomic_add v9, v3, s[16:19], s15 offen sc1
 v_mfma_f32_16x16x32_bf16 v[68:71], a[116:119], a[148:151], v[68:71]
 s_lshl_b32 s32, s3, 13
 ds_read_b64_tr_b16 a[80:81], v4 offset:0
 ds_read_b64_tr_b16 a[82:83], v4 offset:512
 v_mfma_f32_16x16x32_bf16 v[68:71], a[120:123], a[152:155], v[68:71]
 ds_read_b64_tr_b16 a[84:85], v4 offset:4096
 ds_read_b64_tr_b16 a[86:87], v4 offset:4608
 v_mfma_f32_16x16x32_bf16 v[68:71], a[124:127], a[156:159], v[68:71]
 s_lshl_b32 s30, s24, 20
 ds_read_b64_tr_b16 a[88:89], v4 offset:8192
 v_accvgpr_write_b32 a40, v92
 v_mfma_f32_16x16x32_bf16 v[68:71], a[128:131], a[160:163], v[68:71]
 s_waitcnt lgkmcnt(5)
 s_add_u32 s38, s41, 0
 buffer_store_dwordx4 a[0:3], v1, s[16:19], s38 offen sc1
 v_mfma_f32_16x16x32_bf16 v[68:71], a[132:135], a[164:167], v[68:71]
 s_add_u32 s30, s30, s32
 ds_read_b64_tr_b16 a[90:91], v4 offset:8704
 ds_read_b64_tr_b16 a[92:93], v4 offset:12288
 v_mfma_f32_16x16x32_bf16 v[68:71], a[136:139], a[168:171], v[68:71]
 ds_read_b64_tr_b16 a[94:95], v4 offset:12800
 ds_read_b64_tr_b16 a[96:97], v4 offset:16384
 v_mfma_f32_16x16x32_bf16 v[76:79], a[112:115], a[200:203], 0
 s_add_u32 s31, s30, 16777216
 ds_read_b64_tr_b16 a[98:99], v4 offset:16896
 v_accvgpr_write_b32 a41, v93
 v_mfma_f32_16x16x32_bf16 v[76:79], a[116:119], a[204:207], v[76:79]
 ds_read_b64_tr_b16 a[100:101], v4 offset:20480
 v_accvgpr_write_b32 a42, v94
 v_mfma_f32_16x16x32_bf16 v[76:79], a[120:123], a[208:211], v[76:79]
 s_lshl_b32 s21, s27, 1
 ds_read_b64_tr_b16 a[102:103], v4 offset:20992
 v_mfma_f32_16x16x32_bf16 v[76:79], a[124:127], a[212:215], v[76:79]
 ds_read_b64_tr_b16 a[104:105], v4 offset:24576
 v_mfma_f32_16x16x32_bf16 v[76:79], a[128:131], a[216:219], v[76:79]
 s_add_u32 s29, s21, 2
 ds_read_b64_tr_b16 a[106:107], v4 offset:25088
 v_accvgpr_write_b32 a43, v95
 v_mfma_f32_16x16x32_bf16 v[76:79], a[132:135], a[220:223], v[76:79]
 v_add_u32 v5, 0x18000, v5
 v_mfma_f32_16x16x32_bf16 v[76:79], a[136:139], a[224:227], v[76:79]
 s_waitcnt lgkmcnt(3)
 s_sub_u32 s20, 32, s21
 v_mfma_f32_16x16x32_bf16 v[20:23], a[80:83], a[172:175], v[20:23]
 ds_read_b64_tr_b16 a[112:113], v5 offset:0
 ds_read_b64_tr_b16 a[114:115], v5 offset:512
 v_mfma_f32_16x16x32_bf16 v[20:23], a[84:87], a[176:179], v[20:23]
 s_min_u32 s33, s20, 19
 ds_read_b64_tr_b16 a[116:117], v5 offset:4096
 v_cvt_pk_bf16_f32 v116, v116, v117
 v_mfma_f32_16x16x32_bf16 v[20:23], a[88:91], a[180:183], v[20:23]
 ds_read_b64_tr_b16 a[118:119], v5 offset:4608
 v_mfma_f32_16x16x32_bf16 v[20:23], a[92:95], a[184:187], v[20:23]
 s_sub_u32 s25, s20, s33
 ds_read_b64_tr_b16 a[120:121], v5 offset:8192
 v_cvt_pk_bf16_f32 v117, v118, v119
 v_mfma_f32_16x16x32_bf16 v[20:23], a[96:99], a[188:191], v[20:23]
 s_waitcnt lgkmcnt(5)
 ds_read_b64_tr_b16 a[122:123], v5 offset:8704
 v_mfma_f32_16x16x32_bf16 v[20:23], a[100:103], a[192:195], v[20:23]
 s_sub_i32 s20, 9, s29
 ds_read_b64_tr_b16 a[124:125], v5 offset:12288
 v_mfma_f32_16x16x32_bf16 v[20:23], a[104:107], a[196:199], v[20:23]
 s_add_u32 s38, s41, 8192
 buffer_store_dwordx4 a[32:35], v1, s[16:19], s38 offen sc1
 v_mfma_f32_16x16x32_bf16 v[28:31], a[80:83], a[228:231], v[28:31]
 s_max_i32 s20, s20, 0
 ds_read_b64_tr_b16 a[126:127], v5 offset:12800
 ds_read_b64_tr_b16 a[128:129], v5 offset:16384
 v_mfma_f32_16x16x32_bf16 v[28:31], a[84:87], a[232:235], v[28:31]
 ds_read_b64_tr_b16 a[130:131], v5 offset:16896
 ds_read_b64_tr_b16 a[132:133], v5 offset:20480
 v_mfma_f32_16x16x32_bf16 v[28:31], a[88:91], a[236:239], v[28:31]
 s_min_u32 s20, s20, s25
 ds_read_b64_tr_b16 a[134:135], v5 offset:20992
 v_cvt_pk_bf16_f32 v118, v132, v133
 v_mfma_f32_16x16x32_bf16 v[28:31], a[92:95], a[240:243], v[28:31]
 ds_read_b64_tr_b16 a[136:137], v5 offset:24576
 v_cvt_pk_bf16_f32 v119, v134, v135
 v_mfma_f32_16x16x32_bf16 v[28:31], a[96:99], a[244:247], v[28:31]
 s_sub_u32 s21, s25, s20
 ds_read_b64_tr_b16 a[138:139], v5 offset:25088
 v_mfma_f32_16x16x32_bf16 v[28:31], a[100:103], a[248:251], v[28:31]
 v_add_u32 v6, 0x18000, v6
 v_mfma_f32_16x16x32_bf16 v[28:31], a[104:107], a[252:255], v[28:31]
 s_waitcnt lgkmcnt(3)
 s_sub_u32 s28, s33, s29
 v_accvgpr_write_b32 a12, v116
 v_mfma_f32_16x16x32_bf16 v[36:39], a[112:115], a[172:175], v[36:39]
 ds_read_b64_tr_b16 a[80:81], v6 offset:0
 ds_read_b64_tr_b16 a[82:83], v6 offset:512
 v_mfma_f32_16x16x32_bf16 v[36:39], a[116:119], a[176:179], v[36:39]
 s_add_u32 s23, s20, 1
 ds_read_b64_tr_b16 a[84:85], v6 offset:4096
 v_mfma_f32_16x16x32_bf16 v[36:39], a[120:123], a[180:183], v[36:39]
 ds_read_b64_tr_b16 a[86:87], v6 offset:4608
 v_mfma_f32_16x16x32_bf16 v[36:39], a[124:127], a[184:187], v[36:39]
 s_mov_b32 s8, 2
 ds_read_b64_tr_b16 a[88:89], v6 offset:8192
 v_accvgpr_write_b32 a13, v117
 v_mfma_f32_16x16x32_bf16 v[36:39], a[128:131], a[188:191], v[36:39]
 s_waitcnt lgkmcnt(5)
 ds_read_b64_tr_b16 a[90:91], v6 offset:8704
 v_mfma_f32_16x16x32_bf16 v[36:39], a[132:135], a[192:195], v[36:39]
 s_add_u32 s9, s21, 1
 ds_read_b64_tr_b16 a[92:93], v6 offset:12288
 v_mfma_f32_16x16x32_bf16 v[36:39], a[136:139], a[196:199], v[36:39]
 ds_read_b64_tr_b16 a[94:95], v6 offset:12800
 ds_read_b64_tr_b16 a[96:97], v6 offset:16384
 v_mfma_f32_16x16x32_bf16 v[44:47], a[112:115], a[228:231], v[44:47]
 s_sub_u32 s11, s28, 1
 ds_read_b64_tr_b16 a[98:99], v6 offset:16896
 v_accvgpr_write_b32 a14, v118
 v_mfma_f32_16x16x32_bf16 v[44:47], a[116:119], a[232:235], v[44:47]
 ds_read_b64_tr_b16 a[100:101], v6 offset:20480
 v_mfma_f32_16x16x32_bf16 v[44:47], a[120:123], a[236:239], v[44:47]
 s_cmp_eq_u32 s26, 0
 s_cselect_b32 s28, s28, s21
 ds_read_b64_tr_b16 a[102:103], v6 offset:20992
 v_mfma_f32_16x16x32_bf16 v[44:47], a[124:127], a[240:243], v[44:47]
 s_add_u32 s38, s41, 1024
 buffer_store_dwordx4 a[4:7], v1, s[16:19], s38 offen sc1
 v_mfma_f32_16x16x32_bf16 v[44:47], a[128:131], a[244:247], v[44:47]
 s_cmp_eq_u32 s26, 0
 s_cselect_b32 s23, s23, s11
 ds_read_b64_tr_b16 a[104:105], v6 offset:24576
 ds_read_b64_tr_b16 a[106:107], v6 offset:25088
 v_mfma_f32_16x16x32_bf16 v[44:47], a[132:135], a[248:251], v[44:47]
 v_add_u32 v7, 0x18000, v7
 v_accvgpr_write_b32 a15, v119
 v_mfma_f32_16x16x32_bf16 v[44:47], a[136:139], a[252:255], v[44:47]
 s_waitcnt lgkmcnt(3)
 s_cmp_eq_u32 s26, 0
 s_cselect_b32 s8, s8, -1
 v_cvt_pk_bf16_f32 v124, v124, v125
 v_mfma_f32_16x16x32_bf16 v[52:55], a[80:83], a[172:175], v[52:55]
 ds_read_b64_tr_b16 a[112:113], v7 offset:0
 ds_read_b64_tr_b16 a[114:115], v7 offset:512
 v_mfma_f32_16x16x32_bf16 v[52:55], a[84:87], a[176:179], v[52:55]
 s_lshl_b32 s23, s23, 15
 ds_read_b64_tr_b16 a[116:117], v7 offset:4096
 v_mfma_f32_16x16x32_bf16 v[52:55], a[88:91], a[180:183], v[52:55]
 ds_read_b64_tr_b16 a[118:119], v7 offset:4608
 v_cvt_pk_bf16_f32 v125, v126, v127
 v_mfma_f32_16x16x32_bf16 v[52:55], a[92:95], a[184:187], v[52:55]
 s_lshl_b32 s9, s9, 15
 ds_read_b64_tr_b16 a[120:121], v7 offset:8192
 v_mfma_f32_16x16x32_bf16 v[52:55], a[96:99], a[188:191], v[52:55]
 s_waitcnt lgkmcnt(5)
 ds_read_b64_tr_b16 a[122:123], v7 offset:8704
 v_mfma_f32_16x16x32_bf16 v[52:55], a[100:103], a[192:195], v[52:55]
 s_add_u32 s34, s29, s25
 ds_read_b64_tr_b16 a[124:125], v7 offset:12288
 v_cvt_pk_bf16_f32 v126, v140, v141
 v_mfma_f32_16x16x32_bf16 v[52:55], a[104:107], a[196:199], v[52:55]
 ds_read_b64_tr_b16 a[126:127], v7 offset:12800
 ds_read_b64_tr_b16 a[128:129], v7 offset:16384
 v_mfma_f32_16x16x32_bf16 v[60:63], a[80:83], a[228:231], v[60:63]
 s_cmp_eq_u32 s26, 0
 s_cselect_b32 s29, s33, s29
 ds_read_b64_tr_b16 a[130:131], v7 offset:16896
 v_mfma_f32_16x16x32_bf16 v[60:63], a[84:87], a[232:235], v[60:63]
 ds_read_b64_tr_b16 a[132:133], v7 offset:20480
 v_mfma_f32_16x16x32_bf16 v[60:63], a[88:91], a[236:239], v[60:63]
 s_cmp_eq_u32 s26, 0
 s_cselect_b32 s33, s33, s34
 ds_read_b64_tr_b16 a[134:135], v7 offset:20992
 v_mfma_f32_16x16x32_bf16 v[60:63], a[92:95], a[240:243], v[60:63]
 ds_read_b64_tr_b16 a[136:137], v7 offset:24576
 v_cvt_pk_bf16_f32 v127, v142, v143
 v_mfma_f32_16x16x32_bf16 v[60:63], a[96:99], a[244:247], v[60:63]
 s_mov_b32 s34, s33
 ds_read_b64_tr_b16 a[138:139], v7 offset:25088
 v_mfma_f32_16x16x32_bf16 v[60:63], a[100:103], a[248:251], v[60:63]
 v_add_u32 v4, 0xffff0000, v4
 v_accvgpr_write_b32 a44, v124
 v_mfma_f32_16x16x32_bf16 v[60:63], a[104:107], a[252:255], v[60:63]
 s_barrier
 s_mov_b32 s10, 0x7fff
 s_waitcnt lgkmcnt(3)
 v_mfma_f32_16x16x32_bf16 v[68:71], a[112:115], a[172:175], v[68:71]
 s_add_u32 s38, s41, 9216
 buffer_store_dwordx4 a[36:39], v1, s[16:19], s38 offen sc1
 v_mfma_f32_16x16x32_bf16 v[68:71], a[116:119], a[176:179], v[68:71]
 s_mov_b32 s11, 0
 ds_read_b64_tr_b16 a[80:81], v4 offset:0
 ds_read_b64_tr_b16 a[82:83], v4 offset:512
 v_mfma_f32_16x16x32_bf16 v[68:71], a[120:123], a[180:183], v[68:71]
 ds_read_b64_tr_b16 a[84:85], v4 offset:4096
 ds_read_b64_tr_b16 a[86:87], v4 offset:4608
 v_mfma_f32_16x16x32_bf16 v[68:71], a[124:127], a[184:187], v[68:71]
 s_add_u32 s20, s6, s22
 s_addc_u32 s21, s7, 0
 ds_read_b64_tr_b16 a[88:89], v4 offset:8192
 v_mfma_f32_16x16x32_bf16 v[68:71], a[128:131], a[188:191], v[68:71]
 s_waitcnt lgkmcnt(5)
 ds_read_b64_tr_b16 a[90:91], v4 offset:8704
 v_accvgpr_write_b32 a45, v125
 v_mfma_f32_16x16x32_bf16 v[68:71], a[132:135], a[192:195], v[68:71]
 ds_read_b64_tr_b16 a[92:93], v4 offset:12288
 v_accvgpr_write_b32 a46, v126
 v_mfma_f32_16x16x32_bf16 v[68:71], a[136:139], a[196:199], v[68:71]
 ds_read_b64_tr_b16 a[94:95], v4 offset:12800
 ds_read_b64_tr_b16 a[96:97], v4 offset:16384
 v_mfma_f32_16x16x32_bf16 v[76:79], a[112:115], a[228:231], v[76:79]
 ds_read_b64_tr_b16 a[98:99], v4 offset:16896
 v_mfma_f32_16x16x32_bf16 v[76:79], a[116:119], a[232:235], v[76:79]
 ds_read_b64_tr_b16 a[100:101], v4 offset:20480
 v_accvgpr_write_b32 a47, v127
 v_mfma_f32_16x16x32_bf16 v[76:79], a[120:123], a[236:239], v[76:79]
 ds_read_b64_tr_b16 a[102:103], v4 offset:20992
 v_mfma_f32_16x16x32_bf16 v[76:79], a[124:127], a[240:243], v[76:79]
 ds_read_b64_tr_b16 a[104:105], v4 offset:24576
 v_mfma_f32_16x16x32_bf16 v[76:79], a[128:131], a[244:247], v[76:79]
 ds_read_b64_tr_b16 a[106:107], v4 offset:25088
 v_mfma_f32_16x16x32_bf16 v[76:79], a[132:135], a[248:251], v[76:79]
 v_add_u32 v5, 0xffff0000, v5
 v_mfma_f32_16x16x32_bf16 v[76:79], a[136:139], a[252:255], v[76:79]
 s_waitcnt lgkmcnt(3)
 v_mfma_f32_16x16x32_bf16 v[84:87], a[80:83], a[144:147], 0
 s_add_u32 s38, s41, 2048
 buffer_store_dwordx4 a[8:11], v1, s[16:19], s38 offen sc1
 v_mfma_f32_16x16x32_bf16 v[84:87], a[84:87], a[148:151], v[84:87]
 ds_read_b64_tr_b16 a[112:113], v5 offset:0
 ds_read_b64_tr_b16 a[114:115], v5 offset:512
 v_mfma_f32_16x16x32_bf16 v[84:87], a[88:91], a[152:155], v[84:87]
 ds_read_b64_tr_b16 a[116:117], v5 offset:4096
 ds_read_b64_tr_b16 a[118:119], v5 offset:4608
 v_mfma_f32_16x16x32_bf16 v[84:87], a[92:95], a[156:159], v[84:87]
 ds_read_b64_tr_b16 a[120:121], v5 offset:8192
 v_cvt_pk_bf16_f32 v20, v20, v21
 v_mfma_f32_16x16x32_bf16 v[84:87], a[96:99], a[160:163], v[84:87]
 s_waitcnt lgkmcnt(5)
 ds_read_b64_tr_b16 a[122:123], v5 offset:8704
 v_mfma_f32_16x16x32_bf16 v[84:87], a[100:103], a[164:167], v[84:87]
 ds_read_b64_tr_b16 a[124:125], v5 offset:12288
 v_mfma_f32_16x16x32_bf16 v[84:87], a[104:107], a[168:171], v[84:87]
 ds_read_b64_tr_b16 a[126:127], v5 offset:12800
 ds_read_b64_tr_b16 a[128:129], v5 offset:16384
 v_mfma_f32_16x16x32_bf16 v[92:95], a[80:83], a[200:203], 0
 ds_read_b64_tr_b16 a[130:131], v5 offset:16896
 v_cvt_pk_bf16_f32 v21, v22, v23
 v_mfma_f32_16x16x32_bf16 v[92:95], a[84:87], a[204:207], v[92:95]
 ds_read_b64_tr_b16 a[132:133], v5 offset:20480
 v_mfma_f32_16x16x32_bf16 v[92:95], a[88:91], a[208:211], v[92:95]
 s_add_u32 s38, s41, 10240
 buffer_store_dwordx4 a[40:43], v1, s[16:19], s38 offen sc1
 v_mfma_f32_16x16x32_bf16 v[92:95], a[92:95], a[212:215], v[92:95]
 ds_read_b64_tr_b16 a[134:135], v5 offset:20992
 ds_read_b64_tr_b16 a[136:137], v5 offset:24576
 v_mfma_f32_16x16x32_bf16 v[92:95], a[96:99], a[216:219], v[92:95]
 ds_read_b64_tr_b16 a[138:139], v5 offset:25088
 v_cvt_pk_bf16_f32 v22, v36, v37
 v_mfma_f32_16x16x32_bf16 v[92:95], a[100:103], a[220:223], v[92:95]
 s_load_dword s52, s[20:21], 0 glc
 v_add_u32 v6, 0xffff0000, v6
 v_mfma_f32_16x16x32_bf16 v[92:95], a[104:107], a[224:227], v[92:95]
 s_waitcnt lgkmcnt(3)
 v_cvt_pk_bf16_f32 v23, v38, v39
 v_mfma_f32_16x16x32_bf16 v[100:103], a[112:115], a[144:147], 0
 ds_read_b64_tr_b16 a[80:81], v6 offset:0
 ds_read_b64_tr_b16 a[82:83], v6 offset:512
 v_mfma_f32_16x16x32_bf16 v[100:103], a[116:119], a[148:151], v[100:103]
 ds_read_b64_tr_b16 a[84:85], v6 offset:4096
 v_mfma_f32_16x16x32_bf16 v[100:103], a[120:123], a[152:155], v[100:103]
 ds_read_b64_tr_b16 a[86:87], v6 offset:4608
 v_accvgpr_write_b32 a16, v20
 v_mfma_f32_16x16x32_bf16 v[100:103], a[124:127], a[156:159], v[100:103]
 ds_read_b64_tr_b16 a[88:89], v6 offset:8192
 v_mfma_f32_16x16x32_bf16 v[100:103], a[128:131], a[160:163], v[100:103]
 s_waitcnt lgkmcnt(5)
 ds_read_b64_tr_b16 a[90:91], v6 offset:8704
 v_mfma_f32_16x16x32_bf16 v[100:103], a[132:135], a[164:167], v[100:103]
 s_add_u32 s38, s41, 3072
 buffer_store_dwordx4 a[12:15], v1, s[16:19], s38 offen sc1
 v_mfma_f32_16x16x32_bf16 v[100:103], a[136:139], a[168:171], v[100:103]
 ds_read_b64_tr_b16 a[92:93], v6 offset:12288
 ds_read_b64_tr_b16 a[94:95], v6 offset:12800
 v_mfma_f32_16x16x32_bf16 v[108:111], a[112:115], a[200:203], 0
 ds_read_b64_tr_b16 a[96:97], v6 offset:16384
 ds_read_b64_tr_b16 a[98:99], v6 offset:16896
 v_mfma_f32_16x16x32_bf16 v[108:111], a[116:119], a[204:207], v[108:111]
 ds_read_b64_tr_b16 a[100:101], v6 offset:20480
 v_accvgpr_write_b32 a17, v21
 v_mfma_f32_16x16x32_bf16 v[108:111], a[120:123], a[208:211], v[108:111]
 ds_read_b64_tr_b16 a[102:103], v6 offset:20992
 v_accvgpr_write_b32 a18, v22
 v_mfma_f32_16x16x32_bf16 v[108:111], a[124:127], a[212:215], v[108:111]
 ds_read_b64_tr_b16 a[104:105], v6 offset:24576
 v_mfma_f32_16x16x32_bf16 v[108:111], a[128:131], a[216:219], v[108:111]
 ds_read_b64_tr_b16 a[106:107], v6 offset:25088
 v_mfma_f32_16x16x32_bf16 v[108:111], a[132:135], a[220:223], v[108:111]
 v_add_u32 v7, 0xffff0000, v7
 v_accvgpr_write_b32 a19, v23
 v_mfma_f32_16x16x32_bf16 v[108:111], a[136:139], a[224:227], v[108:111]
 s_waitcnt lgkmcnt(3)
 v_mfma_f32_16x16x32_bf16 v[116:119], a[80:83], a[144:147], 0
 ds_read_b64_tr_b16 a[112:113], v7 offset:0
 ds_read_b64_tr_b16 a[114:115], v7 offset:512
 v_mfma_f32_16x16x32_bf16 v[116:119], a[84:87], a[148:151], v[116:119]
 s_add_u32 s38, s41, 11264
 buffer_store_dwordx4 a[44:47], v1, s[16:19], s38 offen sc1
 v_mfma_f32_16x16x32_bf16 v[116:119], a[88:91], a[152:155], v[116:119]
 ds_read_b64_tr_b16 a[116:117], v7 offset:4096
 ds_read_b64_tr_b16 a[118:119], v7 offset:4608
 v_mfma_f32_16x16x32_bf16 v[116:119], a[92:95], a[156:159], v[116:119]
 ds_read_b64_tr_b16 a[120:121], v7 offset:8192
 v_cvt_pk_bf16_f32 v28, v28, v29
 v_mfma_f32_16x16x32_bf16 v[116:119], a[96:99], a[160:163], v[116:119]
 s_waitcnt lgkmcnt(5)
 ds_read_b64_tr_b16 a[122:123], v7 offset:8704
 v_mfma_f32_16x16x32_bf16 v[116:119], a[100:103], a[164:167], v[116:119]
 ds_read_b64_tr_b16 a[124:125], v7 offset:12288
 v_cvt_pk_bf16_f32 v29, v30, v31
 v_mfma_f32_16x16x32_bf16 v[116:119], a[104:107], a[168:171], v[116:119]
 ds_read_b64_tr_b16 a[126:127], v7 offset:12800
 ds_read_b64_tr_b16 a[128:129], v7 offset:16384
 v_mfma_f32_16x16x32_bf16 v[124:127], a[80:83], a[200:203], 0
 ds_read_b64_tr_b16 a[130:131], v7 offset:16896
 v_mfma_f32_16x16x32_bf16 v[124:127], a[84:87], a[204:207], v[124:127]
 ds_read_b64_tr_b16 a[132:133], v7 offset:20480
 v_cvt_pk_bf16_f32 v30, v44, v45
 v_mfma_f32_16x16x32_bf16 v[124:127], a[88:91], a[208:211], v[124:127]
 ds_read_b64_tr_b16 a[134:135], v7 offset:20992
 v_mfma_f32_16x16x32_bf16 v[124:127], a[92:95], a[212:215], v[124:127]
 ds_read_b64_tr_b16 a[136:137], v7 offset:24576
 v_mfma_f32_16x16x32_bf16 v[124:127], a[96:99], a[216:219], v[124:127]
 ds_read_b64_tr_b16 a[138:139], v7 offset:25088
 v_cvt_pk_bf16_f32 v31, v46, v47
 v_mfma_f32_16x16x32_bf16 v[124:127], a[100:103], a[220:223], v[124:127]
 s_waitcnt lgkmcnt(0)
 v_add_u32 v4, 0xffff0000, v4
 v_mfma_f32_16x16x32_bf16 v[124:127], a[104:107], a[224:227], v[124:127]
 s_waitcnt vmcnt(9)
 s_barrier
 s_cmp_ge_u32 s52, 16
 s_cbranch_scc0 L_spin1
L_spun1:
 v_mfma_f32_16x16x32_bf16 v[132:135], a[112:115], a[144:147], 0
 ds_read_b64_tr_b16 a[80:81], v4 offset:0
 ds_read_b64_tr_b16 a[82:83], v4 offset:512
 v_mfma_f32_16x16x32_bf16 v[132:135], a[116:119], a[148:151], v[132:135]
 s_add_u32 m0, s32, 32768
 s_add_u32 s35, s30, 0
 ds_read_b64_tr_b16 a[84:85], v4 offset:4096
 v_mfma_f32_16x16x32_bf16 v[132:135], a[120:123], a[152:155], v[132:135]
 buffer_load_dwordx4 v1, s[16:19], s35 offen offset:0 sc1 lds
 v_mfma_f32_16x16x32_bf16 v[132:135], a[124:127], a[156:159], v[132:135]
 ds_read_b64_tr_b16 a[86:87], v4 offset:4608
 ds_read_b64_tr_b16 a[88:89], v4 offset:8192
 v_mfma_f32_16x16x32_bf16 v[132:135], a[128:131], a[160:163], v[132:135]
 ds_read_b64_tr_b16 a[90:91], v4 offset:8704
 v_accvgpr_write_b32 a48, v28
 v_mfma_f32_16x16x32_bf16 v[132:135], a[132:135], a[164:167], v[132:135]
 ds_read_b64_tr_b16 a[92:93], v4 offset:12288
 v_accvgpr_write_b32 a49, v29
 v_mfma_f32_16x16x32_bf16 v[132:135], a[136:139], a[168:171], v[132:135]
 buffer_load_dwordx4 v1, s[16:19], s35 offen offset:1024 sc1 lds
 v_mfma_f32_16x16x32_bf16 v[140:143], a[112:115], a[200:203], 0
 ds_read_b64_tr_b16 a[94:95], v4 offset:12800
 ds_read_b64_tr_b16 a[96:97], v4 offset:16384
 v_mfma_f32_16x16x32_bf16 v[140:143], a[116:119], a[204:207], v[140:143]
 ds_read_b64_tr_b16 a[98:99], v4 offset:16896
 ds_read_b64_tr_b16 a[100:101], v4 offset:20480
 v_mfma_f32_16x16x32_bf16 v[140:143], a[120:123], a[208:211], v[140:143]
 ds_read_b64_tr_b16 a[102:103], v4 offset:20992
 v_accvgpr_write_b32 a50, v30
 v_mfma_f32_16x16x32_bf16 v[140:143], a[124:127], a[212:215], v[140:143]
 buffer_load_dwordx4 v1, s[16:19], s35 offen offset:2048 sc1 lds
 v_mfma_f32_16x16x32_bf16 v[140:143], a[128:131], a[216:219], v[140:143]
 ds_read_b64_tr_b16 a[104:105], v4 offset:24576
 ds_read_b64_tr_b16 a[106:107], v4 offset:25088
 v_mfma_f32_16x16x32_bf16 v[140:143], a[132:135], a[220:223], v[140:143]
 v_add_u32 v5, 0xffff0000, v5
 v_accvgpr_write_b32 a51, v31
 v_mfma_f32_16x16x32_bf16 v[140:143], a[136:139], a[224:227], v[140:143]
 s_waitcnt lgkmcnt(3)
 v_mfma_f32_16x16x32_bf16 v[84:87], a[80:83], a[172:175], v[84:87]
 buffer_load_dwordx4 v1, s[16:19], s35 offen offset:3072 sc1 lds
 v_mfma_f32_16x16x32_bf16 v[84:87], a[84:87], a[176:179], v[84:87]
 ds_read_b64_tr_b16 a[112:113], v5 offset:0
 ds_read_b64_tr_b16 a[114:115], v5 offset:512
 v_mfma_f32_16x16x32_bf16 v[84:87], a[88:91], a[180:183], v[84:87]
 ds_read_b64_tr_b16 a[116:117], v5 offset:4096
 ds_read_b64_tr_b16 a[118:119], v5 offset:4608
 v_mfma_f32_16x16x32_bf16 v[84:87], a[92:95], a[184:187], v[84:87]
 s_add_u32 m0, s32, 36864
 s_add_u32 s35, s30, 4096
 ds_read_b64_tr_b16 a[120:121], v5 offset:8192
 v_mfma_f32_16x16x32_bf16 v[84:87], a[96:99], a[188:191], v[84:87]
 s_waitcnt lgkmcnt(5)
 buffer_load_dwordx4 v1, s[16:19], s35 offen offset:0 sc1 lds
 v_mfma_f32_16x16x32_bf16 v[84:87], a[100:103], a[192:195], v[84:87]
 ds_read_b64_tr_b16 a[122:123], v5 offset:8704
 ds_read_b64_tr_b16 a[124:125], v5 offset:12288
 v_mfma_f32_16x16x32_bf16 v[84:87], a[104:107], a[196:199], v[84:87]
 ds_read_b64_tr_b16 a[126:127], v5 offset:12800
 ds_read_b64_tr_b16 a[128:129], v5 offset:16384
 v_mfma_f32_16x16x32_bf16 v[92:95], a[80:83], a[228:231], v[92:95]
 ds_read_b64_tr_b16 a[130:131], v5 offset:16896
 v_cvt_pk_bf16_f32 v52, v52, v53
 v_mfma_f32_16x16x32_bf16 v[92:95], a[84:87], a[232:235], v[92:95]
 buffer_load_dwordx4 v1, s[16:19], s35 offen offset:1024 sc1 lds
 v_mfma_f32_16x16x32_bf16 v[92:95], a[88:91], a[236:239], v[92:95]
 ds_read_b64_tr_b16 a[132:133], v5 offset:20480
 ds_read_b64_tr_b16 a[134:135], v5 offset:20992
 v_mfma_f32_16x16x32_bf16 v[92:95], a[92:95], a[240:243], v[92:95]
 ds_read_b64_tr_b16 a[136:137], v5 offset:24576
 v_cvt_pk_bf16_f32 v53, v54, v55
 v_mfma_f32_16x16x32_bf16 v[92:95], a[96:99], a[244:247], v[92:95]
 ds_read_b64_tr_b16 a[138:139], v5 offset:25088
 v_cvt_pk_bf16_f32 v54, v68, v69
 v_mfma_f32_16x16x32_bf16 v[92:95], a[100:103], a[248:251], v[92:95]
 v_add_u32 v6, 0xffff0000, v6
 v_cvt_pk_bf16_f32 v55, v70, v71
 v_mfma_f32_16x16x32_bf16 v[92:95], a[104:107], a[252:255], v[92:95]
 s_waitcnt lgkmcnt(4)
 buffer_load_dwordx4 v1, s[16:19], s35 offen offset:2048 sc1 lds
 v_mfma_f32_16x16x32_bf16 v[100:103], a[112:115], a[172:175], v[100:103]
 ds_read_b64_tr_b16 a[80:81], v6 offset:0
 ds_read_b64_tr_b16 a[82:83], v6 offset:512
 v_mfma_f32_16x16x32_bf16 v[100:103], a[116:119], a[176:179], v[100:103]
 ds_read_b64_tr_b16 a[84:85], v6 offset:4096
 v_accvgpr_write_b32 a20, v52
 v_mfma_f32_16x16x32_bf16 v[100:103], a[120:123], a[180:183], v[100:103]
 ds_read_b64_tr_b16 a[86:87], v6 offset:4608
 v_mfma_f32_16x16x32_bf16 v[100:103], a[124:127], a[184:187], v[100:103]
 buffer_load_dwordx4 v1, s[16:19], s35 offen offset:3072 sc1 lds
 v_mfma_f32_16x16x32_bf16 v[100:103], a[128:131], a[188:191], v[100:103]
 s_waitcnt lgkmcnt(4)
 ds_read_b64_tr_b16 a[88:89], v6 offset:8192
 ds_read_b64_tr_b16 a[90:91], v6 offset:8704
 v_mfma_f32_16x16x32_bf16 v[100:103], a[132:135], a[192:195], v[100:103]
 s_sub_u32 s33, s33, 1
 ds_read_b64_tr_b16 a[92:93], v6 offset:12288
 v_accvgpr_write_b32 a21, v53
 v_mfma_f32_16x16x32_bf16 v[100:103], a[136:139], a[196:199], v[100:103]
 s_cmp_eq_u32 s33, s28
 s_cselect_b32 s20, s23, 0x8000
 ds_read_b64_tr_b16 a[94:95], v6 offset:12800
 v_mfma_f32_16x16x32_bf16 v[108:111], a[112:115], a[228:231], v[108:111]
 s_cmp_eq_u32 s33, s8
 s_cselect_b32 s20, s9, s20
 ds_read_b64_tr_b16 a[96:97], v6 offset:16384
 v_mfma_f32_16x16x32_bf16 v[108:111], a[116:119], a[232:235], v[108:111]
 s_add_u32 s30, s30, s20
 ds_read_b64_tr_b16 a[98:99], v6 offset:16896
 ds_read_b64_tr_b16 a[100:101], v6 offset:20480
 v_mfma_f32_16x16x32_bf16 v[108:111], a[120:123], a[236:239], v[108:111]
 s_cmp_gt_i32 s33, 0
 s_cselect_b32 s30, s30, 1879048192
 ds_read_b64_tr_b16 a[102:103], v6 offset:20992
 v_mfma_f32_16x16x32_bf16 v[108:111], a[124:127], a[240:243], v[108:111]
 s_add_u32 m0, s32, 98304
 s_add_u32 s35, s31, 0
 ds_read_b64_tr_b16 a[104:105], v6 offset:24576
 v_mfma_f32_16x16x32_bf16 v[108:111], a[128:131], a[244:247], v[108:111]
 buffer_load_dwordx4 v1, s[16:19], s35 offen offset:0 sc1 lds
 ds_read_b64_tr_b16 a[106:107], v6 offset:25088
 v_mfma_f32_16x16x32_bf16 v[108:111], a[132:135], a[248:251], v[108:111]
 v_add_u32 v7, 0xffff0000, v7
 v_accvgpr_write_b32 a22, v54
 v_mfma_f32_16x16x32_bf16 v[108:111], a[136:139], a[252:255], v[108:111]
 s_waitcnt lgkmcnt(3)
 v_accvgpr_write_b32 a23, v55
 v_cvt_pk_bf16_f32 v60, v60, v61
 v_mfma_f32_16x16x32_bf16 v[116:119], a[80:83], a[172:175], v[116:119]
 ds_read_b64_tr_b16 a[112:113], v7 offset:0
 ds_read_b64_tr_b16 a[114:115], v7 offset:512
 v_mfma_f32_16x16x32_bf16 v[116:119], a[84:87], a[176:179], v[116:119]
 buffer_load_dwordx4 v1, s[16:19], s35 offen offset:1024 sc1 lds
 v_mfma_f32_16x16x32_bf16 v[116:119], a[88:91], a[180:183], v[116:119]
 ds_read_b64_tr_b16 a[116:117], v7 offset:4096
 ds_read_b64_tr_b16 a[118:119], v7 offset:4608
 v_mfma_f32_16x16x32_bf16 v[116:119], a[92:95], a[184:187], v[116:119]
 ds_read_b64_tr_b16 a[120:121], v7 offset:8192
 v_cvt_pk_bf16_f32 v61, v62, v63
 v_mfma_f32_16x16x32_bf16 v[116:119], a[96:99], a[188:191], v[116:119]
 s_waitcnt lgkmcnt(5)
 ds_read_b64_tr_b16 a[122:123], v7 offset:8704
 v_mfma_f32_16x16x32_bf16 v[116:119], a[100:103], a[192:195], v[116:119]
 buffer_load_dwordx4 v1, s[16:19], s35 offen offset:2048 sc1 lds
 v_mfma_f32_16x16x32_bf16 v[116:119], a[104:107], a[196:199], v[116:119]
 ds_read_b64_tr_b16 a[124:125], v7 offset:12288
 ds_read_b64_tr_b16 a[126:127], v7 offset:12800
 v_mfma_f32_16x16x32_bf16 v[124:127], a[80:83], a[228:231], v[124:127]
 ds_read_b64_tr_b16 a[128:129], v7 offset:16384
 ds_read_b64_tr_b16 a[130:131], v7 offset:16896
 v_mfma_f32_16x16x32_bf16 v[124:127], a[84:87], a[232:235], v[124:127]
 ds_read_b64_tr_b16 a[132:133], v7 offset:20480
 v_cvt_pk_bf16_f32 v62, v76, v77
 v_mfma_f32_16x16x32_bf16 v[124:127], a[88:91], a[236:239], v[124:127]
 buffer_load_dwordx4 v1, s[16:19], s35 offen offset:3072 sc1 lds
 v_mfma_f32_16x16x32_bf16 v[124:127], a[92:95], a[240:243], v[124:127]
 s_add_u32 m0, s32, 102400
 s_add_u32 s35, s31, 4096
 ds_read_b64_tr_b16 a[134:135], v7 offset:20992
 v_mfma_f32_16x16x32_bf16 v[124:127], a[96:99], a[244:247], v[124:127]
 ds_read_b64_tr_b16 a[136:137], v7 offset:24576
 ds_read_b64_tr_b16 a[138:139], v7 offset:25088
 v_mfma_f32_16x16x32_bf16 v[124:127], a[100:103], a[248:251], v[124:127]
 v_cvt_pk_bf16_f32 v63, v78, v79
 v_accvgpr_write_b32 a52, v60
 v_mfma_f32_16x16x32_bf16 v[124:127], a[104:107], a[252:255], v[124:127]
 s_waitcnt lgkmcnt(3)
 buffer_load_dwordx4 v1, s[16:19], s35 offen offset:0 sc1 lds
 v_mfma_f32_16x16x32_bf16 v[132:135], a[112:115], a[172:175], v[132:135]
 v_mfma_f32_16x16x32_bf16 v[132:135], a[116:119], a[176:179], v[132:135]
 v_accvgpr_write_b32 a53, v61
 v_mfma_f32_16x16x32_bf16 v[132:135], a[120:123], a[180:183], v[132:135]
 v_mfma_f32_16x16x32_bf16 v[132:135], a[124:127], a[184:187], v[132:135]
 buffer_load_dwordx4 v1, s[16:19], s35 offen offset:1024 sc1 lds
 v_mfma_f32_16x16x32_bf16 v[132:135], a[128:131], a[188:191], v[132:135]
 s_waitcnt lgkmcnt(0)
 v_mfma_f32_16x16x32_bf16 v[132:135], a[132:135], a[192:195], v[132:135]
 v_accvgpr_write_b32 a54, v62
 v_mfma_f32_16x16x32_bf16 v[132:135], a[136:139], a[196:199], v[132:135]
 v_mfma_f32_16x16x32_bf16 v[140:143], a[112:115], a[228:231], v[140:143]
 buffer_load_dwordx4 v1, s[16:19], s35 offen offset:2048 sc1 lds
 v_mfma_f32_16x16x32_bf16 v[140:143], a[116:119], a[232:235], v[140:143]
 v_accvgpr_write_b32 a55, v63
 v_mfma_f32_16x16x32_bf16 v[140:143], a[120:123], a[236:239], v[140:143]
 v_mfma_f32_16x16x32_bf16 v[140:143], a[124:127], a[240:243], v[140:143]
 v_mfma_f32_16x16x32_bf16 v[140:143], a[128:131], a[244:247], v[140:143]
 buffer_load_dwordx4 v1, s[16:19], s35 offen offset:3072 sc1 lds
 v_mfma_f32_16x16x32_bf16 v[140:143], a[132:135], a[248:251], v[140:143]
 s_sub_u32 s34, s34, 1
 v_mfma_f32_16x16x32_bf16 v[140:143], a[136:139], a[252:255], v[140:143]
 s_cmp_eq_u32 s34, s28
 s_cselect_b32 s21, s23, 0x8000
 s_cmp_eq_u32 s34, s8
 s_cselect_b32 s21, s9, s21
 s_add_u32 s31, s31, s21
 s_cmp_gt_i32 s34, 0
 s_cselect_b32 s31, s31, 1879048192
 v_cvt_pk_bf16_f32 v84, v84, v85
 v_cvt_pk_bf16_f32 v85, v86, v87
 v_cvt_pk_bf16_f32 v86, v100, v101
 v_cvt_pk_bf16_f32 v87, v102, v103
 v_accvgpr_write_b32 a24, v84
 v_accvgpr_write_b32 a25, v85
 v_accvgpr_write_b32 a26, v86
 v_accvgpr_write_b32 a27, v87
 v_cvt_pk_bf16_f32 v92, v92, v93
 v_cvt_pk_bf16_f32 v93, v94, v95
 v_cvt_pk_bf16_f32 v94, v108, v109
 v_cvt_pk_bf16_f32 v95, v110, v111
 v_accvgpr_write_b32 a56, v92
 v_accvgpr_write_b32 a57, v93
 v_accvgpr_write_b32 a58, v94
 v_accvgpr_write_b32 a59, v95
 v_cvt_pk_bf16_f32 v116, v116, v117
 v_cvt_pk_bf16_f32 v117, v118, v119
 v_cvt_pk_bf16_f32 v118, v132, v133
 v_cvt_pk_bf16_f32 v119, v134, v135
 v_accvgpr_write_b32 a28, v116
 v_accvgpr_write_b32 a29, v117
 v_accvgpr_write_b32 a30, v118
 v_accvgpr_write_b32 a31, v119
 v_cvt_pk_bf16_f32 v124, v124, v125
 v_cvt_pk_bf16_f32 v125, v126, v127
 v_cvt_pk_bf16_f32 v126, v140, v141
 v_cvt_pk_bf16_f32 v127, v142, v143
 v_accvgpr_write_b32 a60, v124
 v_accvgpr_write_b32 a61, v125
 v_accvgpr_write_b32 a62, v126
 v_accvgpr_write_b32 a63, v127
 v_mov_b32 v25, v3
 v_add_u32 v2, 0x10000, v1
 v_mov_b32 v26, 1
 s_waitcnt vmcnt(8)
 s_barrier
 ds_read_b128 a[64:67], v1 offset:32768
 ds_read_b128 a[68:71], v1 offset:33792
 ds_read_b128 a[72:75], v1 offset:34816
 ds_read_b128 a[76:79], v1 offset:35840
 ds_read_b128 a[80:83], v1 offset:36864
 ds_read_b128 a[84:87], v1 offset:37888
 ds_read_b128 a[88:91], v1 offset:38912
 ds_read_b128 a[92:95], v1 offset:39936
 s_waitcnt lgkmcnt(7)
 v_mfma_f32_16x16x32_bf16 v[32:35], a[64:67], a[0:3], 0
 s_waitcnt lgkmcnt(6)
 s_add_u32 m0, s32, 0
 s_add_u32 s35, s30, 0
 ds_read_b128 a[96:99], v1 offset:40960
 v_mfma_f32_16x16x32_bf16 v[32:35], a[68:71], a[4:7], v[32:35]
 s_waitcnt lgkmcnt(6)
 buffer_load_dwordx4 v1, s[16:19], s35 offen offset:0 sc1 lds
 v_mfma_f32_16x16x32_bf16 v[32:35], a[72:75], a[8:11], v[32:35]
 s_waitcnt lgkmcnt(5)
 ds_read_b128 a[100:103], v1 offset:41984
 ds_read_b128 a[104:107], v1 offset:43008
 v_mfma_f32_16x16x32_bf16 v[32:35], a[76:79], a[12:15], v[32:35]
 s_waitcnt lgkmcnt(6)
 v_accvgpr_write_b32 a184, v212
 v_accvgpr_write_b32 a185, v213
 v_mfma_f32_16x16x32_bf16 v[32:35], a[80:83], a[16:19], v[32:35]
 s_waitcnt lgkmcnt(3)
 ds_read_b128 a[108:111], v1 offset:44032
 v_accvgpr_write_b32 a186, v214
 v_mfma_f32_16x16x32_bf16 v[32:35], a[84:87], a[20:23], v[32:35]
 buffer_load_dwordx4 v1, s[16:19], s35 offen offset:1024 sc1 lds
 v_mfma_f32_16x16x32_bf16 v[32:35], a[88:91], a[24:27], v[32:35]
 ds_read_b128 a[112:115], v1 offset:45056
 ds_read_b128 a[116:119], v1 offset:46080
 v_mfma_f32_16x16x32_bf16 v[32:35], a[92:95], a[28:31], v[32:35]
 v_accvgpr_write_b32 a187, v215
 v_accvgpr_write_b32 a188, v228
 v_mfma_f32_16x16x32_bf16 v[36:39], a[64:67], a[32:35], 0
 ds_read_b128 a[120:123], v1 offset:47104
 v_accvgpr_write_b32 a189, v229
 v_mfma_f32_16x16x32_bf16 v[36:39], a[68:71], a[36:39], v[36:39]
 buffer_load_dwordx4 v1, s[16:19], s35 offen offset:2048 sc1 lds
 v_mfma_f32_16x16x32_bf16 v[36:39], a[72:75], a[40:43], v[36:39]
 ds_read_b128 a[124:127], v1 offset:48128
 v_accvgpr_write_b32 a190, v230
 v_mfma_f32_16x16x32_bf16 v[36:39], a[76:79], a[44:47], v[36:39]
 v_accvgpr_write_b32 a191, v231
 v_accvgpr_write_b32 a160, v208
 v_mfma_f32_16x16x32_bf16 v[36:39], a[80:83], a[48:51], v[36:39]
 v_accvgpr_write_b32 a161, v209
 v_accvgpr_write_b32 a162, v210
 v_mfma_f32_16x16x32_bf16 v[36:39], a[84:87], a[52:55], v[36:39]
 buffer_load_dwordx4 v1, s[16:19], s35 offen offset:3072 sc1 lds
 v_mfma_f32_16x16x32_bf16 v[36:39], a[88:91], a[56:59], v[36:39]
 v_accvgpr_write_b32 a163, v211
 v_accvgpr_write_b32 a164, v216
 v_mfma_f32_16x16x32_bf16 v[36:39], a[92:95], a[60:63], v[36:39]
 s_waitcnt lgkmcnt(0)
 s_add_u32 m0, s32, 4096
 v_accvgpr_write_b32 a165, v217
 v_accvgpr_write_b32 a166, v218
 v_mfma_f32_16x16x32_bf16 v[40:43], a[96:99], a[0:3], 0
 s_add_u32 s35, s30, 4096
 ds_read_b128 a[64:67], v1 offset:49152
 v_accvgpr_write_b32 a167, v219
 v_mfma_f32_16x16x32_bf16 v[40:43], a[100:103], a[4:7], v[40:43]
 buffer_load_dwordx4 v1, s[16:19], s35 offen offset:0 sc1 lds
 v_mfma_f32_16x16x32_bf16 v[40:43], a[104:107], a[8:11], v[40:43]
 ds_read_b128 a[68:71], v1 offset:50176
 ds_read_b128 a[72:75], v1 offset:51200
 v_mfma_f32_16x16x32_bf16 v[40:43], a[108:111], a[12:15], v[40:43]
 v_accvgpr_write_b32 a168, v224
 v_accvgpr_write_b32 a169, v225
 v_mfma_f32_16x16x32_bf16 v[40:43], a[112:115], a[16:19], v[40:43]
 ds_read_b128 a[76:79], v1 offset:52224
 v_accvgpr_write_b32 a170, v226
 v_mfma_f32_16x16x32_bf16 v[40:43], a[116:119], a[20:23], v[40:43]
 buffer_load_dwordx4 v1, s[16:19], s35 offen offset:1024 sc1 lds
 v_mfma_f32_16x16x32_bf16 v[40:43], a[120:123], a[24:27], v[40:43]
 ds_read_b128 a[80:83], v1 offset:53248
 ds_read_b128 a[84:87], v1 offset:54272
 v_mfma_f32_16x16x32_bf16 v[40:43], a[124:127], a[28:31], v[40:43]
 v_accvgpr_write_b32 a171, v227
 v_accvgpr_write_b32 a172, v232
 v_mfma_f32_16x16x32_bf16 v[44:47], a[96:99], a[32:35], 0
 ds_read_b128 a[88:91], v1 offset:55296
 v_accvgpr_write_b32 a173, v233
 v_mfma_f32_16x16x32_bf16 v[44:47], a[100:103], a[36:39], v[44:47]
 buffer_load_dwordx4 v1, s[16:19], s35 offen offset:2048 sc1 lds
 v_mfma_f32_16x16x32_bf16 v[44:47], a[104:107], a[40:43], v[44:47]
 ds_read_b128 a[92:95], v1 offset:56320
 v_accvgpr_write_b32 a174, v234
 v_mfma_f32_16x16x32_bf16 v[44:47], a[108:111], a[44:47], v[44:47]
 v_accvgpr_write_b32 a175, v235
 v_accvgpr_write_b32 a176, v240
 v_mfma_f32_16x16x32_bf16 v[44:47], a[112:115], a[48:51], v[44:47]
 v_accvgpr_write_b32 a177, v241
 v_accvgpr_write_b32 a178, v242
 v_mfma_f32_16x16x32_bf16 v[44:47], a[116:119], a[52:55], v[44:47]
 buffer_load_dwordx4 v1, s[16:19], s35 offen offset:3072 sc1 lds
 v_mfma_f32_16x16x32_bf16 v[44:47], a[120:123], a[56:59], v[44:47]
 v_accvgpr_write_b32 a179, v243
 v_accvgpr_write_b32 a180, v248
 v_mfma_f32_16x16x32_bf16 v[44:47], a[124:127], a[60:63], v[44:47]
 s_waitcnt lgkmcnt(0)
 s_sub_u32 s33, s33, 1
 v_accvgpr_write_b32 a181, v249
 v_accvgpr_write_b32 a182, v250
 v_mfma_f32_16x16x32_bf16 v[48:51], a[64:67], a[0:3], 0
 s_cmp_eq_u32 s33, s28
 s_cselect_b32 s20, s23, 0x8000
 ds_read_b128 a[96:99], v1 offset:57344
 v_mfma_f32_16x16x32_bf16 v[48:51], a[68:71], a[4:7], v[48:51]
 s_cmp_eq_u32 s33, s8
 s_cselect_b32 s20, s9, s20
 s_add_u32 s30, s30, s20
 s_cmp_gt_i32 s33, 0
 s_cselect_b32 s30, s30, 1879048192
 v_mfma_f32_16x16x32_bf16 v[48:51], a[72:75], a[8:11], v[48:51]
 s_add_u32 s38, s41, 4096
 buffer_store_dwordx4 a[16:19], v1, s[16:19], s38 offen sc1
 v_mfma_f32_16x16x32_bf16 v[48:51], a[76:79], a[12:15], v[48:51]
 ds_read_b128 a[100:103], v1 offset:58368
 ds_read_b128 a[104:107], v1 offset:59392
 v_accvgpr_write_b32 a183, v251
 v_mfma_f32_16x16x32_bf16 v[48:51], a[80:83], a[16:19], v[48:51]
 ds_read_b128 a[108:111], v1 offset:60416
 v_accvgpr_write_b32 a152, v192
 v_accvgpr_write_b32 a153, v193
 v_mfma_f32_16x16x32_bf16 v[48:51], a[84:87], a[20:23], v[48:51]
 ds_read_b128 a[112:115], v1 offset:61440
 v_accvgpr_write_b32 a154, v194
 v_mfma_f32_16x16x32_bf16 v[48:51], a[88:91], a[24:27], v[48:51]
 ds_read_b128 a[116:119], v1 offset:62464
 v_accvgpr_write_b32 a155, v195
 v_mfma_f32_16x16x32_bf16 v[48:51], a[92:95], a[28:31], v[48:51]
 v_accvgpr_write_b32 a156, v200
 v_accvgpr_write_b32 a157, v201
 v_mfma_f32_16x16x32_bf16 v[52:55], a[64:67], a[32:35], 0
 ds_read_b128 a[120:123], v1 offset:63488
 v_accvgpr_write_b32 a158, v202
 v_mfma_f32_16x16x32_bf16 v[52:55], a[68:71], a[36:39], v[52:55]
 ds_read_b128 a[124:127], v1 offset:64512
 v_accvgpr_write_b32 a159, v203
 v_mfma_f32_16x16x32_bf16 v[52:55], a[72:75], a[40:43], v[52:55]
 s_add_u32 s38, s41, 12288
 buffer_store_dwordx4 a[48:51], v1, s[16:19], s38 offen sc1
 v_mfma_f32_16x16x32_bf16 v[52:55], a[76:79], a[44:47], v[52:55]
 v_accvgpr_write_b32 a128, v144
 v_accvgpr_write_b32 a129, v145
 v_mfma_f32_16x16x32_bf16 v[52:55], a[80:83], a[48:51], v[52:55]
 v_accvgpr_write_b32 a130, v146
 v_accvgpr_write_b32 a131, v147
 v_mfma_f32_16x16x32_bf16 v[52:55], a[84:87], a[52:55], v[52:55]
 v_accvgpr_write_b32 a132, v152
 v_accvgpr_write_b32 a133, v153
 v_mfma_f32_16x16x32_bf16 v[52:55], a[88:91], a[56:59], v[52:55]
 v_accvgpr_write_b32 a134, v154
 v_accvgpr_write_b32 a135, v155
 v_mfma_f32_16x16x32_bf16 v[52:55], a[92:95], a[60:63], v[52:55]
 s_waitcnt lgkmcnt(0)
 v_accvgpr_write_b32 a136, v160
 v_accvgpr_write_b32 a137, v161
 v_mfma_f32_16x16x32_bf16 v[56:59], a[96:99], a[0:3], 0
 v_accvgpr_write_b32 a138, v162
 v_accvgpr_write_b32 a139, v163
 v_mfma_f32_16x16x32_bf16 v[56:59], a[100:103], a[4:7], v[56:59]
 v_accvgpr_write_b32 a140, v168
 v_accvgpr_write_b32 a141, v169
 v_mfma_f32_16x16x32_bf16 v[56:59], a[104:107], a[8:11], v[56:59]
 s_add_u32 s38, s41, 5120
 buffer_store_dwordx4 a[20:23], v1, s[16:19], s38 offen sc1
 v_mfma_f32_16x16x32_bf16 v[56:59], a[108:111], a[12:15], v[56:59]
 v_accvgpr_write_b32 a142, v170
 v_accvgpr_write_b32 a143, v171
 v_mfma_f32_16x16x32_bf16 v[56:59], a[112:115], a[16:19], v[56:59]
 v_accvgpr_write_b32 a144, v176
 v_accvgpr_write_b32 a145, v177
 v_mfma_f32_16x16x32_bf16 v[56:59], a[116:119], a[20:23], v[56:59]
 v_accvgpr_write_b32 a146, v178
 v_accvgpr_write_b32 a147, v179
 v_mfma_f32_16x16x32_bf16 v[56:59], a[120:123], a[24:27], v[56:59]
 v_accvgpr_write_b32 a148, v184
 v_accvgpr_write_b32 a149, v185
 v_mfma_f32_16x16x32_bf16 v[56:59], a[124:127], a[28:31], v[56:59]
 v_accvgpr_write_b32 a150, v186
 v_accvgpr_write_b32 a151, v187
 v_mfma_f32_16x16x32_bf16 v[60:63], a[96:99], a[32:35], 0
 v_lshrrev_b32 v12, 4, v0
 v_lshlrev_b32 v12, 2, v12
 v_mfma_f32_16x16x32_bf16 v[60:63], a[100:103], a[36:39], v[60:63]
 v_and_b32 v13, 15, v0
 v_mfma_f32_16x16x32_bf16 v[60:63], a[104:107], a[40:43], v[60:63]
 s_add_u32 s38, s41, 13312
 buffer_store_dwordx4 a[52:55], v1, s[16:19], s38 offen sc1
 v_mfma_f32_16x16x32_bf16 v[60:63], a[108:111], a[44:47], v[60:63]
 v_sub_u32 v3, v13, v12
 v_mov_b32 v104, 0x3f803f80
 v_mfma_f32_16x16x32_bf16 v[60:63], a[112:115], a[48:51], v[60:63]
 v_mov_b32 v105, 0x3f803f80
 v_mfma_f32_16x16x32_bf16 v[60:63], a[116:119], a[52:55], v[60:63]
 v_mov_b32 v106, 0x3f803f80
 v_mfma_f32_16x16x32_bf16 v[60:63], a[120:123], a[56:59], v[60:63]
 v_mov_b32 v107, 0x3f803f80
 v_mfma_f32_16x16x32_bf16 v[60:63], a[124:127], a[60:63], v[60:63]
 s_barrier
 s_mov_b32 s36, 3
 s_cmp_eq_u32 s26, 0
 s_cselect_b32 s37, 2, 3
 s_cmp_eq_u32 s25, 0
 s_cselect_b32 s37, 1, s37
 s_lshl_b32 s38, 1, s27
 v_mov_b32 v26, s38
 s_mov_b32 s12, 0
 s_cmp_lt_u32 s29, s36
 s_cbranch_scc0 L_nomask0
 s_sub_u32 s38, 2, s29
 s_lshl_b32 s38, s38, 6
 s_lshl_b32 s39, s3, 5
 s_sub_u32 s38, s39, s38
 v_add_u32 v12, s38, v3
 v_cvt_f32_i32 v12, v12
 v_add_f32 v12, 0.5, v12
 v_mul_f32 v12, 0x7149f2ca, v12
 v_add_f32 v13, 0x7349f2ca, v12
 v_min_f32 v36, v36, v13
 v_add_f32 v14, 0x733d539d, v12
 v_min_f32 v37, v37, v14
 v_add_f32 v15, 0x7330b471, v12
 v_min_f32 v38, v38, v15
 v_add_f32 v16, 0x73241544, v12
 v_min_f32 v39, v39, v16
 v_add_f32 v13, 0x0, v12
 v_min_f32 v32, v32, v13
 v_min_f32 v44, v44, v13
 v_add_f32 v14, 0xf149f2ca, v12
 v_min_f32 v33, v33, v14
 v_min_f32 v45, v45, v14
 v_add_f32 v15, 0xf1c9f2ca, v12
 v_min_f32 v34, v34, v15
 v_min_f32 v46, v46, v15
 v_add_f32 v16, 0xf2177617, v12
 v_min_f32 v35, v35, v16
 v_min_f32 v47, v47, v16
 v_add_f32 v13, 0xf349f2ca, v12
 v_min_f32 v40, v40, v13
 v_min_f32 v52, v52, v13
 v_add_f32 v14, 0xf35691f6, v12
 v_min_f32 v41, v41, v14
 v_min_f32 v53, v53, v14
 v_add_f32 v15, 0xf3633123, v12
 v_min_f32 v42, v42, v15
 v_min_f32 v54, v54, v15
 v_add_f32 v16, 0xf36fd050, v12
 v_min_f32 v43, v43, v16
 v_min_f32 v55, v55, v16
 v_add_f32 v13, 0xf3c9f2ca, v12
 v_min_f32 v48, v48, v13
 v_min_f32 v60, v60, v13
 v_add_f32 v14, 0xf3d04260, v12
 v_min_f32 v49, v49, v14
 v_min_f32 v61, v61, v14
 v_add_f32 v15, 0xf3d691f6, v12
 v_min_f32 v50, v50, v15
 v_min_f32 v62, v62, v15
 v_add_f32 v16, 0xf3dce18d, v12
 v_min_f32 v51, v51, v16
 v_min_f32 v63, v63, v16
 v_add_f32 v13, 0xf4177617, v12
 v_min_f32 v56, v56, v13
 v_add_f32 v14, 0xf41a9de3, v12
 v_min_f32 v57, v57, v14
 v_add_f32 v15, 0xf41dc5ae, v12
 v_min_f32 v58, v58, v15
 v_add_f32 v16, 0xf420ed79, v12
 v_min_f32 v59, v59, v16
L_nomask0:
 v_max3_f32 v12, v32, v33, v34
 v_max3_f32 v12, v12, v35, v40
 v_max3_f32 v12, v12, v41, v42
 v_max3_f32 v12, v12, v43, v48
 v_max3_f32 v12, v12, v49, v50
 v_max3_f32 v12, v12, v51, v56
 v_max3_f32 v12, v12, v57, v58
 v_max_f32 v12, v12, v59
 v_max3_f32 v14, v36, v37, v38
 v_max3_f32 v14, v14, v39, v44
 v_max3_f32 v14, v14, v45, v46
 v_max3_f32 v14, v14, v47, v52
 s_add_u32 m0, s32, 32768
 s_add_u32 s35, s30, 0
 buffer_load_dwordx4 v1, s[16:19], s35 offen offset:0 sc1 lds
 v_max3_f32 v14, v14, v53, v54
 v_max3_f32 v14, v14, v55, v60
 v_max3_f32 v14, v14, v61, v62
 v_max_f32 v14, v14, v63
 v_mov_b32 v13, v12
 v_mov_b32 v15, v14
 s_nop 0
 v_permlane16_swap_b32 v12, v13
 v_permlane16_swap_b32 v14, v15
 v_max_f32 v12, v12, v13
 v_max_f32 v14, v14, v15
 v_mov_b32 v13, v12
 v_mov_b32 v15, v14
 buffer_load_dwordx4 v1, s[16:19], s35 offen offset:1024 sc1 lds
 v_permlane32_swap_b32 v12, v13
 v_permlane32_swap_b32 v14, v15
 v_max_f32 v12, v12, v13
 v_max_f32 v14, v14, v15
 v_sub_f32 v12, 0xc0c00000, v12
 v_floor_f32 v12, v12
 v_mov_b32 v13, v12
 v_sub_f32 v14, 0xc0c00000, v14
 v_floor_f32 v14, v14
 v_mov_b32 v15, v14
 v_pk_mov_b32 v[4:5], v[12:13], v[12:13]
 v_pk_mov_b32 v[6:7], v[12:13], v[12:13]
 buffer_load_dwordx4 v1, s[16:19], s35 offen offset:2048 sc1 lds
 v_pk_add_f32 v[32:33], v[32:33], v[12:13]
 v_pk_add_f32 v[34:35], v[34:35], v[12:13]
 v_pk_add_f32 v[40:41], v[40:41], v[12:13]
 v_pk_add_f32 v[42:43], v[42:43], v[12:13]
 v_pk_add_f32 v[48:49], v[48:49], v[12:13]
 v_pk_add_f32 v[50:51], v[50:51], v[12:13]
 v_pk_add_f32 v[56:57], v[56:57], v[12:13]
 v_pk_add_f32 v[58:59], v[58:59], v[12:13]
 v_pk_mov_b32 v[8:9], v[14:15], v[14:15]
 v_pk_mov_b32 v[10:11], v[14:15], v[14:15]
 v_pk_add_f32 v[36:37], v[36:37], v[14:15]
 v_pk_add_f32 v[38:39], v[38:39], v[14:15]
 buffer_load_dwordx4 v1, s[16:19], s35 offen offset:3072 sc1 lds
 v_pk_add_f32 v[44:45], v[44:45], v[14:15]
 v_pk_add_f32 v[46:47], v[46:47], v[14:15]
 v_pk_add_f32 v[52:53], v[52:53], v[14:15]
 v_pk_add_f32 v[54:55], v[54:55], v[14:15]
 v_pk_add_f32 v[60:61], v[60:61], v[14:15]
 v_pk_add_f32 v[62:63], v[62:63], v[14:15]
 v_exp_f32 v12, v32
 v_exp_f32 v13, v33
 v_exp_f32 v14, v34
 v_exp_f32 v15, v35
 v_cvt_pk_bf16_f32 v80, v12, v13
 v_cvt_pk_bf16_f32 v81, v14, v15
 s_add_u32 m0, s32, 36864
 s_add_u32 s35, s30, 4096
 buffer_load_dwordx4 v1, s[16:19], s35 offen offset:0 sc1 lds
 v_or_b32 v24, v80, v81
 v_exp_f32 v16, v36
 v_exp_f32 v17, v37
 v_exp_f32 v18, v38
 v_exp_f32 v19, v39
 v_cvt_pk_bf16_f32 v84, v16, v17
 v_cvt_pk_bf16_f32 v85, v18, v19
 v_or3_b32 v24, v24, v84, v85
 v_exp_f32 v20, v40
 v_exp_f32 v21, v41
 v_exp_f32 v22, v42
 v_exp_f32 v23, v43
 buffer_load_dwordx4 v1, s[16:19], s35 offen offset:1024 sc1 lds
 v_cvt_pk_bf16_f32 v82, v20, v21
 v_cvt_pk_bf16_f32 v83, v22, v23
 v_or3_b32 v24, v24, v82, v83
 v_exp_f32 v12, v44
 v_exp_f32 v13, v45
 v_exp_f32 v14, v46
 v_exp_f32 v15, v47
 v_cvt_pk_bf16_f32 v86, v12, v13
 v_cvt_pk_bf16_f32 v87, v14, v15
 v_or3_b32 v24, v24, v86, v87
 v_exp_f32 v16, v48
 v_exp_f32 v17, v49
 buffer_load_dwordx4 v1, s[16:19], s35 offen offset:2048 sc1 lds
 v_exp_f32 v18, v50
 v_exp_f32 v19, v51
 v_cvt_pk_bf16_f32 v88, v16, v17
 v_cvt_pk_bf16_f32 v89, v18, v19
 v_or3_b32 v24, v24, v88, v89
 v_exp_f32 v20, v52
 v_exp_f32 v21, v53
 v_exp_f32 v22, v54
 v_exp_f32 v23, v55
 v_cvt_pk_bf16_f32 v92, v20, v21
 v_cvt_pk_bf16_f32 v93, v22, v23
 v_or3_b32 v24, v24, v92, v93
 buffer_load_dwordx4 v1, s[16:19], s35 offen offset:3072 sc1 lds
 s_sub_u32 s33, s33, 1
 s_cmp_eq_u32 s33, s28
 s_cselect_b32 s20, s23, 0x8000
 s_cmp_eq_u32 s33, s8
 s_cselect_b32 s20, s9, s20
 s_add_u32 s30, s30, s20
 s_cmp_gt_i32 s33, 0
 s_cselect_b32 s30, s30, 1879048192
 v_exp_f32 v12, v56
 v_exp_f32 v13, v57
 v_exp_f32 v14, v58
 v_exp_f32 v15, v59
 v_cvt_pk_bf16_f32 v90, v12, v13
 v_cvt_pk_bf16_f32 v91, v14, v15
 v_or3_b32 v24, v24, v90, v91
 v_exp_f32 v16, v60
 v_exp_f32 v17, v61
 v_exp_f32 v18, v62
 v_exp_f32 v19, v63
 v_cvt_pk_bf16_f32 v94, v16, v17
 v_cvt_pk_bf16_f32 v95, v18, v19
 v_or3_b32 v24, v24, v94, v95
 s_waitcnt vmcnt(12)
 s_barrier
 ds_read_b128 a[64:67], v1 offset:0
 ds_read_b128 a[68:71], v1 offset:1024
 ds_read_b128 a[72:75], v1 offset:2048
 ds_read_b128 a[76:79], v1 offset:3072
 ds_read_b128 a[80:83], v1 offset:4096
 ds_read_b128 a[84:87], v1 offset:5120
 ds_read_b128 a[88:91], v1 offset:6144
 ds_read_b128 a[92:95], v1 offset:7168
 s_cmp_le_u32 s29, 4
 s_cbranch_scc1 L_slow
L_pk0:
 s_waitcnt lgkmcnt(7)
 v_mfma_f32_16x16x32_bf16 v[32:35], a[64:67], a[0:3], v[4:7]
 s_waitcnt lgkmcnt(6)
 s_add_u32 m0, s32, 65536
 ds_read_b128 a[96:99], v1 offset:8192
 v_mfma_f32_16x16x32_bf16 v[32:35], a[68:71], a[4:7], v[32:35]
 s_waitcnt lgkmcnt(6)
 s_add_u32 s35, s31, 0
 ds_read_b128 a[100:103], v1 offset:9216
 v_mfma_f32_16x16x32_bf16 v[32:35], a[72:75], a[8:11], v[32:35]
 s_waitcnt lgkmcnt(6)
 s_mov_b32 s39, 0x12492493
 buffer_load_dwordx4 v1, s[16:19], s35 offen offset:0 sc1 lds
 v_mfma_f32_16x16x32_bf16 v[32:35], a[76:79], a[12:15], v[32:35]
 s_waitcnt lgkmcnt(5)
 ds_read_b128 a[104:107], v1 offset:10240
 v_add_u32 v28, 0, v0
 v_mfma_f32_16x16x32_bf16 v[32:35], a[80:83], a[16:19], v[32:35]
 s_waitcnt lgkmcnt(3)
 ds_read_b128 a[108:111], v1 offset:11264
 v_mul_hi_u32 v29, v28, s39
 v_mfma_f32_16x16x32_bf16 v[32:35], a[84:87], a[20:23], v[32:35]
 ds_read_b128 a[112:115], v1 offset:12288
 v_mul_u32_u24 v30, 14, v29
 v_mfma_f32_16x16x32_bf16 v[32:35], a[88:91], a[24:27], v[32:35]
 buffer_load_dwordx4 v1, s[16:19], s35 offen offset:1024 sc1 lds
 v_mfma_f32_16x16x32_bf16 v[32:35], a[92:95], a[28:31], v[32:35]
 ds_read_b128 a[116:119], v1 offset:13312
 v_sub_u32 v28, v28, v30
 v_mfma_f32_16x16x32_bf16 v[36:39], a[64:67], a[32:35], v[8:11]
 ds_read_b128 a[120:123], v1 offset:14336
 v_mul_u32_u24 v29, 896, v29
 v_mfma_f32_16x16x32_bf16 v[36:39], a[68:71], a[36:39], v[36:39]
 ds_read_b128 a[124:127], v1 offset:15360
 v_lshl_add_u32 v28, v28, 4, v29
 v_mfma_f32_16x16x32_bf16 v[36:39], a[72:75], a[40:43], v[36:39]
 buffer_load_dwordx4 v1, s[16:19], s35 offen offset:2048 sc1 lds
 v_mfma_f32_16x16x32_bf16 v[36:39], a[76:79], a[44:47], v[36:39]
 ds_read_b128 a[64:67], v1 offset:16384
 v_subrev_u32 v112, 0, v28
 v_mfma_f32_16x16x32_bf16 v[36:39], a[80:83], a[48:51], v[36:39]
 ds_read_b128 a[68:71], v1 offset:17408
 v_add_u32 v28, 64, v0
 v_mfma_f32_16x16x32_bf16 v[36:39], a[84:87], a[52:55], v[36:39]
 ds_read_b128 a[72:75], v1 offset:18432
 v_mul_hi_u32 v29, v28, s39
 v_mfma_f32_16x16x32_bf16 v[36:39], a[88:91], a[56:59], v[36:39]
 buffer_load_dwordx4 v1, s[16:19], s35 offen offset:3072 sc1 lds
 v_mfma_f32_16x16x32_bf16 v[36:39], a[92:95], a[60:63], v[36:39]
 s_waitcnt lgkmcnt(3)
 ds_read_b128 a[76:79], v1 offset:19456
 v_mul_u32_u24 v30, 14, v29
 v_mfma_f32_16x16x32_bf16 v[40:43], a[96:99], a[0:3], v[4:7]
 s_add_u32 m0, s32, 69632
 ds_read_b128 a[80:83], v1 offset:20480
 v_sub_u32 v28, v28, v30
 v_mfma_f32_16x16x32_bf16 v[40:43], a[100:103], a[4:7], v[40:43]
 s_add_u32 s35, s31, 4096
 ds_read_b128 a[84:87], v1 offset:21504
 v_mfma_f32_16x16x32_bf16 v[40:43], a[104:107], a[8:11], v[40:43]
 buffer_load_dwordx4 v1, s[16:19], s35 offen offset:0 sc1 lds
 v_mfma_f32_16x16x32_bf16 v[40:43], a[108:111], a[12:15], v[40:43]
 ds_read_b128 a[88:91], v1 offset:22528
 v_mul_u32_u24 v29, 896, v29
 v_mfma_f32_16x16x32_bf16 v[40:43], a[112:115], a[16:19], v[40:43]
 ds_read_b128 a[92:95], v1 offset:23552
 v_lshl_add_u32 v28, v28, 4, v29
 v_mfma_f32_16x16x32_bf16 v[40:43], a[116:119], a[20:23], v[40:43]
 v_subrev_u32 v113, 1024, v28
 v_mfma_f32_16x16x32_bf16 v[40:43], a[120:123], a[24:27], v[40:43]
 buffer_load_dwordx4 v1, s[16:19], s35 offen offset:1024 sc1 lds
 v_mfma_f32_16x16x32_bf16 v[40:43], a[124:127], a[28:31], v[40:43]
 v_add_u32 v28, 128, v0
 v_mfma_f32_16x16x32_bf16 v[44:47], a[96:99], a[32:35], v[8:11]
 ds_read_b128 a[96:99], v1 offset:24576
 v_mul_hi_u32 v29, v28, s39
 v_mfma_f32_16x16x32_bf16 v[44:47], a[100:103], a[36:39], v[44:47]
 ds_read_b128 a[100:103], v1 offset:25600
 v_mfma_f32_16x16x32_bf16 v[44:47], a[104:107], a[40:43], v[44:47]
 buffer_load_dwordx4 v1, s[16:19], s35 offen offset:2048 sc1 lds
 v_mfma_f32_16x16x32_bf16 v[44:47], a[108:111], a[44:47], v[44:47]
 ds_read_b128 a[104:107], v1 offset:26624
 ds_read_b128 a[108:111], v1 offset:27648
 v_mfma_f32_16x16x32_bf16 v[44:47], a[112:115], a[48:51], v[44:47]
 v_mul_u32_u24 v30, 14, v29
 v_sub_u32 v28, v28, v30
 v_mfma_f32_16x16x32_bf16 v[44:47], a[116:119], a[52:55], v[44:47]
 ds_read_b128 a[112:115], v1 offset:28672
 v_mul_u32_u24 v29, 896, v29
 v_mfma_f32_16x16x32_bf16 v[44:47], a[120:123], a[56:59], v[44:47]
 buffer_load_dwordx4 v1, s[16:19], s35 offen offset:3072 sc1 lds
 v_mfma_f32_16x16x32_bf16 v[44:47], a[124:127], a[60:63], v[44:47]
 s_waitcnt lgkmcnt(3)
 ds_read_b128 a[116:119], v1 offset:29696
 ds_read_b128 a[120:123], v1 offset:30720
 v_mfma_f32_16x16x32_bf16 v[48:51], a[64:67], a[0:3], v[4:7]
 ds_read_b128 a[124:127], v1 offset:31744
 v_lshl_add_u32 v28, v28, 4, v29
 v_mfma_f32_16x16x32_bf16 v[48:51], a[68:71], a[4:7], v[48:51]
 v_exp_f32 v12, v32
 v_mfma_f32_16x16x32_bf16 v[48:51], a[72:75], a[8:11], v[48:51]
 v_mfma_f32_16x16x32_bf16 v[48:51], a[76:79], a[12:15], v[48:51]
 v_exp_f32 v13, v33
 v_mfma_f32_16x16x32_bf16 v[48:51], a[80:83], a[16:19], v[48:51]
 v_mfma_f32_16x16x32_bf16 v[48:51], a[84:87], a[20:23], v[48:51]
 s_add_u32 m0, s32, 0
 v_exp_f32 v14, v34
 v_mfma_f32_16x16x32_bf16 v[48:51], a[88:91], a[24:27], v[48:51]
 s_waitcnt lgkmcnt(0)
 s_barrier
 v_mfma_f32_16x16x32_bf16 v[48:51], a[92:95], a[28:31], v[48:51]
 s_add_u32 s35, s30, 0
 v_exp_f32 v15, v35
 v_mfma_f32_16x16x32_bf16 v[52:55], a[64:67], a[32:35], v[8:11]
 buffer_load_dwordx4 v1, s[16:19], s35 offen offset:0 sc1 lds
 v_mfma_f32_16x16x32_bf16 v[52:55], a[68:71], a[36:39], v[52:55]
 v_mfma_f32_16x16x32_bf16 v[52:55], a[72:75], a[40:43], v[52:55]
 v_cvt_pk_bf16_f32 v64, v12, v13
 v_mfma_f32_16x16x32_bf16 v[52:55], a[76:79], a[44:47], v[52:55]
 v_mfma_f32_16x16x32_bf16 v[52:55], a[80:83], a[48:51], v[52:55]
 s_add_u32 s38, s41, 6144
 buffer_store_dwordx4 a[24:27], v1, s[16:19], s38 offen sc1
 v_mfma_f32_16x16x32_bf16 v[52:55], a[84:87], a[52:55], v[52:55]
 v_exp_f32 v16, v36
 v_mfma_f32_16x16x32_bf16 v[52:55], a[88:91], a[56:59], v[52:55]
 s_sub_u32 s34, s34, 1
 v_exp_f32 v17, v37
 v_mfma_f32_16x16x32_bf16 v[52:55], a[92:95], a[60:63], v[52:55]
 v_cvt_pk_bf16_f32 v65, v14, v15
 v_or_b32 v24, v64, v65
 v_mfma_f32_16x16x32_bf16 v[56:59], a[96:99], a[0:3], v[4:7]
 v_exp_f32 v18, v38
 v_mfma_f32_16x16x32_bf16 v[56:59], a[100:103], a[4:7], v[56:59]
 ds_read_b128 a[64:67], v2 offset:32768
 v_mfma_f32_16x16x32_bf16 v[56:59], a[104:107], a[8:11], v[56:59]
 v_exp_f32 v19, v39
 v_mfma_f32_16x16x32_bf16 v[56:59], a[108:111], a[12:15], v[56:59]
 buffer_load_dwordx4 v1, s[16:19], s35 offen offset:1024 sc1 lds
 v_mfma_f32_16x16x32_bf16 v[56:59], a[112:115], a[16:19], v[56:59]
 ds_read_b128 a[68:71], v2 offset:49152
 ds_read_b128 a[72:75], v2 offset:33792
 v_mfma_f32_16x16x32_bf16 v[56:59], a[116:119], a[20:23], v[56:59]
 s_cmp_eq_u32 s34, s28
 s_cselect_b32 s21, s23, 0x8000
 v_cvt_pk_bf16_f32 v68, v16, v17
 v_mfma_f32_16x16x32_bf16 v[56:59], a[120:123], a[24:27], v[56:59]
 ds_read_b128 a[76:79], v2 offset:50176
 v_mfma_f32_16x16x32_bf16 v[56:59], a[124:127], a[28:31], v[56:59]
 s_add_u32 s38, s41, 14336
 buffer_store_dwordx4 a[56:59], v1, s[16:19], s38 offen sc1
 v_mfma_f32_16x16x32_bf16 v[60:63], a[96:99], a[32:35], v[8:11]
 v_exp_f32 v20, v40
 v_cvt_pk_bf16_f32 v69, v18, v19
 v_mfma_f32_16x16x32_bf16 v[60:63], a[100:103], a[36:39], v[60:63]
 v_exp_f32 v21, v41
 v_or3_b32 v24, v24, v68, v69
 v_mfma_f32_16x16x32_bf16 v[60:63], a[104:107], a[40:43], v[60:63]
 s_cmp_eq_u32 s34, s8
 s_cselect_b32 s21, s9, s21
 ds_read_b128 a[80:83], v2 offset:34816
 ds_read_b128 a[84:87], v2 offset:51200
 v_mfma_f32_16x16x32_bf16 v[60:63], a[108:111], a[44:47], v[60:63]
 v_exp_f32 v22, v42
 v_mfma_f32_16x16x32_bf16 v[60:63], a[112:115], a[48:51], v[60:63]
 s_add_u32 s31, s31, s21
 ds_read_b128 a[88:91], v2 offset:35840
 v_mfma_f32_16x16x32_bf16 v[60:63], a[116:119], a[52:55], v[60:63]
 v_exp_f32 v23, v43
 v_mfma_f32_16x16x32_bf16 v[60:63], a[120:123], a[56:59], v[60:63]
 buffer_load_dwordx4 v1, s[16:19], s35 offen offset:2048 sc1 lds
 v_mfma_f32_16x16x32_bf16 v[60:63], a[124:127], a[60:63], v[60:63]
 ds_read_b128 a[92:95], v2 offset:52224
 v_mfma_f32_16x16x32_bf16 v[96:99], v[104:107], v[80:83], 0
 v_cvt_pk_bf16_f32 v66, v20, v21
 v_mfma_f32_16x16x32_bf16 v[96:99], v[104:107], v[88:91], v[96:99]
 s_cmp_gt_i32 s34, 0
 s_cselect_b32 s31, s31, 1879048192
 v_mfma_f32_16x16x32_bf16 v[100:103], v[104:107], v[84:87], 0
 s_add_u32 s38, s41, 7168
 buffer_store_dwordx4 a[28:31], v1, s[16:19], s38 offen sc1
 v_mfma_f32_16x16x32_bf16 v[100:103], v[104:107], v[92:95], v[100:103]
 s_waitcnt lgkmcnt(1)
 v_exp_f32 v12, v44
 v_cvt_pk_bf16_f32 v67, v22, v23
 v_mfma_f32_16x16x32_bf16 v[128:131], a[64:67], v[80:83], 0
 v_exp_f32 v13, v45
 v_or3_b32 v24, v24, v66, v67
 v_mfma_f32_16x16x32_bf16 v[128:131], a[68:71], v[88:91], v[128:131]
 ds_read_b128 a[96:99], v2 offset:36864
 ds_read_b128 a[100:103], v2 offset:53248
 v_mfma_f32_16x16x32_bf16 v[132:135], a[68:71], v[92:95], 0
 s_sub_u32 s29, s29, 1
 v_exp_f32 v14, v46
 v_mfma_f32_16x16x32_bf16 v[132:135], a[64:67], v[84:87], v[132:135]
 ds_read_b128 a[104:107], v2 offset:37888
 v_mfma_f32_16x16x32_bf16 v[140:143], a[72:75], v[84:87], 0
 v_exp_f32 v15, v47
 v_mfma_f32_16x16x32_bf16 v[140:143], a[76:79], v[92:95], v[140:143]
 buffer_load_dwordx4 v1, s[16:19], s35 offen offset:3072 sc1 lds
 v_mfma_f32_16x16x32_bf16 v[136:139], a[76:79], v[88:91], 0
 ds_read_b128 a[108:111], v2 offset:54272
 ds_read_b128 a[112:115], v2 offset:38912
 v_mfma_f32_16x16x32_bf16 v[136:139], a[72:75], v[80:83], v[136:139]
 s_mov_b32 s12, 1
 v_cvt_pk_bf16_f32 v70, v12, v13
 v_mfma_f32_16x16x32_bf16 v[144:147], a[80:83], v[80:83], 0
 ds_read_b128 a[116:119], v2 offset:55296
 v_mfma_f32_16x16x32_bf16 v[144:147], a[84:87], v[88:91], v[144:147]
 s_add_u32 s38, s41, 15360
 buffer_store_dwordx4 a[60:63], v1, s[16:19], s38 offen sc1
 v_mfma_f32_16x16x32_bf16 v[148:151], a[84:87], v[92:95], 0
 v_exp_f32 v16, v48
 v_cvt_pk_bf16_f32 v71, v14, v15
 v_mfma_f32_16x16x32_bf16 v[148:151], a[80:83], v[84:87], v[148:151]
 v_exp_f32 v17, v49
 v_or3_b32 v24, v24, v70, v71
 v_mfma_f32_16x16x32_bf16 v[156:159], a[88:91], v[84:87], 0
 s_waitcnt lgkmcnt(1)
 ds_read_b128 a[120:123], v2 offset:39936
 ds_read_b128 a[124:127], v2 offset:56320
 v_mfma_f32_16x16x32_bf16 v[156:159], a[92:95], v[92:95], v[156:159]
 v_exp_f32 v18, v50
 v_mfma_f32_16x16x32_bf16 v[152:155], a[92:95], v[88:91], 0
 s_add_u32 m0, s32, 4096
 v_mfma_f32_16x16x32_bf16 v[152:155], a[88:91], v[80:83], v[152:155]
 s_add_u32 s35, s30, 4096
 v_exp_f32 v19, v51
 v_mfma_f32_16x16x32_bf16 v[160:163], a[96:99], v[80:83], 0
 buffer_load_dwordx4 v1, s[16:19], s35 offen offset:0 sc1 lds
 v_mfma_f32_16x16x32_bf16 v[160:163], a[100:103], v[88:91], v[160:163]
 s_mul_i32 s40, s13, 1
 ds_read_b128 a[64:67], v2 offset:40960
 ds_read_b128 a[68:71], v2 offset:57344
 v_mfma_f32_16x16x32_bf16 v[164:167], a[100:103], v[92:95], 0
 s_add_u32 s40, s40, s58
 v_cvt_pk_bf16_f32 v72, v16, v17
 v_mfma_f32_16x16x32_bf16 v[164:167], a[96:99], v[84:87], v[164:167]
 s_add_u32 s40, s40, 524288
 ds_read_b128 a[72:75], v2 offset:41984
 v_mfma_f32_16x16x32_bf16 v[172:175], a[104:107], v[84:87], 0
 buffer_store_dwordx4 a[160:163], v1, s[16:19], s40 offen sc1
 v_cvt_pk_bf16_f32 v73, v18, v19
 v_mfma_f32_16x16x32_bf16 v[172:175], a[108:111], v[92:95], v[172:175]
 v_exp_f32 v20, v52
 v_mfma_f32_16x16x32_bf16 v[168:171], a[108:111], v[88:91], 0
 v_exp_f32 v21, v53
 v_or3_b32 v24, v24, v72, v73
 v_mfma_f32_16x16x32_bf16 v[168:171], a[104:107], v[80:83], v[168:171]
 ds_read_b128 a[76:79], v2 offset:58368
 ds_read_b128 a[80:83], v2 offset:43008
 v_mfma_f32_16x16x32_bf16 v[176:179], a[112:115], v[80:83], 0
 s_waitcnt lgkmcnt(2)
 v_exp_f32 v22, v54
 v_mfma_f32_16x16x32_bf16 v[176:179], a[116:119], v[88:91], v[176:179]
 ds_read_b128 a[84:87], v2 offset:59392
 v_mfma_f32_16x16x32_bf16 v[180:183], a[116:119], v[92:95], 0
 v_exp_f32 v23, v55
 v_mfma_f32_16x16x32_bf16 v[180:183], a[112:115], v[84:87], v[180:183]
 buffer_load_dwordx4 v1, s[16:19], s35 offen offset:1024 sc1 lds
 v_mfma_f32_16x16x32_bf16 v[188:191], a[120:123], v[84:87], 0
 ds_read_b128 a[88:91], v2 offset:44032
 ds_read_b128 a[92:95], v2 offset:60416
 v_mfma_f32_16x16x32_bf16 v[188:191], a[124:127], v[92:95], v[188:191]
 v_cvt_pk_bf16_f32 v76, v20, v21
 v_mfma_f32_16x16x32_bf16 v[184:187], a[124:127], v[88:91], 0
 v_mfma_f32_16x16x32_bf16 v[184:187], a[120:123], v[80:83], v[184:187]
 s_add_u32 s40, s40, s59
 buffer_store_dwordx4 a[164:167], v1, s[16:19], s40 offen sc1
 v_mfma_f32_16x16x32_bf16 v[192:195], a[64:67], v[80:83], 0
 v_exp_f32 v12, v56
 v_cvt_pk_bf16_f32 v77, v22, v23
 v_mfma_f32_16x16x32_bf16 v[192:195], a[68:71], v[88:91], v[192:195]
 v_exp_f32 v13, v57
 v_or3_b32 v24, v24, v76, v77
 v_mfma_f32_16x16x32_bf16 v[196:199], a[68:71], v[92:95], 0
 ds_read_b128 a[96:99], v2 offset:45056
 ds_read_b128 a[100:103], v2 offset:61440
 v_mfma_f32_16x16x32_bf16 v[196:199], a[64:67], v[84:87], v[196:199]
 v_exp_f32 v14, v58
 v_mfma_f32_16x16x32_bf16 v[204:207], a[72:75], v[84:87], 0
 s_waitcnt lgkmcnt(2)
 ds_read_b128 a[104:107], v2 offset:46080
 v_mfma_f32_16x16x32_bf16 v[204:207], a[76:79], v[92:95], v[204:207]
 v_exp_f32 v15, v59
 v_mfma_f32_16x16x32_bf16 v[200:203], a[76:79], v[88:91], 0
 buffer_load_dwordx4 v1, s[16:19], s35 offen offset:2048 sc1 lds
 v_mfma_f32_16x16x32_bf16 v[200:203], a[72:75], v[80:83], v[200:203]
 ds_read_b128 a[108:111], v2 offset:62464
 ds_read_b128 a[112:115], v2 offset:47104
 v_mfma_f32_16x16x32_bf16 v[208:211], a[80:83], v[80:83], 0
 v_cvt_pk_bf16_f32 v74, v12, v13
 v_mfma_f32_16x16x32_bf16 v[208:211], a[84:87], v[88:91], v[208:211]
 ds_read_b128 a[116:119], v2 offset:63488
 v_mfma_f32_16x16x32_bf16 v[212:215], a[84:87], v[92:95], 0
 s_add_u32 s40, s40, s14
 buffer_store_dwordx4 a[168:171], v1, s[16:19], s40 offen sc1
 v_mfma_f32_16x16x32_bf16 v[212:215], a[80:83], v[84:87], v[212:215]
 v_exp_f32 v16, v60
 v_cvt_pk_bf16_f32 v75, v14, v15
 v_mfma_f32_16x16x32_bf16 v[220:223], a[88:91], v[84:87], 0
 v_exp_f32 v17, v61
 v_or3_b32 v24, v24, v74, v75
 v_mfma_f32_16x16x32_bf16 v[220:223], a[92:95], v[92:95], v[220:223]
 ds_read_b128 a[120:123], v2 offset:48128
 ds_read_b128 a[124:127], v2 offset:64512
 v_mfma_f32_16x16x32_bf16 v[216:219], a[92:95], v[88:91], 0
 v_exp_f32 v18, v62
 v_mfma_f32_16x16x32_bf16 v[216:219], a[88:91], v[80:83], v[216:219]
 s_waitcnt lgkmcnt(2)
 v_mfma_f32_16x16x32_bf16 v[224:227], a[96:99], v[80:83], 0
 v_exp_f32 v19, v63
 v_mfma_f32_16x16x32_bf16 v[224:227], a[100:103], v[88:91], v[224:227]
 buffer_load_dwordx4 v1, s[16:19], s35 offen offset:3072 sc1 lds
 v_mfma_f32_16x16x32_bf16 v[228:231], a[100:103], v[92:95], 0
 v_mfma_f32_16x16x32_bf16 v[228:231], a[96:99], v[84:87], v[228:231]
 v_cvt_pk_bf16_f32 v78, v16, v17
 v_mfma_f32_16x16x32_bf16 v[236:239], a[104:107], v[84:87], 0
 s_waitcnt vmcnt(7)
 s_waitcnt lgkmcnt(0)
 s_barrier
 v_mfma_f32_16x16x32_bf16 v[236:239], a[108:111], v[92:95], v[236:239]
 s_add_u32 s40, s40, s59
 buffer_store_dwordx4 a[172:175], v1, s[16:19], s40 offen sc1
 v_mfma_f32_16x16x32_bf16 v[232:235], a[108:111], v[88:91], 0
 s_sub_u32 s33, s33, 1
 ds_read_b128 a[64:67], v1 offset:32768
 ds_read_b128 a[68:71], v1 offset:33792
 v_mfma_f32_16x16x32_bf16 v[232:235], a[104:107], v[80:83], v[232:235]
 ds_read_b128 a[72:75], v1 offset:34816
 v_cvt_pk_bf16_f32 v79, v18, v19
 v_mfma_f32_16x16x32_bf16 v[240:243], a[112:115], v[80:83], 0
 ds_read_b128 a[76:79], v1 offset:35840
 v_or3_b32 v24, v24, v78, v79
 v_mfma_f32_16x16x32_bf16 v[240:243], a[116:119], v[88:91], v[240:243]
 s_cmp_eq_u32 s33, s28
 s_cselect_b32 s20, s23, 0x8000
 ds_read_b128 a[80:83], v1 offset:36864
 v_mfma_f32_16x16x32_bf16 v[244:247], a[116:119], v[92:95], 0
 ds_read_b128 a[84:87], v1 offset:37888
 v_and_b32 v24, 0x40004000, v24
 v_mfma_f32_16x16x32_bf16 v[244:247], a[112:115], v[84:87], v[244:247]
 ds_read_b128 a[88:91], v1 offset:38912
 v_cmp_ne_u32 vcc, 0, v24
 v_mfma_f32_16x16x32_bf16 v[252:255], a[120:123], v[84:87], 0
 s_cmp_eq_u32 s33, s8
 s_cselect_b32 s20, s9, s20
 ds_read_b128 a[92:95], v1 offset:39936
 v_mfma_f32_16x16x32_bf16 v[252:255], a[124:127], v[92:95], v[252:255]
 s_add_u32 s30, s30, s20
 s_cmp_gt_i32 s33, 0
 s_cselect_b32 s30, s30, 1879048192
 v_mfma_f32_16x16x32_bf16 v[248:251], a[124:127], v[88:91], 0
 s_cmp_eq_u32 s26, 0
 s_cselect_b32 s38, s15, 1879048192
 buffer_atomic_add v26, v25, s[16:19], s38 offen offset:8 sc1
 v_mfma_f32_16x16x32_bf16 v[248:251], a[120:123], v[80:83], v[248:251]
 s_cbranch_vccnz L_rare1
L_pk1:
 s_waitcnt lgkmcnt(2)
 v_mfma_f32_16x16x32_bf16 v[32:35], a[64:67], a[0:3], v[4:7]
 s_add_u32 m0, s32, 98304
 ds_read_b128 a[96:99], v1 offset:40960
 v_subrev_u32 v114, 2048, v28
 v_mfma_f32_16x16x32_bf16 v[32:35], a[68:71], a[4:7], v[32:35]
 s_add_u32 s35, s31, 0
 ds_read_b128 a[100:103], v1 offset:41984
 v_add_u32 v28, 192, v0
 v_mfma_f32_16x16x32_bf16 v[32:35], a[72:75], a[8:11], v[32:35]
 buffer_load_dwordx4 v1, s[16:19], s35 offen offset:0 sc1 lds
 v_mfma_f32_16x16x32_bf16 v[32:35], a[76:79], a[12:15], v[32:35]
 ds_read_b128 a[104:107], v1 offset:43008
 v_mul_hi_u32 v29, v28, s39
 v_mfma_f32_16x16x32_bf16 v[32:35], a[80:83], a[16:19], v[32:35]
 ds_read_b128 a[108:111], v1 offset:44032
 v_mul_u32_u24 v30, 14, v29
 v_mfma_f32_16x16x32_bf16 v[32:35], a[84:87], a[20:23], v[32:35]
 s_waitcnt lgkmcnt(3)
 ds_read_b128 a[112:115], v1 offset:45056
 v_mfma_f32_16x16x32_bf16 v[32:35], a[88:91], a[24:27], v[32:35]
 buffer_load_dwordx4 v1, s[16:19], s35 offen offset:1024 sc1 lds
 v_mfma_f32_16x16x32_bf16 v[32:35], a[92:95], a[28:31], v[32:35]
 ds_read_b128 a[116:119], v1 offset:46080
 v_sub_u32 v28, v28, v30
 v_mfma_f32_16x16x32_bf16 v[36:39], a[64:67], a[32:35], v[8:11]
 ds_read_b128 a[120:123], v1 offset:47104
 v_mul_u32_u24 v29, 896, v29
 v_mfma_f32_16x16x32_bf16 v[36:39], a[68:71], a[36:39], v[36:39]
 ds_read_b128 a[124:127], v1 offset:48128
 v_lshl_add_u32 v28, v28, 4, v29
 v_mfma_f32_16x16x32_bf16 v[36:39], a[72:75], a[40:43], v[36:39]
 buffer_load_dwordx4 v1, s[16:19], s35 offen offset:2048 sc1 lds
 v_mfma_f32_16x16x32_bf16 v[36:39], a[76:79], a[44:47], v[36:39]
 ds_read_b128 a[64:67], v1 offset:49152
 v_subrev_u32 v115, 3072, v28
 v_mfma_f32_16x16x32_bf16 v[36:39], a[80:83], a[48:51], v[36:39]
 ds_read_b128 a[68:71], v1 offset:50176
 v_add_u32 v28, 256, v0
 v_mfma_f32_16x16x32_bf16 v[36:39], a[84:87], a[52:55], v[36:39]
 ds_read_b128 a[72:75], v1 offset:51200
 v_mfma_f32_16x16x32_bf16 v[36:39], a[88:91], a[56:59], v[36:39]
 buffer_load_dwordx4 v1, s[16:19], s35 offen offset:3072 sc1 lds
 v_mfma_f32_16x16x32_bf16 v[36:39], a[92:95], a[60:63], v[36:39]
 ds_read_b128 a[76:79], v1 offset:52224
 v_mul_hi_u32 v29, v28, s39
 v_mfma_f32_16x16x32_bf16 v[40:43], a[96:99], a[0:3], v[4:7]
 s_waitcnt lgkmcnt(3)
 s_add_u32 m0, s32, 102400
 ds_read_b128 a[80:83], v1 offset:53248
 v_mul_u32_u24 v30, 14, v29
 v_mfma_f32_16x16x32_bf16 v[40:43], a[100:103], a[4:7], v[40:43]
 s_add_u32 s35, s31, 4096
 ds_read_b128 a[84:87], v1 offset:54272
 v_sub_u32 v28, v28, v30
 v_mfma_f32_16x16x32_bf16 v[40:43], a[104:107], a[8:11], v[40:43]
 buffer_load_dwordx4 v1, s[16:19], s35 offen offset:0 sc1 lds
 v_mfma_f32_16x16x32_bf16 v[40:43], a[108:111], a[12:15], v[40:43]
 ds_read_b128 a[88:91], v1 offset:55296
 v_mul_u32_u24 v29, 896, v29
 v_mfma_f32_16x16x32_bf16 v[40:43], a[112:115], a[16:19], v[40:43]
 ds_read_b128 a[92:95], v1 offset:56320
 v_lshl_add_u32 v28, v28, 4, v29
 v_mfma_f32_16x16x32_bf16 v[40:43], a[116:119], a[20:23], v[40:43]
 v_mfma_f32_16x16x32_bf16 v[40:43], a[120:123], a[24:27], v[40:43]
 buffer_load_dwordx4 v1, s[16:19], s35 offen offset:1024 sc1 lds
 v_mfma_f32_16x16x32_bf16 v[40:43], a[124:127], a[28:31], v[40:43]
 v_subrev_u32 v116, 0, v28
 v_add_u32 v28, 320, v0
 v_mfma_f32_16x16x32_bf16 v[44:47], a[96:99], a[32:35], v[8:11]
 ds_read_b128 a[96:99], v1 offset:57344
 v_mfma_f32_16x16x32_bf16 v[44:47], a[100:103], a[36:39], v[44:47]
 ds_read_b128 a[100:103], v1 offset:58368
 v_mul_hi_u32 v29, v28, s39
 v_mfma_f32_16x16x32_bf16 v[44:47], a[104:107], a[40:43], v[44:47]
 buffer_load_dwordx4 v1, s[16:19], s35 offen offset:2048 sc1 lds
 v_mfma_f32_16x16x32_bf16 v[44:47], a[108:111], a[44:47], v[44:47]
 ds_read_b128 a[104:107], v1 offset:59392
 ds_read_b128 a[108:111], v1 offset:60416
 v_mfma_f32_16x16x32_bf16 v[44:47], a[112:115], a[48:51], v[44:47]
 v_mul_u32_u24 v30, 14, v29
 v_sub_u32 v28, v28, v30
 v_mfma_f32_16x16x32_bf16 v[44:47], a[116:119], a[52:55], v[44:47]
 ds_read_b128 a[112:115], v1 offset:61440
 v_mul_u32_u24 v29, 896, v29
 v_mfma_f32_16x16x32_bf16 v[44:47], a[120:123], a[56:59], v[44:47]
 buffer_load_dwordx4 v1, s[16:19], s35 offen offset:3072 sc1 lds
 v_mfma_f32_16x16x32_bf16 v[44:47], a[124:127], a[60:63], v[44:47]
 ds_read_b128 a[116:119], v1 offset:62464
 ds_read_b128 a[120:123], v1 offset:63488
 v_mfma_f32_16x16x32_bf16 v[48:51], a[64:67], a[0:3], v[4:7]
 s_waitcnt lgkmcnt(3)
 ds_read_b128 a[124:127], v1 offset:64512
 v_lshl_add_u32 v28, v28, 4, v29
 v_mfma_f32_16x16x32_bf16 v[48:51], a[68:71], a[4:7], v[48:51]
 v_exp_f32 v12, v32
 v_mfma_f32_16x16x32_bf16 v[48:51], a[72:75], a[8:11], v[48:51]
 v_mfma_f32_16x16x32_bf16 v[48:51], a[76:79], a[12:15], v[48:51]
 v_exp_f32 v13, v33
 v_mfma_f32_16x16x32_bf16 v[48:51], a[80:83], a[16:19], v[48:51]
 v_mfma_f32_16x16x32_bf16 v[48:51], a[84:87], a[20:23], v[48:51]
 s_add_u32 m0, s32, 32768
 v_exp_f32 v14, v34
 v_mfma_f32_16x16x32_bf16 v[48:51], a[88:91], a[24:27], v[48:51]
 s_waitcnt lgkmcnt(0)
 s_barrier
 v_mfma_f32_16x16x32_bf16 v[48:51], a[92:95], a[28:31], v[48:51]
 s_add_u32 s35, s30, 0
 v_exp_f32 v15, v35
 v_mfma_f32_16x16x32_bf16 v[52:55], a[64:67], a[32:35], v[8:11]
 buffer_load_dwordx4 v1, s[16:19], s35 offen offset:0 sc1 lds
 v_mfma_f32_16x16x32_bf16 v[52:55], a[68:71], a[36:39], v[52:55]
 v_mfma_f32_16x16x32_bf16 v[52:55], a[72:75], a[40:43], v[52:55]
 v_cvt_pk_bf16_f32 v80, v12, v13
 v_mfma_f32_16x16x32_bf16 v[52:55], a[76:79], a[44:47], v[52:55]
 v_mfma_f32_16x16x32_bf16 v[52:55], a[80:83], a[48:51], v[52:55]
 s_add_u32 s40, s40, s14
 buffer_store_dwordx4 a[176:179], v1, s[16:19], s40 offen sc1
 v_mfma_f32_16x16x32_bf16 v[52:55], a[84:87], a[52:55], v[52:55]
 v_exp_f32 v16, v36
 v_mfma_f32_16x16x32_bf16 v[52:55], a[88:91], a[56:59], v[52:55]
 s_sub_u32 s34, s34, 1
 v_exp_f32 v17, v37
 v_mfma_f32_16x16x32_bf16 v[52:55], a[92:95], a[60:63], v[52:55]
 v_cvt_pk_bf16_f32 v81, v14, v15
 v_or_b32 v24, v80, v81
 v_mfma_f32_16x16x32_bf16 v[56:59], a[96:99], a[0:3], v[4:7]
 v_exp_f32 v18, v38
 v_mfma_f32_16x16x32_bf16 v[56:59], a[100:103], a[4:7], v[56:59]
 ds_read_b128 a[64:67], v2 offset:0
 v_mfma_f32_16x16x32_bf16 v[56:59], a[104:107], a[8:11], v[56:59]
 v_exp_f32 v19, v39
 v_mfma_f32_16x16x32_bf16 v[56:59], a[108:111], a[12:15], v[56:59]
 buffer_load_dwordx4 v1, s[16:19], s35 offen offset:1024 sc1 lds
 v_mfma_f32_16x16x32_bf16 v[56:59], a[112:115], a[16:19], v[56:59]
 ds_read_b128 a[68:71], v2 offset:16384
 ds_read_b128 a[72:75], v2 offset:1024
 v_mfma_f32_16x16x32_bf16 v[56:59], a[116:119], a[20:23], v[56:59]
 s_cmp_eq_u32 s34, s28
 s_cselect_b32 s21, s23, 0x8000
 v_cvt_pk_bf16_f32 v84, v16, v17
 v_mfma_f32_16x16x32_bf16 v[56:59], a[120:123], a[24:27], v[56:59]
 ds_read_b128 a[76:79], v2 offset:17408
 v_mfma_f32_16x16x32_bf16 v[56:59], a[124:127], a[28:31], v[56:59]
 s_add_u32 s40, s40, s59
 buffer_store_dwordx4 a[180:183], v1, s[16:19], s40 offen sc1
 v_mfma_f32_16x16x32_bf16 v[60:63], a[96:99], a[32:35], v[8:11]
 v_exp_f32 v20, v40
 v_cvt_pk_bf16_f32 v85, v18, v19
 v_mfma_f32_16x16x32_bf16 v[60:63], a[100:103], a[36:39], v[60:63]
 v_exp_f32 v21, v41
 v_or3_b32 v24, v24, v84, v85
 v_mfma_f32_16x16x32_bf16 v[60:63], a[104:107], a[40:43], v[60:63]
 s_cmp_eq_u32 s34, s8
 s_cselect_b32 s21, s9, s21
 ds_read_b128 a[80:83], v2 offset:2048
 ds_read_b128 a[84:87], v2 offset:18432
 v_mfma_f32_16x16x32_bf16 v[60:63], a[108:111], a[44:47], v[60:63]
 v_exp_f32 v22, v42
 v_mfma_f32_16x16x32_bf16 v[60:63], a[112:115], a[48:51], v[60:63]
 s_add_u32 s31, s31, s21
 ds_read_b128 a[88:91], v2 offset:3072
 v_mfma_f32_16x16x32_bf16 v[60:63], a[116:119], a[52:55], v[60:63]
 v_exp_f32 v23, v43
 v_mfma_f32_16x16x32_bf16 v[60:63], a[120:123], a[56:59], v[60:63]
 buffer_load_dwordx4 v1, s[16:19], s35 offen offset:2048 sc1 lds
 v_mfma_f32_16x16x32_bf16 v[60:63], a[124:127], a[60:63], v[60:63]
 ds_read_b128 a[92:95], v2 offset:19456
 v_mfma_f32_16x16x32_bf16 v[96:99], v[104:107], v[64:67], v[96:99]
 v_cvt_pk_bf16_f32 v82, v20, v21
 v_mfma_f32_16x16x32_bf16 v[96:99], v[104:107], v[72:75], v[96:99]
 s_cmp_gt_i32 s34, 0
 s_cselect_b32 s31, s31, 1879048192
 v_mfma_f32_16x16x32_bf16 v[100:103], v[104:107], v[68:71], v[100:103]
 s_add_u32 s40, s40, s14
 buffer_store_dwordx4 a[184:187], v1, s[16:19], s40 offen sc1
 v_mfma_f32_16x16x32_bf16 v[100:103], v[104:107], v[76:79], v[100:103]
 s_waitcnt lgkmcnt(1)
 v_exp_f32 v12, v44
 v_cvt_pk_bf16_f32 v83, v22, v23
 v_mfma_f32_16x16x32_bf16 v[128:131], a[64:67], v[64:67], v[128:131]
 v_exp_f32 v13, v45
 v_or3_b32 v24, v24, v82, v83
 v_mfma_f32_16x16x32_bf16 v[128:131], a[68:71], v[72:75], v[128:131]
 ds_read_b128 a[96:99], v2 offset:4096
 ds_read_b128 a[100:103], v2 offset:20480
 v_mfma_f32_16x16x32_bf16 v[132:135], a[68:71], v[76:79], v[132:135]
 s_sub_u32 s29, s29, 1
 v_exp_f32 v14, v46
 v_mfma_f32_16x16x32_bf16 v[132:135], a[64:67], v[68:71], v[132:135]
 ds_read_b128 a[104:107], v2 offset:5120
 v_mfma_f32_16x16x32_bf16 v[140:143], a[72:75], v[68:71], v[140:143]
 v_exp_f32 v15, v47
 v_mfma_f32_16x16x32_bf16 v[140:143], a[76:79], v[76:79], v[140:143]
 buffer_load_dwordx4 v1, s[16:19], s35 offen offset:3072 sc1 lds
 v_mfma_f32_16x16x32_bf16 v[136:139], a[76:79], v[72:75], v[136:139]
 ds_read_b128 a[108:111], v2 offset:21504
 ds_read_b128 a[112:115], v2 offset:6144
 v_mfma_f32_16x16x32_bf16 v[136:139], a[72:75], v[64:67], v[136:139]
 s_mov_b32 s12, 2
 v_cvt_pk_bf16_f32 v86, v12, v13
 v_mfma_f32_16x16x32_bf16 v[144:147], a[80:83], v[64:67], v[144:147]
 ds_read_b128 a[116:119], v2 offset:22528
 v_mfma_f32_16x16x32_bf16 v[144:147], a[84:87], v[72:75], v[144:147]
 s_add_u32 s40, s40, s59
 buffer_store_dwordx4 a[188:191], v1, s[16:19], s40 offen sc1
 v_mfma_f32_16x16x32_bf16 v[148:151], a[84:87], v[76:79], v[148:151]
 v_exp_f32 v16, v48
 v_cvt_pk_bf16_f32 v87, v14, v15
 v_mfma_f32_16x16x32_bf16 v[148:151], a[80:83], v[68:71], v[148:151]
 v_exp_f32 v17, v49
 v_or3_b32 v24, v24, v86, v87
 v_mfma_f32_16x16x32_bf16 v[156:159], a[88:91], v[68:71], v[156:159]
 s_waitcnt lgkmcnt(1)
 ds_read_b128 a[120:123], v2 offset:7168
 ds_read_b128 a[124:127], v2 offset:23552
 v_mfma_f32_16x16x32_bf16 v[156:159], a[92:95], v[76:79], v[156:159]
 v_exp_f32 v18, v50
 v_mfma_f32_16x16x32_bf16 v[152:155], a[92:95], v[72:75], v[152:155]
 s_add_u32 m0, s32, 36864
 v_mfma_f32_16x16x32_bf16 v[152:155], a[88:91], v[64:67], v[152:155]
 s_add_u32 s35, s30, 4096
 v_exp_f32 v19, v51
 v_mfma_f32_16x16x32_bf16 v[160:163], a[96:99], v[64:67], v[160:163]
 buffer_load_dwordx4 v1, s[16:19], s35 offen offset:0 sc1 lds
 v_mfma_f32_16x16x32_bf16 v[160:163], a[100:103], v[72:75], v[160:163]
 s_mul_i32 s40, s13, 0
 ds_read_b128 a[64:67], v2 offset:8192
 ds_read_b128 a[68:71], v2 offset:24576
 v_mfma_f32_16x16x32_bf16 v[164:167], a[100:103], v[76:79], v[164:167]
 s_add_u32 s40, s40, s58
 v_cvt_pk_bf16_f32 v88, v16, v17
 v_mfma_f32_16x16x32_bf16 v[164:167], a[96:99], v[68:71], v[164:167]
 s_add_u32 s40, s40, 524288
 ds_read_b128 a[72:75], v2 offset:9216
 v_mfma_f32_16x16x32_bf16 v[172:175], a[104:107], v[68:71], v[172:175]
 buffer_store_dwordx4 a[128:131], v1, s[16:19], s40 offen sc1
 v_cvt_pk_bf16_f32 v89, v18, v19
 v_mfma_f32_16x16x32_bf16 v[172:175], a[108:111], v[76:79], v[172:175]
 v_exp_f32 v20, v52
 v_mfma_f32_16x16x32_bf16 v[168:171], a[108:111], v[72:75], v[168:171]
 v_exp_f32 v21, v53
 v_or3_b32 v24, v24, v88, v89
 v_mfma_f32_16x16x32_bf16 v[168:171], a[104:107], v[64:67], v[168:171]
 ds_read_b128 a[76:79], v2 offset:25600
 ds_read_b128 a[80:83], v2 offset:10240
 v_mfma_f32_16x16x32_bf16 v[176:179], a[112:115], v[64:67], v[176:179]
 s_waitcnt lgkmcnt(2)
 v_exp_f32 v22, v54
 v_mfma_f32_16x16x32_bf16 v[176:179], a[116:119], v[72:75], v[176:179]
 ds_read_b128 a[84:87], v2 offset:26624
 v_mfma_f32_16x16x32_bf16 v[180:183], a[116:119], v[76:79], v[180:183]
 v_exp_f32 v23, v55
 v_mfma_f32_16x16x32_bf16 v[180:183], a[112:115], v[68:71], v[180:183]
 buffer_load_dwordx4 v1, s[16:19], s35 offen offset:1024 sc1 lds
 v_mfma_f32_16x16x32_bf16 v[188:191], a[120:123], v[68:71], v[188:191]
 ds_read_b128 a[88:91], v2 offset:11264
 ds_read_b128 a[92:95], v2 offset:27648
 v_mfma_f32_16x16x32_bf16 v[188:191], a[124:127], v[76:79], v[188:191]
 v_cvt_pk_bf16_f32 v92, v20, v21
 v_mfma_f32_16x16x32_bf16 v[184:187], a[124:127], v[72:75], v[184:187]
 v_mfma_f32_16x16x32_bf16 v[184:187], a[120:123], v[64:67], v[184:187]
 s_add_u32 s40, s40, s59
 buffer_store_dwordx4 a[132:135], v1, s[16:19], s40 offen sc1
 v_mfma_f32_16x16x32_bf16 v[192:195], a[64:67], v[64:67], v[192:195]
 v_exp_f32 v12, v56
 v_cvt_pk_bf16_f32 v93, v22, v23
 v_mfma_f32_16x16x32_bf16 v[192:195], a[68:71], v[72:75], v[192:195]
 v_exp_f32 v13, v57
 v_or3_b32 v24, v24, v92, v93
 v_mfma_f32_16x16x32_bf16 v[196:199], a[68:71], v[76:79], v[196:199]
 ds_read_b128 a[96:99], v2 offset:12288
 ds_read_b128 a[100:103], v2 offset:28672
 v_mfma_f32_16x16x32_bf16 v[196:199], a[64:67], v[68:71], v[196:199]
 v_exp_f32 v14, v58
 v_mfma_f32_16x16x32_bf16 v[204:207], a[72:75], v[68:71], v[204:207]
 s_waitcnt lgkmcnt(2)
 ds_read_b128 a[104:107], v2 offset:13312
 v_mfma_f32_16x16x32_bf16 v[204:207], a[76:79], v[76:79], v[204:207]
 v_exp_f32 v15, v59
 v_mfma_f32_16x16x32_bf16 v[200:203], a[76:79], v[72:75], v[200:203]
 buffer_load_dwordx4 v1, s[16:19], s35 offen offset:2048 sc1 lds
 v_mfma_f32_16x16x32_bf16 v[200:203], a[72:75], v[64:67], v[200:203]
 ds_read_b128 a[108:111], v2 offset:29696
 ds_read_b128 a[112:115], v2 offset:14336
 v_mfma_f32_16x16x32_bf16 v[208:211], a[80:83], v[64:67], v[208:211]
 v_cvt_pk_bf16_f32 v90, v12, v13
 v_mfma_f32_16x16x32_bf16 v[208:211], a[84:87], v[72:75], v[208:211]
 ds_read_b128 a[116:119], v2 offset:30720
 v_mfma_f32_16x16x32_bf16 v[212:215], a[84:87], v[76:79], v[212:215]
 s_add_u32 s40, s40, s14
 buffer_store_dwordx4 a[136:139], v1, s[16:19], s40 offen sc1
 v_mfma_f32_16x16x32_bf16 v[212:215], a[80:83], v[68:71], v[212:215]
 v_exp_f32 v16, v60
 v_cvt_pk_bf16_f32 v91, v14, v15
 v_mfma_f32_16x16x32_bf16 v[220:223], a[88:91], v[68:71], v[220:223]
 v_exp_f32 v17, v61
 v_or3_b32 v24, v24, v90, v91
 v_mfma_f32_16x16x32_bf16 v[220:223], a[92:95], v[76:79], v[220:223]
 ds_read_b128 a[120:123], v2 offset:15360
 ds_read_b128 a[124:127], v2 offset:31744
 v_mfma_f32_16x16x32_bf16 v[216:219], a[92:95], v[72:75], v[216:219]
 v_exp_f32 v18, v62
 v_mfma_f32_16x16x32_bf16 v[216:219], a[88:91], v[64:67], v[216:219]
 s_waitcnt lgkmcnt(2)
 v_mfma_f32_16x16x32_bf16 v[224:227], a[96:99], v[64:67], v[224:227]
 v_exp_f32 v19, v63
 v_mfma_f32_16x16x32_bf16 v[224:227], a[100:103], v[72:75], v[224:227]
 buffer_load_dwordx4 v1, s[16:19], s35 offen offset:3072 sc1 lds
 v_mfma_f32_16x16x32_bf16 v[228:231], a[100:103], v[76:79], v[228:231]
 v_mfma_f32_16x16x32_bf16 v[228:231], a[96:99], v[68:71], v[228:231]
 v_cvt_pk_bf16_f32 v94, v16, v17
 v_mfma_f32_16x16x32_bf16 v[236:239], a[104:107], v[68:71], v[236:239]
 s_waitcnt vmcnt(25)
 s_waitcnt lgkmcnt(0)
 s_barrier
 v_mfma_f32_16x16x32_bf16 v[236:239], a[108:111], v[76:79], v[236:239]
 s_add_u32 s40, s40, s59
 buffer_store_dwordx4 a[140:143], v1, s[16:19], s40 offen sc1
 v_mfma_f32_16x16x32_bf16 v[232:235], a[108:111], v[72:75], v[232:235]
 s_sub_u32 s33, s33, 1
 ds_read_b128 a[64:67], v1 offset:0
 ds_read_b128 a[68:71], v1 offset:1024
 v_mfma_f32_16x16x32_bf16 v[232:235], a[104:107], v[64:67], v[232:235]
 ds_read_b128 a[72:75], v1 offset:2048
 v_cvt_pk_bf16_f32 v95, v18, v19
 v_mfma_f32_16x16x32_bf16 v[240:243], a[112:115], v[64:67], v[240:243]
 ds_read_b128 a[76:79], v1 offset:3072
 v_or3_b32 v24, v24, v94, v95
 v_mfma_f32_16x16x32_bf16 v[240:243], a[116:119], v[72:75], v[240:243]
 s_cmp_eq_u32 s33, s28
 s_cselect_b32 s20, s23, 0x8000
 ds_read_b128 a[80:83], v1 offset:4096
 v_mfma_f32_16x16x32_bf16 v[244:247], a[116:119], v[76:79], v[244:247]
 ds_read_b128 a[84:87], v1 offset:5120
 v_and_b32 v24, 0x40004000, v24
 v_mfma_f32_16x16x32_bf16 v[244:247], a[112:115], v[68:71], v[244:247]
 ds_read_b128 a[88:91], v1 offset:6144
 v_cmp_ne_u32 vcc, 0, v24
 v_mfma_f32_16x16x32_bf16 v[252:255], a[120:123], v[68:71], v[252:255]
 s_cmp_eq_u32 s33, s8
 s_cselect_b32 s20, s9, s20
 ds_read_b128 a[92:95], v1 offset:7168
 v_mfma_f32_16x16x32_bf16 v[252:255], a[124:127], v[76:79], v[252:255]
 s_add_u32 s30, s30, s20
 s_cmp_gt_i32 s33, 0
 s_cselect_b32 s30, s30, 1879048192
 v_mfma_f32_16x16x32_bf16 v[248:251], a[124:127], v[72:75], v[248:251]
 v_mfma_f32_16x16x32_bf16 v[248:251], a[120:123], v[64:67], v[248:251]
 s_cbranch_vccnz L_rare0
L_pk2:
 s_waitcnt lgkmcnt(2)
 v_mfma_f32_16x16x32_bf16 v[32:35], a[64:67], a[0:3], v[4:7]
 s_add_u32 m0, s32, 65536
 ds_read_b128 a[96:99], v1 offset:8192
 v_subrev_u32 v117, 1024, v28
 v_mfma_f32_16x16x32_bf16 v[32:35], a[68:71], a[4:7], v[32:35]
 s_add_u32 s35, s31, 0
 ds_read_b128 a[100:103], v1 offset:9216
 v_add_u32 v28, 384, v0
 v_mfma_f32_16x16x32_bf16 v[32:35], a[72:75], a[8:11], v[32:35]
 buffer_load_dwordx4 v1, s[16:19], s35 offen offset:0 sc1 lds
 v_mfma_f32_16x16x32_bf16 v[32:35], a[76:79], a[12:15], v[32:35]
 ds_read_b128 a[104:107], v1 offset:10240
 v_mul_hi_u32 v29, v28, s39
 v_mfma_f32_16x16x32_bf16 v[32:35], a[80:83], a[16:19], v[32:35]
 ds_read_b128 a[108:111], v1 offset:11264
 v_mul_u32_u24 v30, 14, v29
 v_mfma_f32_16x16x32_bf16 v[32:35], a[84:87], a[20:23], v[32:35]
 s_waitcnt lgkmcnt(3)
 ds_read_b128 a[112:115], v1 offset:12288
 v_mfma_f32_16x16x32_bf16 v[32:35], a[88:91], a[24:27], v[32:35]
 buffer_load_dwordx4 v1, s[16:19], s35 offen offset:1024 sc1 lds
 v_mfma_f32_16x16x32_bf16 v[32:35], a[92:95], a[28:31], v[32:35]
 ds_read_b128 a[116:119], v1 offset:13312
 v_sub_u32 v28, v28, v30
 v_mfma_f32_16x16x32_bf16 v[36:39], a[64:67], a[32:35], v[8:11]
 ds_read_b128 a[120:123], v1 offset:14336
 v_mul_u32_u24 v29, 896, v29
 v_mfma_f32_16x16x32_bf16 v[36:39], a[68:71], a[36:39], v[36:39]
 ds_read_b128 a[124:127], v1 offset:15360
 v_lshl_add_u32 v28, v28, 4, v29
 v_mfma_f32_16x16x32_bf16 v[36:39], a[72:75], a[40:43], v[36:39]
 buffer_load_dwordx4 v1, s[16:19], s35 offen offset:2048 sc1 lds
 v_mfma_f32_16x16x32_bf16 v[36:39], a[76:79], a[44:47], v[36:39]
 ds_read_b128 a[64:67], v1 offset:16384
 v_subrev_u32 v118, 2048, v28
 v_mfma_f32_16x16x32_bf16 v[36:39], a[80:83], a[48:51], v[36:39]
 ds_read_b128 a[68:71], v1 offset:17408
 v_lshrrev_b32 v28, 3, v0
 v_mfma_f32_16x16x32_bf16 v[36:39], a[84:87], a[52:55], v[36:39]
 ds_read_b128 a[72:75], v1 offset:18432
 v_mfma_f32_16x16x32_bf16 v[36:39], a[88:91], a[56:59], v[36:39]
 buffer_load_dwordx4 v1, s[16:19], s35 offen offset:3072 sc1 lds
 v_mfma_f32_16x16x32_bf16 v[36:39], a[92:95], a[60:63], v[36:39]
 ds_read_b128 a[76:79], v1 offset:19456
 v_mul_u32_u24 v29, 896, v28
 v_mfma_f32_16x16x32_bf16 v[40:43], a[96:99], a[0:3], v[4:7]
 s_waitcnt lgkmcnt(3)
 s_add_u32 m0, s32, 69632
 ds_read_b128 a[80:83], v1 offset:20480
 v_and_b32 v28, 6, v28
 v_mfma_f32_16x16x32_bf16 v[40:43], a[100:103], a[4:7], v[40:43]
 s_add_u32 s35, s31, 4096
 ds_read_b128 a[84:87], v1 offset:21504
 v_and_b32 v30, 7, v0
 v_mfma_f32_16x16x32_bf16 v[40:43], a[104:107], a[8:11], v[40:43]
 buffer_load_dwordx4 v1, s[16:19], s35 offen offset:0 sc1 lds
 v_mfma_f32_16x16x32_bf16 v[40:43], a[108:111], a[12:15], v[40:43]
 ds_read_b128 a[88:91], v1 offset:22528
 v_xor_b32 v28, v28, v30
 v_mfma_f32_16x16x32_bf16 v[40:43], a[112:115], a[16:19], v[40:43]
 ds_read_b128 a[92:95], v1 offset:23552
 v_lshl_add_u32 v31, v28, 4, v29
 v_mfma_f32_16x16x32_bf16 v[40:43], a[116:119], a[20:23], v[40:43]
 v_mfma_f32_16x16x32_bf16 v[40:43], a[120:123], a[24:27], v[40:43]
 buffer_load_dwordx4 v1, s[16:19], s35 offen offset:1024 sc1 lds
 v_mfma_f32_16x16x32_bf16 v[40:43], a[124:127], a[28:31], v[40:43]
 v_lshrrev_b32 v28, 2, v0
 v_lshlrev_b32 v28, 7, v28
 v_mfma_f32_16x16x32_bf16 v[44:47], a[96:99], a[32:35], v[8:11]
 ds_read_b128 a[96:99], v1 offset:24576
 v_mfma_f32_16x16x32_bf16 v[44:47], a[100:103], a[36:39], v[44:47]
 ds_read_b128 a[100:103], v1 offset:25600
 v_bfe_u32 v29, v0, 3, 2
 v_mfma_f32_16x16x32_bf16 v[44:47], a[104:107], a[40:43], v[44:47]
 buffer_load_dwordx4 v1, s[16:19], s35 offen offset:2048 sc1 lds
 v_mfma_f32_16x16x32_bf16 v[44:47], a[108:111], a[44:47], v[44:47]
 ds_read_b128 a[104:107], v1 offset:26624
 ds_read_b128 a[108:111], v1 offset:27648
 v_mfma_f32_16x16x32_bf16 v[44:47], a[112:115], a[48:51], v[44:47]
 v_lshl_add_u32 v28, v29, 5, v28
 v_and_b32 v29, 3, v0
 v_mfma_f32_16x16x32_bf16 v[44:47], a[116:119], a[52:55], v[44:47]
 ds_read_b128 a[112:115], v1 offset:28672
 v_lshl_add_u32 v119, v29, 3, v28
 v_mfma_f32_16x16x32_bf16 v[44:47], a[120:123], a[56:59], v[44:47]
 buffer_load_dwordx4 v1, s[16:19], s35 offen offset:3072 sc1 lds
 v_mfma_f32_16x16x32_bf16 v[44:47], a[124:127], a[60:63], v[44:47]
 ds_read_b128 a[116:119], v1 offset:29696
 ds_read_b128 a[120:123], v1 offset:30720
 v_mfma_f32_16x16x32_bf16 v[48:51], a[64:67], a[0:3], v[4:7]
 s_waitcnt lgkmcnt(3)
 ds_read_b128 a[124:127], v1 offset:31744
 v_mov_b32 v28, 1
 v_mfma_f32_16x16x32_bf16 v[48:51], a[68:71], a[4:7], v[48:51]
 v_exp_f32 v12, v32
 v_mfma_f32_16x16x32_bf16 v[48:51], a[72:75], a[8:11], v[48:51]
 v_mfma_f32_16x16x32_bf16 v[48:51], a[76:79], a[12:15], v[48:51]
 v_exp_f32 v13, v33
 v_mfma_f32_16x16x32_bf16 v[48:51], a[80:83], a[16:19], v[48:51]
 v_mfma_f32_16x16x32_bf16 v[48:51], a[84:87], a[20:23], v[48:51]
 s_add_u32 m0, s32, 0
 v_exp_f32 v14, v34
 v_mfma_f32_16x16x32_bf16 v[48:51], a[88:91], a[24:27], v[48:51]
 s_waitcnt vmcnt(24)
 s_waitcnt lgkmcnt(0)
 s_barrier
 v_mfma_f32_16x16x32_bf16 v[48:51], a[92:95], a[28:31], v[48:51]
 s_add_u32 s35, s30, 0
 v_exp_f32 v15, v35
 v_mfma_f32_16x16x32_bf16 v[52:55], a[64:67], a[32:35], v[8:11]
 buffer_load_dwordx4 v1, s[16:19], s35 offen offset:0 sc1 lds
 v_mfma_f32_16x16x32_bf16 v[52:55], a[68:71], a[36:39], v[52:55]
 v_mfma_f32_16x16x32_bf16 v[52:55], a[72:75], a[40:43], v[52:55]
 v_cvt_pk_bf16_f32 v64, v12, v13
 v_mfma_f32_16x16x32_bf16 v[52:55], a[76:79], a[44:47], v[52:55]
 v_mfma_f32_16x16x32_bf16 v[52:55], a[80:83], a[48:51], v[52:55]
 s_add_u32 s40, s40, s14
 buffer_store_dwordx4 a[144:147], v1, s[16:19], s40 offen sc1
 v_mfma_f32_16x16x32_bf16 v[52:55], a[84:87], a[52:55], v[52:55]
 v_exp_f32 v16, v36
 v_mfma_f32_16x16x32_bf16 v[52:55], a[88:91], a[56:59], v[52:55]
 s_sub_u32 s34, s34, 1
 v_exp_f32 v17, v37
 v_mfma_f32_16x16x32_bf16 v[52:55], a[92:95], a[60:63], v[52:55]
 v_cvt_pk_bf16_f32 v65, v14, v15
 v_or_b32 v24, v64, v65
 v_mfma_f32_16x16x32_bf16 v[56:59], a[96:99], a[0:3], v[4:7]
 v_exp_f32 v18, v38
 v_mfma_f32_16x16x32_bf16 v[56:59], a[100:103], a[4:7], v[56:59]
 ds_read_b128 a[64:67], v2 offset:32768
 v_mfma_f32_16x16x32_bf16 v[56:59], a[104:107], a[8:11], v[56:59]
 v_exp_f32 v19, v39
 v_mfma_f32_16x16x32_bf16 v[56:59], a[108:111], a[12:15], v[56:59]
 buffer_load_dwordx4 v1, s[16:19], s35 offen offset:1024 sc1 lds
 v_mfma_f32_16x16x32_bf16 v[56:59], a[112:115], a[16:19], v[56:59]
 ds_read_b128 a[68:71], v2 offset:49152
 ds_read_b128 a[72:75], v2 offset:33792
 v_mfma_f32_16x16x32_bf16 v[56:59], a[116:119], a[20:23], v[56:59]
 s_cmp_eq_u32 s34, s28
 s_cselect_b32 s21, s23, 0x8000
 v_cvt_pk_bf16_f32 v68, v16, v17
 v_mfma_f32_16x16x32_bf16 v[56:59], a[120:123], a[24:27], v[56:59]
 ds_read_b128 a[76:79], v2 offset:50176
 v_mfma_f32_16x16x32_bf16 v[56:59], a[124:127], a[28:31], v[56:59]
 s_add_u32 s40, s40, s59
 buffer_store_dwordx4 a[148:151], v1, s[16:19], s40 offen sc1
 v_mfma_f32_16x16x32_bf16 v[60:63], a[96:99], a[32:35], v[8:11]
 v_exp_f32 v20, v40
 v_cvt_pk_bf16_f32 v69, v18, v19
 v_mfma_f32_16x16x32_bf16 v[60:63], a[100:103], a[36:39], v[60:63]
 v_exp_f32 v21, v41
 v_or3_b32 v24, v24, v68, v69
 v_mfma_f32_16x16x32_bf16 v[60:63], a[104:107], a[40:43], v[60:63]
 s_cmp_eq_u32 s34, s8
 s_cselect_b32 s21, s9, s21
 ds_read_b128 a[80:83], v2 offset:34816
 ds_read_b128 a[84:87], v2 offset:51200
 v_mfma_f32_16x16x32_bf16 v[60:63], a[108:111], a[44:47], v[60:63]
 v_exp_f32 v22, v42
 v_mfma_f32_16x16x32_bf16 v[60:63], a[112:115], a[48:51], v[60:63]
 s_add_u32 s31, s31, s21
 ds_read_b128 a[88:91], v2 offset:35840
 v_mfma_f32_16x16x32_bf16 v[60:63], a[116:119], a[52:55], v[60:63]
 v_exp_f32 v23, v43
 v_mfma_f32_16x16x32_bf16 v[60:63], a[120:123], a[56:59], v[60:63]
 buffer_load_dwordx4 v1, s[16:19], s35 offen offset:2048 sc1 lds
 v_mfma_f32_16x16x32_bf16 v[60:63], a[124:127], a[60:63], v[60:63]
 ds_read_b128 a[92:95], v2 offset:52224
 v_mfma_f32_16x16x32_bf16 v[96:99], v[104:107], v[80:83], v[96:99]
 v_cvt_pk_bf16_f32 v66, v20, v21
 v_mfma_f32_16x16x32_bf16 v[96:99], v[104:107], v[88:91], v[96:99]
 s_cmp_gt_i32 s34, 0
 s_cselect_b32 s31, s31, 1879048192
 v_mfma_f32_16x16x32_bf16 v[100:103], v[104:107], v[84:87], v[100:103]
 s_add_u32 s40, s40, s14
 buffer_store_dwordx4 a[152:155], v1, s[16:19], s40 offen sc1
 v_mfma_f32_16x16x32_bf16 v[100:103], v[104:107], v[92:95], v[100:103]
 s_waitcnt lgkmcnt(1)
 v_exp_f32 v12, v44
 v_cvt_pk_bf16_f32 v67, v22, v23
 v_mfma_f32_16x16x32_bf16 v[128:131], a[64:67], v[80:83], v[128:131]
 v_exp_f32 v13, v45
 v_or3_b32 v24, v24, v66, v67
 v_mfma_f32_16x16x32_bf16 v[128:131], a[68:71], v[88:91], v[128:131]
 ds_read_b128 a[96:99], v2 offset:36864
 ds_read_b128 a[100:103], v2 offset:53248
 v_mfma_f32_16x16x32_bf16 v[132:135], a[68:71], v[92:95], v[132:135]
 s_sub_u32 s29, s29, 1
 v_exp_f32 v14, v46
 v_mfma_f32_16x16x32_bf16 v[132:135], a[64:67], v[84:87], v[132:135]
 ds_read_b128 a[104:107], v2 offset:37888
 v_mfma_f32_16x16x32_bf16 v[140:143], a[72:75], v[84:87], v[140:143]
 v_exp_f32 v15, v47
 v_mfma_f32_16x16x32_bf16 v[140:143], a[76:79], v[92:95], v[140:143]
 buffer_load_dwordx4 v1, s[16:19], s35 offen offset:3072 sc1 lds
 v_mfma_f32_16x16x32_bf16 v[136:139], a[76:79], v[88:91], v[136:139]
 ds_read_b128 a[108:111], v2 offset:54272
 ds_read_b128 a[112:115], v2 offset:38912
 v_mfma_f32_16x16x32_bf16 v[136:139], a[72:75], v[80:83], v[136:139]
 s_mov_b32 s12, 0
 v_cvt_pk_bf16_f32 v70, v12, v13
 v_mfma_f32_16x16x32_bf16 v[144:147], a[80:83], v[80:83], v[144:147]
 ds_read_b128 a[116:119], v2 offset:55296
 v_mfma_f32_16x16x32_bf16 v[144:147], a[84:87], v[88:91], v[144:147]
 s_add_u32 s40, s40, s59
 buffer_store_dwordx4 a[156:159], v1, s[16:19], s40 offen sc1
 v_mfma_f32_16x16x32_bf16 v[148:151], a[84:87], v[92:95], v[148:151]
 v_exp_f32 v16, v48
 v_cvt_pk_bf16_f32 v71, v14, v15
 v_mfma_f32_16x16x32_bf16 v[148:151], a[80:83], v[84:87], v[148:151]
 v_exp_f32 v17, v49
 v_or3_b32 v24, v24, v70, v71
 v_mfma_f32_16x16x32_bf16 v[156:159], a[88:91], v[84:87], v[156:159]
 s_waitcnt lgkmcnt(1)
 ds_read_b128 a[120:123], v2 offset:39936
 ds_read_b128 a[124:127], v2 offset:56320
 v_mfma_f32_16x16x32_bf16 v[156:159], a[92:95], v[92:95], v[156:159]
 v_exp_f32 v18, v50
 v_mfma_f32_16x16x32_bf16 v[152:155], a[92:95], v[88:91], v[152:155]
 s_add_u32 m0, s32, 4096
 v_mfma_f32_16x16x32_bf16 v[152:155], a[88:91], v[80:83], v[152:155]
 s_add_u32 s35, s30, 4096
 v_exp_f32 v19, v51
 v_mfma_f32_16x16x32_bf16 v[160:163], a[96:99], v[80:83], v[160:163]
 buffer_load_dwordx4 v1, s[16:19], s35 offen offset:0 sc1 lds
 v_mfma_f32_16x16x32_bf16 v[160:163], a[100:103], v[88:91], v[160:163]
 ds_read_b128 a[64:67], v2 offset:40960
 ds_read_b128 a[68:71], v2 offset:57344
 v_mfma_f32_16x16x32_bf16 v[164:167], a[100:103], v[92:95], v[164:167]
 v_cvt_pk_bf16_f32 v72, v16, v17
 v_mfma_f32_16x16x32_bf16 v[164:167], a[96:99], v[84:87], v[164:167]
 ds_read_b128 a[72:75], v2 offset:41984
 v_mfma_f32_16x16x32_bf16 v[172:175], a[104:107], v[84:87], v[172:175]
 v_exp_f32 v20, v52
 v_mfma_f32_16x16x32_bf16 v[172:175], a[108:111], v[92:95], v[172:175]
 ds_read_b128 a[76:79], v2 offset:58368
 v_cvt_pk_bf16_f32 v73, v18, v19
 v_mfma_f32_16x16x32_bf16 v[168:171], a[108:111], v[88:91], v[168:171]
 v_exp_f32 v21, v53
 v_mfma_f32_16x16x32_bf16 v[168:171], a[104:107], v[80:83], v[168:171]
 ds_read_b128 a[80:83], v2 offset:43008
 v_or3_b32 v24, v24, v72, v73
 v_mfma_f32_16x16x32_bf16 v[176:179], a[112:115], v[80:83], v[176:179]
 s_waitcnt lgkmcnt(2)
 v_exp_f32 v22, v54
 v_mfma_f32_16x16x32_bf16 v[176:179], a[116:119], v[88:91], v[176:179]
 ds_read_b128 a[84:87], v2 offset:59392
 v_mfma_f32_16x16x32_bf16 v[180:183], a[116:119], v[92:95], v[180:183]
 v_exp_f32 v23, v55
 v_mfma_f32_16x16x32_bf16 v[180:183], a[112:115], v[84:87], v[180:183]
 buffer_load_dwordx4 v1, s[16:19], s35 offen offset:1024 sc1 lds
 v_mfma_f32_16x16x32_bf16 v[188:191], a[120:123], v[84:87], v[188:191]
 ds_read_b128 a[88:91], v2 offset:44032
 ds_read_b128 a[92:95], v2 offset:60416
 v_mfma_f32_16x16x32_bf16 v[188:191], a[124:127], v[92:95], v[188:191]
 v_cvt_pk_bf16_f32 v76, v20, v21
 v_mfma_f32_16x16x32_bf16 v[184:187], a[124:127], v[88:91], v[184:187]
 v_mfma_f32_16x16x32_bf16 v[184:187], a[120:123], v[80:83], v[184:187]
 v_exp_f32 v12, v56
 v_mfma_f32_16x16x32_bf16 v[192:195], a[64:67], v[80:83], v[192:195]
 ds_read_b128 a[96:99], v2 offset:45056
 v_cvt_pk_bf16_f32 v77, v22, v23
 v_mfma_f32_16x16x32_bf16 v[192:195], a[68:71], v[88:91], v[192:195]
 v_exp_f32 v13, v57
 v_mfma_f32_16x16x32_bf16 v[196:199], a[68:71], v[92:95], v[196:199]
 ds_read_b128 a[100:103], v2 offset:61440
 v_or3_b32 v24, v24, v76, v77
 v_mfma_f32_16x16x32_bf16 v[196:199], a[64:67], v[84:87], v[196:199]
 v_exp_f32 v14, v58
 v_mfma_f32_16x16x32_bf16 v[204:207], a[72:75], v[84:87], v[204:207]
 s_waitcnt lgkmcnt(2)
 ds_read_b128 a[104:107], v2 offset:46080
 v_mfma_f32_16x16x32_bf16 v[204:207], a[76:79], v[92:95], v[204:207]
 v_exp_f32 v15, v59
 v_mfma_f32_16x16x32_bf16 v[200:203], a[76:79], v[88:91], v[200:203]
 buffer_load_dwordx4 v1, s[16:19], s35 offen offset:2048 sc1 lds
 v_mfma_f32_16x16x32_bf16 v[200:203], a[72:75], v[80:83], v[200:203]
 ds_read_b128 a[108:111], v2 offset:62464
 ds_read_b128 a[112:115], v2 offset:47104
 v_mfma_f32_16x16x32_bf16 v[208:211], a[80:83], v[80:83], v[208:211]
 v_cvt_pk_bf16_f32 v74, v12, v13
 v_mfma_f32_16x16x32_bf16 v[208:211], a[84:87], v[88:91], v[208:211]
 ds_read_b128 a[116:119], v2 offset:63488
 v_mfma_f32_16x16x32_bf16 v[212:215], a[84:87], v[92:95], v[212:215]
 v_exp_f32 v16, v60
 v_mfma_f32_16x16x32_bf16 v[212:215], a[80:83], v[84:87], v[212:215]
 ds_read_b128 a[120:123], v2 offset:48128
 v_cvt_pk_bf16_f32 v75, v14, v15
 v_mfma_f32_16x16x32_bf16 v[220:223], a[88:91], v[84:87], v[220:223]
 v_exp_f32 v17, v61
 v_mfma_f32_16x16x32_bf16 v[220:223], a[92:95], v[92:95], v[220:223]
 ds_read_b128 a[124:127], v2 offset:64512
 v_or3_b32 v24, v24, v74, v75
 v_mfma_f32_16x16x32_bf16 v[216:219], a[92:95], v[88:91], v[216:219]
 v_exp_f32 v18, v62
 v_mfma_f32_16x16x32_bf16 v[216:219], a[88:91], v[80:83], v[216:219]
 s_waitcnt lgkmcnt(2)
 v_mfma_f32_16x16x32_bf16 v[224:227], a[96:99], v[80:83], v[224:227]
 v_exp_f32 v19, v63
 v_mfma_f32_16x16x32_bf16 v[224:227], a[100:103], v[88:91], v[224:227]
 buffer_load_dwordx4 v1, s[16:19], s35 offen offset:3072 sc1 lds
 v_mfma_f32_16x16x32_bf16 v[228:231], a[100:103], v[92:95], v[228:231]
 v_mfma_f32_16x16x32_bf16 v[228:231], a[96:99], v[84:87], v[228:231]
 v_cvt_pk_bf16_f32 v78, v16, v17
 v_mfma_f32_16x16x32_bf16 v[236:239], a[104:107], v[84:87], v[236:239]
 s_waitcnt vmcnt(4)
 s_waitcnt lgkmcnt(0)
 s_barrier
 v_mfma_f32_16x16x32_bf16 v[236:239], a[108:111], v[92:95], v[236:239]
 s_sub_u32 s33, s33, 1
 ds_read_b128 a[64:67], v1 offset:32768
 v_cvt_pk_bf16_f32 v79, v18, v19
 v_mfma_f32_16x16x32_bf16 v[232:235], a[108:111], v[88:91], v[232:235]
 s_cmp_eq_u32 s33, s28
 s_cselect_b32 s20, s23, 0x8000
 ds_read_b128 a[68:71], v1 offset:33792
 v_mfma_f32_16x16x32_bf16 v[232:235], a[104:107], v[80:83], v[232:235]
 ds_read_b128 a[72:75], v1 offset:34816
 v_or3_b32 v24, v24, v78, v79
 v_mfma_f32_16x16x32_bf16 v[240:243], a[112:115], v[80:83], v[240:243]
 s_cmp_eq_u32 s33, s8
 s_cselect_b32 s20, s9, s20
 ds_read_b128 a[76:79], v1 offset:35840
 v_mfma_f32_16x16x32_bf16 v[240:243], a[116:119], v[88:91], v[240:243]
 ds_read_b128 a[80:83], v1 offset:36864
 v_mfma_f32_16x16x32_bf16 v[244:247], a[116:119], v[92:95], v[244:247]
 s_add_u32 s30, s30, s20
 ds_read_b128 a[84:87], v1 offset:37888
 v_and_b32 v24, 0x40004000, v24
 v_mfma_f32_16x16x32_bf16 v[244:247], a[112:115], v[84:87], v[244:247]
 ds_read_b128 a[88:91], v1 offset:38912
 v_cmp_ne_u32 vcc, 0, v24
 v_mfma_f32_16x16x32_bf16 v[252:255], a[120:123], v[84:87], v[252:255]
 ds_read_b128 a[92:95], v1 offset:39936
 v_mfma_f32_16x16x32_bf16 v[252:255], a[124:127], v[92:95], v[252:255]
 s_cmp_gt_i32 s33, 0
 s_cselect_b32 s30, s30, 1879048192
 v_mfma_f32_16x16x32_bf16 v[248:251], a[124:127], v[88:91], v[248:251]
 buffer_atomic_add v28, v25, s[16:19], s15 offen offset:4 sc1
 v_mfma_f32_16x16x32_bf16 v[248:251], a[120:123], v[80:83], v[248:251]
 s_mov_b32 s11, 4
 s_sub_u32 s10, s29, 2
 s_waitcnt lgkmcnt(0)
 s_cbranch_vccnz L_rare1
 s_branch L_top0
L_slow:
 v_pk_mov_b32 v[128:129], 0, 0
 v_pk_mov_b32 v[130:131], 0, 0
 v_pk_mov_b32 v[132:133], 0, 0
 v_pk_mov_b32 v[134:135], 0, 0
 v_pk_mov_b32 v[136:137], 0, 0
 v_pk_mov_b32 v[138:139], 0, 0
 v_pk_mov_b32 v[140:141], 0, 0
 v_pk_mov_b32 v[142:143], 0, 0
 v_pk_mov_b32 v[144:145], 0, 0
 v_pk_mov_b32 v[146:147], 0, 0
 v_pk_mov_b32 v[148:149], 0, 0
 v_pk_mov_b32 v[150:151], 0, 0
 v_pk_mov_b32 v[152:153], 0, 0
 v_pk_mov_b32 v[154:155], 0, 0
 v_pk_mov_b32 v[156:157], 0, 0
 v_pk_mov_b32 v[158:159], 0, 0
 v_pk_mov_b32 v[160:161], 0, 0
 v_pk_mov_b32 v[162:163], 0, 0
 s_mul_i32 s40, s13, 1
 s_add_u32 s40, s40, s58
 s_add_u32 s40, s40, 524288
 buffer_store_dwordx4 a[160:163], v1, s[16:19], s40 offen sc1
 v_pk_mov_b32 v[164:165], 0, 0
 v_pk_mov_b32 v[166:167], 0, 0
 v_pk_mov_b32 v[168:169], 0, 0
 v_pk_mov_b32 v[170:171], 0, 0
 v_pk_mov_b32 v[172:173], 0, 0
 v_pk_mov_b32 v[174:175], 0, 0
 v_pk_mov_b32 v[176:177], 0, 0
 v_pk_mov_b32 v[178:179], 0, 0
 v_pk_mov_b32 v[180:181], 0, 0
 v_pk_mov_b32 v[182:183], 0, 0
 v_pk_mov_b32 v[184:185], 0, 0
 v_pk_mov_b32 v[186:187], 0, 0
 v_pk_mov_b32 v[188:189], 0, 0
 v_pk_mov_b32 v[190:191], 0, 0
 v_pk_mov_b32 v[192:193], 0, 0
 v_pk_mov_b32 v[194:195], 0, 0
 v_pk_mov_b32 v[196:197], 0, 0
 v_pk_mov_b32 v[198:199], 0, 0
 s_add_u32 s40, s40, s59
 buffer_store_dwordx4 a[164:167], v1, s[16:19], s40 offen sc1
 v_pk_mov_b32 v[200:201], 0, 0
 v_pk_mov_b32 v[202:203], 0, 0
 v_pk_mov_b32 v[204:205], 0, 0
 v_pk_mov_b32 v[206:207], 0, 0
 v_pk_mov_b32 v[208:209], 0, 0
 v_pk_mov_b32 v[210:211], 0, 0
 v_pk_mov_b32 v[212:213], 0, 0
 v_pk_mov_b32 v[214:215], 0, 0
 v_pk_mov_b32 v[216:217], 0, 0
 v_pk_mov_b32 v[218:219], 0, 0
 v_pk_mov_b32 v[220:221], 0, 0
 v_pk_mov_b32 v[222:223], 0, 0
 v_pk_mov_b32 v[224:225], 0, 0
 v_pk_mov_b32 v[226:227], 0, 0
 v_pk_mov_b32 v[228:229], 0, 0
 v_pk_mov_b32 v[230:231], 0, 0
 v_pk_mov_b32 v[232:233], 0, 0
 v_pk_mov_b32 v[234:235], 0, 0
 s_add_u32 s40, s40, s14
 buffer_store_dwordx4 a[168:171], v1, s[16:19], s40 offen sc1
 v_pk_mov_b32 v[236:237], 0, 0
 v_pk_mov_b32 v[238:239], 0, 0
 v_pk_mov_b32 v[240:241], 0, 0
 v_pk_mov_b32 v[242:243], 0, 0
 v_pk_mov_b32 v[244:245], 0, 0
 v_pk_mov_b32 v[246:247], 0, 0
 v_pk_mov_b32 v[248:249], 0, 0
 v_pk_mov_b32 v[250:251], 0, 0
 v_pk_mov_b32 v[252:253], 0, 0
 v_pk_mov_b32 v[254:255], 0, 0
 v_pk_mov_b32 v[96:97], 0, 0
 v_pk_mov_b32 v[98:99], 0, 0
 v_pk_mov_b32 v[100:101], 0, 0
 v_pk_mov_b32 v[102:103], 0, 0
 s_mov_b32 s39, 0x12492493
 v_add_u32 v28, 0, v0
 v_mul_hi_u32 v29, v28, s39
 v_mul_u32_u24 v30, 14, v29
 s_add_u32 s40, s40, s59
 buffer_store_dwordx4 a[172:175], v1, s[16:19], s40 offen sc1
 v_sub_u32 v28, v28, v30
 v_mul_u32_u24 v29, 896, v29
 v_lshl_add_u32 v28, v28, 4, v29
 v_subrev_u32 v112, 0, v28
 v_add_u32 v28, 64, v0
 v_mul_hi_u32 v29, v28, s39
 v_mul_u32_u24 v30, 14, v29
 v_sub_u32 v28, v28, v30
 v_mul_u32_u24 v29, 896, v29
 v_lshl_add_u32 v28, v28, 4, v29
 v_subrev_u32 v113, 1024, v28
 v_add_u32 v28, 128, v0
 v_mul_hi_u32 v29, v28, s39
 v_mul_u32_u24 v30, 14, v29
 v_sub_u32 v28, v28, v30
 v_mul_u32_u24 v29, 896, v29
 v_lshl_add_u32 v28, v28, 4, v29
 v_subrev_u32 v114, 2048, v28
 s_add_u32 s40, s40, s14
 buffer_store_dwordx4 a[176:179], v1, s[16:19], s40 offen sc1
 v_add_u32 v28, 192, v0
 v_mul_hi_u32 v29, v28, s39
 v_mul_u32_u24 v30, 14, v29
 v_sub_u32 v28, v28, v30
 v_mul_u32_u24 v29, 896, v29
 v_lshl_add_u32 v28, v28, 4, v29
 v_subrev_u32 v115, 3072, v28
 v_add_u32 v28, 256, v0
 v_mul_hi_u32 v29, v28, s39
 v_mul_u32_u24 v30, 14, v29
 v_sub_u32 v28, v28, v30
 v_mul_u32_u24 v29, 896, v29
 v_lshl_add_u32 v28, v28, 4, v29
 v_subrev_u32 v116, 0, v28
 v_add_u32 v28, 320, v0
 v_mul_hi_u32 v29, v28, s39
 v_mul_u32_u24 v30, 14, v29
 v_sub_u32 v28, v28, v30
 s_add_u32 s40, s40, s59
 buffer_store_dwordx4 a[180:183], v1, s[16:19], s40 offen sc1
 v_mul_u32_u24 v29, 896, v29
 v_lshl_add_u32 v28, v28, 4, v29
 v_subrev_u32 v117, 1024, v28
 v_add_u32 v28, 384, v0
 v_mul_hi_u32 v29, v28, s39
 v_mul_u32_u24 v30, 14, v29
 v_sub_u32 v28, v28, v30
 v_mul_u32_u24 v29, 896, v29
 v_lshl_add_u32 v28, v28, 4, v29
 v_subrev_u32 v118, 2048, v28
 v_lshrrev_b32 v28, 3, v0
 v_mul_u32_u24 v29, 896, v28
 v_and_b32 v28, 6, v28
 v_and_b32 v30, 7, v0
 v_xor_b32 v28, v28, v30
 v_lshl_add_u32 v31, v28, 4, v29
 v_lshrrev_b32 v28, 2, v0
 v_lshlrev_b32 v28, 7, v28
 v_bfe_u32 v29, v0, 3, 2
 v_lshl_add_u32 v28, v29, 5, v28
 v_and_b32 v29, 3, v0
 v_lshl_add_u32 v119, v29, 3, v28
 s_waitcnt lgkmcnt(0)
 s_branch L_top1
 .p2align 6
L_top0:
 s_waitcnt lgkmcnt(2)
 v_mfma_f32_16x16x32_bf16 v[32:35], a[64:67], a[0:3], v[4:7]
 s_add_u32 m0, s32, 98304
 ds_read_b128 a[96:99], v1 offset:40960
 v_mfma_f32_16x16x32_bf16 v[32:35], a[68:71], a[4:7], v[32:35]
 s_add_u32 s35, s31, 0
 ds_read_b128 a[100:103], v1 offset:41984
 v_mfma_f32_16x16x32_bf16 v[32:35], a[72:75], a[8:11], v[32:35]
 buffer_load_dwordx4 v1, s[16:19], s35 offen offset:0 sc1 lds
 v_mfma_f32_16x16x32_bf16 v[32:35], a[76:79], a[12:15], v[32:35]
 ds_read_b128 a[104:107], v1 offset:43008
 v_mfma_f32_16x16x32_bf16 v[32:35], a[80:83], a[16:19], v[32:35]
 ds_read_b128 a[108:111], v1 offset:44032
 v_mfma_f32_16x16x32_bf16 v[32:35], a[84:87], a[20:23], v[32:35]
 s_waitcnt lgkmcnt(3)
 ds_read_b128 a[112:115], v1 offset:45056
 v_mfma_f32_16x16x32_bf16 v[32:35], a[88:91], a[24:27], v[32:35]
 buffer_load_dwordx4 v1, s[16:19], s35 offen offset:1024 sc1 lds
 v_mfma_f32_16x16x32_bf16 v[32:35], a[92:95], a[28:31], v[32:35]
 ds_read_b128 a[116:119], v1 offset:46080
 v_mfma_f32_16x16x32_bf16 v[36:39], a[64:67], a[32:35], v[8:11]
 ds_read_b128 a[120:123], v1 offset:47104
 v_mfma_f32_16x16x32_bf16 v[36:39], a[68:71], a[36:39], v[36:39]
 ds_read_b128 a[124:127], v1 offset:48128
 v_mfma_f32_16x16x32_bf16 v[36:39], a[72:75], a[40:43], v[36:39]
 buffer_load_dwordx4 v1, s[16:19], s35 offen offset:2048 sc1 lds
 v_mfma_f32_16x16x32_bf16 v[36:39], a[76:79], a[44:47], v[36:39]
 ds_read_b128 a[64:67], v1 offset:49152
 v_mfma_f32_16x16x32_bf16 v[36:39], a[80:83], a[48:51], v[36:39]
 ds_read_b128 a[68:71], v1 offset:50176
 v_mfma_f32_16x16x32_bf16 v[36:39], a[84:87], a[52:55], v[36:39]
 ds_read_b128 a[72:75], v1 offset:51200
 v_mfma_f32_16x16x32_bf16 v[36:39], a[88:91], a[56:59], v[36:39]
 buffer_load_dwordx4 v1, s[16:19], s35 offen offset:3072 sc1 lds
 v_mfma_f32_16x16x32_bf16 v[36:39], a[92:95], a[60:63], v[36:39]
 ds_read_b128 a[76:79], v1 offset:52224
 v_mfma_f32_16x16x32_bf16 v[40:43], a[96:99], a[0:3], v[4:7]
 s_waitcnt lgkmcnt(3)
 s_add_u32 m0, s32, 102400
 ds_read_b128 a[80:83], v1 offset:53248
 v_mfma_f32_16x16x32_bf16 v[40:43], a[100:103], a[4:7], v[40:43]
 s_add_u32 s35, s31, 4096
 ds_read_b128 a[84:87], v1 offset:54272
 v_mfma_f32_16x16x32_bf16 v[40:43], a[104:107], a[8:11], v[40:43]
 buffer_load_dwordx4 v1, s[16:19], s35 offen offset:0 sc1 lds
 v_mfma_f32_16x16x32_bf16 v[40:43], a[108:111], a[12:15], v[40:43]
 ds_read_b128 a[88:91], v1 offset:55296
 v_mfma_f32_16x16x32_bf16 v[40:43], a[112:115], a[16:19], v[40:43]
 ds_read_b128 a[92:95], v1 offset:56320
 v_mfma_f32_16x16x32_bf16 v[40:43], a[116:119], a[20:23], v[40:43]
 v_exp_f32 v12, v32
 v_mfma_f32_16x16x32_bf16 v[40:43], a[120:123], a[24:27], v[40:43]
 buffer_load_dwordx4 v1, s[16:19], s35 offen offset:1024 sc1 lds
 v_mfma_f32_16x16x32_bf16 v[40:43], a[124:127], a[28:31], v[40:43]
 v_exp_f32 v13, v33
 v_mfma_f32_16x16x32_bf16 v[44:47], a[96:99], a[32:35], v[8:11]
 ds_read_b128 a[96:99], v1 offset:57344
 v_cvt_pk_bf16_f32 v80, v12, v13
 v_mfma_f32_16x16x32_bf16 v[44:47], a[100:103], a[36:39], v[44:47]
 ds_read_b128 a[100:103], v1 offset:58368
 v_mfma_f32_16x16x32_bf16 v[44:47], a[104:107], a[40:43], v[44:47]
 buffer_load_dwordx4 v1, s[16:19], s35 offen offset:2048 sc1 lds
 v_mfma_f32_16x16x32_bf16 v[44:47], a[108:111], a[44:47], v[44:47]
 ds_read_b128 a[104:107], v1 offset:59392
 v_mfma_f32_16x16x32_bf16 v[44:47], a[112:115], a[48:51], v[44:47]
 ds_read_b128 a[108:111], v1 offset:60416
 v_mfma_f32_16x16x32_bf16 v[44:47], a[116:119], a[52:55], v[44:47]
 ds_read_b128 a[112:115], v1 offset:61440
 v_mfma_f32_16x16x32_bf16 v[44:47], a[120:123], a[56:59], v[44:47]
 buffer_load_dwordx4 v1, s[16:19], s35 offen offset:3072 sc1 lds
 v_mfma_f32_16x16x32_bf16 v[44:47], a[124:127], a[60:63], v[44:47]
 ds_read_b128 a[116:119], v1 offset:62464
 v_mfma_f32_16x16x32_bf16 v[48:51], a[64:67], a[0:3], v[4:7]
 s_waitcnt lgkmcnt(3)
 ds_read_b128 a[120:123], v1 offset:63488
 v_mfma_f32_16x16x32_bf16 v[48:51], a[68:71], a[4:7], v[48:51]
 ds_read_b128 a[124:127], v1 offset:64512
 v_mfma_f32_16x16x32_bf16 v[48:51], a[72:75], a[8:11], v[48:51]
 v_exp_f32 v14, v34
 v_mfma_f32_16x16x32_bf16 v[48:51], a[76:79], a[12:15], v[48:51]
 v_exp_f32 v15, v35
 v_mfma_f32_16x16x32_bf16 v[48:51], a[80:83], a[16:19], v[48:51]
 v_exp_f32 v16, v36
 v_mfma_f32_16x16x32_bf16 v[48:51], a[84:87], a[20:23], v[48:51]
 s_add_u32 m0, s32, 32768
 v_exp_f32 v17, v37
 v_mfma_f32_16x16x32_bf16 v[48:51], a[88:91], a[24:27], v[48:51]
 s_waitcnt vmcnt(16) lgkmcnt(0)
 s_barrier
 v_cvt_pk_bf16_f32 v81, v14, v15
 v_mfma_f32_16x16x32_bf16 v[48:51], a[92:95], a[28:31], v[48:51]
 s_add_u32 s35, s30, 0
 v_or_b32 v24, v80, v81
 v_mfma_f32_16x16x32_bf16 v[52:55], a[64:67], a[32:35], v[8:11]
 buffer_load_dwordx4 v1, s[16:19], s35 offen offset:0 sc1 lds
 v_mfma_f32_16x16x32_bf16 v[52:55], a[68:71], a[36:39], v[52:55]
 v_cvt_pk_bf16_f32 v84, v16, v17
 v_mfma_f32_16x16x32_bf16 v[52:55], a[72:75], a[40:43], v[52:55]
 v_exp_f32 v18, v38
 v_mfma_f32_16x16x32_bf16 v[52:55], a[76:79], a[44:47], v[52:55]
 s_sub_u32 s34, s34, 1
 v_mfma_f32_16x16x32_bf16 v[52:55], a[80:83], a[48:51], v[52:55]
 v_exp_f32 v19, v39
 v_mfma_f32_16x16x32_bf16 v[52:55], a[84:87], a[52:55], v[52:55]
 s_cmp_eq_u32 s34, s28
 s_cselect_b32 s21, s23, 0x8000
 v_mfma_f32_16x16x32_bf16 v[52:55], a[88:91], a[56:59], v[52:55]
 buffer_load_dwordx4 v1, s[16:19], s35 offen offset:1024 sc1 lds
 v_mfma_f32_16x16x32_bf16 v[52:55], a[92:95], a[60:63], v[52:55]
 ds_read_b128 a[64:67], v2 offset:0
 v_cvt_pk_bf16_f32 v85, v18, v19
 v_mfma_f32_16x16x32_bf16 v[56:59], a[96:99], a[0:3], v[4:7]
 s_cmp_eq_u32 s34, s8
 s_cselect_b32 s21, s9, s21
 v_mfma_f32_16x16x32_bf16 v[56:59], a[100:103], a[4:7], v[56:59]
 ds_read_b128 a[68:71], v2 offset:16384
 v_or3_b32 v24, v24, v84, v85
 v_mfma_f32_16x16x32_bf16 v[56:59], a[104:107], a[8:11], v[56:59]
 s_add_u32 s31, s31, s21
 v_mfma_f32_16x16x32_bf16 v[56:59], a[108:111], a[12:15], v[56:59]
 ds_read_b128 a[72:75], v2 offset:1024
 v_mfma_f32_16x16x32_bf16 v[56:59], a[112:115], a[16:19], v[56:59]
 buffer_load_dwordx4 v1, s[16:19], s35 offen offset:2048 sc1 lds
 v_mfma_f32_16x16x32_bf16 v[56:59], a[116:119], a[20:23], v[56:59]
 ds_read_b128 a[76:79], v2 offset:17408
 v_mfma_f32_16x16x32_bf16 v[56:59], a[120:123], a[24:27], v[56:59]
 s_cmp_gt_i32 s34, 0
 s_cselect_b32 s31, s31, 1879048192
 v_mfma_f32_16x16x32_bf16 v[56:59], a[124:127], a[28:31], v[56:59]
 ds_read_b128 a[80:83], v2 offset:2048
 v_mfma_f32_16x16x32_bf16 v[60:63], a[96:99], a[32:35], v[8:11]
 v_mfma_f32_16x16x32_bf16 v[60:63], a[100:103], a[36:39], v[60:63]
 ds_read_b128 a[84:87], v2 offset:18432
 v_mfma_f32_16x16x32_bf16 v[60:63], a[104:107], a[40:43], v[60:63]
 buffer_load_dwordx4 v1, s[16:19], s35 offen offset:3072 sc1 lds
 v_mfma_f32_16x16x32_bf16 v[60:63], a[108:111], a[44:47], v[60:63]
 ds_read_b128 a[88:91], v2 offset:3072
 v_mfma_f32_16x16x32_bf16 v[60:63], a[112:115], a[48:51], v[60:63]
 v_mfma_f32_16x16x32_bf16 v[60:63], a[116:119], a[52:55], v[60:63]
 ds_read_b128 a[92:95], v2 offset:19456
 v_mfma_f32_16x16x32_bf16 v[60:63], a[120:123], a[56:59], v[60:63]
 s_cmp_le_u32 s29, s36
 v_mfma_f32_16x16x32_bf16 v[60:63], a[124:127], a[60:63], v[60:63]
 s_cbranch_scc1 L_mask0
L_B0:
 v_mfma_f32_16x16x32_bf16 v[96:99], v[104:107], v[64:67], v[96:99]
 s_sub_u32 s29, s29, 1
 v_exp_f32 v20, v40
 v_mfma_f32_16x16x32_bf16 v[96:99], v[104:107], v[72:75], v[96:99]
 s_add_u32 m0, s32, 36864
 v_mfma_f32_16x16x32_bf16 v[100:103], v[104:107], v[68:71], v[100:103]
 s_add_u32 s35, s30, 4096
 v_exp_f32 v21, v41
 v_mfma_f32_16x16x32_bf16 v[100:103], v[104:107], v[76:79], v[100:103]
 s_waitcnt lgkmcnt(0)
 v_cvt_pk_bf16_f32 v82, v20, v21
 v_mfma_f32_16x16x32_bf16 v[128:131], a[64:67], v[64:67], v[128:131]
 v_exp_f32 v22, v42
 v_mfma_f32_16x16x32_bf16 v[128:131], a[68:71], v[72:75], v[128:131]
 ds_read_b128 a[96:99], v2 offset:4096
 v_mfma_f32_16x16x32_bf16 v[132:135], a[68:71], v[76:79], v[132:135]
 buffer_load_dwordx4 v1, s[16:19], s35 offen offset:0 sc1 lds
 v_mfma_f32_16x16x32_bf16 v[132:135], a[64:67], v[68:71], v[132:135]
 ds_read_b128 a[100:103], v2 offset:20480
 v_mfma_f32_16x16x32_bf16 v[140:143], a[72:75], v[68:71], v[140:143]
 v_exp_f32 v23, v43
 v_mfma_f32_16x16x32_bf16 v[140:143], a[76:79], v[76:79], v[140:143]
 ds_read_b128 a[104:107], v2 offset:5120
 v_cvt_pk_bf16_f32 v83, v22, v23
 v_mfma_f32_16x16x32_bf16 v[136:139], a[76:79], v[72:75], v[136:139]
 v_exp_f32 v12, v44
 v_mfma_f32_16x16x32_bf16 v[136:139], a[72:75], v[64:67], v[136:139]
 ds_read_b128 a[108:111], v2 offset:21504
 v_or3_b32 v24, v24, v82, v83
 v_mfma_f32_16x16x32_bf16 v[144:147], a[80:83], v[64:67], v[144:147]
 v_exp_f32 v13, v45
 v_mfma_f32_16x16x32_bf16 v[144:147], a[84:87], v[72:75], v[144:147]
 ds_read_b128 a[112:115], v2 offset:6144
 v_cvt_pk_bf16_f32 v86, v12, v13
 v_mfma_f32_16x16x32_bf16 v[148:151], a[84:87], v[76:79], v[148:151]
 v_exp_f32 v14, v46
 v_mfma_f32_16x16x32_bf16 v[148:151], a[80:83], v[68:71], v[148:151]
 ds_read_b128 a[116:119], v2 offset:22528
 v_mfma_f32_16x16x32_bf16 v[156:159], a[88:91], v[68:71], v[156:159]
 v_exp_f32 v15, v47
 v_mfma_f32_16x16x32_bf16 v[156:159], a[92:95], v[76:79], v[156:159]
 ds_read_b128 a[120:123], v2 offset:7168
 v_cvt_pk_bf16_f32 v87, v14, v15
 v_mfma_f32_16x16x32_bf16 v[152:155], a[92:95], v[72:75], v[152:155]
 v_exp_f32 v16, v48
 v_mfma_f32_16x16x32_bf16 v[152:155], a[88:91], v[64:67], v[152:155]
 s_waitcnt lgkmcnt(2)
 ds_read_b128 a[124:127], v2 offset:23552
 v_or3_b32 v24, v24, v86, v87
 v_mfma_f32_16x16x32_bf16 v[160:163], a[96:99], v[64:67], v[160:163]
 buffer_load_dwordx4 v1, s[16:19], s35 offen offset:1024 sc1 lds
 v_mfma_f32_16x16x32_bf16 v[160:163], a[100:103], v[72:75], v[160:163]
 ds_read_b128 a[64:67], v2 offset:8192
 v_mfma_f32_16x16x32_bf16 v[164:167], a[100:103], v[76:79], v[164:167]
 v_exp_f32 v17, v49
 v_mfma_f32_16x16x32_bf16 v[164:167], a[96:99], v[68:71], v[164:167]
 ds_read_b128 a[68:71], v2 offset:24576
 v_cvt_pk_bf16_f32 v88, v16, v17
 v_mfma_f32_16x16x32_bf16 v[172:175], a[104:107], v[68:71], v[172:175]
 v_exp_f32 v18, v50
 v_mfma_f32_16x16x32_bf16 v[172:175], a[108:111], v[76:79], v[172:175]
 ds_read_b128 a[72:75], v2 offset:9216
 v_mfma_f32_16x16x32_bf16 v[168:171], a[108:111], v[72:75], v[168:171]
 v_exp_f32 v19, v51
 v_mfma_f32_16x16x32_bf16 v[168:171], a[104:107], v[64:67], v[168:171]
 ds_read_b128 a[76:79], v2 offset:25600
 v_cvt_pk_bf16_f32 v89, v18, v19
 v_mfma_f32_16x16x32_bf16 v[176:179], a[112:115], v[64:67], v[176:179]
 s_waitcnt lgkmcnt(2)
 v_exp_f32 v20, v52
 v_mfma_f32_16x16x32_bf16 v[176:179], a[116:119], v[72:75], v[176:179]
 ds_read_b128 a[80:83], v2 offset:10240
 v_or3_b32 v24, v24, v88, v89
 v_mfma_f32_16x16x32_bf16 v[180:183], a[116:119], v[76:79], v[180:183]
 v_exp_f32 v21, v53
 v_mfma_f32_16x16x32_bf16 v[180:183], a[112:115], v[68:71], v[180:183]
 ds_read_b128 a[84:87], v2 offset:26624
 v_cvt_pk_bf16_f32 v92, v20, v21
 v_mfma_f32_16x16x32_bf16 v[188:191], a[120:123], v[68:71], v[188:191]
 v_exp_f32 v22, v54
 v_mfma_f32_16x16x32_bf16 v[188:191], a[124:127], v[76:79], v[188:191]
 ds_read_b128 a[88:91], v2 offset:11264
 v_mfma_f32_16x16x32_bf16 v[184:187], a[124:127], v[72:75], v[184:187]
 buffer_load_dwordx4 v1, s[16:19], s35 offen offset:2048 sc1 lds
 v_mfma_f32_16x16x32_bf16 v[184:187], a[120:123], v[64:67], v[184:187]
 ds_read_b128 a[92:95], v2 offset:27648
 v_mfma_f32_16x16x32_bf16 v[192:195], a[64:67], v[64:67], v[192:195]
 v_exp_f32 v23, v55
 v_mfma_f32_16x16x32_bf16 v[192:195], a[68:71], v[72:75], v[192:195]
 ds_read_b128 a[96:99], v2 offset:12288
 v_cvt_pk_bf16_f32 v93, v22, v23
 v_mfma_f32_16x16x32_bf16 v[196:199], a[68:71], v[76:79], v[196:199]
 v_exp_f32 v12, v56
 v_mfma_f32_16x16x32_bf16 v[196:199], a[64:67], v[68:71], v[196:199]
 s_waitcnt lgkmcnt(2)
 ds_read_b128 a[100:103], v2 offset:28672
 v_or3_b32 v24, v24, v92, v93
 v_mfma_f32_16x16x32_bf16 v[204:207], a[72:75], v[68:71], v[204:207]
 v_exp_f32 v13, v57
 v_mfma_f32_16x16x32_bf16 v[204:207], a[76:79], v[76:79], v[204:207]
 ds_read_b128 a[104:107], v2 offset:13312
 v_cvt_pk_bf16_f32 v90, v12, v13
 v_mfma_f32_16x16x32_bf16 v[200:203], a[76:79], v[72:75], v[200:203]
 v_exp_f32 v14, v58
 v_mfma_f32_16x16x32_bf16 v[200:203], a[72:75], v[64:67], v[200:203]
 ds_read_b128 a[108:111], v2 offset:29696
 v_mfma_f32_16x16x32_bf16 v[208:211], a[80:83], v[64:67], v[208:211]
 v_exp_f32 v15, v59
 v_mfma_f32_16x16x32_bf16 v[208:211], a[84:87], v[72:75], v[208:211]
 ds_read_b128 a[112:115], v2 offset:14336
 v_cvt_pk_bf16_f32 v91, v14, v15
 v_mfma_f32_16x16x32_bf16 v[212:215], a[84:87], v[76:79], v[212:215]
 v_exp_f32 v16, v60
 v_mfma_f32_16x16x32_bf16 v[212:215], a[80:83], v[68:71], v[212:215]
 ds_read_b128 a[116:119], v2 offset:30720
 v_or3_b32 v24, v24, v90, v91
 v_mfma_f32_16x16x32_bf16 v[220:223], a[88:91], v[68:71], v[220:223]
 s_waitcnt lgkmcnt(2)
 buffer_load_dwordx4 v1, s[16:19], s35 offen offset:3072 sc1 lds
 v_mfma_f32_16x16x32_bf16 v[220:223], a[92:95], v[76:79], v[220:223]
 ds_read_b128 a[120:123], v2 offset:15360
 v_mfma_f32_16x16x32_bf16 v[216:219], a[92:95], v[72:75], v[216:219]
 s_sub_u32 s33, s33, 1
 v_exp_f32 v17, v61
 v_mfma_f32_16x16x32_bf16 v[216:219], a[88:91], v[64:67], v[216:219]
 ds_read_b128 a[124:127], v2 offset:31744
 v_cvt_pk_bf16_f32 v94, v16, v17
 v_mfma_f32_16x16x32_bf16 v[224:227], a[96:99], v[64:67], v[224:227]
 v_exp_f32 v18, v62
 v_mfma_f32_16x16x32_bf16 v[224:227], a[100:103], v[72:75], v[224:227]
 v_mfma_f32_16x16x32_bf16 v[228:231], a[100:103], v[76:79], v[228:231]
 v_exp_f32 v19, v63
 v_mfma_f32_16x16x32_bf16 v[228:231], a[96:99], v[68:71], v[228:231]
 v_cvt_pk_bf16_f32 v95, v18, v19
 v_mfma_f32_16x16x32_bf16 v[236:239], a[104:107], v[68:71], v[236:239]
 s_waitcnt vmcnt(16) lgkmcnt(0)
 s_barrier
 v_mfma_f32_16x16x32_bf16 v[236:239], a[108:111], v[76:79], v[236:239]
 ds_read_b128 a[64:67], v1 offset:0
 v_or3_b32 v24, v24, v94, v95
 v_mfma_f32_16x16x32_bf16 v[232:235], a[108:111], v[72:75], v[232:235]
 s_cmp_eq_u32 s33, s28
 s_cselect_b32 s20, s23, 0x8000
 ds_read_b128 a[68:71], v1 offset:1024
 v_mfma_f32_16x16x32_bf16 v[232:235], a[104:107], v[64:67], v[232:235]
 ds_read_b128 a[72:75], v1 offset:2048
 v_and_b32 v24, 0x40004000, v24
 v_mfma_f32_16x16x32_bf16 v[240:243], a[112:115], v[64:67], v[240:243]
 s_cmp_eq_u32 s33, s8
 s_cselect_b32 s20, s9, s20
 ds_read_b128 a[76:79], v1 offset:3072
 v_mfma_f32_16x16x32_bf16 v[240:243], a[116:119], v[72:75], v[240:243]
 ds_read_b128 a[80:83], v1 offset:4096
 v_cmp_ne_u32 vcc, 0, v24
 v_mfma_f32_16x16x32_bf16 v[244:247], a[116:119], v[76:79], v[244:247]
 s_add_u32 s30, s30, s20
 ds_read_b128 a[84:87], v1 offset:5120
 v_mfma_f32_16x16x32_bf16 v[244:247], a[112:115], v[68:71], v[244:247]
 s_cmp_gt_i32 s33, 0
 s_cselect_b32 s30, s30, 1879048192
 ds_read_b128 a[88:91], v1 offset:6144
 v_mfma_f32_16x16x32_bf16 v[252:255], a[120:123], v[68:71], v[252:255]
 ds_read_b128 a[92:95], v1 offset:7168
 v_mfma_f32_16x16x32_bf16 v[252:255], a[124:127], v[76:79], v[252:255]
 v_mfma_f32_16x16x32_bf16 v[248:251], a[124:127], v[72:75], v[248:251]
 s_cmp_le_u32 s29, s10
 v_mfma_f32_16x16x32_bf16 v[248:251], a[120:123], v[64:67], v[248:251]
 s_cbranch_scc1 L_endg0
 s_cbranch_vccnz L_rare0
L_top1:
 s_waitcnt lgkmcnt(2)
 v_mfma_f32_16x16x32_bf16 v[32:35], a[64:67], a[0:3], v[4:7]
 s_add_u32 m0, s32, 65536
 ds_read_b128 a[96:99], v1 offset:8192
 v_mfma_f32_16x16x32_bf16 v[32:35], a[68:71], a[4:7], v[32:35]
 s_add_u32 s35, s31, 0
 ds_read_b128 a[100:103], v1 offset:9216
 v_mfma_f32_16x16x32_bf16 v[32:35], a[72:75], a[8:11], v[32:35]
 buffer_load_dwordx4 v1, s[16:19], s35 offen offset:0 sc1 lds
 v_mfma_f32_16x16x32_bf16 v[32:35], a[76:79], a[12:15], v[32:35]
 ds_read_b128 a[104:107], v1 offset:10240
 v_mfma_f32_16x16x32_bf16 v[32:35], a[80:83], a[16:19], v[32:35]
 ds_read_b128 a[108:111], v1 offset:11264
 v_mfma_f32_16x16x32_bf16 v[32:35], a[84:87], a[20:23], v[32:35]
 s_waitcnt lgkmcnt(3)
 ds_read_b128 a[112:115], v1 offset:12288
 v_mfma_f32_16x16x32_bf16 v[32:35], a[88:91], a[24:27], v[32:35]
 buffer_load_dwordx4 v1, s[16:19], s35 offen offset:1024 sc1 lds
 v_mfma_f32_16x16x32_bf16 v[32:35], a[92:95], a[28:31], v[32:35]
 ds_read_b128 a[116:119], v1 offset:13312
 v_mfma_f32_16x16x32_bf16 v[36:39], a[64:67], a[32:35], v[8:11]
 ds_read_b128 a[120:123], v1 offset:14336
 v_mfma_f32_16x16x32_bf16 v[36:39], a[68:71], a[36:39], v[36:39]
 ds_read_b128 a[124:127], v1 offset:15360
 v_mfma_f32_16x16x32_bf16 v[36:39], a[72:75], a[40:43], v[36:39]
 buffer_load_dwordx4 v1, s[16:19], s35 offen offset:2048 sc1 lds
 v_mfma_f32_16x16x32_bf16 v[36:39], a[76:79], a[44:47], v[36:39]
 ds_read_b128 a[64:67], v1 offset:16384
 v_mfma_f32_16x16x32_bf16 v[36:39], a[80:83], a[48:51], v[36:39]
 ds_read_b128 a[68:71], v1 offset:17408
 v_mfma_f32_16x16x32_bf16 v[36:39], a[84:87], a[52:55], v[36:39]
 ds_read_b128 a[72:75], v1 offset:18432
 v_mfma_f32_16x16x32_bf16 v[36:39], a[88:91], a[56:59], v[36:39]
 buffer_load_dwordx4 v1, s[16:19], s35 offen offset:3072 sc1 lds
 v_mfma_f32_16x16x32_bf16 v[36:39], a[92:95], a[60:63], v[36:39]
 ds_read_b128 a[76:79], v1 offset:19456
 v_mfma_f32_16x16x32_bf16 v[40:43], a[96:99], a[0:3], v[4:7]
 s_waitcnt lgkmcnt(3)
 s_add_u32 m0, s32, 69632
 ds_read_b128 a[80:83], v1 offset:20480
 v_mfma_f32_16x16x32_bf16 v[40:43], a[100:103], a[4:7], v[40:43]
 s_add_u32 s35, s31, 4096
 ds_read_b128 a[84:87], v1 offset:21504
 v_mfma_f32_16x16x32_bf16 v[40:43], a[104:107], a[8:11], v[40:43]
 buffer_load_dwordx4 v1, s[16:19], s35 offen offset:0 sc1 lds
 v_mfma_f32_16x16x32_bf16 v[40:43], a[108:111], a[12:15], v[40:43]
 ds_read_b128 a[88:91], v1 offset:22528
 v_mfma_f32_16x16x32_bf16 v[40:43], a[112:115], a[16:19], v[40:43]
 ds_read_b128 a[92:95], v1 offset:23552
 v_mfma_f32_16x16x32_bf16 v[40:43], a[116:119], a[20:23], v[40:43]
 v_exp_f32 v12, v32
 v_mfma_f32_16x16x32_bf16 v[40:43], a[120:123], a[24:27], v[40:43]
 buffer_load_dwordx4 v1, s[16:19], s35 offen offset:1024 sc1 lds
 v_mfma_f32_16x16x32_bf16 v[40:43], a[124:127], a[28:31], v[40:43]
 v_exp_f32 v13, v33
 v_mfma_f32_16x16x32_bf16 v[44:47], a[96:99], a[32:35], v[8:11]
 ds_read_b128 a[96:99], v1 offset:24576
 v_cvt_pk_bf16_f32 v64, v12, v13
 v_mfma_f32_16x16x32_bf16 v[44:47], a[100:103], a[36:39], v[44:47]
 ds_read_b128 a[100:103], v1 offset:25600
 v_mfma_f32_16x16x32_bf16 v[44:47], a[104:107], a[40:43], v[44:47]
 buffer_load_dwordx4 v1, s[16:19], s35 offen offset:2048 sc1 lds
 v_mfma_f32_16x16x32_bf16 v[44:47], a[108:111], a[44:47], v[44:47]
 ds_read_b128 a[104:107], v1 offset:26624
 v_mfma_f32_16x16x32_bf16 v[44:47], a[112:115], a[48:51], v[44:47]
 ds_read_b128 a[108:111], v1 offset:27648
 v_mfma_f32_16x16x32_bf16 v[44:47], a[116:119], a[52:55], v[44:47]
 ds_read_b128 a[112:115], v1 offset:28672
 v_mfma_f32_16x16x32_bf16 v[44:47], a[120:123], a[56:59], v[44:47]
 buffer_load_dwordx4 v1, s[16:19], s35 offen offset:3072 sc1 lds
 v_mfma_f32_16x16x32_bf16 v[44:47], a[124:127], a[60:63], v[44:47]
 ds_read_b128 a[116:119], v1 offset:29696
 v_mfma_f32_16x16x32_bf16 v[48:51], a[64:67], a[0:3], v[4:7]
 s_waitcnt lgkmcnt(3)
 ds_read_b128 a[120:123], v1 offset:30720
 v_mfma_f32_16x16x32_bf16 v[48:51], a[68:71], a[4:7], v[48:51]
 ds_read_b128 a[124:127], v1 offset:31744
 v_mfma_f32_16x16x32_bf16 v[48:51], a[72:75], a[8:11], v[48:51]
 v_exp_f32 v14, v34
 v_mfma_f32_16x16x32_bf16 v[48:51], a[76:79], a[12:15], v[48:51]
 v_exp_f32 v15, v35
 v_mfma_f32_16x16x32_bf16 v[48:51], a[80:83], a[16:19], v[48:51]
 v_exp_f32 v16, v36
 v_mfma_f32_16x16x32_bf16 v[48:51], a[84:87], a[20:23], v[48:51]
 s_add_u32 m0, s32, 0
 v_exp_f32 v17, v37
 v_mfma_f32_16x16x32_bf16 v[48:51], a[88:91], a[24:27], v[48:51]
 s_waitcnt vmcnt(16) lgkmcnt(0)
 s_barrier
 v_cvt_pk_bf16_f32 v65, v14, v15
 v_mfma_f32_16x16x32_bf16 v[48:51], a[92:95], a[28:31], v[48:51]
 s_add_u32 s35, s30, 0
 v_or_b32 v24, v64, v65
 v_mfma_f32_16x16x32_bf16 v[52:55], a[64:67], a[32:35], v[8:11]
 buffer_load_dwordx4 v1, s[16:19], s35 offen offset:0 sc1 lds
 v_mfma_f32_16x16x32_bf16 v[52:55], a[68:71], a[36:39], v[52:55]
 v_cvt_pk_bf16_f32 v68, v16, v17
 v_mfma_f32_16x16x32_bf16 v[52:55], a[72:75], a[40:43], v[52:55]
 v_exp_f32 v18, v38
 v_mfma_f32_16x16x32_bf16 v[52:55], a[76:79], a[44:47], v[52:55]
 s_sub_u32 s34, s34, 1
 v_mfma_f32_16x16x32_bf16 v[52:55], a[80:83], a[48:51], v[52:55]
 v_exp_f32 v19, v39
 v_mfma_f32_16x16x32_bf16 v[52:55], a[84:87], a[52:55], v[52:55]
 s_cmp_eq_u32 s34, s28
 s_cselect_b32 s21, s23, 0x8000
 v_mfma_f32_16x16x32_bf16 v[52:55], a[88:91], a[56:59], v[52:55]
 buffer_load_dwordx4 v1, s[16:19], s35 offen offset:1024 sc1 lds
 v_mfma_f32_16x16x32_bf16 v[52:55], a[92:95], a[60:63], v[52:55]
 ds_read_b128 a[64:67], v2 offset:32768
 v_cvt_pk_bf16_f32 v69, v18, v19
 v_mfma_f32_16x16x32_bf16 v[56:59], a[96:99], a[0:3], v[4:7]
 s_cmp_eq_u32 s34, s8
 s_cselect_b32 s21, s9, s21
 v_mfma_f32_16x16x32_bf16 v[56:59], a[100:103], a[4:7], v[56:59]
 ds_read_b128 a[68:71], v2 offset:49152
 v_or3_b32 v24, v24, v68, v69
 v_mfma_f32_16x16x32_bf16 v[56:59], a[104:107], a[8:11], v[56:59]
 s_add_u32 s31, s31, s21
 v_mfma_f32_16x16x32_bf16 v[56:59], a[108:111], a[12:15], v[56:59]
 ds_read_b128 a[72:75], v2 offset:33792
 v_mfma_f32_16x16x32_bf16 v[56:59], a[112:115], a[16:19], v[56:59]
 buffer_load_dwordx4 v1, s[16:19], s35 offen offset:2048 sc1 lds
 v_mfma_f32_16x16x32_bf16 v[56:59], a[116:119], a[20:23], v[56:59]
 ds_read_b128 a[76:79], v2 offset:50176
 v_mfma_f32_16x16x32_bf16 v[56:59], a[120:123], a[24:27], v[56:59]
 s_cmp_gt_i32 s34, 0
 s_cselect_b32 s31, s31, 1879048192
 v_mfma_f32_16x16x32_bf16 v[56:59], a[124:127], a[28:31], v[56:59]
 ds_read_b128 a[80:83], v2 offset:34816
 v_mfma_f32_16x16x32_bf16 v[60:63], a[96:99], a[32:35], v[8:11]
 v_mfma_f32_16x16x32_bf16 v[60:63], a[100:103], a[36:39], v[60:63]
 ds_read_b128 a[84:87], v2 offset:51200
 v_mfma_f32_16x16x32_bf16 v[60:63], a[104:107], a[40:43], v[60:63]
 buffer_load_dwordx4 v1, s[16:19], s35 offen offset:3072 sc1 lds
 v_mfma_f32_16x16x32_bf16 v[60:63], a[108:111], a[44:47], v[60:63]
 ds_read_b128 a[88:91], v2 offset:35840
 v_mfma_f32_16x16x32_bf16 v[60:63], a[112:115], a[48:51], v[60:63]
 v_mfma_f32_16x16x32_bf16 v[60:63], a[116:119], a[52:55], v[60:63]
 ds_read_b128 a[92:95], v2 offset:52224
 v_mfma_f32_16x16x32_bf16 v[60:63], a[120:123], a[56:59], v[60:63]
 s_cmp_le_u32 s29, s36
 v_mfma_f32_16x16x32_bf16 v[60:63], a[124:127], a[60:63], v[60:63]
 s_cbranch_scc1 L_mask1
L_B1:
 v_mfma_f32_16x16x32_bf16 v[96:99], v[104:107], v[80:83], v[96:99]
 s_sub_u32 s29, s29, 1
 v_exp_f32 v20, v40
 v_mfma_f32_16x16x32_bf16 v[96:99], v[104:107], v[88:91], v[96:99]
 s_add_u32 m0, s32, 4096
 v_mfma_f32_16x16x32_bf16 v[100:103], v[104:107], v[84:87], v[100:103]
 s_add_u32 s35, s30, 4096
 v_exp_f32 v21, v41
 v_mfma_f32_16x16x32_bf16 v[100:103], v[104:107], v[92:95], v[100:103]
 s_waitcnt lgkmcnt(0)
 v_cvt_pk_bf16_f32 v66, v20, v21
 v_mfma_f32_16x16x32_bf16 v[128:131], a[64:67], v[80:83], v[128:131]
 v_exp_f32 v22, v42
 v_mfma_f32_16x16x32_bf16 v[128:131], a[68:71], v[88:91], v[128:131]
 ds_read_b128 a[96:99], v2 offset:36864
 v_mfma_f32_16x16x32_bf16 v[132:135], a[68:71], v[92:95], v[132:135]
 buffer_load_dwordx4 v1, s[16:19], s35 offen offset:0 sc1 lds
 v_mfma_f32_16x16x32_bf16 v[132:135], a[64:67], v[84:87], v[132:135]
 ds_read_b128 a[100:103], v2 offset:53248
 v_mfma_f32_16x16x32_bf16 v[140:143], a[72:75], v[84:87], v[140:143]
 v_exp_f32 v23, v43
 v_mfma_f32_16x16x32_bf16 v[140:143], a[76:79], v[92:95], v[140:143]
 ds_read_b128 a[104:107], v2 offset:37888
 v_cvt_pk_bf16_f32 v67, v22, v23
 v_mfma_f32_16x16x32_bf16 v[136:139], a[76:79], v[88:91], v[136:139]
 v_exp_f32 v12, v44
 v_mfma_f32_16x16x32_bf16 v[136:139], a[72:75], v[80:83], v[136:139]
 ds_read_b128 a[108:111], v2 offset:54272
 v_or3_b32 v24, v24, v66, v67
 v_mfma_f32_16x16x32_bf16 v[144:147], a[80:83], v[80:83], v[144:147]
 v_exp_f32 v13, v45
 v_mfma_f32_16x16x32_bf16 v[144:147], a[84:87], v[88:91], v[144:147]
 ds_read_b128 a[112:115], v2 offset:38912
 v_cvt_pk_bf16_f32 v70, v12, v13
 v_mfma_f32_16x16x32_bf16 v[148:151], a[84:87], v[92:95], v[148:151]
 v_exp_f32 v14, v46
 v_mfma_f32_16x16x32_bf16 v[148:151], a[80:83], v[84:87], v[148:151]
 ds_read_b128 a[116:119], v2 offset:55296
 v_mfma_f32_16x16x32_bf16 v[156:159], a[88:91], v[84:87], v[156:159]
 v_exp_f32 v15, v47
 v_mfma_f32_16x16x32_bf16 v[156:159], a[92:95], v[92:95], v[156:159]
 ds_read_b128 a[120:123], v2 offset:39936
 v_cvt_pk_bf16_f32 v71, v14, v15
 v_mfma_f32_16x16x32_bf16 v[152:155], a[92:95], v[88:91], v[152:155]
 v_exp_f32 v16, v48
 v_mfma_f32_16x16x32_bf16 v[152:155], a[88:91], v[80:83], v[152:155]
 s_waitcnt lgkmcnt(2)
 ds_read_b128 a[124:127], v2 offset:56320
 v_or3_b32 v24, v24, v70, v71
 v_mfma_f32_16x16x32_bf16 v[160:163], a[96:99], v[80:83], v[160:163]
 buffer_load_dwordx4 v1, s[16:19], s35 offen offset:1024 sc1 lds
 v_mfma_f32_16x16x32_bf16 v[160:163], a[100:103], v[88:91], v[160:163]
 ds_read_b128 a[64:67], v2 offset:40960
 v_mfma_f32_16x16x32_bf16 v[164:167], a[100:103], v[92:95], v[164:167]
 v_exp_f32 v17, v49
 v_mfma_f32_16x16x32_bf16 v[164:167], a[96:99], v[84:87], v[164:167]
 ds_read_b128 a[68:71], v2 offset:57344
 v_cvt_pk_bf16_f32 v72, v16, v17
 v_mfma_f32_16x16x32_bf16 v[172:175], a[104:107], v[84:87], v[172:175]
 v_exp_f32 v18, v50
 v_mfma_f32_16x16x32_bf16 v[172:175], a[108:111], v[92:95], v[172:175]
 ds_read_b128 a[72:75], v2 offset:41984
 v_mfma_f32_16x16x32_bf16 v[168:171], a[108:111], v[88:91], v[168:171]
 v_exp_f32 v19, v51
 v_mfma_f32_16x16x32_bf16 v[168:171], a[104:107], v[80:83], v[168:171]
 ds_read_b128 a[76:79], v2 offset:58368
 v_cvt_pk_bf16_f32 v73, v18, v19
 v_mfma_f32_16x16x32_bf16 v[176:179], a[112:115], v[80:83], v[176:179]
 s_waitcnt lgkmcnt(2)
 v_exp_f32 v20, v52
 v_mfma_f32_16x16x32_bf16 v[176:179], a[116:119], v[88:91], v[176:179]
 ds_read_b128 a[80:83], v2 offset:43008
 v_or3_b32 v24, v24, v72, v73
 v_mfma_f32_16x16x32_bf16 v[180:183], a[116:119], v[92:95], v[180:183]
 v_exp_f32 v21, v53
 v_mfma_f32_16x16x32_bf16 v[180:183], a[112:115], v[84:87], v[180:183]
 ds_read_b128 a[84:87], v2 offset:59392
 v_cvt_pk_bf16_f32 v76, v20, v21
 v_mfma_f32_16x16x32_bf16 v[188:191], a[120:123], v[84:87], v[188:191]
 v_exp_f32 v22, v54
 v_mfma_f32_16x16x32_bf16 v[188:191], a[124:127], v[92:95], v[188:191]
 ds_read_b128 a[88:91], v2 offset:44032
 v_mfma_f32_16x16x32_bf16 v[184:187], a[124:127], v[88:91], v[184:187]
 buffer_load_dwordx4 v1, s[16:19], s35 offen offset:2048 sc1 lds
 v_mfma_f32_16x16x32_bf16 v[184:187], a[120:123], v[80:83], v[184:187]
 ds_read_b128 a[92:95], v2 offset:60416
 v_mfma_f32_16x16x32_bf16 v[192:195], a[64:67], v[80:83], v[192:195]
 v_exp_f32 v23, v55
 v_mfma_f32_16x16x32_bf16 v[192:195], a[68:71], v[88:91], v[192:195]
 ds_read_b128 a[96:99], v2 offset:45056
 v_cvt_pk_bf16_f32 v77, v22, v23
 v_mfma_f32_16x16x32_bf16 v[196:199], a[68:71], v[92:95], v[196:199]
 v_exp_f32 v12, v56
 v_mfma_f32_16x16x32_bf16 v[196:199], a[64:67], v[84:87], v[196:199]
 s_waitcnt lgkmcnt(2)
 ds_read_b128 a[100:103], v2 offset:61440
 v_or3_b32 v24, v24, v76, v77
 v_mfma_f32_16x16x32_bf16 v[204:207], a[72:75], v[84:87], v[204:207]
 v_exp_f32 v13, v57
 v_mfma_f32_16x16x32_bf16 v[204:207], a[76:79], v[92:95], v[204:207]
 ds_read_b128 a[104:107], v2 offset:46080
 v_cvt_pk_bf16_f32 v74, v12, v13
 v_mfma_f32_16x16x32_bf16 v[200:203], a[76:79], v[88:91], v[200:203]
 v_exp_f32 v14, v58
 v_mfma_f32_16x16x32_bf16 v[200:203], a[72:75], v[80:83], v[200:203]
 ds_read_b128 a[108:111], v2 offset:62464
 v_mfma_f32_16x16x32_bf16 v[208:211], a[80:83], v[80:83], v[208:211]
 v_exp_f32 v15, v59
 v_mfma_f32_16x16x32_bf16 v[208:211], a[84:87], v[88:91], v[208:211]
 ds_read_b128 a[112:115], v2 offset:47104
 v_cvt_pk_bf16_f32 v75, v14, v15
 v_mfma_f32_16x16x32_bf16 v[212:215], a[84:87], v[92:95], v[212:215]
 v_exp_f32 v16, v60
 v_mfma_f32_16x16x32_bf16 v[212:215], a[80:83], v[84:87], v[212:215]
 ds_read_b128 a[116:119], v2 offset:63488
 v_or3_b32 v24, v24, v74, v75
 v_mfma_f32_16x16x32_bf16 v[220:223], a[88:91], v[84:87], v[220:223]
 s_waitcnt lgkmcnt(2)
 buffer_load_dwordx4 v1, s[16:19], s35 offen offset:3072 sc1 lds
 v_mfma_f32_16x16x32_bf16 v[220:223], a[92:95], v[92:95], v[220:223]
 ds_read_b128 a[120:123], v2 offset:48128
 v_mfma_f32_16x16x32_bf16 v[216:219], a[92:95], v[88:91], v[216:219]
 s_sub_u32 s33, s33, 1
 v_exp_f32 v17, v61
 v_mfma_f32_16x16x32_bf16 v[216:219], a[88:91], v[80:83], v[216:219]
 ds_read_b128 a[124:127], v2 offset:64512
 v_cvt_pk_bf16_f32 v78, v16, v17
 v_mfma_f32_16x16x32_bf16 v[224:227], a[96:99], v[80:83], v[224:227]
 v_exp_f32 v18, v62
 v_mfma_f32_16x16x32_bf16 v[224:227], a[100:103], v[88:91], v[224:227]
 v_mfma_f32_16x16x32_bf16 v[228:231], a[100:103], v[92:95], v[228:231]
 v_exp_f32 v19, v63
 v_mfma_f32_16x16x32_bf16 v[228:231], a[96:99], v[84:87], v[228:231]
 v_cvt_pk_bf16_f32 v79, v18, v19
 v_mfma_f32_16x16x32_bf16 v[236:239], a[104:107], v[84:87], v[236:239]
 s_waitcnt vmcnt(16) lgkmcnt(0)
 s_barrier
 v_mfma_f32_16x16x32_bf16 v[236:239], a[108:111], v[92:95], v[236:239]
 ds_read_b128 a[64:67], v1 offset:32768
 v_or3_b32 v24, v24, v78, v79
 v_mfma_f32_16x16x32_bf16 v[232:235], a[108:111], v[88:91], v[232:235]
 s_cmp_eq_u32 s33, s28
 s_cselect_b32 s20, s23, 0x8000
 ds_read_b128 a[68:71], v1 offset:33792
 v_mfma_f32_16x16x32_bf16 v[232:235], a[104:107], v[80:83], v[232:235]
 ds_read_b128 a[72:75], v1 offset:34816
 v_and_b32 v24, 0x40004000, v24
 v_mfma_f32_16x16x32_bf16 v[240:243], a[112:115], v[80:83], v[240:243]
 s_cmp_eq_u32 s33, s8
 s_cselect_b32 s20, s9, s20
 ds_read_b128 a[76:79], v1 offset:35840
 v_mfma_f32_16x16x32_bf16 v[240:243], a[116:119], v[88:91], v[240:243]
 ds_read_b128 a[80:83], v1 offset:36864
 v_cmp_ne_u32 vcc, 0, v24
 v_mfma_f32_16x16x32_bf16 v[244:247], a[116:119], v[92:95], v[244:247]
 s_add_u32 s30, s30, s20
 ds_read_b128 a[84:87], v1 offset:37888
 v_mfma_f32_16x16x32_bf16 v[244:247], a[112:115], v[84:87], v[244:247]
 s_cmp_gt_i32 s33, 0
 s_cselect_b32 s30, s30, 1879048192
 ds_read_b128 a[88:91], v1 offset:38912
 v_mfma_f32_16x16x32_bf16 v[252:255], a[120:123], v[84:87], v[252:255]
 ds_read_b128 a[92:95], v1 offset:39936
 v_mfma_f32_16x16x32_bf16 v[252:255], a[124:127], v[92:95], v[252:255]
 v_mfma_f32_16x16x32_bf16 v[248:251], a[124:127], v[88:91], v[248:251]
 s_cmp_le_u32 s29, s10
 v_mfma_f32_16x16x32_bf16 v[248:251], a[120:123], v[80:83], v[248:251]
 s_cbranch_scc1 L_endg1
 s_cbranch_vccz L_top0
L_rare1:
 s_nop 7
 v_max3_f32 v12, v32, v33, v34
 v_max3_f32 v12, v12, v35, v40
 v_max3_f32 v12, v12, v41, v42
 v_max3_f32 v12, v12, v43, v48
 v_max3_f32 v12, v12, v49, v50
 v_max3_f32 v12, v12, v51, v56
 v_max3_f32 v12, v12, v57, v58
 v_max_f32 v12, v12, v59
 v_max3_f32 v14, v36, v37, v38
 v_max3_f32 v14, v14, v39, v44
 v_max3_f32 v14, v14, v45, v46
 v_max3_f32 v14, v14, v47, v52
 v_max3_f32 v14, v14, v53, v54
 v_max3_f32 v14, v14, v55, v60
 v_max3_f32 v14, v14, v61, v62
 v_max_f32 v14, v14, v63
 v_mov_b32 v13, v12
 v_mov_b32 v15, v14
 s_nop 0
 v_permlane16_swap_b32 v12, v13
 v_permlane16_swap_b32 v14, v15
 v_max_f32 v12, v12, v13
 v_max_f32 v14, v14, v15
 v_mov_b32 v13, v12
 v_mov_b32 v15, v14
 s_nop 0
 v_permlane32_swap_b32 v12, v13
 v_permlane32_swap_b32 v14, v15
 v_max_f32 v12, v12, v13
 v_max_f32 v14, v14, v15
 v_sub_f32 v12, 0xc0c00000, v12
 v_floor_f32 v12, v12
 v_min_f32 v12, 0, v12
 v_mov_b32 v13, v12
 v_sub_f32 v14, 0xc0c00000, v14
 v_floor_f32 v14, v14
 v_min_f32 v14, 0, v14
 v_mov_b32 v15, v14
 v_pk_add_f32 v[4:5], v[4:5], v[12:13]
 v_pk_add_f32 v[6:7], v[6:7], v[12:13]
 v_pk_add_f32 v[32:33], v[32:33], v[12:13]
 v_pk_add_f32 v[34:35], v[34:35], v[12:13]
 v_pk_add_f32 v[40:41], v[40:41], v[12:13]
 v_pk_add_f32 v[42:43], v[42:43], v[12:13]
 v_pk_add_f32 v[48:49], v[48:49], v[12:13]
 v_pk_add_f32 v[50:51], v[50:51], v[12:13]
 v_pk_add_f32 v[56:57], v[56:57], v[12:13]
 v_pk_add_f32 v[58:59], v[58:59], v[12:13]
 v_pk_add_f32 v[8:9], v[8:9], v[14:15]
 v_pk_add_f32 v[10:11], v[10:11], v[14:15]
 v_pk_add_f32 v[36:37], v[36:37], v[14:15]
 v_pk_add_f32 v[38:39], v[38:39], v[14:15]
 v_pk_add_f32 v[44:45], v[44:45], v[14:15]
 v_pk_add_f32 v[46:47], v[46:47], v[14:15]
 v_pk_add_f32 v[52:53], v[52:53], v[14:15]
 v_pk_add_f32 v[54:55], v[54:55], v[14:15]
 v_pk_add_f32 v[60:61], v[60:61], v[14:15]
 v_pk_add_f32 v[62:63], v[62:63], v[14:15]
 v_exp_f32 v12, v12
 s_nop 0
 v_mov_b32 v13, v12
 v_pk_mul_f32 v[128:129], v[128:129], v[12:13]
 v_pk_mul_f32 v[130:131], v[130:131], v[12:13]
 v_pk_mul_f32 v[136:137], v[136:137], v[12:13]
 v_pk_mul_f32 v[138:139], v[138:139], v[12:13]
 v_pk_mul_f32 v[144:145], v[144:145], v[12:13]
 v_pk_mul_f32 v[146:147], v[146:147], v[12:13]
 v_pk_mul_f32 v[152:153], v[152:153], v[12:13]
 v_pk_mul_f32 v[154:155], v[154:155], v[12:13]
 v_pk_mul_f32 v[160:161], v[160:161], v[12:13]
 v_pk_mul_f32 v[162:163], v[162:163], v[12:13]
 v_pk_mul_f32 v[168:169], v[168:169], v[12:13]
 v_pk_mul_f32 v[170:171], v[170:171], v[12:13]
 v_pk_mul_f32 v[176:177], v[176:177], v[12:13]
 v_pk_mul_f32 v[178:179], v[178:179], v[12:13]
 v_pk_mul_f32 v[184:185], v[184:185], v[12:13]
 v_pk_mul_f32 v[186:187], v[186:187], v[12:13]
 v_pk_mul_f32 v[192:193], v[192:193], v[12:13]
 v_pk_mul_f32 v[194:195], v[194:195], v[12:13]
 v_pk_mul_f32 v[200:201], v[200:201], v[12:13]
 v_pk_mul_f32 v[202:203], v[202:203], v[12:13]
 v_pk_mul_f32 v[208:209], v[208:209], v[12:13]
 v_pk_mul_f32 v[210:211], v[210:211], v[12:13]
 v_pk_mul_f32 v[216:217], v[216:217], v[12:13]
 v_pk_mul_f32 v[218:219], v[218:219], v[12:13]
 v_pk_mul_f32 v[224:225], v[224:225], v[12:13]
 v_pk_mul_f32 v[226:227], v[226:227], v[12:13]
 v_pk_mul_f32 v[232:233], v[232:233], v[12:13]
 v_pk_mul_f32 v[234:235], v[234:235], v[12:13]
 v_pk_mul_f32 v[240:241], v[240:241], v[12:13]
 v_pk_mul_f32 v[242:243], v[242:243], v[12:13]
 v_pk_mul_f32 v[248:249], v[248:249], v[12:13]
 v_pk_mul_f32 v[250:251], v[250:251], v[12:13]
 v_pk_mul_f32 v[96:97], v[96:97], v[12:13]
 v_pk_mul_f32 v[98:99], v[98:99], v[12:13]
 v_exp_f32 v14, v14
 s_nop 0
 v_mov_b32 v15, v14
 v_pk_mul_f32 v[132:133], v[132:133], v[14:15]
 v_pk_mul_f32 v[134:135], v[134:135], v[14:15]
 v_pk_mul_f32 v[140:141], v[140:141], v[14:15]
 v_pk_mul_f32 v[142:143], v[142:143], v[14:15]
 v_pk_mul_f32 v[148:149], v[148:149], v[14:15]
 v_pk_mul_f32 v[150:151], v[150:151], v[14:15]
 v_pk_mul_f32 v[156:157], v[156:157], v[14:15]
 v_pk_mul_f32 v[158:159], v[158:159], v[14:15]
 v_pk_mul_f32 v[164:165], v[164:165], v[14:15]
 v_pk_mul_f32 v[166:167], v[166:167], v[14:15]
 v_pk_mul_f32 v[172:173], v[172:173], v[14:15]
 v_pk_mul_f32 v[174:175], v[174:175], v[14:15]
 v_pk_mul_f32 v[180:181], v[180:181], v[14:15]
 v_pk_mul_f32 v[182:183], v[182:183], v[14:15]
 v_pk_mul_f32 v[188:189], v[188:189], v[14:15]
 v_pk_mul_f32 v[190:191], v[190:191], v[14:15]
 v_pk_mul_f32 v[196:197], v[196:197], v[14:15]
 v_pk_mul_f32 v[198:199], v[198:199], v[14:15]
 v_pk_mul_f32 v[204:205], v[204:205], v[14:15]
 v_pk_mul_f32 v[206:207], v[206:207], v[14:15]
 v_pk_mul_f32 v[212:213], v[212:213], v[14:15]
 v_pk_mul_f32 v[214:215], v[214:215], v[14:15]
 v_pk_mul_f32 v[220:221], v[220:221], v[14:15]
 v_pk_mul_f32 v[222:223], v[222:223], v[14:15]
 v_pk_mul_f32 v[228:229], v[228:229], v[14:15]
 v_pk_mul_f32 v[230:231], v[230:231], v[14:15]
 v_pk_mul_f32 v[236:237], v[236:237], v[14:15]
 v_pk_mul_f32 v[238:239], v[238:239], v[14:15]
 v_pk_mul_f32 v[244:245], v[244:245], v[14:15]
 v_pk_mul_f32 v[246:247], v[246:247], v[14:15]
 v_pk_mul_f32 v[252:253], v[252:253], v[14:15]
 v_pk_mul_f32 v[254:255], v[254:255], v[14:15]
 v_pk_mul_f32 v[100:101], v[100:101], v[14:15]
 v_pk_mul_f32 v[102:103], v[102:103], v[14:15]
 v_exp_f32 v12, v32
 v_exp_f32 v13, v33
 v_exp_f32 v14, v34
 v_exp_f32 v15, v35
 v_cvt_pk_bf16_f32 v64, v12, v13
 v_cvt_pk_bf16_f32 v65, v14, v15
 v_or_b32 v24, v64, v65
 v_exp_f32 v16, v36
 v_exp_f32 v17, v37
 v_exp_f32 v18, v38
 v_exp_f32 v19, v39
 v_cvt_pk_bf16_f32 v68, v16, v17
 v_cvt_pk_bf16_f32 v69, v18, v19
 v_or3_b32 v24, v24, v68, v69
 v_exp_f32 v20, v40
 v_exp_f32 v21, v41
 v_exp_f32 v22, v42
 v_exp_f32 v23, v43
 v_cvt_pk_bf16_f32 v66, v20, v21
 v_cvt_pk_bf16_f32 v67, v22, v23
 v_or3_b32 v24, v24, v66, v67
 v_exp_f32 v12, v44
 v_exp_f32 v13, v45
 v_exp_f32 v14, v46
 v_exp_f32 v15, v47
 v_cvt_pk_bf16_f32 v70, v12, v13
 v_cvt_pk_bf16_f32 v71, v14, v15
 v_or3_b32 v24, v24, v70, v71
 v_exp_f32 v16, v48
 v_exp_f32 v17, v49
 v_exp_f32 v18, v50
 v_exp_f32 v19, v51
 v_cvt_pk_bf16_f32 v72, v16, v17
 v_cvt_pk_bf16_f32 v73, v18, v19
 v_or3_b32 v24, v24, v72, v73
 v_exp_f32 v20, v52
 v_exp_f32 v21, v53
 v_exp_f32 v22, v54
 v_exp_f32 v23, v55
 v_cvt_pk_bf16_f32 v76, v20, v21
 v_cvt_pk_bf16_f32 v77, v22, v23
 v_or3_b32 v24, v24, v76, v77
 v_exp_f32 v12, v56
 v_exp_f32 v13, v57
 v_exp_f32 v14, v58
 v_exp_f32 v15, v59
 v_cvt_pk_bf16_f32 v74, v12, v13
 v_cvt_pk_bf16_f32 v75, v14, v15
 v_or3_b32 v24, v24, v74, v75
 v_exp_f32 v16, v60
 v_exp_f32 v17, v61
 v_exp_f32 v18, v62
 v_exp_f32 v19, v63
 v_cvt_pk_bf16_f32 v78, v16, v17
 v_cvt_pk_bf16_f32 v79, v18, v19
 v_or3_b32 v24, v24, v78, v79
 s_cmp_eq_u32 s12, 1
 s_cbranch_scc1 L_pk1
 s_cmp_eq_u32 s29, 1
 s_cbranch_scc0 L_top0
L_one1:
 s_cmp_eq_u32 s37, 3
 s_cbranch_scc1 L_preswitch
 s_branch L_last0
L_endg1:
 s_cmp_ge_u32 s11, 100
 s_cbranch_scc1 L_endh1
 s_add_u32 s11, s11, 1
 s_cmp_eq_u32 s11, 5
 s_cbranch_scc0 L_hk4_n
 s_add_u32 s38, s6, s22
 s_addc_u32 s39, s7, 0
 s_load_dword s42, s[38:39], 4 glc
 s_mov_b32 s10, 0x7fff
L_hk4_n:
 s_cmp_eq_u32 s11, 3
 s_cbranch_scc0 L_hk2_n
 v_mov_b32 v12, 1
 buffer_atomic_add v12, v25, s[16:19], s15 offen offset:4 sc1
L_hk2_n:
 s_cmp_eq_u32 s11, 1
 s_cbranch_scc0 L_hk0_n
 s_add_u32 s40, s40, s14
 buffer_store_dwordx4 a[184:187], v1, s[16:19], s40 offen sc1
 s_add_u32 s40, s40, s59
 buffer_store_dwordx4 a[188:191], v1, s[16:19], s40 offen sc1
 s_mul_i32 s40, s13, 0
 s_add_u32 s40, s40, s58
 s_add_u32 s40, s40, 524288
 buffer_store_dwordx4 a[128:131], v1, s[16:19], s40 offen sc1
 s_add_u32 s40, s40, s59
 buffer_store_dwordx4 a[132:135], v1, s[16:19], s40 offen sc1
 s_add_u32 s40, s40, s14
 buffer_store_dwordx4 a[136:139], v1, s[16:19], s40 offen sc1
L_hk0_n:
L_hkend1:
 s_cmp_le_u32 s29, 1
 s_cbranch_scc1 L_endh1
 s_cbranch_vccnz L_rare1
 s_branch L_top0
L_endh1:
 s_cbranch_vccnz L_rare1
 s_branch L_one1
L_mask1:
 s_lshl_b32 s38, s37, 2
 s_add_u32 s38, s38, s29
 s_cmp_eq_u32 s38, 14
 s_cbranch_scc1 L_getq
L_gotq:
 s_nop 7
 s_getpc_b64 s[20:21]
L_pcx21:
 s_add_u32 s20, s20, L_last0-L_pcx21
 s_addc_u32 s21, s21, 0
 s_lshl_b32 s38, s3, 13
 v_lshl_add_u32 v13, v0, 7, s38
 v_min_u32 v13, L_textend-L_last0-4, v13
 global_load_dword v27, v13, s[20:21]
 s_sub_u32 s38, 3, s29
 s_lshl_b32 s38, s38, 6
 s_lshl_b32 s39, s3, 5
 s_sub_u32 s38, s39, s38
 v_add_u32 v12, s38, v3
 v_cvt_f32_i32 v12, v12
 v_add_f32 v12, 0.5, v12
 v_mul_f32 v12, 0x7149f2ca, v12
 v_add_f32 v13, 0x7349f2ca, v12
 v_min_f32 v36, v36, v13
 v_add_f32 v14, 0x733d539d, v12
 v_min_f32 v37, v37, v14
 v_add_f32 v15, 0x7330b471, v12
 v_min_f32 v38, v38, v15
 v_add_f32 v16, 0x73241544, v12
 v_min_f32 v39, v39, v16
 v_add_f32 v13, 0x0, v12
 v_min_f32 v32, v32, v13
 v_min_f32 v44, v44, v13
 v_add_f32 v14, 0xf149f2ca, v12
 v_min_f32 v33, v33, v14
 v_min_f32 v45, v45, v14
 v_add_f32 v15, 0xf1c9f2ca, v12
 v_min_f32 v34, v34, v15
 v_min_f32 v46, v46, v15
 v_add_f32 v16, 0xf2177617, v12
 v_min_f32 v35, v35, v16
 v_min_f32 v47, v47, v16
 v_add_f32 v13, 0xf349f2ca, v12
 v_min_f32 v40, v40, v13
 v_min_f32 v52, v52, v13
 v_add_f32 v14, 0xf35691f6, v12
 v_min_f32 v41, v41, v14
 v_min_f32 v53, v53, v14
 v_add_f32 v15, 0xf3633123, v12
 v_min_f32 v42, v42, v15
 v_min_f32 v54, v54, v15
 v_add_f32 v16, 0xf36fd050, v12
 v_min_f32 v43, v43, v16
 v_min_f32 v55, v55, v16
 v_add_f32 v13, 0xf3c9f2ca, v12
 v_min_f32 v48, v48, v13
 v_min_f32 v60, v60, v13
 v_add_f32 v14, 0xf3d04260, v12
 v_min_f32 v49, v49, v14
 v_min_f32 v61, v61, v14
 v_add_f32 v15, 0xf3d691f6, v12
 v_min_f32 v50, v50, v15
 v_min_f32 v62, v62, v15
 v_add_f32 v16, 0xf3dce18d, v12
 v_min_f32 v51, v51, v16
 v_min_f32 v63, v63, v16
 v_add_f32 v13, 0xf4177617, v12
 v_min_f32 v56, v56, v13
 v_add_f32 v14, 0xf41a9de3, v12
 v_min_f32 v57, v57, v14
 v_add_f32 v15, 0xf41dc5ae, v12
 v_min_f32 v58, v58, v15
 v_add_f32 v16, 0xf420ed79, v12
 v_min_f32 v59, v59, v16
 v_exp_f32 v12, v32
 v_exp_f32 v13, v33
 v_exp_f32 v14, v34
 v_exp_f32 v15, v35
 v_cvt_pk_bf16_f32 v64, v12, v13
 v_cvt_pk_bf16_f32 v65, v14, v15
 v_or_b32 v24, v64, v65
 v_exp_f32 v16, v36
 v_exp_f32 v17, v37
 v_exp_f32 v18, v38
 v_exp_f32 v19, v39
 v_cvt_pk_bf16_f32 v68, v16, v17
 v_cvt_pk_bf16_f32 v69, v18, v19
 v_or3_b32 v24, v24, v68, v69
 s_branch L_B1
L_rare0:
 s_nop 7
 v_max3_f32 v12, v32, v33, v34
 v_max3_f32 v12, v12, v35, v40
 v_max3_f32 v12, v12, v41, v42
 v_max3_f32 v12, v12, v43, v48
 v_max3_f32 v12, v12, v49, v50
 v_max3_f32 v12, v12, v51, v56
 v_max3_f32 v12, v12, v57, v58
 v_max_f32 v12, v12, v59
 v_max3_f32 v14, v36, v37, v38
 v_max3_f32 v14, v14, v39, v44
 v_max3_f32 v14, v14, v45, v46
 v_max3_f32 v14, v14, v47, v52
 v_max3_f32 v14, v14, v53, v54
 v_max3_f32 v14, v14, v55, v60
 v_max3_f32 v14, v14, v61, v62
 v_max_f32 v14, v14, v63
 v_mov_b32 v13, v12
 v_mov_b32 v15, v14
 s_nop 0
 v_permlane16_swap_b32 v12, v13
 v_permlane16_swap_b32 v14, v15
 v_max_f32 v12, v12, v13
 v_max_f32 v14, v14, v15
 v_mov_b32 v13, v12
 v_mov_b32 v15, v14
 s_nop 0
 v_permlane32_swap_b32 v12, v13
 v_permlane32_swap_b32 v14, v15
 v_max_f32 v12, v12, v13
 v_max_f32 v14, v14, v15
 v_sub_f32 v12, 0xc0c00000, v12
 v_floor_f32 v12, v12
 v_min_f32 v12, 0, v12
 v_mov_b32 v13, v12
 v_sub_f32 v14, 0xc0c00000, v14
 v_floor_f32 v14, v14
 v_min_f32 v14, 0, v14
 v_mov_b32 v15, v14
 v_pk_add_f32 v[4:5], v[4:5], v[12:13]
 v_pk_add_f32 v[6:7], v[6:7], v[12:13]
 v_pk_add_f32 v[32:33], v[32:33], v[12:13]
 v_pk_add_f32 v[34:35], v[34:35], v[12:13]
 v_pk_add_f32 v[40:41], v[40:41], v[12:13]
 v_pk_add_f32 v[42:43], v[42:43], v[12:13]
 v_pk_add_f32 v[48:49], v[48:49], v[12:13]
 v_pk_add_f32 v[50:51], v[50:51], v[12:13]
 v_pk_add_f32 v[56:57], v[56:57], v[12:13]
 v_pk_add_f32 v[58:59], v[58:59], v[12:13]
 v_pk_add_f32 v[8:9], v[8:9], v[14:15]
 v_pk_add_f32 v[10:11], v[10:11], v[14:15]
 v_pk_add_f32 v[36:37], v[36:37], v[14:15]
 v_pk_add_f32 v[38:39], v[38:39], v[14:15]
 v_pk_add_f32 v[44:45], v[44:45], v[14:15]
 v_pk_add_f32 v[46:47], v[46:47], v[14:15]
 v_pk_add_f32 v[52:53], v[52:53], v[14:15]
 v_pk_add_f32 v[54:55], v[54:55], v[14:15]
 v_pk_add_f32 v[60:61], v[60:61], v[14:15]
 v_pk_add_f32 v[62:63], v[62:63], v[14:15]
 v_exp_f32 v12, v12
 s_nop 0
 v_mov_b32 v13, v12
 v_pk_mul_f32 v[128:129], v[128:129], v[12:13]
 v_pk_mul_f32 v[130:131], v[130:131], v[12:13]
 v_pk_mul_f32 v[136:137], v[136:137], v[12:13]
 v_pk_mul_f32 v[138:139], v[138:139], v[12:13]
 v_pk_mul_f32 v[144:145], v[144:145], v[12:13]
 v_pk_mul_f32 v[146:147], v[146:147], v[12:13]
 v_pk_mul_f32 v[152:153], v[152:153], v[12:13]
 v_pk_mul_f32 v[154:155], v[154:155], v[12:13]
 v_pk_mul_f32 v[160:161], v[160:161], v[12:13]
 v_pk_mul_f32 v[162:163], v[162:163], v[12:13]
 v_pk_mul_f32 v[168:169], v[168:169], v[12:13]
 v_pk_mul_f32 v[170:171], v[170:171], v[12:13]
 v_pk_mul_f32 v[176:177], v[176:177], v[12:13]
 v_pk_mul_f32 v[178:179], v[178:179], v[12:13]
 v_pk_mul_f32 v[184:185], v[184:185], v[12:13]
 v_pk_mul_f32 v[186:187], v[186:187], v[12:13]
 v_pk_mul_f32 v[192:193], v[192:193], v[12:13]
 v_pk_mul_f32 v[194:195], v[194:195], v[12:13]
 v_pk_mul_f32 v[200:201], v[200:201], v[12:13]
 v_pk_mul_f32 v[202:203], v[202:203], v[12:13]
 v_pk_mul_f32 v[208:209], v[208:209], v[12:13]
 v_pk_mul_f32 v[210:211], v[210:211], v[12:13]
 v_pk_mul_f32 v[216:217], v[216:217], v[12:13]
 v_pk_mul_f32 v[218:219], v[218:219], v[12:13]
 v_pk_mul_f32 v[224:225], v[224:225], v[12:13]
 v_pk_mul_f32 v[226:227], v[226:227], v[12:13]
 v_pk_mul_f32 v[232:233], v[232:233], v[12:13]
 v_pk_mul_f32 v[234:235], v[234:235], v[12:13]
 v_pk_mul_f32 v[240:241], v[240:241], v[12:13]
 v_pk_mul_f32 v[242:243], v[242:243], v[12:13]
 v_pk_mul_f32 v[248:249], v[248:249], v[12:13]
 v_pk_mul_f32 v[250:251], v[250:251], v[12:13]
 v_pk_mul_f32 v[96:97], v[96:97], v[12:13]
 v_pk_mul_f32 v[98:99], v[98:99], v[12:13]
 v_exp_f32 v14, v14
 s_nop 0
 v_mov_b32 v15, v14
 v_pk_mul_f32 v[132:133], v[132:133], v[14:15]
 v_pk_mul_f32 v[134:135], v[134:135], v[14:15]
 v_pk_mul_f32 v[140:141], v[140:141], v[14:15]
 v_pk_mul_f32 v[142:143], v[142:143], v[14:15]
 v_pk_mul_f32 v[148:149], v[148:149], v[14:15]
 v_pk_mul_f32 v[150:151], v[150:151], v[14:15]
 v_pk_mul_f32 v[156:157], v[156:157], v[14:15]
 v_pk_mul_f32 v[158:159], v[158:159], v[14:15]
 v_pk_mul_f32 v[164:165], v[164:165], v[14:15]
 v_pk_mul_f32 v[166:167], v[166:167], v[14:15]
 v_pk_mul_f32 v[172:173], v[172:173], v[14:15]
 v_pk_mul_f32 v[174:175], v[174:175], v[14:15]
 v_pk_mul_f32 v[180:181], v[180:181], v[14:15]
 v_pk_mul_f32 v[182:183], v[182:183], v[14:15]
 v_pk_mul_f32 v[188:189], v[188:189], v[14:15]
 v_pk_mul_f32 v[190:191], v[190:191], v[14:15]
 v_pk_mul_f32 v[196:197], v[196:197], v[14:15]
 v_pk_mul_f32 v[198:199], v[198:199], v[14:15]
 v_pk_mul_f32 v[204:205], v[204:205], v[14:15]
 v_pk_mul_f32 v[206:207], v[206:207], v[14:15]
 v_pk_mul_f32 v[212:213], v[212:213], v[14:15]
 v_pk_mul_f32 v[214:215], v[214:215], v[14:15]
 v_pk_mul_f32 v[220:221], v[220:221], v[14:15]
 v_pk_mul_f32 v[222:223], v[222:223], v[14:15]
 v_pk_mul_f32 v[228:229], v[228:229], v[14:15]
 v_pk_mul_f32 v[230:231], v[230:231], v[14:15]
 v_pk_mul_f32 v[236:237], v[236:237], v[14:15]
 v_pk_mul_f32 v[238:239], v[238:239], v[14:15]
 v_pk_mul_f32 v[244:245], v[244:245], v[14:15]
 v_pk_mul_f32 v[246:247], v[246:247], v[14:15]
 v_pk_mul_f32 v[252:253], v[252:253], v[14:15]
 v_pk_mul_f32 v[254:255], v[254:255], v[14:15]
 v_pk_mul_f32 v[100:101], v[100:101], v[14:15]
 v_pk_mul_f32 v[102:103], v[102:103], v[14:15]
 v_exp_f32 v12, v32
 v_exp_f32 v13, v33
 v_exp_f32 v14, v34
 v_exp_f32 v15, v35
 v_cvt_pk_bf16_f32 v80, v12, v13
 v_cvt_pk_bf16_f32 v81, v14, v15
 v_or_b32 v24, v80, v81
 v_exp_f32 v16, v36
 v_exp_f32 v17, v37
 v_exp_f32 v18, v38
 v_exp_f32 v19, v39
 v_cvt_pk_bf16_f32 v84, v16, v17
 v_cvt_pk_bf16_f32 v85, v18, v19
 v_or3_b32 v24, v24, v84, v85
 v_exp_f32 v20, v40
 v_exp_f32 v21, v41
 v_exp_f32 v22, v42
 v_exp_f32 v23, v43
 v_cvt_pk_bf16_f32 v82, v20, v21
 v_cvt_pk_bf16_f32 v83, v22, v23
 v_or3_b32 v24, v24, v82, v83
 v_exp_f32 v12, v44
 v_exp_f32 v13, v45
 v_exp_f32 v14, v46
 v_exp_f32 v15, v47
 v_cvt_pk_bf16_f32 v86, v12, v13
 v_cvt_pk_bf16_f32 v87, v14, v15
 v_or3_b32 v24, v24, v86, v87
 v_exp_f32 v16, v48
 v_exp_f32 v17, v49
 v_exp_f32 v18, v50
 v_exp_f32 v19, v51
 v_cvt_pk_bf16_f32 v88, v16, v17
 v_cvt_pk_bf16_f32 v89, v18, v19
 v_or3_b32 v24, v24, v88, v89
 v_exp_f32 v20, v52
 v_exp_f32 v21, v53
 v_exp_f32 v22, v54
 v_exp_f32 v23, v55
 v_cvt_pk_bf16_f32 v92, v20, v21
 v_cvt_pk_bf16_f32 v93, v22, v23
 v_or3_b32 v24, v24, v92, v93
 v_exp_f32 v12, v56
 v_exp_f32 v13, v57
 v_exp_f32 v14, v58
 v_exp_f32 v15, v59
 v_cvt_pk_bf16_f32 v90, v12, v13
 v_cvt_pk_bf16_f32 v91, v14, v15
 v_or3_b32 v24, v24, v90, v91
 v_exp_f32 v16, v60
 v_exp_f32 v17, v61
 v_exp_f32 v18, v62
 v_exp_f32 v19, v63
 v_cvt_pk_bf16_f32 v94, v16, v17
 v_cvt_pk_bf16_f32 v95, v18, v19
 v_or3_b32 v24, v24, v94, v95
 s_cmp_eq_u32 s12, 2
 s_cbranch_scc1 L_pk2
 s_cmp_eq_u32 s29, 1
 s_cbranch_scc0 L_top1
L_one0:
 s_branch L_last1
L_endg0:
 s_cmp_ge_u32 s11, 100
 s_cbranch_scc1 L_endh0
 s_add_u32 s11, s11, 1
 s_cmp_eq_u32 s11, 6
 s_cbranch_scc0 L_hk5_n
 s_mov_b32 s10, 1
 s_mov_b32 s11, 100
 s_mov_b32 s38, s42
 s_cmp_ge_u32 s38, 16
 s_cbranch_scc0 L_spin2
L_spun2:
L_hk5_n:
 s_cmp_eq_u32 s11, 2
 s_cbranch_scc0 L_hk1_n
 s_add_u32 s40, s40, s59
 buffer_store_dwordx4 a[140:143], v1, s[16:19], s40 offen sc1
 s_add_u32 s40, s40, s14
 buffer_store_dwordx4 a[144:147], v1, s[16:19], s40 offen sc1
 s_add_u32 s40, s40, s59
 buffer_store_dwordx4 a[148:151], v1, s[16:19], s40 offen sc1
 s_add_u32 s40, s40, s14
 buffer_store_dwordx4 a[152:155], v1, s[16:19], s40 offen sc1
 s_add_u32 s40, s40, s59
 buffer_store_dwordx4 a[156:159], v1, s[16:19], s40 offen sc1
L_hk1_n:
L_hkend0:
 s_cmp_le_u32 s29, 1
 s_cbranch_scc1 L_endh0
 s_cbranch_vccnz L_rare0
 s_branch L_top1
L_endh0:
 s_cmp_eq_u32 s29, 0
 s_cbranch_scc1 L_switch
 s_cbranch_vccnz L_rare0
 s_branch L_one0
L_mask0:
 s_nop 7
 s_getpc_b64 s[20:21]
L_pcx20:
 s_add_u32 s20, s20, L_last0-L_pcx20
 s_addc_u32 s21, s21, 0
 s_lshl_b32 s38, s3, 13
 v_lshl_add_u32 v13, v0, 7, s38
 v_min_u32 v13, L_textend-L_last0-4, v13
 global_load_dword v27, v13, s[20:21]
 s_sub_u32 s38, 3, s29
 s_lshl_b32 s38, s38, 6
 s_lshl_b32 s39, s3, 5
 s_sub_u32 s38, s39, s38
 v_add_u32 v12, s38, v3
 v_cvt_f32_i32 v12, v12
 v_add_f32 v12, 0.5, v12
 v_mul_f32 v12, 0x7149f2ca, v12
 v_add_f32 v13, 0x7349f2ca, v12
 v_min_f32 v36, v36, v13
 v_add_f32 v14, 0x733d539d, v12
 v_min_f32 v37, v37, v14
 v_add_f32 v15, 0x7330b471, v12
 v_min_f32 v38, v38, v15
 v_add_f32 v16, 0x73241544, v12
 v_min_f32 v39, v39, v16
 v_add_f32 v13, 0x0, v12
 v_min_f32 v32, v32, v13
 v_min_f32 v44, v44, v13
 v_add_f32 v14, 0xf149f2ca, v12
 v_min_f32 v33, v33, v14
 v_min_f32 v45, v45, v14
 v_add_f32 v15, 0xf1c9f2ca, v12
 v_min_f32 v34, v34, v15
 v_min_f32 v46, v46, v15
 v_add_f32 v16, 0xf2177617, v12
 v_min_f32 v35, v35, v16
 v_min_f32 v47, v47, v16
 v_add_f32 v13, 0xf349f2ca, v12
 v_min_f32 v40, v40, v13
 v_min_f32 v52, v52, v13
 v_add_f32 v14, 0xf35691f6, v12
 v_min_f32 v41, v41, v14
 v_min_f32 v53, v53, v14
 v_add_f32 v15, 0xf3633123, v12
 v_min_f32 v42, v42, v15
 v_min_f32 v54, v54, v15
 v_add_f32 v16, 0xf36fd050, v12
 v_min_f32 v43, v43, v16
 v_min_f32 v55, v55, v16
 v_add_f32 v13, 0xf3c9f2ca, v12
 v_min_f32 v48, v48, v13
 v_min_f32 v60, v60, v13
 v_add_f32 v14, 0xf3d04260, v12
 v_min_f32 v49, v49, v14
 v_min_f32 v61, v61, v14
 v_add_f32 v15, 0xf3d691f6, v12
 v_min_f32 v50, v50, v15
 v_min_f32 v62, v62, v15
 v_add_f32 v16, 0xf3dce18d, v12
 v_min_f32 v51, v51, v16
 v_min_f32 v63, v63, v16
 v_add_f32 v13, 0xf4177617, v12
 v_min_f32 v56, v56, v13
 v_add_f32 v14, 0xf41a9de3, v12
 v_min_f32 v57, v57, v14
 v_add_f32 v15, 0xf41dc5ae, v12
 v_min_f32 v58, v58, v15
 v_add_f32 v16, 0xf420ed79, v12
 v_min_f32 v59, v59, v16
 v_exp_f32 v12, v32
 v_exp_f32 v13, v33
 v_exp_f32 v14, v34
 v_exp_f32 v15, v35
 v_cvt_pk_bf16_f32 v80, v12, v13
 v_cvt_pk_bf16_f32 v81, v14, v15
 v_or_b32 v24, v80, v81
 v_exp_f32 v16, v36
 v_exp_f32 v17, v37
 v_exp_f32 v18, v38
 v_exp_f32 v19, v39
 v_cvt_pk_bf16_f32 v84, v16, v17
 v_cvt_pk_bf16_f32 v85, v18, v19
 v_or3_b32 v24, v24, v84, v85
 s_branch L_B0
L_getq:
 s_add_u32 s20, s6, s22
 s_addc_u32 s21, s7, 0
 s_load_dword s38, s[20:21], 8 glc
 s_waitcnt lgkmcnt(0)
 s_bitcmp1_b32 s38, s27
 s_cbranch_scc1 L_getq2
L_getq_p:
 s_mov_b32 s39, 0
 s_add_u32 s20, s6, s22
 s_addc_u32 s21, s7, 0
L_getq_p_l:
 s_load_dword s38, s[20:21], 8 glc
 s_waitcnt lgkmcnt(0)
 s_bitcmp1_b32 s38, s27
 s_cbranch_scc1 L_getq2
 s_add_u32 s39, s39, 1
 s_cmp_gt_u32 s39, 100000
 s_cbranch_scc1 L_getq2
 s_sleep 2
 s_branch L_getq_p_l
L_getq2:
 s_mov_b32 s38, s49
 buffer_load_dwordx4 a[0:3], v1, s[16:19], s38 offen offset:0 sc1
 buffer_load_dwordx4 a[4:7], v1, s[16:19], s38 offen offset:1024 sc1
 buffer_load_dwordx4 a[8:11], v1, s[16:19], s38 offen offset:2048 sc1
 buffer_load_dwordx4 a[12:15], v1, s[16:19], s38 offen offset:3072 sc1
 s_add_u32 s38, s38, 4096
 buffer_load_dwordx4 a[16:19], v1, s[16:19], s38 offen offset:0 sc1
 buffer_load_dwordx4 a[20:23], v1, s[16:19], s38 offen offset:1024 sc1
 buffer_load_dwordx4 a[24:27], v1, s[16:19], s38 offen offset:2048 sc1
 buffer_load_dwordx4 a[28:31], v1, s[16:19], s38 offen offset:3072 sc1
 s_add_u32 s38, s38, 4096
 buffer_load_dwordx4 a[32:35], v1, s[16:19], s38 offen offset:0 sc1
 buffer_load_dwordx4 a[36:39], v1, s[16:19], s38 offen offset:1024 sc1
 buffer_load_dwordx4 a[40:43], v1, s[16:19], s38 offen offset:2048 sc1
 buffer_load_dwordx4 a[44:47], v1, s[16:19], s38 offen offset:3072 sc1
 s_add_u32 s38, s38, 4096
 buffer_load_dwordx4 a[48:51], v1, s[16:19], s38 offen offset:0 sc1
 buffer_load_dwordx4 a[52:55], v1, s[16:19], s38 offen offset:1024 sc1
 buffer_load_dwordx4 a[56:59], v1, s[16:19], s38 offen offset:2048 sc1
 buffer_load_dwordx4 a[60:63], v1, s[16:19], s38 offen offset:3072 sc1
 s_branch L_gotq
L_preswitch:
 v_mov_b32 v4, 0
 v_mov_b32 v5, 0
 v_mov_b32 v6, 0
 v_mov_b32 v7, 0
 v_mov_b32 v8, 0
 v_mov_b32 v9, 0
 v_mov_b32 v10, 0
 v_mov_b32 v11, 0
 s_mov_b32 s36, 0
 s_cmp_le_u32 s11, 2
 s_cbranch_scc1 L_presw2
 s_waitcnt vmcnt(4)
 s_branch L_top0
L_presw2:
 s_waitcnt vmcnt(9)
 s_branch L_top0
L_switch:
 s_nop 7
 v_rcp_f32 v12, v96
 v_rcp_f32 v14, v100
 v_mov_b32 v13, v12
 v_mov_b32 v15, v14
 v_pk_mul_f32 v[128:129], v[128:129], v[12:13]
 v_pk_mul_f32 v[130:131], v[130:131], v[12:13]
 v_cvt_pk_bf16_f32 v128, v128, v129
 v_cvt_pk_bf16_f32 v129, v130, v131
 v_pk_mul_f32 v[136:137], v[136:137], v[12:13]
 v_pk_mul_f32 v[138:139], v[138:139], v[12:13]
 v_cvt_pk_bf16_f32 v130, v136, v137
 v_cvt_pk_bf16_f32 v131, v138, v139
 v_accvgpr_write_b32 a192, v128
 v_accvgpr_write_b32 a193, v129
 v_accvgpr_write_b32 a194, v130
 v_accvgpr_write_b32 a195, v131
 v_pk_mul_f32 v[144:145], v[144:145], v[12:13]
 v_pk_mul_f32 v[146:147], v[146:147], v[12:13]
 v_cvt_pk_bf16_f32 v144, v144, v145
 v_cvt_pk_bf16_f32 v145, v146, v147
 v_pk_mul_f32 v[152:153], v[152:153], v[12:13]
 v_pk_mul_f32 v[154:155], v[154:155], v[12:13]
 v_cvt_pk_bf16_f32 v146, v152, v153
 v_cvt_pk_bf16_f32 v147, v154, v155
 v_accvgpr_write_b32 a196, v144
 v_accvgpr_write_b32 a197, v145
 v_accvgpr_write_b32 a198, v146
 v_accvgpr_write_b32 a199, v147
 v_pk_mul_f32 v[160:161], v[160:161], v[12:13]
 v_pk_mul_f32 v[162:163], v[162:163], v[12:13]
 v_cvt_pk_bf16_f32 v160, v160, v161
 v_cvt_pk_bf16_f32 v161, v162, v163
 v_pk_mul_f32 v[168:169], v[168:169], v[12:13]
 v_pk_mul_f32 v[170:171], v[170:171], v[12:13]
 v_cvt_pk_bf16_f32 v162, v168, v169
 v_cvt_pk_bf16_f32 v163, v170, v171
 v_accvgpr_write_b32 a200, v160
 v_accvgpr_write_b32 a201, v161
 v_accvgpr_write_b32 a202, v162
 v_accvgpr_write_b32 a203, v163
 v_pk_mul_f32 v[176:177], v[176:177], v[12:13]
 v_pk_mul_f32 v[178:179], v[178:179], v[12:13]
 v_cvt_pk_bf16_f32 v176, v176, v177
 v_cvt_pk_bf16_f32 v177, v178, v179
 v_pk_mul_f32 v[184:185], v[184:185], v[12:13]
 v_pk_mul_f32 v[186:187], v[186:187], v[12:13]
 v_cvt_pk_bf16_f32 v178, v184, v185
 v_cvt_pk_bf16_f32 v179, v186, v187
 v_accvgpr_write_b32 a204, v176
 v_accvgpr_write_b32 a205, v177
 v_accvgpr_write_b32 a206, v178
 v_accvgpr_write_b32 a207, v179
 v_pk_mul_f32 v[192:193], v[192:193], v[12:13]
 v_pk_mul_f32 v[194:195], v[194:195], v[12:13]
 v_cvt_pk_bf16_f32 v192, v192, v193
 v_cvt_pk_bf16_f32 v193, v194, v195
 v_pk_mul_f32 v[200:201], v[200:201], v[12:13]
 v_pk_mul_f32 v[202:203], v[202:203], v[12:13]
 v_cvt_pk_bf16_f32 v194, v200, v201
 v_cvt_pk_bf16_f32 v195, v202, v203
 v_accvgpr_write_b32 a208, v192
 v_accvgpr_write_b32 a209, v193
 v_accvgpr_write_b32 a210, v194
 v_accvgpr_write_b32 a211, v195
 v_pk_mul_f32 v[208:209], v[208:209], v[12:13]
 v_pk_mul_f32 v[210:211], v[210:211], v[12:13]
 v_cvt_pk_bf16_f32 v208, v208, v209
 v_cvt_pk_bf16_f32 v209, v210, v211
 v_pk_mul_f32 v[216:217], v[216:217], v[12:13]
 v_pk_mul_f32 v[218:219], v[218:219], v[12:13]
 v_cvt_pk_bf16_f32 v210, v216, v217
 v_cvt_pk_bf16_f32 v211, v218, v219
 v_accvgpr_write_b32 a212, v208
 v_accvgpr_write_b32 a213, v209
 v_accvgpr_write_b32 a214, v210
 v_accvgpr_write_b32 a215, v211
 v_pk_mul_f32 v[224:225], v[224:225], v[12:13]
 v_pk_mul_f32 v[226:227], v[226:227], v[12:13]
 v_cvt_pk_bf16_f32 v224, v224, v225
 v_cvt_pk_bf16_f32 v225, v226, v227
 v_pk_mul_f32 v[232:233], v[232:233], v[12:13]
 v_pk_mul_f32 v[234:235], v[234:235], v[12:13]
 v_cvt_pk_bf16_f32 v226, v232, v233
 v_cvt_pk_bf16_f32 v227, v234, v235
 v_accvgpr_write_b32 a216, v224
 v_accvgpr_write_b32 a217, v225
 v_accvgpr_write_b32 a218, v226
 v_accvgpr_write_b32 a219, v227
 v_pk_mul_f32 v[240:241], v[240:241], v[12:13]
 v_pk_mul_f32 v[242:243], v[242:243], v[12:13]
 v_cvt_pk_bf16_f32 v240, v240, v241
 v_cvt_pk_bf16_f32 v241, v242, v243
 v_pk_mul_f32 v[248:249], v[248:249], v[12:13]
 v_pk_mul_f32 v[250:251], v[250:251], v[12:13]
 v_cvt_pk_bf16_f32 v242, v248, v249
 v_cvt_pk_bf16_f32 v243, v250, v251
 v_accvgpr_write_b32 a220, v240
 v_accvgpr_write_b32 a221, v241
 v_accvgpr_write_b32 a222, v242
 v_accvgpr_write_b32 a223, v243
 v_pk_mul_f32 v[132:133], v[132:133], v[14:15]
 v_pk_mul_f32 v[134:135], v[134:135], v[14:15]
 v_cvt_pk_bf16_f32 v132, v132, v133
 v_cvt_pk_bf16_f32 v133, v134, v135
 v_pk_mul_f32 v[140:141], v[140:141], v[14:15]
 v_pk_mul_f32 v[142:143], v[142:143], v[14:15]
 v_cvt_pk_bf16_f32 v134, v140, v141
 v_cvt_pk_bf16_f32 v135, v142, v143
 v_accvgpr_write_b32 a224, v132
 v_accvgpr_write_b32 a225, v133
 v_accvgpr_write_b32 a226, v134
 v_accvgpr_write_b32 a227, v135
 v_pk_mul_f32 v[148:149], v[148:149], v[14:15]
 v_pk_mul_f32 v[150:151], v[150:151], v[14:15]
 v_cvt_pk_bf16_f32 v148, v148, v149
 v_cvt_pk_bf16_f32 v149, v150, v151
 v_pk_mul_f32 v[156:157], v[156:157], v[14:15]
 v_pk_mul_f32 v[158:159], v[158:159], v[14:15]
 v_cvt_pk_bf16_f32 v150, v156, v157
 v_cvt_pk_bf16_f32 v151, v158, v159
 v_accvgpr_write_b32 a228, v148
 v_accvgpr_write_b32 a229, v149
 v_accvgpr_write_b32 a230, v150
 v_accvgpr_write_b32 a231, v151
 v_pk_mul_f32 v[164:165], v[164:165], v[14:15]
 v_pk_mul_f32 v[166:167], v[166:167], v[14:15]
 v_cvt_pk_bf16_f32 v164, v164, v165
 v_cvt_pk_bf16_f32 v165, v166, v167
 v_pk_mul_f32 v[172:173], v[172:173], v[14:15]
 v_pk_mul_f32 v[174:175], v[174:175], v[14:15]
 v_cvt_pk_bf16_f32 v166, v172, v173
 v_cvt_pk_bf16_f32 v167, v174, v175
 v_accvgpr_write_b32 a232, v164
 v_accvgpr_write_b32 a233, v165
 v_accvgpr_write_b32 a234, v166
 v_accvgpr_write_b32 a235, v167
 v_pk_mul_f32 v[180:181], v[180:181], v[14:15]
 v_pk_mul_f32 v[182:183], v[182:183], v[14:15]
 v_cvt_pk_bf16_f32 v180, v180, v181
 v_cvt_pk_bf16_f32 v181, v182, v183
 v_pk_mul_f32 v[188:189], v[188:189], v[14:15]
 v_pk_mul_f32 v[190:191], v[190:191], v[14:15]
 v_cvt_pk_bf16_f32 v182, v188, v189
 v_cvt_pk_bf16_f32 v183, v190, v191
 v_accvgpr_write_b32 a236, v180
 v_accvgpr_write_b32 a237, v181
 v_accvgpr_write_b32 a238, v182
 v_accvgpr_write_b32 a239, v183
 v_pk_mul_f32 v[196:197], v[196:197], v[14:15]
 v_pk_mul_f32 v[198:199], v[198:199], v[14:15]
 v_cvt_pk_bf16_f32 v196, v196, v197
 v_cvt_pk_bf16_f32 v197, v198, v199
 v_pk_mul_f32 v[204:205], v[204:205], v[14:15]
 v_pk_mul_f32 v[206:207], v[206:207], v[14:15]
 v_cvt_pk_bf16_f32 v198, v204, v205
 v_cvt_pk_bf16_f32 v199, v206, v207
 v_accvgpr_write_b32 a240, v196
 v_accvgpr_write_b32 a241, v197
 v_accvgpr_write_b32 a242, v198
 v_accvgpr_write_b32 a243, v199
 v_pk_mul_f32 v[212:213], v[212:213], v[14:15]
 v_pk_mul_f32 v[214:215], v[214:215], v[14:15]
 v_cvt_pk_bf16_f32 v212, v212, v213
 v_cvt_pk_bf16_f32 v213, v214, v215
 v_pk_mul_f32 v[220:221], v[220:221], v[14:15]
 v_pk_mul_f32 v[222:223], v[222:223], v[14:15]
 v_cvt_pk_bf16_f32 v214, v220, v221
 v_cvt_pk_bf16_f32 v215, v222, v223
 v_accvgpr_write_b32 a244, v212
 v_accvgpr_write_b32 a245, v213
 v_accvgpr_write_b32 a246, v214
 v_accvgpr_write_b32 a247, v215
 v_pk_mul_f32 v[228:229], v[228:229], v[14:15]
 v_pk_mul_f32 v[230:231], v[230:231], v[14:15]
 v_cvt_pk_bf16_f32 v228, v228, v229
 v_cvt_pk_bf16_f32 v229, v230, v231
 v_pk_mul_f32 v[236:237], v[236:237], v[14:15]
 v_pk_mul_f32 v[238:239], v[238:239], v[14:15]
 v_cvt_pk_bf16_f32 v230, v236, v237
 v_cvt_pk_bf16_f32 v231, v238, v239
 v_accvgpr_write_b32 a248, v228
 v_accvgpr_write_b32 a249, v229
 v_accvgpr_write_b32 a250, v230
 v_accvgpr_write_b32 a251, v231
 v_pk_mul_f32 v[244:245], v[244:245], v[14:15]
 v_pk_mul_f32 v[246:247], v[246:247], v[14:15]
 v_cvt_pk_bf16_f32 v244, v244, v245
 v_cvt_pk_bf16_f32 v245, v246, v247
 v_pk_mul_f32 v[252:253], v[252:253], v[14:15]
 v_pk_mul_f32 v[254:255], v[254:255], v[14:15]
 v_cvt_pk_bf16_f32 v246, v252, v253
 v_cvt_pk_bf16_f32 v247, v254, v255
 v_accvgpr_write_b32 a252, v244
 v_accvgpr_write_b32 a253, v245
 v_accvgpr_write_b32 a254, v246
 v_accvgpr_write_b32 a255, v247
 v_pk_mov_b32 v[128:129], 0, 0
 v_pk_mov_b32 v[130:131], 0, 0
 v_pk_mov_b32 v[132:133], 0, 0
 v_pk_mov_b32 v[134:135], 0, 0
 v_pk_mov_b32 v[136:137], 0, 0
 v_pk_mov_b32 v[138:139], 0, 0
 v_pk_mov_b32 v[140:141], 0, 0
 v_pk_mov_b32 v[142:143], 0, 0
 v_pk_mov_b32 v[144:145], 0, 0
 v_pk_mov_b32 v[146:147], 0, 0
 v_pk_mov_b32 v[148:149], 0, 0
 v_pk_mov_b32 v[150:151], 0, 0
 v_pk_mov_b32 v[152:153], 0, 0
 v_pk_mov_b32 v[154:155], 0, 0
 v_pk_mov_b32 v[156:157], 0, 0
 v_pk_mov_b32 v[158:159], 0, 0
 v_pk_mov_b32 v[160:161], 0, 0
 v_pk_mov_b32 v[162:163], 0, 0
 v_pk_mov_b32 v[164:165], 0, 0
 v_pk_mov_b32 v[166:167], 0, 0
 v_pk_mov_b32 v[168:169], 0, 0
 v_pk_mov_b32 v[170:171], 0, 0
 v_pk_mov_b32 v[172:173], 0, 0
 v_pk_mov_b32 v[174:175], 0, 0
 v_pk_mov_b32 v[176:177], 0, 0
 v_pk_mov_b32 v[178:179], 0, 0
 v_pk_mov_b32 v[180:181], 0, 0
 v_pk_mov_b32 v[182:183], 0, 0
 v_pk_mov_b32 v[184:185], 0, 0
 v_pk_mov_b32 v[186:187], 0, 0
 v_pk_mov_b32 v[188:189], 0, 0
 v_pk_mov_b32 v[190:191], 0, 0
 v_pk_mov_b32 v[192:193], 0, 0
 v_pk_mov_b32 v[194:195], 0, 0
 v_pk_mov_b32 v[196:197], 0, 0
 v_pk_mov_b32 v[198:199], 0, 0
 v_pk_mov_b32 v[200:201], 0, 0
 v_pk_mov_b32 v[202:203], 0, 0
 v_pk_mov_b32 v[204:205], 0, 0
 v_pk_mov_b32 v[206:207], 0, 0
 v_pk_mov_b32 v[208:209], 0, 0
 v_pk_mov_b32 v[210:211], 0, 0
 v_pk_mov_b32 v[212:213], 0, 0
 v_pk_mov_b32 v[214:215], 0, 0
 v_pk_mov_b32 v[216:217], 0, 0
 v_pk_mov_b32 v[218:219], 0, 0
 v_pk_mov_b32 v[220:221], 0, 0
 v_pk_mov_b32 v[222:223], 0, 0
 v_pk_mov_b32 v[224:225], 0, 0
 v_pk_mov_b32 v[226:227], 0, 0
 v_pk_mov_b32 v[228:229], 0, 0
 v_pk_mov_b32 v[230:231], 0, 0
 v_pk_mov_b32 v[232:233], 0, 0
 v_pk_mov_b32 v[234:235], 0, 0
 v_pk_mov_b32 v[236:237], 0, 0
 v_pk_mov_b32 v[238:239], 0, 0
 v_pk_mov_b32 v[240:241], 0, 0
 v_pk_mov_b32 v[242:243], 0, 0
 v_pk_mov_b32 v[244:245], 0, 0
 v_pk_mov_b32 v[246:247], 0, 0
 v_pk_mov_b32 v[248:249], 0, 0
 v_pk_mov_b32 v[250:251], 0, 0
 v_pk_mov_b32 v[252:253], 0, 0
 v_pk_mov_b32 v[254:255], 0, 0
 v_pk_mov_b32 v[96:97], 0, 0
 v_pk_mov_b32 v[98:99], 0, 0
 v_pk_mov_b32 v[100:101], 0, 0
 v_pk_mov_b32 v[102:103], 0, 0
 v_max3_f32 v12, v32, v33, v34
 v_max3_f32 v12, v12, v35, v40
 v_max3_f32 v12, v12, v41, v42
 v_max3_f32 v12, v12, v43, v48
 v_max3_f32 v12, v12, v49, v50
 v_max3_f32 v12, v12, v51, v56
 v_max3_f32 v12, v12, v57, v58
 v_max_f32 v12, v12, v59
 v_max3_f32 v14, v36, v37, v38
 v_max3_f32 v14, v14, v39, v44
 v_max3_f32 v14, v14, v45, v46
 v_max3_f32 v14, v14, v47, v52
 v_max3_f32 v14, v14, v53, v54
 v_max3_f32 v14, v14, v55, v60
 v_max3_f32 v14, v14, v61, v62
 v_max_f32 v14, v14, v63
 v_mov_b32 v13, v12
 v_mov_b32 v15, v14
 s_nop 0
 v_permlane16_swap_b32 v12, v13
 v_permlane16_swap_b32 v14, v15
 v_max_f32 v12, v12, v13
 v_max_f32 v14, v14, v15
 v_mov_b32 v13, v12
 v_mov_b32 v15, v14
 s_nop 0
 v_permlane32_swap_b32 v12, v13
 v_permlane32_swap_b32 v14, v15
 v_max_f32 v12, v12, v13
 v_max_f32 v14, v14, v15
 v_sub_f32 v12, 0xc0c00000, v12
 v_floor_f32 v12, v12
 v_mov_b32 v13, v12
 v_sub_f32 v14, 0xc0c00000, v14
 v_floor_f32 v14, v14
 v_mov_b32 v15, v14
 v_pk_mov_b32 v[4:5], v[12:13], v[12:13]
 v_pk_mov_b32 v[6:7], v[12:13], v[12:13]
 v_pk_add_f32 v[32:33], v[32:33], v[12:13]
 v_pk_add_f32 v[34:35], v[34:35], v[12:13]
 v_pk_add_f32 v[40:41], v[40:41], v[12:13]
 v_pk_add_f32 v[42:43], v[42:43], v[12:13]
 v_pk_add_f32 v[48:49], v[48:49], v[12:13]
 v_pk_add_f32 v[50:51], v[50:51], v[12:13]
 v_pk_add_f32 v[56:57], v[56:57], v[12:13]
 v_pk_add_f32 v[58:59], v[58:59], v[12:13]
 v_pk_mov_b32 v[8:9], v[14:15], v[14:15]
 v_pk_mov_b32 v[10:11], v[14:15], v[14:15]
 v_pk_add_f32 v[36:37], v[36:37], v[14:15]
 v_pk_add_f32 v[38:39], v[38:39], v[14:15]
 v_pk_add_f32 v[44:45], v[44:45], v[14:15]
 v_pk_add_f32 v[46:47], v[46:47], v[14:15]
 v_pk_add_f32 v[52:53], v[52:53], v[14:15]
 v_pk_add_f32 v[54:55], v[54:55], v[14:15]
 v_pk_add_f32 v[60:61], v[60:61], v[14:15]
 v_pk_add_f32 v[62:63], v[62:63], v[14:15]
 v_exp_f32 v12, v32
 v_exp_f32 v13, v33
 v_exp_f32 v14, v34
 v_exp_f32 v15, v35
 v_cvt_pk_bf16_f32 v80, v12, v13
 v_cvt_pk_bf16_f32 v81, v14, v15
 v_or_b32 v24, v80, v81
 v_exp_f32 v16, v36
 v_exp_f32 v17, v37
 v_exp_f32 v18, v38
 v_exp_f32 v19, v39
 v_cvt_pk_bf16_f32 v84, v16, v17
 v_cvt_pk_bf16_f32 v85, v18, v19
 v_or3_b32 v24, v24, v84, v85
 v_exp_f32 v20, v40
 v_exp_f32 v21, v41
 v_exp_f32 v22, v42
 v_exp_f32 v23, v43
 v_cvt_pk_bf16_f32 v82, v20, v21
 v_cvt_pk_bf16_f32 v83, v22, v23
 v_or3_b32 v24, v24, v82, v83
 v_exp_f32 v12, v44
 v_exp_f32 v13, v45
 v_exp_f32 v14, v46
 v_exp_f32 v15, v47
 v_cvt_pk_bf16_f32 v86, v12, v13
 v_cvt_pk_bf16_f32 v87, v14, v15
 v_or3_b32 v24, v24, v86, v87
 v_exp_f32 v16, v48
 v_exp_f32 v17, v49
 v_exp_f32 v18, v50
 v_exp_f32 v19, v51
 v_cvt_pk_bf16_f32 v88, v16, v17
 v_cvt_pk_bf16_f32 v89, v18, v19
 v_or3_b32 v24, v24, v88, v89
 v_exp_f32 v20, v52
 v_exp_f32 v21, v53
 v_exp_f32 v22, v54
 v_exp_f32 v23, v55
 v_cvt_pk_bf16_f32 v92, v20, v21
 v_cvt_pk_bf16_f32 v93, v22, v23
 v_or3_b32 v24, v24, v92, v93
 v_exp_f32 v12, v56
 v_exp_f32 v13, v57
 v_exp_f32 v14, v58
 v_exp_f32 v15, v59
 v_cvt_pk_bf16_f32 v90, v12, v13
 v_cvt_pk_bf16_f32 v91, v14, v15
 v_or3_b32 v24, v24, v90, v91
 v_exp_f32 v16, v60
 v_exp_f32 v17, v61
 v_exp_f32 v18, v62
 v_exp_f32 v19, v63
 v_cvt_pk_bf16_f32 v94, v16, v17
 v_cvt_pk_bf16_f32 v95, v18, v19
 v_or3_b32 v24, v24, v94, v95
 s_mov_b32 s29, s25
 s_mov_b32 s37, 0
 s_cmp_eq_u32 s29, 1
 s_cbranch_scc0 L_top1
 s_branch L_last1
L_last0:
 s_add_u32 s20, s6, s22
 s_addc_u32 s21, s7, 0
 s_load_dword s54, s[20:21], 12 glc
 s_load_dwordx2 s[8:9], s[0:1], 56
 s_load_dwordx2 s[100:101], s[0:1], 64
 s_load_dwordx2 s[12:13], s[0:1], 72
 s_load_dwordx2 s[56:57], s[0:1], 80
 s_load_dwordx2 s[52:53], s[0:1], 0
 s_lshl_b32 s41, s24, 3
 s_add_u32 s41, s41, s27
 s_lshl_b32 s42, s41, 12
 s_lshl_b32 s38, s3, 10
 s_add_u32 s42, s42, s38
 s_add_u32 s42, s42, 92274688
 s_lshl_b32 s41, s41, 16
 s_lshl_b32 s38, s3, 14
 s_add_u32 s41, s41, s38
 s_add_u32 s41, s41, 83886080
 s_mul_i32 s43, s3, 7168
 s_mul_i32 s48, s24, 229376
 s_mul_i32 s38, s3, 57344
 s_add_u32 s48, s48, s38
 s_lshl_b32 s51, s24, 7
 s_lshl_b32 s38, s50, 3
 s_add_u32 s51, s51, s38
 s_lshl_b32 s38, s3, 1
 s_add_u32 s51, s51, s38
 s_mul_i32 s51, s51, 14336
 s_add_u32 s51, s51, 50331648
 s_waitcnt vmcnt(0) lgkmcnt(0)
 s_barrier
 ds_read_b128 a[64:67], v2 offset:0
 ds_read_b128 a[68:71], v2 offset:16384
 ds_read_b128 a[72:75], v2 offset:1024
 ds_read_b128 a[76:79], v2 offset:17408
 ds_read_b128 a[80:83], v2 offset:2048
 ds_read_b128 a[84:87], v2 offset:18432
 ds_read_b128 a[88:91], v2 offset:3072
 ds_read_b128 a[92:95], v2 offset:19456
 v_mfma_f32_16x16x32_bf16 v[96:99], v[104:107], v[64:67], v[96:99]
 s_add_u32 m0, s32, 0
 s_add_u32 s35, s48, 0
 v_mfma_f32_16x16x32_bf16 v[96:99], v[104:107], v[72:75], v[96:99]
 buffer_load_dwordx4 v31, s[44:47], s35 offen lds
 v_mfma_f32_16x16x32_bf16 v[100:103], v[104:107], v[68:71], v[100:103]
 v_mfma_f32_16x16x32_bf16 v[100:103], v[104:107], v[76:79], v[100:103]
 s_waitcnt lgkmcnt(7)
 v_mfma_f32_16x16x32_bf16 v[128:131], a[64:67], v[64:67], v[128:131]
 s_waitcnt lgkmcnt(0)
 s_add_u32 m0, s32, 1024
 s_add_u32 s35, s48, 7168
 ds_read_b128 a[96:99], v2 offset:4096
 v_mfma_f32_16x16x32_bf16 v[128:131], a[68:71], v[72:75], v[128:131]
 buffer_load_dwordx4 v31, s[44:47], s35 offen lds
 v_mfma_f32_16x16x32_bf16 v[132:135], a[68:71], v[76:79], v[132:135]
 ds_read_b128 a[100:103], v2 offset:20480
 v_mfma_f32_16x16x32_bf16 v[132:135], a[64:67], v[68:71], v[132:135]
 ds_read_b128 a[104:107], v2 offset:5120
 v_mfma_f32_16x16x32_bf16 v[140:143], a[72:75], v[68:71], v[140:143]
 s_add_u32 m0, s32, 2048
 s_add_u32 s35, s48, 14336
 ds_read_b128 a[108:111], v2 offset:21504
 v_mfma_f32_16x16x32_bf16 v[140:143], a[76:79], v[76:79], v[140:143]
 buffer_load_dwordx4 v31, s[44:47], s35 offen lds
 v_mfma_f32_16x16x32_bf16 v[136:139], a[76:79], v[72:75], v[136:139]
 ds_read_b128 a[112:115], v2 offset:6144
 v_mfma_f32_16x16x32_bf16 v[136:139], a[72:75], v[64:67], v[136:139]
 ds_read_b128 a[116:119], v2 offset:22528
 v_mfma_f32_16x16x32_bf16 v[144:147], a[80:83], v[64:67], v[144:147]
 s_add_u32 m0, s32, 3072
 s_add_u32 s35, s48, 21504
 v_mfma_f32_16x16x32_bf16 v[144:147], a[84:87], v[72:75], v[144:147]
 buffer_load_dwordx4 v31, s[44:47], s35 offen lds
 v_mfma_f32_16x16x32_bf16 v[148:151], a[84:87], v[76:79], v[148:151]
 ds_read_b128 a[120:123], v2 offset:7168
 ds_read_b128 a[124:127], v2 offset:23552
 v_mfma_f32_16x16x32_bf16 v[148:151], a[80:83], v[68:71], v[148:151]
 v_mfma_f32_16x16x32_bf16 v[156:159], a[88:91], v[68:71], v[156:159]
 s_add_u32 m0, s32, 4096
 v_mfma_f32_16x16x32_bf16 v[156:159], a[92:95], v[76:79], v[156:159]
 s_add_u32 s35, s48, 28672
 buffer_load_dwordx4 v31, s[44:47], s35 offen lds
 v_mfma_f32_16x16x32_bf16 v[152:155], a[92:95], v[72:75], v[152:155]
 v_mfma_f32_16x16x32_bf16 v[152:155], a[88:91], v[64:67], v[152:155]
 s_waitcnt lgkmcnt(0)
 v_mfma_f32_16x16x32_bf16 v[160:163], a[96:99], v[64:67], v[160:163]
 s_add_u32 m0, s32, 5120
 ds_read_b128 a[64:67], v2 offset:8192
 v_mfma_f32_16x16x32_bf16 v[160:163], a[100:103], v[72:75], v[160:163]
 s_add_u32 s35, s48, 35840
 buffer_load_dwordx4 v31, s[44:47], s35 offen lds
 v_mfma_f32_16x16x32_bf16 v[164:167], a[100:103], v[76:79], v[164:167]
 ds_read_b128 a[68:71], v2 offset:24576
 v_mfma_f32_16x16x32_bf16 v[164:167], a[96:99], v[68:71], v[164:167]
 ds_read_b128 a[72:75], v2 offset:9216
 v_mfma_f32_16x16x32_bf16 v[172:175], a[104:107], v[68:71], v[172:175]
 ds_read_b128 a[76:79], v2 offset:25600
 v_mfma_f32_16x16x32_bf16 v[172:175], a[108:111], v[76:79], v[172:175]
 s_add_u32 m0, s32, 6144
 s_add_u32 s35, s48, 43008
 v_mfma_f32_16x16x32_bf16 v[168:171], a[108:111], v[72:75], v[168:171]
 buffer_load_dwordx4 v31, s[44:47], s35 offen lds
 v_mfma_f32_16x16x32_bf16 v[168:171], a[104:107], v[64:67], v[168:171]
 ds_read_b128 a[80:83], v2 offset:10240
 ds_read_b128 a[84:87], v2 offset:26624
 v_mfma_f32_16x16x32_bf16 v[176:179], a[112:115], v[64:67], v[176:179]
 v_mfma_f32_16x16x32_bf16 v[176:179], a[116:119], v[72:75], v[176:179]
 s_add_u32 m0, s32, 7168
 s_add_u32 s35, s48, 50176
 ds_read_b128 a[88:91], v2 offset:11264
 v_mfma_f32_16x16x32_bf16 v[180:183], a[116:119], v[76:79], v[180:183]
 buffer_load_dwordx4 v31, s[44:47], s35 offen lds
 v_mfma_f32_16x16x32_bf16 v[180:183], a[112:115], v[68:71], v[180:183]
 ds_read_b128 a[92:95], v2 offset:27648
 v_mfma_f32_16x16x32_bf16 v[188:191], a[120:123], v[68:71], v[188:191]
 v_mfma_f32_16x16x32_bf16 v[188:191], a[124:127], v[76:79], v[188:191]
 s_add_u32 m0, s32, 32768
 s_add_u32 s35, s48, 128
 v_mfma_f32_16x16x32_bf16 v[184:187], a[124:127], v[72:75], v[184:187]
 buffer_load_dwordx4 v31, s[44:47], s35 offen lds
 v_mfma_f32_16x16x32_bf16 v[184:187], a[120:123], v[64:67], v[184:187]
 s_waitcnt lgkmcnt(1)
 v_mfma_f32_16x16x32_bf16 v[192:195], a[64:67], v[64:67], v[192:195]
 ds_read_b128 a[96:99], v2 offset:12288
 v_mfma_f32_16x16x32_bf16 v[192:195], a[68:71], v[72:75], v[192:195]
 s_add_u32 m0, s32, 33792
 ds_read_b128 a[100:103], v2 offset:28672
 v_mfma_f32_16x16x32_bf16 v[196:199], a[68:71], v[76:79], v[196:199]
 s_add_u32 s35, s48, 7296
 buffer_load_dwordx4 v31, s[44:47], s35 offen lds
 v_mfma_f32_16x16x32_bf16 v[196:199], a[64:67], v[68:71], v[196:199]
 ds_read_b128 a[104:107], v2 offset:13312
 v_mfma_f32_16x16x32_bf16 v[204:207], a[72:75], v[68:71], v[204:207]
 ds_read_b128 a[108:111], v2 offset:29696
 v_mfma_f32_16x16x32_bf16 v[204:207], a[76:79], v[76:79], v[204:207]
 s_add_u32 m0, s32, 34816
 v_mfma_f32_16x16x32_bf16 v[200:203], a[76:79], v[72:75], v[200:203]
 s_add_u32 s35, s48, 14464
 buffer_load_dwordx4 v31, s[44:47], s35 offen lds
 v_mfma_f32_16x16x32_bf16 v[200:203], a[72:75], v[64:67], v[200:203]
 ds_read_b128 a[112:115], v2 offset:14336
 ds_read_b128 a[116:119], v2 offset:30720
 v_mfma_f32_16x16x32_bf16 v[208:211], a[80:83], v[64:67], v[208:211]
 v_mfma_f32_16x16x32_bf16 v[208:211], a[84:87], v[72:75], v[208:211]
 ds_read_b128 a[120:123], v2 offset:15360
 v_mfma_f32_16x16x32_bf16 v[212:215], a[84:87], v[76:79], v[212:215]
 s_add_u32 m0, s32, 35840
 s_add_u32 s35, s48, 21632
 ds_read_b128 a[124:127], v2 offset:31744
 v_mfma_f32_16x16x32_bf16 v[212:215], a[80:83], v[68:71], v[212:215]
 buffer_load_dwordx4 v31, s[44:47], s35 offen lds
 v_mfma_f32_16x16x32_bf16 v[220:223], a[88:91], v[68:71], v[220:223]
 s_waitcnt lgkmcnt(2)
 v_mfma_f32_16x16x32_bf16 v[220:223], a[92:95], v[76:79], v[220:223]
 v_mfma_f32_16x16x32_bf16 v[216:219], a[92:95], v[72:75], v[216:219]
 s_add_u32 m0, s32, 36864
 s_add_u32 s35, s48, 28800
 v_mfma_f32_16x16x32_bf16 v[216:219], a[88:91], v[64:67], v[216:219]
 buffer_load_dwordx4 v31, s[44:47], s35 offen lds
 v_mfma_f32_16x16x32_bf16 v[224:227], a[96:99], v[64:67], v[224:227]
 v_mfma_f32_16x16x32_bf16 v[224:227], a[100:103], v[72:75], v[224:227]
 v_mfma_f32_16x16x32_bf16 v[228:231], a[100:103], v[76:79], v[228:231]
 s_add_u32 m0, s32, 37888
 s_add_u32 s35, s48, 35968
 v_mfma_f32_16x16x32_bf16 v[228:231], a[96:99], v[68:71], v[228:231]
 buffer_load_dwordx4 v31, s[44:47], s35 offen lds
 v_mfma_f32_16x16x32_bf16 v[236:239], a[104:107], v[68:71], v[236:239]
 v_mfma_f32_16x16x32_bf16 v[236:239], a[108:111], v[76:79], v[236:239]
 v_mfma_f32_16x16x32_bf16 v[232:235], a[108:111], v[72:75], v[232:235]
 s_add_u32 m0, s32, 38912
 v_mfma_f32_16x16x32_bf16 v[232:235], a[104:107], v[64:67], v[232:235]
 s_add_u32 s35, s48, 43136
 buffer_load_dwordx4 v31, s[44:47], s35 offen lds
 v_mfma_f32_16x16x32_bf16 v[240:243], a[112:115], v[64:67], v[240:243]
 v_mfma_f32_16x16x32_bf16 v[240:243], a[116:119], v[72:75], v[240:243]
 v_mfma_f32_16x16x32_bf16 v[244:247], a[116:119], v[76:79], v[244:247]
 s_add_u32 m0, s32, 39936
 v_mfma_f32_16x16x32_bf16 v[244:247], a[112:115], v[68:71], v[244:247]
 s_waitcnt lgkmcnt(0)
 s_add_u32 s35, s48, 50304
 buffer_load_dwordx4 v31, s[44:47], s35 offen lds
 v_mfma_f32_16x16x32_bf16 v[252:255], a[120:123], v[68:71], v[252:255]
 v_mfma_f32_16x16x32_bf16 v[252:255], a[124:127], v[76:79], v[252:255]
 v_mfma_f32_16x16x32_bf16 v[248:251], a[124:127], v[72:75], v[248:251]
 v_mfma_f32_16x16x32_bf16 v[248:251], a[120:123], v[64:67], v[248:251]
 s_nop 5
 s_branch L_fin1
L_last1:
 s_add_u32 s20, s6, s22
 s_addc_u32 s21, s7, 0
 s_load_dword s54, s[20:21], 12 glc
 s_load_dwordx2 s[8:9], s[0:1], 56
 s_load_dwordx2 s[100:101], s[0:1], 64
 s_load_dwordx2 s[12:13], s[0:1], 72
 s_load_dwordx2 s[56:57], s[0:1], 80
 s_load_dwordx2 s[52:53], s[0:1], 0
 s_lshl_b32 s41, s24, 3
 s_add_u32 s41, s41, s27
 s_lshl_b32 s42, s41, 12
 s_lshl_b32 s38, s3, 10
 s_add_u32 s42, s42, s38
 s_add_u32 s42, s42, 92274688
 s_lshl_b32 s41, s41, 16
 s_lshl_b32 s38, s3, 14
 s_add_u32 s41, s41, s38
 s_add_u32 s41, s41, 83886080
 s_mul_i32 s43, s3, 7168
 s_mul_i32 s48, s24, 229376
 s_mul_i32 s38, s3, 57344
 s_add_u32 s48, s48, s38
 s_lshl_b32 s51, s24, 7
 s_lshl_b32 s38, s50, 3
 s_add_u32 s51, s51, s38
 s_lshl_b32 s38, s3, 1
 s_add_u32 s51, s51, s38
 s_mul_i32 s51, s51, 14336
 s_add_u32 s51, s51, 50331648
 s_waitcnt vmcnt(0) lgkmcnt(0)
 s_barrier
 ds_read_b128 a[64:67], v2 offset:32768
 ds_read_b128 a[68:71], v2 offset:49152
 ds_read_b128 a[72:75], v2 offset:33792
 ds_read_b128 a[76:79], v2 offset:50176
 ds_read_b128 a[80:83], v2 offset:34816
 ds_read_b128 a[84:87], v2 offset:51200
 ds_read_b128 a[88:91], v2 offset:35840
 ds_read_b128 a[92:95], v2 offset:52224
 s_cmp_eq_u32 s37, 2
 s_cselect_b32 s38, s54, 0
 s_bitcmp1_b32 s38, s27
 s_cbranch_scc1 L_lastC
 v_mfma_f32_16x16x32_bf16 v[96:99], v[104:107], v[80:83], v[96:99]
 s_add_u32 m0, s32, 0
 s_add_u32 s35, s48, 0
 v_mfma_f32_16x16x32_bf16 v[96:99], v[104:107], v[88:91], v[96:99]
 buffer_load_dwordx4 v31, s[44:47], s35 offen lds
 v_mfma_f32_16x16x32_bf16 v[100:103], v[104:107], v[84:87], v[100:103]
 v_mfma_f32_16x16x32_bf16 v[100:103], v[104:107], v[92:95], v[100:103]
 s_waitcnt lgkmcnt(7)
 v_mfma_f32_16x16x32_bf16 v[128:131], a[64:67], v[80:83], v[128:131]
 s_waitcnt lgkmcnt(0)
 s_add_u32 m0, s32, 1024
 s_add_u32 s35, s48, 7168
 ds_read_b128 a[96:99], v2 offset:36864
 v_mfma_f32_16x16x32_bf16 v[128:131], a[68:71], v[88:91], v[128:131]
 buffer_load_dwordx4 v31, s[44:47], s35 offen lds
 v_mfma_f32_16x16x32_bf16 v[132:135], a[68:71], v[92:95], v[132:135]
 ds_read_b128 a[100:103], v2 offset:53248
 v_mfma_f32_16x16x32_bf16 v[132:135], a[64:67], v[84:87], v[132:135]
 ds_read_b128 a[104:107], v2 offset:37888
 v_mfma_f32_16x16x32_bf16 v[140:143], a[72:75], v[84:87], v[140:143]
 s_add_u32 m0, s32, 2048
 s_add_u32 s35, s48, 14336
 ds_read_b128 a[108:111], v2 offset:54272
 v_mfma_f32_16x16x32_bf16 v[140:143], a[76:79], v[92:95], v[140:143]
 buffer_load_dwordx4 v31, s[44:47], s35 offen lds
 v_mfma_f32_16x16x32_bf16 v[136:139], a[76:79], v[88:91], v[136:139]
 ds_read_b128 a[112:115], v2 offset:38912
 v_mfma_f32_16x16x32_bf16 v[136:139], a[72:75], v[80:83], v[136:139]
 ds_read_b128 a[116:119], v2 offset:55296
 v_mfma_f32_16x16x32_bf16 v[144:147], a[80:83], v[80:83], v[144:147]
 s_add_u32 m0, s32, 3072
 s_add_u32 s35, s48, 21504
 v_mfma_f32_16x16x32_bf16 v[144:147], a[84:87], v[88:91], v[144:147]
 buffer_load_dwordx4 v31, s[44:47], s35 offen lds
 v_mfma_f32_16x16x32_bf16 v[148:151], a[84:87], v[92:95], v[148:151]
 ds_read_b128 a[120:123], v2 offset:39936
 ds_read_b128 a[124:127], v2 offset:56320
 v_mfma_f32_16x16x32_bf16 v[148:151], a[80:83], v[84:87], v[148:151]
 v_mfma_f32_16x16x32_bf16 v[156:159], a[88:91], v[84:87], v[156:159]
 s_add_u32 m0, s32, 4096
 v_mfma_f32_16x16x32_bf16 v[156:159], a[92:95], v[92:95], v[156:159]
 s_add_u32 s35, s48, 28672
 buffer_load_dwordx4 v31, s[44:47], s35 offen lds
 v_mfma_f32_16x16x32_bf16 v[152:155], a[92:95], v[88:91], v[152:155]
 v_mfma_f32_16x16x32_bf16 v[152:155], a[88:91], v[80:83], v[152:155]
 s_waitcnt lgkmcnt(0)
 v_mfma_f32_16x16x32_bf16 v[160:163], a[96:99], v[80:83], v[160:163]
 s_add_u32 m0, s32, 5120
 ds_read_b128 a[64:67], v2 offset:40960
 v_mfma_f32_16x16x32_bf16 v[160:163], a[100:103], v[88:91], v[160:163]
 s_add_u32 s35, s48, 35840
 buffer_load_dwordx4 v31, s[44:47], s35 offen lds
 v_mfma_f32_16x16x32_bf16 v[164:167], a[100:103], v[92:95], v[164:167]
 ds_read_b128 a[68:71], v2 offset:57344
 v_mfma_f32_16x16x32_bf16 v[164:167], a[96:99], v[84:87], v[164:167]
 ds_read_b128 a[72:75], v2 offset:41984
 v_mfma_f32_16x16x32_bf16 v[172:175], a[104:107], v[84:87], v[172:175]
 ds_read_b128 a[76:79], v2 offset:58368
 v_mfma_f32_16x16x32_bf16 v[172:175], a[108:111], v[92:95], v[172:175]
 s_add_u32 m0, s32, 6144
 s_add_u32 s35, s48, 43008
 v_mfma_f32_16x16x32_bf16 v[168:171], a[108:111], v[88:91], v[168:171]
 buffer_load_dwordx4 v31, s[44:47], s35 offen lds
 v_mfma_f32_16x16x32_bf16 v[168:171], a[104:107], v[80:83], v[168:171]
 ds_read_b128 a[80:83], v2 offset:43008
 ds_read_b128 a[84:87], v2 offset:59392
 v_mfma_f32_16x16x32_bf16 v[176:179], a[112:115], v[80:83], v[176:179]
 v_mfma_f32_16x16x32_bf16 v[176:179], a[116:119], v[88:91], v[176:179]
 s_add_u32 m0, s32, 7168
 s_add_u32 s35, s48, 50176
 ds_read_b128 a[88:91], v2 offset:44032
 v_mfma_f32_16x16x32_bf16 v[180:183], a[116:119], v[92:95], v[180:183]
 buffer_load_dwordx4 v31, s[44:47], s35 offen lds
 v_mfma_f32_16x16x32_bf16 v[180:183], a[112:115], v[84:87], v[180:183]
 ds_read_b128 a[92:95], v2 offset:60416
 v_mfma_f32_16x16x32_bf16 v[188:191], a[120:123], v[84:87], v[188:191]
 v_mfma_f32_16x16x32_bf16 v[188:191], a[124:127], v[92:95], v[188:191]
 s_add_u32 m0, s32, 32768
 s_add_u32 s35, s48, 128
 v_mfma_f32_16x16x32_bf16 v[184:187], a[124:127], v[88:91], v[184:187]
 buffer_load_dwordx4 v31, s[44:47], s35 offen lds
 v_mfma_f32_16x16x32_bf16 v[184:187], a[120:123], v[80:83], v[184:187]
 s_waitcnt lgkmcnt(1)
 v_mfma_f32_16x16x32_bf16 v[192:195], a[64:67], v[80:83], v[192:195]
 ds_read_b128 a[96:99], v2 offset:45056
 v_mfma_f32_16x16x32_bf16 v[192:195], a[68:71], v[88:91], v[192:195]
 s_add_u32 m0, s32, 33792
 ds_read_b128 a[100:103], v2 offset:61440
 v_mfma_f32_16x16x32_bf16 v[196:199], a[68:71], v[92:95], v[196:199]
 s_add_u32 s35, s48, 7296
 buffer_load_dwordx4 v31, s[44:47], s35 offen lds
 v_mfma_f32_16x16x32_bf16 v[196:199], a[64:67], v[84:87], v[196:199]
 ds_read_b128 a[104:107], v2 offset:46080
 v_mfma_f32_16x16x32_bf16 v[204:207], a[72:75], v[84:87], v[204:207]
 ds_read_b128 a[108:111], v2 offset:62464
 v_mfma_f32_16x16x32_bf16 v[204:207], a[76:79], v[92:95], v[204:207]
 s_add_u32 m0, s32, 34816
 v_mfma_f32_16x16x32_bf16 v[200:203], a[76:79], v[88:91], v[200:203]
 s_add_u32 s35, s48, 14464
 buffer_load_dwordx4 v31, s[44:47], s35 offen lds
 v_mfma_f32_16x16x32_bf16 v[200:203], a[72:75], v[80:83], v[200:203]
 ds_read_b128 a[112:115], v2 offset:47104
 ds_read_b128 a[116:119], v2 offset:63488
 v_mfma_f32_16x16x32_bf16 v[208:211], a[80:83], v[80:83], v[208:211]
 v_mfma_f32_16x16x32_bf16 v[208:211], a[84:87], v[88:91], v[208:211]
 ds_read_b128 a[120:123], v2 offset:48128
 v_mfma_f32_16x16x32_bf16 v[212:215], a[84:87], v[92:95], v[212:215]
 s_add_u32 m0, s32, 35840
 s_add_u32 s35, s48, 21632
 ds_read_b128 a[124:127], v2 offset:64512
 v_mfma_f32_16x16x32_bf16 v[212:215], a[80:83], v[84:87], v[212:215]
 buffer_load_dwordx4 v31, s[44:47], s35 offen lds
 v_mfma_f32_16x16x32_bf16 v[220:223], a[88:91], v[84:87], v[220:223]
 s_waitcnt lgkmcnt(2)
 v_mfma_f32_16x16x32_bf16 v[220:223], a[92:95], v[92:95], v[220:223]
 v_mfma_f32_16x16x32_bf16 v[216:219], a[92:95], v[88:91], v[216:219]
 s_add_u32 m0, s32, 36864
 s_add_u32 s35, s48, 28800
 v_mfma_f32_16x16x32_bf16 v[216:219], a[88:91], v[80:83], v[216:219]
 buffer_load_dwordx4 v31, s[44:47], s35 offen lds
 v_mfma_f32_16x16x32_bf16 v[224:227], a[96:99], v[80:83], v[224:227]
 v_mfma_f32_16x16x32_bf16 v[224:227], a[100:103], v[88:91], v[224:227]
 v_mfma_f32_16x16x32_bf16 v[228:231], a[100:103], v[92:95], v[228:231]
 s_add_u32 m0, s32, 37888
 s_add_u32 s35, s48, 35968
 v_mfma_f32_16x16x32_bf16 v[228:231], a[96:99], v[84:87], v[228:231]
 buffer_load_dwordx4 v31, s[44:47], s35 offen lds
 v_mfma_f32_16x16x32_bf16 v[236:239], a[104:107], v[84:87], v[236:239]
 v_mfma_f32_16x16x32_bf16 v[236:239], a[108:111], v[92:95], v[236:239]
 v_mfma_f32_16x16x32_bf16 v[232:235], a[108:111], v[88:91], v[232:235]
 s_add_u32 m0, s32, 38912
 v_mfma_f32_16x16x32_bf16 v[232:235], a[104:107], v[80:83], v[232:235]
 s_add_u32 s35, s48, 43136
 buffer_load_dwordx4 v31, s[44:47], s35 offen lds
 v_mfma_f32_16x16x32_bf16 v[240:243], a[112:115], v[80:83], v[240:243]
 v_mfma_f32_16x16x32_bf16 v[240:243], a[116:119], v[88:91], v[240:243]
 v_mfma_f32_16x16x32_bf16 v[244:247], a[116:119], v[92:95], v[244:247]
 s_add_u32 m0, s32, 39936
 v_mfma_f32_16x16x32_bf16 v[244:247], a[112:115], v[84:87], v[244:247]
 s_waitcnt lgkmcnt(0)
 s_add_u32 s35, s48, 50304
 buffer_load_dwordx4 v31, s[44:47], s35 offen lds
 v_mfma_f32_16x16x32_bf16 v[252:255], a[120:123], v[84:87], v[252:255]
 v_mfma_f32_16x16x32_bf16 v[252:255], a[124:127], v[92:95], v[252:255]
 v_mfma_f32_16x16x32_bf16 v[248:251], a[124:127], v[88:91], v[248:251]
 v_mfma_f32_16x16x32_bf16 v[248:251], a[120:123], v[80:83], v[248:251]
 s_nop 5
 s_cmp_eq_u32 s37, 0
 s_cbranch_scc1 L_pub
 s_cmp_eq_u32 s37, 2
 s_cbranch_scc1 L_late
L_fin1:
 v_rcp_f32 v12, v96
 v_rcp_f32 v14, v100
 v_mov_b32 v13, v12
 v_mov_b32 v15, v14
 v_pk_mul_f32 v[128:129], v[128:129], v[12:13]
 v_pk_mul_f32 v[130:131], v[130:131], v[12:13]
 v_cvt_pk_bf16_f32 v32, v128, v129
 v_cvt_pk_bf16_f32 v33, v130, v131
 v_pk_mul_f32 v[136:137], v[136:137], v[12:13]
 v_pk_mul_f32 v[138:139], v[138:139], v[12:13]
 v_cvt_pk_bf16_f32 v34, v136, v137
 v_cvt_pk_bf16_f32 v35, v138, v139
 v_pk_mul_f32 v[144:145], v[144:145], v[12:13]
 v_pk_mul_f32 v[146:147], v[146:147], v[12:13]
 v_cvt_pk_bf16_f32 v36, v144, v145
 v_cvt_pk_bf16_f32 v37, v146, v147
 v_pk_mul_f32 v[152:153], v[152:153], v[12:13]
 v_pk_mul_f32 v[154:155], v[154:155], v[12:13]
 v_cvt_pk_bf16_f32 v38, v152, v153
 v_cvt_pk_bf16_f32 v39, v154, v155
 v_pk_mul_f32 v[160:161], v[160:161], v[12:13]
 v_pk_mul_f32 v[162:163], v[162:163], v[12:13]
 v_cvt_pk_bf16_f32 v40, v160, v161
 v_cvt_pk_bf16_f32 v41, v162, v163
 v_pk_mul_f32 v[168:169], v[168:169], v[12:13]
 v_pk_mul_f32 v[170:171], v[170:171], v[12:13]
 v_cvt_pk_bf16_f32 v42, v168, v169
 v_cvt_pk_bf16_f32 v43, v170, v171
 v_pk_mul_f32 v[176:177], v[176:177], v[12:13]
 v_pk_mul_f32 v[178:179], v[178:179], v[12:13]
 v_cvt_pk_bf16_f32 v44, v176, v177
 v_cvt_pk_bf16_f32 v45, v178, v179
 v_pk_mul_f32 v[184:185], v[184:185], v[12:13]
 v_pk_mul_f32 v[186:187], v[186:187], v[12:13]
 v_cvt_pk_bf16_f32 v46, v184, v185
 v_cvt_pk_bf16_f32 v47, v186, v187
 v_pk_mul_f32 v[192:193], v[192:193], v[12:13]
 v_pk_mul_f32 v[194:195], v[194:195], v[12:13]
 v_cvt_pk_bf16_f32 v48, v192, v193
 v_cvt_pk_bf16_f32 v49, v194, v195
 v_pk_mul_f32 v[200:201], v[200:201], v[12:13]
 v_pk_mul_f32 v[202:203], v[202:203], v[12:13]
 v_cvt_pk_bf16_f32 v50, v200, v201
 v_cvt_pk_bf16_f32 v51, v202, v203
 v_pk_mul_f32 v[208:209], v[208:209], v[12:13]
 v_pk_mul_f32 v[210:211], v[210:211], v[12:13]
 v_cvt_pk_bf16_f32 v52, v208, v209
 v_cvt_pk_bf16_f32 v53, v210, v211
 v_pk_mul_f32 v[216:217], v[216:217], v[12:13]
 v_pk_mul_f32 v[218:219], v[218:219], v[12:13]
 v_cvt_pk_bf16_f32 v54, v216, v217
 v_cvt_pk_bf16_f32 v55, v218, v219
 v_pk_mul_f32 v[224:225], v[224:225], v[12:13]
 v_pk_mul_f32 v[226:227], v[226:227], v[12:13]
 v_cvt_pk_bf16_f32 v56, v224, v225
 v_cvt_pk_bf16_f32 v57, v226, v227
 v_pk_mul_f32 v[232:233], v[232:233], v[12:13]
 v_pk_mul_f32 v[234:235], v[234:235], v[12:13]
 v_cvt_pk_bf16_f32 v58, v232, v233
 v_cvt_pk_bf16_f32 v59, v234, v235
 v_pk_mul_f32 v[240:241], v[240:241], v[12:13]
 v_pk_mul_f32 v[242:243], v[242:243], v[12:13]
 v_cvt_pk_bf16_f32 v60, v240, v241
 v_cvt_pk_bf16_f32 v61, v242, v243
 v_pk_mul_f32 v[248:249], v[248:249], v[12:13]
 v_pk_mul_f32 v[250:251], v[250:251], v[12:13]
 v_cvt_pk_bf16_f32 v62, v248, v249
 v_cvt_pk_bf16_f32 v63, v250, v251
 v_pk_mul_f32 v[132:133], v[132:133], v[14:15]
 v_pk_mul_f32 v[134:135], v[134:135], v[14:15]
 v_cvt_pk_bf16_f32 v64, v132, v133
 v_cvt_pk_bf16_f32 v65, v134, v135
 v_pk_mul_f32 v[140:141], v[140:141], v[14:15]
 v_pk_mul_f32 v[142:143], v[142:143], v[14:15]
 v_cvt_pk_bf16_f32 v66, v140, v141
 v_cvt_pk_bf16_f32 v67, v142, v143
 v_pk_mul_f32 v[148:149], v[148:149], v[14:15]
 v_pk_mul_f32 v[150:151], v[150:151], v[14:15]
 v_cvt_pk_bf16_f32 v68, v148, v149
 v_cvt_pk_bf16_f32 v69, v150, v151
 v_pk_mul_f32 v[156:157], v[156:157], v[14:15]
 v_pk_mul_f32 v[158:159], v[158:159], v[14:15]
 v_cvt_pk_bf16_f32 v70, v156, v157
 v_cvt_pk_bf16_f32 v71, v158, v159
 v_pk_mul_f32 v[164:165], v[164:165], v[14:15]
 v_pk_mul_f32 v[166:167], v[166:167], v[14:15]
 v_cvt_pk_bf16_f32 v72, v164, v165
 v_cvt_pk_bf16_f32 v73, v166, v167
 v_pk_mul_f32 v[172:173], v[172:173], v[14:15]
 v_pk_mul_f32 v[174:175], v[174:175], v[14:15]
 v_cvt_pk_bf16_f32 v74, v172, v173
 v_cvt_pk_bf16_f32 v75, v174, v175
 v_pk_mul_f32 v[180:181], v[180:181], v[14:15]
 v_pk_mul_f32 v[182:183], v[182:183], v[14:15]
 v_cvt_pk_bf16_f32 v76, v180, v181
 v_cvt_pk_bf16_f32 v77, v182, v183
 v_pk_mul_f32 v[188:189], v[188:189], v[14:15]
 v_pk_mul_f32 v[190:191], v[190:191], v[14:15]
 v_cvt_pk_bf16_f32 v78, v188, v189
 v_cvt_pk_bf16_f32 v79, v190, v191
 v_pk_mul_f32 v[196:197], v[196:197], v[14:15]
 v_pk_mul_f32 v[198:199], v[198:199], v[14:15]
 v_cvt_pk_bf16_f32 v80, v196, v197
 v_cvt_pk_bf16_f32 v81, v198, v199
 v_pk_mul_f32 v[204:205], v[204:205], v[14:15]
 v_pk_mul_f32 v[206:207], v[206:207], v[14:15]
 v_cvt_pk_bf16_f32 v82, v204, v205
 v_cvt_pk_bf16_f32 v83, v206, v207
 v_pk_mul_f32 v[212:213], v[212:213], v[14:15]
 v_pk_mul_f32 v[214:215], v[214:215], v[14:15]
 v_cvt_pk_bf16_f32 v84, v212, v213
 v_cvt_pk_bf16_f32 v85, v214, v215
 v_pk_mul_f32 v[220:221], v[220:221], v[14:15]
 v_pk_mul_f32 v[222:223], v[222:223], v[14:15]
 v_cvt_pk_bf16_f32 v86, v220, v221
 v_cvt_pk_bf16_f32 v87, v222, v223
 v_pk_mul_f32 v[228:229], v[228:229], v[14:15]
 v_pk_mul_f32 v[230:231], v[230:231], v[14:15]
 v_cvt_pk_bf16_f32 v88, v228, v229
 v_cvt_pk_bf16_f32 v89, v230, v231
 v_pk_mul_f32 v[236:237], v[236:237], v[14:15]
 v_pk_mul_f32 v[238:239], v[238:239], v[14:15]
 v_cvt_pk_bf16_f32 v90, v236, v237
 v_cvt_pk_bf16_f32 v91, v238, v239
 v_pk_mul_f32 v[244:245], v[244:245], v[14:15]
 v_pk_mul_f32 v[246:247], v[246:247], v[14:15]
 v_cvt_pk_bf16_f32 v92, v244, v245
 v_cvt_pk_bf16_f32 v93, v246, v247
 v_pk_mul_f32 v[252:253], v[252:253], v[14:15]
 v_pk_mul_f32 v[254:255], v[254:255], v[14:15]
 v_cvt_pk_bf16_f32 v94, v252, v253
 v_cvt_pk_bf16_f32 v95, v254, v255
 s_branch L_oproj
L_pub:
 v_mov_b32 v108, v4
 v_mov_b32 v109, v96
 v_mov_b32 v110, v8
 v_mov_b32 v111, v100
 buffer_store_dwordx4 v[108:111], v1, s[16:19], s42 offen sc1
 v_rcp_f32 v12, v96
 v_rcp_f32 v14, v100
 v_mov_b32 v13, v12
 v_mov_b32 v15, v14
 v_cvt_pk_bf16_f32 v128, v128, v129
 v_cvt_pk_bf16_f32 v129, v130, v131
 v_cvt_pk_bf16_f32 v130, v136, v137
 v_cvt_pk_bf16_f32 v131, v138, v139
 buffer_store_dwordx4 v[128:131], v1, s[16:19], s41 offen offset:0 sc1
 v_cvt_pk_bf16_f32 v144, v144, v145
 v_cvt_pk_bf16_f32 v145, v146, v147
 v_cvt_pk_bf16_f32 v146, v152, v153
 v_cvt_pk_bf16_f32 v147, v154, v155
 buffer_store_dwordx4 v[144:147], v1, s[16:19], s41 offen offset:1024 sc1
 v_cvt_pk_bf16_f32 v160, v160, v161
 v_cvt_pk_bf16_f32 v161, v162, v163
 v_cvt_pk_bf16_f32 v162, v168, v169
 v_cvt_pk_bf16_f32 v163, v170, v171
 buffer_store_dwordx4 v[160:163], v1, s[16:19], s41 offen offset:2048 sc1
 v_cvt_pk_bf16_f32 v176, v176, v177
 v_cvt_pk_bf16_f32 v177, v178, v179
 v_cvt_pk_bf16_f32 v178, v184, v185
 v_cvt_pk_bf16_f32 v179, v186, v187
 buffer_store_dwordx4 v[176:179], v1, s[16:19], s41 offen offset:3072 sc1
 v_cvt_pk_bf16_f32 v192, v192, v193
 v_cvt_pk_bf16_f32 v193, v194, v195
 v_cvt_pk_bf16_f32 v194, v200, v201
 v_cvt_pk_bf16_f32 v195, v202, v203
 s_add_u32 s41, s41, 4096
 buffer_store_dwordx4 v[192:195], v1, s[16:19], s41 offen offset:0 sc1
 v_cvt_pk_bf16_f32 v208, v208, v209
 v_cvt_pk_bf16_f32 v209, v210, v211
 v_cvt_pk_bf16_f32 v210, v216, v217
 v_cvt_pk_bf16_f32 v211, v218, v219
 buffer_store_dwordx4 v[208:211], v1, s[16:19], s41 offen offset:1024 sc1
 v_cvt_pk_bf16_f32 v224, v224, v225
 v_cvt_pk_bf16_f32 v225, v226, v227
 v_cvt_pk_bf16_f32 v226, v232, v233
 v_cvt_pk_bf16_f32 v227, v234, v235
 buffer_store_dwordx4 v[224:227], v1, s[16:19], s41 offen offset:2048 sc1
 v_cvt_pk_bf16_f32 v240, v240, v241
 v_cvt_pk_bf16_f32 v241, v242, v243
 v_cvt_pk_bf16_f32 v242, v248, v249
 v_cvt_pk_bf16_f32 v243, v250, v251
 buffer_store_dwordx4 v[240:243], v1, s[16:19], s41 offen offset:3072 sc1
 v_cvt_pk_bf16_f32 v132, v132, v133
 v_cvt_pk_bf16_f32 v133, v134, v135
 v_cvt_pk_bf16_f32 v134, v140, v141
 v_cvt_pk_bf16_f32 v135, v142, v143
 s_add_u32 s41, s41, 4096
 buffer_store_dwordx4 v[132:135], v1, s[16:19], s41 offen offset:0 sc1
 v_cvt_pk_bf16_f32 v148, v148, v149
 v_cvt_pk_bf16_f32 v149, v150, v151
 v_cvt_pk_bf16_f32 v150, v156, v157
 v_cvt_pk_bf16_f32 v151, v158, v159
 buffer_store_dwordx4 v[148:151], v1, s[16:19], s41 offen offset:1024 sc1
 v_cvt_pk_bf16_f32 v164, v164, v165
 v_cvt_pk_bf16_f32 v165, v166, v167
 v_cvt_pk_bf16_f32 v166, v172, v173
 v_cvt_pk_bf16_f32 v167, v174, v175
 buffer_store_dwordx4 v[164:167], v1, s[16:19], s41 offen offset:2048 sc1
 v_cvt_pk_bf16_f32 v180, v180, v181
 v_cvt_pk_bf16_f32 v181, v182, v183
 v_cvt_pk_bf16_f32 v182, v188, v189
 v_cvt_pk_bf16_f32 v183, v190, v191
 buffer_store_dwordx4 v[180:183], v1, s[16:19], s41 offen offset:3072 sc1
 v_cvt_pk_bf16_f32 v196, v196, v197
 v_cvt_pk_bf16_f32 v197, v198, v199
 v_cvt_pk_bf16_f32 v198, v204, v205
 v_cvt_pk_bf16_f32 v199, v206, v207
 s_add_u32 s41, s41, 4096
 buffer_store_dwordx4 v[196:199], v1, s[16:19], s41 offen offset:0 sc1
 v_cvt_pk_bf16_f32 v212, v212, v213
 v_cvt_pk_bf16_f32 v213, v214, v215
 v_cvt_pk_bf16_f32 v214, v220, v221
 v_cvt_pk_bf16_f32 v215, v222, v223
 buffer_store_dwordx4 v[212:215], v1, s[16:19], s41 offen offset:1024 sc1
 v_cvt_pk_bf16_f32 v228, v228, v229
 v_cvt_pk_bf16_f32 v229, v230, v231
 v_cvt_pk_bf16_f32 v230, v236, v237
 v_cvt_pk_bf16_f32 v231, v238, v239
 buffer_store_dwordx4 v[228:231], v1, s[16:19], s41 offen offset:2048 sc1
 v_cvt_pk_bf16_f32 v244, v244, v245
 v_cvt_pk_bf16_f32 v245, v246, v247
 v_cvt_pk_bf16_f32 v246, v252, v253
 v_cvt_pk_bf16_f32 v247, v254, v255
 buffer_store_dwordx4 v[244:247], v1, s[16:19], s41 offen offset:3072 sc1
 v_accvgpr_read_b32 v32, a192
 v_accvgpr_read_b32 v33, a193
 v_accvgpr_read_b32 v34, a194
 v_accvgpr_read_b32 v35, a195
 v_accvgpr_read_b32 v36, a196
 v_accvgpr_read_b32 v37, a197
 v_accvgpr_read_b32 v38, a198
 v_accvgpr_read_b32 v39, a199
 v_accvgpr_read_b32 v40, a200
 v_accvgpr_read_b32 v41, a201
 v_accvgpr_read_b32 v42, a202
 v_accvgpr_read_b32 v43, a203
 v_accvgpr_read_b32 v44, a204
 v_accvgpr_read_b32 v45, a205
 v_accvgpr_read_b32 v46, a206
 v_accvgpr_read_b32 v47, a207
 v_accvgpr_read_b32 v48, a208
 v_accvgpr_read_b32 v49, a209
 v_accvgpr_read_b32 v50, a210
 v_accvgpr_read_b32 v51, a211
 v_accvgpr_read_b32 v52, a212
 v_accvgpr_read_b32 v53, a213
 v_accvgpr_read_b32 v54, a214
 v_accvgpr_read_b32 v55, a215
 v_accvgpr_read_b32 v56, a216
 v_accvgpr_read_b32 v57, a217
 v_accvgpr_read_b32 v58, a218
 v_accvgpr_read_b32 v59, a219
 v_accvgpr_read_b32 v60, a220
 v_accvgpr_read_b32 v61, a221
 v_accvgpr_read_b32 v62, a222
 v_accvgpr_read_b32 v63, a223
 v_accvgpr_read_b32 v64, a224
 v_accvgpr_read_b32 v65, a225
 v_accvgpr_read_b32 v66, a226
 v_accvgpr_read_b32 v67, a227
 v_accvgpr_read_b32 v68, a228
 v_accvgpr_read_b32 v69, a229
 v_accvgpr_read_b32 v70, a230
 v_accvgpr_read_b32 v71, a231
 v_accvgpr_read_b32 v72, a232
 v_accvgpr_read_b32 v73, a233
 v_accvgpr_read_b32 v74, a234
 v_accvgpr_read_b32 v75, a235
 v_accvgpr_read_b32 v76, a236
 v_accvgpr_read_b32 v77, a237
 v_accvgpr_read_b32 v78, a238
 v_accvgpr_read_b32 v79, a239
 v_accvgpr_read_b32 v80, a240
 v_accvgpr_read_b32 v81, a241
 v_accvgpr_read_b32 v82, a242
 v_accvgpr_read_b32 v83, a243
 v_accvgpr_read_b32 v84, a244
 v_accvgpr_read_b32 v85, a245
 v_accvgpr_read_b32 v86, a246
 v_accvgpr_read_b32 v87, a247
 v_accvgpr_read_b32 v88, a248
 v_accvgpr_read_b32 v89, a249
 v_accvgpr_read_b32 v90, a250
 v_accvgpr_read_b32 v91, a251
 v_accvgpr_read_b32 v92, a252
 v_accvgpr_read_b32 v93, a253
 v_accvgpr_read_b32 v94, a254
 v_accvgpr_read_b32 v95, a255
 s_waitcnt vmcnt(0)
 s_barrier
 buffer_atomic_add v26, v25, s[16:19], s15 offen offset:12 sc1
 s_branch L_oproj
L_late:
L_part_p:
 s_mov_b32 s39, 0
 s_add_u32 s20, s6, s22
 s_addc_u32 s21, s7, 0
L_part_p_l:
 s_load_dword s38, s[20:21], 12 glc
 s_waitcnt lgkmcnt(0)
 s_bitcmp1_b32 s38, s27
 s_cbranch_scc1 L_late2
 s_add_u32 s39, s39, 1
 s_cmp_gt_u32 s39, 100000
 s_cbranch_scc1 L_late2
 s_sleep 2
 s_branch L_part_p_l
L_late2:
 buffer_load_dwordx4 v[108:111], v1, s[16:19], s42 offen sc1
 buffer_load_dwordx4 v[32:35], v1, s[16:19], s41 offen offset:0 sc1
 buffer_load_dwordx4 v[36:39], v1, s[16:19], s41 offen offset:1024 sc1
 buffer_load_dwordx4 v[40:43], v1, s[16:19], s41 offen offset:2048 sc1
 buffer_load_dwordx4 v[44:47], v1, s[16:19], s41 offen offset:3072 sc1
 s_add_u32 s41, s41, 4096
 buffer_load_dwordx4 v[48:51], v1, s[16:19], s41 offen offset:0 sc1
 buffer_load_dwordx4 v[52:55], v1, s[16:19], s41 offen offset:1024 sc1
 buffer_load_dwordx4 v[56:59], v1, s[16:19], s41 offen offset:2048 sc1
 buffer_load_dwordx4 v[60:63], v1, s[16:19], s41 offen offset:3072 sc1
 s_add_u32 s41, s41, 4096
 buffer_load_dwordx4 v[64:67], v1, s[16:19], s41 offen offset:0 sc1
 buffer_load_dwordx4 v[68:71], v1, s[16:19], s41 offen offset:1024 sc1
 buffer_load_dwordx4 v[72:75], v1, s[16:19], s41 offen offset:2048 sc1
 buffer_load_dwordx4 v[76:79], v1, s[16:19], s41 offen offset:3072 sc1
 s_add_u32 s41, s41, 4096
 buffer_load_dwordx4 v[120:123], v1, s[16:19], s41 offen offset:0 sc1
 buffer_load_dwordx4 v[124:127], v1, s[16:19], s41 offen offset:1024 sc1
 buffer_load_dwordx4 v[16:19], v1, s[16:19], s41 offen offset:2048 sc1
 buffer_load_dwordx4 v[20:23], v1, s[16:19], s41 offen offset:3072 sc1
 s_waitcnt vmcnt(16)
 v_sub_f32 v104, v4, v108
 v_min_f32 v104, 0x42800000, v104
 v_max_f32 v104, 0xc2f00000, v104
 v_cvt_i32_f32 v104, v104
 v_ldexp_f32 v104, 1.0, v104
 v_lshrrev_b32 v105, 16, v104
 v_fma_f32 v12, v104, v109, v96
 v_rcp_f32 v12, v12
 s_nop 0
 v_mov_b32 v13, v12
 v_sub_f32 v106, v8, v110
 v_min_f32 v106, 0x42800000, v106
 v_max_f32 v106, 0xc2f00000, v106
 v_cvt_i32_f32 v106, v106
 v_ldexp_f32 v106, 1.0, v106
 v_lshrrev_b32 v107, 16, v106
 v_fma_f32 v14, v106, v111, v100
 v_rcp_f32 v14, v14
 s_nop 0
 v_mov_b32 v15, v14
 s_waitcnt vmcnt(15)
 v_dot2_f32_bf16 v128, v32, v105, v128
 v_dot2_f32_bf16 v129, v32, v104, v129
 v_dot2_f32_bf16 v130, v33, v105, v130
 v_dot2_f32_bf16 v131, v33, v104, v131
 v_dot2_f32_bf16 v136, v34, v105, v136
 v_dot2_f32_bf16 v137, v34, v104, v137
 v_dot2_f32_bf16 v138, v35, v105, v138
 v_dot2_f32_bf16 v139, v35, v104, v139
 v_pk_mul_f32 v[128:129], v[128:129], v[12:13]
 v_pk_mul_f32 v[130:131], v[130:131], v[12:13]
 v_pk_mul_f32 v[136:137], v[136:137], v[12:13]
 v_pk_mul_f32 v[138:139], v[138:139], v[12:13]
 v_cvt_pk_bf16_f32 v32, v128, v129
 v_cvt_pk_bf16_f32 v33, v130, v131
 v_cvt_pk_bf16_f32 v34, v136, v137
 v_cvt_pk_bf16_f32 v35, v138, v139
 s_waitcnt vmcnt(14)
 v_dot2_f32_bf16 v144, v36, v105, v144
 v_dot2_f32_bf16 v145, v36, v104, v145
 v_dot2_f32_bf16 v146, v37, v105, v146
 v_dot2_f32_bf16 v147, v37, v104, v147
 v_dot2_f32_bf16 v152, v38, v105, v152
 v_dot2_f32_bf16 v153, v38, v104, v153
 v_dot2_f32_bf16 v154, v39, v105, v154
 v_dot2_f32_bf16 v155, v39, v104, v155
 v_pk_mul_f32 v[144:145], v[144:145], v[12:13]
 v_pk_mul_f32 v[146:147], v[146:147], v[12:13]
 v_pk_mul_f32 v[152:153], v[152:153], v[12:13]
 v_pk_mul_f32 v[154:155], v[154:155], v[12:13]
 v_cvt_pk_bf16_f32 v36, v144, v145
 v_cvt_pk_bf16_f32 v37, v146, v147
 v_cvt_pk_bf16_f32 v38, v152, v153
 v_cvt_pk_bf16_f32 v39, v154, v155
 s_waitcnt vmcnt(13)
 v_dot2_f32_bf16 v160, v40, v105, v160
 v_dot2_f32_bf16 v161, v40, v104, v161
 v_dot2_f32_bf16 v162, v41, v105, v162
 v_dot2_f32_bf16 v163, v41, v104, v163
 v_dot2_f32_bf16 v168, v42, v105, v168
 v_dot2_f32_bf16 v169, v42, v104, v169
 v_dot2_f32_bf16 v170, v43, v105, v170
 v_dot2_f32_bf16 v171, v43, v104, v171
 v_pk_mul_f32 v[160:161], v[160:161], v[12:13]
 v_pk_mul_f32 v[162:163], v[162:163], v[12:13]
 v_pk_mul_f32 v[168:169], v[168:169], v[12:13]
 v_pk_mul_f32 v[170:171], v[170:171], v[12:13]
 v_cvt_pk_bf16_f32 v40, v160, v161
 v_cvt_pk_bf16_f32 v41, v162, v163
 v_cvt_pk_bf16_f32 v42, v168, v169
 v_cvt_pk_bf16_f32 v43, v170, v171
 s_waitcnt vmcnt(12)
 v_dot2_f32_bf16 v176, v44, v105, v176
 v_dot2_f32_bf16 v177, v44, v104, v177
 v_dot2_f32_bf16 v178, v45, v105, v178
 v_dot2_f32_bf16 v179, v45, v104, v179
 v_dot2_f32_bf16 v184, v46, v105, v184
 v_dot2_f32_bf16 v185, v46, v104, v185
 v_dot2_f32_bf16 v186, v47, v105, v186
 v_dot2_f32_bf16 v187, v47, v104, v187
 v_pk_mul_f32 v[176:177], v[176:177], v[12:13]
 v_pk_mul_f32 v[178:179], v[178:179], v[12:13]
 v_pk_mul_f32 v[184:185], v[184:185], v[12:13]
 v_pk_mul_f32 v[186:187], v[186:187], v[12:13]
 v_cvt_pk_bf16_f32 v44, v176, v177
 v_cvt_pk_bf16_f32 v45, v178, v179
 v_cvt_pk_bf16_f32 v46, v184, v185
 v_cvt_pk_bf16_f32 v47, v186, v187
 s_waitcnt vmcnt(11)
 v_dot2_f32_bf16 v192, v48, v105, v192
 v_dot2_f32_bf16 v193, v48, v104, v193
 v_dot2_f32_bf16 v194, v49, v105, v194
 v_dot2_f32_bf16 v195, v49, v104, v195
 v_dot2_f32_bf16 v200, v50, v105, v200
 v_dot2_f32_bf16 v201, v50, v104, v201
 v_dot2_f32_bf16 v202, v51, v105, v202
 v_dot2_f32_bf16 v203, v51, v104, v203
 v_pk_mul_f32 v[192:193], v[192:193], v[12:13]
 v_pk_mul_f32 v[194:195], v[194:195], v[12:13]
 v_pk_mul_f32 v[200:201], v[200:201], v[12:13]
 v_pk_mul_f32 v[202:203], v[202:203], v[12:13]
 v_cvt_pk_bf16_f32 v48, v192, v193
 v_cvt_pk_bf16_f32 v49, v194, v195
 v_cvt_pk_bf16_f32 v50, v200, v201
 v_cvt_pk_bf16_f32 v51, v202, v203
 s_waitcnt vmcnt(10)
 v_dot2_f32_bf16 v208, v52, v105, v208
 v_dot2_f32_bf16 v209, v52, v104, v209
 v_dot2_f32_bf16 v210, v53, v105, v210
 v_dot2_f32_bf16 v211, v53, v104, v211
 v_dot2_f32_bf16 v216, v54, v105, v216
 v_dot2_f32_bf16 v217, v54, v104, v217
 v_dot2_f32_bf16 v218, v55, v105, v218
 v_dot2_f32_bf16 v219, v55, v104, v219
 v_pk_mul_f32 v[208:209], v[208:209], v[12:13]
 v_pk_mul_f32 v[210:211], v[210:211], v[12:13]
 v_pk_mul_f32 v[216:217], v[216:217], v[12:13]
 v_pk_mul_f32 v[218:219], v[218:219], v[12:13]
 v_cvt_pk_bf16_f32 v52, v208, v209
 v_cvt_pk_bf16_f32 v53, v210, v211
 v_cvt_pk_bf16_f32 v54, v216, v217
 v_cvt_pk_bf16_f32 v55, v218, v219
 s_waitcnt vmcnt(9)
 v_dot2_f32_bf16 v224, v56, v105, v224
 v_dot2_f32_bf16 v225, v56, v104, v225
 v_dot2_f32_bf16 v226, v57, v105, v226
 v_dot2_f32_bf16 v227, v57, v104, v227
 v_dot2_f32_bf16 v232, v58, v105, v232
 v_dot2_f32_bf16 v233, v58, v104, v233
 v_dot2_f32_bf16 v234, v59, v105, v234
 v_dot2_f32_bf16 v235, v59, v104, v235
 v_pk_mul_f32 v[224:225], v[224:225], v[12:13]
 v_pk_mul_f32 v[226:227], v[226:227], v[12:13]
 v_pk_mul_f32 v[232:233], v[232:233], v[12:13]
 v_pk_mul_f32 v[234:235], v[234:235], v[12:13]
 v_cvt_pk_bf16_f32 v56, v224, v225
 v_cvt_pk_bf16_f32 v57, v226, v227
 v_cvt_pk_bf16_f32 v58, v232, v233
 v_cvt_pk_bf16_f32 v59, v234, v235
 s_waitcnt vmcnt(8)
 v_dot2_f32_bf16 v240, v60, v105, v240
 v_dot2_f32_bf16 v241, v60, v104, v241
 v_dot2_f32_bf16 v242, v61, v105, v242
 v_dot2_f32_bf16 v243, v61, v104, v243
 v_dot2_f32_bf16 v248, v62, v105, v248
 v_dot2_f32_bf16 v249, v62, v104, v249
 v_dot2_f32_bf16 v250, v63, v105, v250
 v_dot2_f32_bf16 v251, v63, v104, v251
 v_pk_mul_f32 v[240:241], v[240:241], v[12:13]
 v_pk_mul_f32 v[242:243], v[242:243], v[12:13]
 v_pk_mul_f32 v[248:249], v[248:249], v[12:13]
 v_pk_mul_f32 v[250:251], v[250:251], v[12:13]
 v_cvt_pk_bf16_f32 v60, v240, v241
 v_cvt_pk_bf16_f32 v61, v242, v243
 v_cvt_pk_bf16_f32 v62, v248, v249
 v_cvt_pk_bf16_f32 v63, v250, v251
 s_waitcnt vmcnt(7)
 v_dot2_f32_bf16 v132, v64, v107, v132
 v_dot2_f32_bf16 v133, v64, v106, v133
 v_dot2_f32_bf16 v134, v65, v107, v134
 v_dot2_f32_bf16 v135, v65, v106, v135
 v_dot2_f32_bf16 v140, v66, v107, v140
 v_dot2_f32_bf16 v141, v66, v106, v141
 v_dot2_f32_bf16 v142, v67, v107, v142
 v_dot2_f32_bf16 v143, v67, v106, v143
 v_pk_mul_f32 v[132:133], v[132:133], v[14:15]
 v_pk_mul_f32 v[134:135], v[134:135], v[14:15]
 v_pk_mul_f32 v[140:141], v[140:141], v[14:15]
 v_pk_mul_f32 v[142:143], v[142:143], v[14:15]
 v_cvt_pk_bf16_f32 v64, v132, v133
 v_cvt_pk_bf16_f32 v65, v134, v135
 v_cvt_pk_bf16_f32 v66, v140, v141
 v_cvt_pk_bf16_f32 v67, v142, v143
 s_waitcnt vmcnt(6)
 v_dot2_f32_bf16 v148, v68, v107, v148
 v_dot2_f32_bf16 v149, v68, v106, v149
 v_dot2_f32_bf16 v150, v69, v107, v150
 v_dot2_f32_bf16 v151, v69, v106, v151
 v_dot2_f32_bf16 v156, v70, v107, v156
 v_dot2_f32_bf16 v157, v70, v106, v157
 v_dot2_f32_bf16 v158, v71, v107, v158
 v_dot2_f32_bf16 v159, v71, v106, v159
 v_pk_mul_f32 v[148:149], v[148:149], v[14:15]
 v_pk_mul_f32 v[150:151], v[150:151], v[14:15]
 v_pk_mul_f32 v[156:157], v[156:157], v[14:15]
 v_pk_mul_f32 v[158:159], v[158:159], v[14:15]
 v_cvt_pk_bf16_f32 v68, v148, v149
 v_cvt_pk_bf16_f32 v69, v150, v151
 v_cvt_pk_bf16_f32 v70, v156, v157
 v_cvt_pk_bf16_f32 v71, v158, v159
 s_waitcnt vmcnt(5)
 v_dot2_f32_bf16 v164, v72, v107, v164
 v_dot2_f32_bf16 v165, v72, v106, v165
 v_dot2_f32_bf16 v166, v73, v107, v166
 v_dot2_f32_bf16 v167, v73, v106, v167
 v_dot2_f32_bf16 v172, v74, v107, v172
 v_dot2_f32_bf16 v173, v74, v106, v173
 v_dot2_f32_bf16 v174, v75, v107, v174
 v_dot2_f32_bf16 v175, v75, v106, v175
 v_pk_mul_f32 v[164:165], v[164:165], v[14:15]
 v_pk_mul_f32 v[166:167], v[166:167], v[14:15]
 v_pk_mul_f32 v[172:173], v[172:173], v[14:15]
 v_pk_mul_f32 v[174:175], v[174:175], v[14:15]
 v_cvt_pk_bf16_f32 v72, v164, v165
 v_cvt_pk_bf16_f32 v73, v166, v167
 v_cvt_pk_bf16_f32 v74, v172, v173
 v_cvt_pk_bf16_f32 v75, v174, v175
 s_waitcnt vmcnt(4)
 v_dot2_f32_bf16 v180, v76, v107, v180
 v_dot2_f32_bf16 v181, v76, v106, v181
 v_dot2_f32_bf16 v182, v77, v107, v182
 v_dot2_f32_bf16 v183, v77, v106, v183
 v_dot2_f32_bf16 v188, v78, v107, v188
 v_dot2_f32_bf16 v189, v78, v106, v189
 v_dot2_f32_bf16 v190, v79, v107, v190
 v_dot2_f32_bf16 v191, v79, v106, v191
 v_pk_mul_f32 v[180:181], v[180:181], v[14:15]
 v_pk_mul_f32 v[182:183], v[182:183], v[14:15]
 v_pk_mul_f32 v[188:189], v[188:189], v[14:15]
 v_pk_mul_f32 v[190:191], v[190:191], v[14:15]
 v_cvt_pk_bf16_f32 v76, v180, v181
 v_cvt_pk_bf16_f32 v77, v182, v183
 v_cvt_pk_bf16_f32 v78, v188, v189
 v_cvt_pk_bf16_f32 v79, v190, v191
 s_waitcnt vmcnt(3)
 v_dot2_f32_bf16 v196, v120, v107, v196
 v_dot2_f32_bf16 v197, v120, v106, v197
 v_dot2_f32_bf16 v198, v121, v107, v198
 v_dot2_f32_bf16 v199, v121, v106, v199
 v_dot2_f32_bf16 v204, v122, v107, v204
 v_dot2_f32_bf16 v205, v122, v106, v205
 v_dot2_f32_bf16 v206, v123, v107, v206
 v_dot2_f32_bf16 v207, v123, v106, v207
 v_pk_mul_f32 v[196:197], v[196:197], v[14:15]
 v_pk_mul_f32 v[198:199], v[198:199], v[14:15]
 v_pk_mul_f32 v[204:205], v[204:205], v[14:15]
 v_pk_mul_f32 v[206:207], v[206:207], v[14:15]
 v_cvt_pk_bf16_f32 v80, v196, v197
 v_cvt_pk_bf16_f32 v81, v198, v199
 v_cvt_pk_bf16_f32 v82, v204, v205
 v_cvt_pk_bf16_f32 v83, v206, v207
 s_waitcnt vmcnt(2)
 v_dot2_f32_bf16 v212, v124, v107, v212
 v_dot2_f32_bf16 v213, v124, v106, v213
 v_dot2_f32_bf16 v214, v125, v107, v214
 v_dot2_f32_bf16 v215, v125, v106, v215
 v_dot2_f32_bf16 v220, v126, v107, v220
 v_dot2_f32_bf16 v221, v126, v106, v221
 v_dot2_f32_bf16 v222, v127, v107, v222
 v_dot2_f32_bf16 v223, v127, v106, v223
 v_pk_mul_f32 v[212:213], v[212:213], v[14:15]
 v_pk_mul_f32 v[214:215], v[214:215], v[14:15]
 v_pk_mul_f32 v[220:221], v[220:221], v[14:15]
 v_pk_mul_f32 v[222:223], v[222:223], v[14:15]
 v_cvt_pk_bf16_f32 v84, v212, v213
 v_cvt_pk_bf16_f32 v85, v214, v215
 v_cvt_pk_bf16_f32 v86, v220, v221
 v_cvt_pk_bf16_f32 v87, v222, v223
 s_waitcnt vmcnt(1)
 v_dot2_f32_bf16 v228, v16, v107, v228
 v_dot2_f32_bf16 v229, v16, v106, v229
 v_dot2_f32_bf16 v230, v17, v107, v230
 v_dot2_f32_bf16 v231, v17, v106, v231
 v_dot2_f32_bf16 v236, v18, v107, v236
 v_dot2_f32_bf16 v237, v18, v106, v237
 v_dot2_f32_bf16 v238, v19, v107, v238
 v_dot2_f32_bf16 v239, v19, v106, v239
 v_pk_mul_f32 v[228:229], v[228:229], v[14:15]
 v_pk_mul_f32 v[230:231], v[230:231], v[14:15]
 v_pk_mul_f32 v[236:237], v[236:237], v[14:15]
 v_pk_mul_f32 v[238:239], v[238:239], v[14:15]
 v_cvt_pk_bf16_f32 v88, v228, v229
 v_cvt_pk_bf16_f32 v89, v230, v231
 v_cvt_pk_bf16_f32 v90, v236, v237
 v_cvt_pk_bf16_f32 v91, v238, v239
 s_waitcnt vmcnt(0)
 v_dot2_f32_bf16 v244, v20, v107, v244
 v_dot2_f32_bf16 v245, v20, v106, v245
 v_dot2_f32_bf16 v246, v21, v107, v246
 v_dot2_f32_bf16 v247, v21, v106, v247
 v_dot2_f32_bf16 v252, v22, v107, v252
 v_dot2_f32_bf16 v253, v22, v106, v253
 v_dot2_f32_bf16 v254, v23, v107, v254
 v_dot2_f32_bf16 v255, v23, v106, v255
 v_pk_mul_f32 v[244:245], v[244:245], v[14:15]
 v_pk_mul_f32 v[246:247], v[246:247], v[14:15]
 v_pk_mul_f32 v[252:253], v[252:253], v[14:15]
 v_pk_mul_f32 v[254:255], v[254:255], v[14:15]
 v_cvt_pk_bf16_f32 v92, v244, v245
 v_cvt_pk_bf16_f32 v93, v246, v247
 v_cvt_pk_bf16_f32 v94, v252, v253
 v_cvt_pk_bf16_f32 v95, v254, v255
 s_branch L_oproj
L_lastC:
 v_mfma_f32_16x16x32_bf16 v[96:99], v[104:107], v[80:83], v[96:99]
 buffer_load_dwordx4 v[108:111], v1, s[16:19], s42 offen sc1
 v_mfma_f32_16x16x32_bf16 v[96:99], v[104:107], v[88:91], v[96:99]
 v_mfma_f32_16x16x32_bf16 v[100:103], v[104:107], v[84:87], v[100:103]
 v_mfma_f32_16x16x32_bf16 v[100:103], v[104:107], v[92:95], v[100:103]
 s_waitcnt lgkmcnt(7)
 v_mfma_f32_16x16x32_bf16 v[128:131], a[64:67], v[80:83], v[128:131]
 s_waitcnt lgkmcnt(0)
 buffer_load_dwordx4 v[32:35], v1, s[16:19], s41 offen offset:0 sc1
 v_mfma_f32_16x16x32_bf16 v[128:131], a[68:71], v[88:91], v[128:131]
 ds_read_b128 a[96:99], v2 offset:36864
 ds_read_b128 a[100:103], v2 offset:53248
 v_mfma_f32_16x16x32_bf16 v[132:135], a[68:71], v[92:95], v[132:135]
 v_mfma_f32_16x16x32_bf16 v[132:135], a[64:67], v[84:87], v[132:135]
 ds_read_b128 a[104:107], v2 offset:37888
 v_mfma_f32_16x16x32_bf16 v[140:143], a[72:75], v[84:87], v[140:143]
 buffer_load_dwordx4 v[36:39], v1, s[16:19], s41 offen offset:1024 sc1
 v_mfma_f32_16x16x32_bf16 v[140:143], a[76:79], v[92:95], v[140:143]
 ds_read_b128 a[108:111], v2 offset:54272
 v_mfma_f32_16x16x32_bf16 v[136:139], a[76:79], v[88:91], v[136:139]
 ds_read_b128 a[112:115], v2 offset:38912
 v_mfma_f32_16x16x32_bf16 v[136:139], a[72:75], v[80:83], v[136:139]
 ds_read_b128 a[116:119], v2 offset:55296
 v_mfma_f32_16x16x32_bf16 v[144:147], a[80:83], v[80:83], v[144:147]
 buffer_load_dwordx4 v[40:43], v1, s[16:19], s41 offen offset:2048 sc1
 v_mfma_f32_16x16x32_bf16 v[144:147], a[84:87], v[88:91], v[144:147]
 ds_read_b128 a[120:123], v2 offset:39936
 v_mfma_f32_16x16x32_bf16 v[148:151], a[84:87], v[92:95], v[148:151]
 ds_read_b128 a[124:127], v2 offset:56320
 v_mfma_f32_16x16x32_bf16 v[148:151], a[80:83], v[84:87], v[148:151]
 v_mfma_f32_16x16x32_bf16 v[156:159], a[88:91], v[84:87], v[156:159]
 buffer_load_dwordx4 v[44:47], v1, s[16:19], s41 offen offset:3072 sc1
 v_mfma_f32_16x16x32_bf16 v[156:159], a[92:95], v[92:95], v[156:159]
 v_mfma_f32_16x16x32_bf16 v[152:155], a[92:95], v[88:91], v[152:155]
 v_mfma_f32_16x16x32_bf16 v[152:155], a[88:91], v[80:83], v[152:155]
 s_waitcnt lgkmcnt(0)
 s_add_u32 s41, s41, 4096
 v_mfma_f32_16x16x32_bf16 v[160:163], a[96:99], v[80:83], v[160:163]
 buffer_load_dwordx4 v[48:51], v1, s[16:19], s41 offen offset:0 sc1
 v_mfma_f32_16x16x32_bf16 v[160:163], a[100:103], v[88:91], v[160:163]
 ds_read_b128 a[64:67], v2 offset:40960
 ds_read_b128 a[68:71], v2 offset:57344
 v_mfma_f32_16x16x32_bf16 v[164:167], a[100:103], v[92:95], v[164:167]
 v_mfma_f32_16x16x32_bf16 v[164:167], a[96:99], v[84:87], v[164:167]
 ds_read_b128 a[72:75], v2 offset:41984
 v_mfma_f32_16x16x32_bf16 v[172:175], a[104:107], v[84:87], v[172:175]
 buffer_load_dwordx4 v[52:55], v1, s[16:19], s41 offen offset:1024 sc1
 v_mfma_f32_16x16x32_bf16 v[172:175], a[108:111], v[92:95], v[172:175]
 ds_read_b128 a[76:79], v2 offset:58368
 v_mfma_f32_16x16x32_bf16 v[168:171], a[108:111], v[88:91], v[168:171]
 ds_read_b128 a[80:83], v2 offset:43008
 v_mfma_f32_16x16x32_bf16 v[168:171], a[104:107], v[80:83], v[168:171]
 ds_read_b128 a[84:87], v2 offset:59392
 v_mfma_f32_16x16x32_bf16 v[176:179], a[112:115], v[80:83], v[176:179]
 buffer_load_dwordx4 v[56:59], v1, s[16:19], s41 offen offset:2048 sc1
 v_mfma_f32_16x16x32_bf16 v[176:179], a[116:119], v[88:91], v[176:179]
 ds_read_b128 a[88:91], v2 offset:44032
 v_mfma_f32_16x16x32_bf16 v[180:183], a[116:119], v[92:95], v[180:183]
 ds_read_b128 a[92:95], v2 offset:60416
 v_mfma_f32_16x16x32_bf16 v[180:183], a[112:115], v[84:87], v[180:183]
 v_mfma_f32_16x16x32_bf16 v[188:191], a[120:123], v[84:87], v[188:191]
 buffer_load_dwordx4 v[60:63], v1, s[16:19], s41 offen offset:3072 sc1
 v_mfma_f32_16x16x32_bf16 v[188:191], a[124:127], v[92:95], v[188:191]
 v_mfma_f32_16x16x32_bf16 v[184:187], a[124:127], v[88:91], v[184:187]
 v_mfma_f32_16x16x32_bf16 v[184:187], a[120:123], v[80:83], v[184:187]
 s_waitcnt lgkmcnt(0)
 s_add_u32 s41, s41, 4096
 v_mfma_f32_16x16x32_bf16 v[192:195], a[64:67], v[80:83], v[192:195]
 buffer_load_dwordx4 v[64:67], v1, s[16:19], s41 offen offset:0 sc1
 v_mfma_f32_16x16x32_bf16 v[192:195], a[68:71], v[88:91], v[192:195]
 ds_read_b128 a[96:99], v2 offset:45056
 ds_read_b128 a[100:103], v2 offset:61440
 v_mfma_f32_16x16x32_bf16 v[196:199], a[68:71], v[92:95], v[196:199]
 v_mfma_f32_16x16x32_bf16 v[196:199], a[64:67], v[84:87], v[196:199]
 ds_read_b128 a[104:107], v2 offset:46080
 v_mfma_f32_16x16x32_bf16 v[204:207], a[72:75], v[84:87], v[204:207]
 buffer_load_dwordx4 v[68:71], v1, s[16:19], s41 offen offset:1024 sc1
 v_mfma_f32_16x16x32_bf16 v[204:207], a[76:79], v[92:95], v[204:207]
 ds_read_b128 a[108:111], v2 offset:62464
 v_mfma_f32_16x16x32_bf16 v[200:203], a[76:79], v[88:91], v[200:203]
 ds_read_b128 a[112:115], v2 offset:47104
 v_mfma_f32_16x16x32_bf16 v[200:203], a[72:75], v[80:83], v[200:203]
 ds_read_b128 a[116:119], v2 offset:63488
 v_mfma_f32_16x16x32_bf16 v[208:211], a[80:83], v[80:83], v[208:211]
 buffer_load_dwordx4 v[72:75], v1, s[16:19], s41 offen offset:2048 sc1
 v_mfma_f32_16x16x32_bf16 v[208:211], a[84:87], v[88:91], v[208:211]
 ds_read_b128 a[120:123], v2 offset:48128
 v_mfma_f32_16x16x32_bf16 v[212:215], a[84:87], v[92:95], v[212:215]
 ds_read_b128 a[124:127], v2 offset:64512
 v_mfma_f32_16x16x32_bf16 v[212:215], a[80:83], v[84:87], v[212:215]
 v_mfma_f32_16x16x32_bf16 v[220:223], a[88:91], v[84:87], v[220:223]
 buffer_load_dwordx4 v[76:79], v1, s[16:19], s41 offen offset:3072 sc1
 v_mfma_f32_16x16x32_bf16 v[220:223], a[92:95], v[92:95], v[220:223]
 v_mfma_f32_16x16x32_bf16 v[216:219], a[92:95], v[88:91], v[216:219]
 v_mfma_f32_16x16x32_bf16 v[216:219], a[88:91], v[80:83], v[216:219]
 s_waitcnt lgkmcnt(0)
 s_add_u32 s41, s41, 4096
 v_mfma_f32_16x16x32_bf16 v[224:227], a[96:99], v[80:83], v[224:227]
 buffer_load_dwordx4 v[120:123], v1, s[16:19], s41 offen offset:0 sc1
 v_mfma_f32_16x16x32_bf16 v[224:227], a[100:103], v[88:91], v[224:227]
 v_mfma_f32_16x16x32_bf16 v[228:231], a[100:103], v[92:95], v[228:231]
 v_mfma_f32_16x16x32_bf16 v[228:231], a[96:99], v[84:87], v[228:231]
 v_mfma_f32_16x16x32_bf16 v[236:239], a[104:107], v[84:87], v[236:239]
 buffer_load_dwordx4 v[124:127], v1, s[16:19], s41 offen offset:1024 sc1
 v_mfma_f32_16x16x32_bf16 v[236:239], a[108:111], v[92:95], v[236:239]
 v_mfma_f32_16x16x32_bf16 v[232:235], a[108:111], v[88:91], v[232:235]
 v_mfma_f32_16x16x32_bf16 v[232:235], a[104:107], v[80:83], v[232:235]
 v_mfma_f32_16x16x32_bf16 v[240:243], a[112:115], v[80:83], v[240:243]
 buffer_load_dwordx4 v[16:19], v1, s[16:19], s41 offen offset:2048 sc1
 v_mfma_f32_16x16x32_bf16 v[240:243], a[116:119], v[88:91], v[240:243]
 v_mfma_f32_16x16x32_bf16 v[244:247], a[116:119], v[92:95], v[244:247]
 v_mfma_f32_16x16x32_bf16 v[244:247], a[112:115], v[84:87], v[244:247]
 v_mfma_f32_16x16x32_bf16 v[252:255], a[120:123], v[84:87], v[252:255]
 buffer_load_dwordx4 v[20:23], v1, s[16:19], s41 offen offset:3072 sc1
 v_mfma_f32_16x16x32_bf16 v[252:255], a[124:127], v[92:95], v[252:255]
 v_mfma_f32_16x16x32_bf16 v[248:251], a[124:127], v[88:91], v[248:251]
 v_mfma_f32_16x16x32_bf16 v[248:251], a[120:123], v[80:83], v[248:251]
 s_waitcnt vmcnt(16)
 v_sub_f32 v104, v4, v108
 v_min_f32 v104, 0x42800000, v104
 v_max_f32 v104, 0xc2f00000, v104
 v_cvt_i32_f32 v104, v104
 v_ldexp_f32 v104, 1.0, v104
 v_lshrrev_b32 v105, 16, v104
 v_fma_f32 v12, v104, v109, v96
 v_rcp_f32 v12, v12
 s_nop 0
 v_mov_b32 v13, v12
 v_sub_f32 v106, v8, v110
 v_min_f32 v106, 0x42800000, v106
 v_max_f32 v106, 0xc2f00000, v106
 v_cvt_i32_f32 v106, v106
 v_ldexp_f32 v106, 1.0, v106
 v_lshrrev_b32 v107, 16, v106
 s_add_u32 m0, s32, 0
 s_add_u32 s35, s48, 0
 buffer_load_dwordx4 v31, s[44:47], s35 offen lds
 v_fma_f32 v14, v106, v111, v100
 v_rcp_f32 v14, v14
 s_nop 0
 v_mov_b32 v15, v14
 s_waitcnt vmcnt(16)
 v_dot2_f32_bf16 v128, v32, v105, v128
 v_dot2_f32_bf16 v129, v32, v104, v129
 v_dot2_f32_bf16 v130, v33, v105, v130
 v_dot2_f32_bf16 v131, v33, v104, v131
 v_dot2_f32_bf16 v136, v34, v105, v136
 v_dot2_f32_bf16 v137, v34, v104, v137
 v_dot2_f32_bf16 v138, v35, v105, v138
 v_dot2_f32_bf16 v139, v35, v104, v139
 v_pk_mul_f32 v[128:129], v[128:129], v[12:13]
 v_pk_mul_f32 v[130:131], v[130:131], v[12:13]
 v_pk_mul_f32 v[136:137], v[136:137], v[12:13]
 v_pk_mul_f32 v[138:139], v[138:139], v[12:13]
 s_add_u32 m0, s32, 1024
 s_add_u32 s35, s48, 7168
 buffer_load_dwordx4 v31, s[44:47], s35 offen lds
 v_cvt_pk_bf16_f32 v32, v128, v129
 v_cvt_pk_bf16_f32 v33, v130, v131
 v_cvt_pk_bf16_f32 v34, v136, v137
 v_cvt_pk_bf16_f32 v35, v138, v139
 s_waitcnt vmcnt(16)
 v_dot2_f32_bf16 v144, v36, v105, v144
 v_dot2_f32_bf16 v145, v36, v104, v145
 v_dot2_f32_bf16 v146, v37, v105, v146
 v_dot2_f32_bf16 v147, v37, v104, v147
 v_dot2_f32_bf16 v152, v38, v105, v152
 v_dot2_f32_bf16 v153, v38, v104, v153
 v_dot2_f32_bf16 v154, v39, v105, v154
 v_dot2_f32_bf16 v155, v39, v104, v155
 v_pk_mul_f32 v[144:145], v[144:145], v[12:13]
 v_pk_mul_f32 v[146:147], v[146:147], v[12:13]
 v_pk_mul_f32 v[152:153], v[152:153], v[12:13]
 v_pk_mul_f32 v[154:155], v[154:155], v[12:13]
 s_add_u32 m0, s32, 2048
 s_add_u32 s35, s48, 14336
 buffer_load_dwordx4 v31, s[44:47], s35 offen lds
 v_cvt_pk_bf16_f32 v36, v144, v145
 v_cvt_pk_bf16_f32 v37, v146, v147
 v_cvt_pk_bf16_f32 v38, v152, v153
 v_cvt_pk_bf16_f32 v39, v154, v155
 s_waitcnt vmcnt(16)
 v_dot2_f32_bf16 v160, v40, v105, v160
 v_dot2_f32_bf16 v161, v40, v104, v161
 v_dot2_f32_bf16 v162, v41, v105, v162
 v_dot2_f32_bf16 v163, v41, v104, v163
 v_dot2_f32_bf16 v168, v42, v105, v168
 v_dot2_f32_bf16 v169, v42, v104, v169
 v_dot2_f32_bf16 v170, v43, v105, v170
 v_dot2_f32_bf16 v171, v43, v104, v171
 v_pk_mul_f32 v[160:161], v[160:161], v[12:13]
 v_pk_mul_f32 v[162:163], v[162:163], v[12:13]
 v_pk_mul_f32 v[168:169], v[168:169], v[12:13]
 v_pk_mul_f32 v[170:171], v[170:171], v[12:13]
 s_add_u32 m0, s32, 3072
 s_add_u32 s35, s48, 21504
 buffer_load_dwordx4 v31, s[44:47], s35 offen lds
 v_cvt_pk_bf16_f32 v40, v160, v161
 v_cvt_pk_bf16_f32 v41, v162, v163
 v_cvt_pk_bf16_f32 v42, v168, v169
 v_cvt_pk_bf16_f32 v43, v170, v171
 s_waitcnt vmcnt(16)
 v_dot2_f32_bf16 v176, v44, v105, v176
 v_dot2_f32_bf16 v177, v44, v104, v177
 v_dot2_f32_bf16 v178, v45, v105, v178
 v_dot2_f32_bf16 v179, v45, v104, v179
 v_dot2_f32_bf16 v184, v46, v105, v184
 v_dot2_f32_bf16 v185, v46, v104, v185
 v_dot2_f32_bf16 v186, v47, v105, v186
 v_dot2_f32_bf16 v187, v47, v104, v187
 v_pk_mul_f32 v[176:177], v[176:177], v[12:13]
 v_pk_mul_f32 v[178:179], v[178:179], v[12:13]
 v_pk_mul_f32 v[184:185], v[184:185], v[12:13]
 v_pk_mul_f32 v[186:187], v[186:187], v[12:13]
 s_add_u32 m0, s32, 4096
 s_add_u32 s35, s48, 28672
 buffer_load_dwordx4 v31, s[44:47], s35 offen lds
 v_cvt_pk_bf16_f32 v44, v176, v177
 v_cvt_pk_bf16_f32 v45, v178, v179
 v_cvt_pk_bf16_f32 v46, v184, v185
 v_cvt_pk_bf16_f32 v47, v186, v187
 s_waitcnt vmcnt(16)
 v_dot2_f32_bf16 v192, v48, v105, v192
 v_dot2_f32_bf16 v193, v48, v104, v193
 v_dot2_f32_bf16 v194, v49, v105, v194
 v_dot2_f32_bf16 v195, v49, v104, v195
 v_dot2_f32_bf16 v200, v50, v105, v200
 v_dot2_f32_bf16 v201, v50, v104, v201
 v_dot2_f32_bf16 v202, v51, v105, v202
 v_dot2_f32_bf16 v203, v51, v104, v203
 v_pk_mul_f32 v[192:193], v[192:193], v[12:13]
 v_pk_mul_f32 v[194:195], v[194:195], v[12:13]
 v_pk_mul_f32 v[200:201], v[200:201], v[12:13]
 v_pk_mul_f32 v[202:203], v[202:203], v[12:13]
 s_add_u32 m0, s32, 5120
 s_add_u32 s35, s48, 35840
 buffer_load_dwordx4 v31, s[44:47], s35 offen lds
 v_cvt_pk_bf16_f32 v48, v192, v193
 v_cvt_pk_bf16_f32 v49, v194, v195
 v_cvt_pk_bf16_f32 v50, v200, v201
 v_cvt_pk_bf16_f32 v51, v202, v203
 s_waitcnt vmcnt(16)
 v_dot2_f32_bf16 v208, v52, v105, v208
 v_dot2_f32_bf16 v209, v52, v104, v209
 v_dot2_f32_bf16 v210, v53, v105, v210
 v_dot2_f32_bf16 v211, v53, v104, v211
 v_dot2_f32_bf16 v216, v54, v105, v216
 v_dot2_f32_bf16 v217, v54, v104, v217
 v_dot2_f32_bf16 v218, v55, v105, v218
 v_dot2_f32_bf16 v219, v55, v104, v219
 v_pk_mul_f32 v[208:209], v[208:209], v[12:13]
 v_pk_mul_f32 v[210:211], v[210:211], v[12:13]
 v_pk_mul_f32 v[216:217], v[216:217], v[12:13]
 v_pk_mul_f32 v[218:219], v[218:219], v[12:13]
 s_add_u32 m0, s32, 6144
 s_add_u32 s35, s48, 43008
 buffer_load_dwordx4 v31, s[44:47], s35 offen lds
 v_cvt_pk_bf16_f32 v52, v208, v209
 v_cvt_pk_bf16_f32 v53, v210, v211
 v_cvt_pk_bf16_f32 v54, v216, v217
 v_cvt_pk_bf16_f32 v55, v218, v219
 s_waitcnt vmcnt(16)
 v_dot2_f32_bf16 v224, v56, v105, v224
 v_dot2_f32_bf16 v225, v56, v104, v225
 v_dot2_f32_bf16 v226, v57, v105, v226
 v_dot2_f32_bf16 v227, v57, v104, v227
 v_dot2_f32_bf16 v232, v58, v105, v232
 v_dot2_f32_bf16 v233, v58, v104, v233
 v_dot2_f32_bf16 v234, v59, v105, v234
 v_dot2_f32_bf16 v235, v59, v104, v235
 v_pk_mul_f32 v[224:225], v[224:225], v[12:13]
 v_pk_mul_f32 v[226:227], v[226:227], v[12:13]
 v_pk_mul_f32 v[232:233], v[232:233], v[12:13]
 v_pk_mul_f32 v[234:235], v[234:235], v[12:13]
 s_add_u32 m0, s32, 7168
 s_add_u32 s35, s48, 50176
 buffer_load_dwordx4 v31, s[44:47], s35 offen lds
 v_cvt_pk_bf16_f32 v56, v224, v225
 v_cvt_pk_bf16_f32 v57, v226, v227
 v_cvt_pk_bf16_f32 v58, v232, v233
 v_cvt_pk_bf16_f32 v59, v234, v235
 s_waitcnt vmcnt(16)
 v_dot2_f32_bf16 v240, v60, v105, v240
 v_dot2_f32_bf16 v241, v60, v104, v241
 v_dot2_f32_bf16 v242, v61, v105, v242
 v_dot2_f32_bf16 v243, v61, v104, v243
 v_dot2_f32_bf16 v248, v62, v105, v248
 v_dot2_f32_bf16 v249, v62, v104, v249
 v_dot2_f32_bf16 v250, v63, v105, v250
 v_dot2_f32_bf16 v251, v63, v104, v251
 v_pk_mul_f32 v[240:241], v[240:241], v[12:13]
 v_pk_mul_f32 v[242:243], v[242:243], v[12:13]
 v_pk_mul_f32 v[248:249], v[248:249], v[12:13]
 v_pk_mul_f32 v[250:251], v[250:251], v[12:13]
 s_add_u32 m0, s32, 32768
 s_add_u32 s35, s48, 128
 buffer_load_dwordx4 v31, s[44:47], s35 offen lds
 v_cvt_pk_bf16_f32 v60, v240, v241
 v_cvt_pk_bf16_f32 v61, v242, v243
 v_cvt_pk_bf16_f32 v62, v248, v249
 v_cvt_pk_bf16_f32 v63, v250, v251
 s_waitcnt vmcnt(16)
 v_dot2_f32_bf16 v132, v64, v107, v132
 v_dot2_f32_bf16 v133, v64, v106, v133
 v_dot2_f32_bf16 v134, v65, v107, v134
 v_dot2_f32_bf16 v135, v65, v106, v135
 v_dot2_f32_bf16 v140, v66, v107, v140
 v_dot2_f32_bf16 v141, v66, v106, v141
 v_dot2_f32_bf16 v142, v67, v107, v142
 v_dot2_f32_bf16 v143, v67, v106, v143
 v_pk_mul_f32 v[132:133], v[132:133], v[14:15]
 v_pk_mul_f32 v[134:135], v[134:135], v[14:15]
 v_pk_mul_f32 v[140:141], v[140:141], v[14:15]
 v_pk_mul_f32 v[142:143], v[142:143], v[14:15]
 s_add_u32 m0, s32, 33792
 s_add_u32 s35, s48, 7296
 buffer_load_dwordx4 v31, s[44:47], s35 offen lds
 v_cvt_pk_bf16_f32 v64, v132, v133
 v_cvt_pk_bf16_f32 v65, v134, v135
 v_cvt_pk_bf16_f32 v66, v140, v141
 v_cvt_pk_bf16_f32 v67, v142, v143
 s_waitcnt vmcnt(16)
 v_dot2_f32_bf16 v148, v68, v107, v148
 v_dot2_f32_bf16 v149, v68, v106, v149
 v_dot2_f32_bf16 v150, v69, v107, v150
 v_dot2_f32_bf16 v151, v69, v106, v151
 v_dot2_f32_bf16 v156, v70, v107, v156
 v_dot2_f32_bf16 v157, v70, v106, v157
 v_dot2_f32_bf16 v158, v71, v107, v158
 v_dot2_f32_bf16 v159, v71, v106, v159
 v_pk_mul_f32 v[148:149], v[148:149], v[14:15]
 v_pk_mul_f32 v[150:151], v[150:151], v[14:15]
 v_pk_mul_f32 v[156:157], v[156:157], v[14:15]
 v_pk_mul_f32 v[158:159], v[158:159], v[14:15]
 s_add_u32 m0, s32, 34816
 s_add_u32 s35, s48, 14464
 buffer_load_dwordx4 v31, s[44:47], s35 offen lds
 v_cvt_pk_bf16_f32 v68, v148, v149
 v_cvt_pk_bf16_f32 v69, v150, v151
 v_cvt_pk_bf16_f32 v70, v156, v157
 v_cvt_pk_bf16_f32 v71, v158, v159
 s_waitcnt vmcnt(16)
 v_dot2_f32_bf16 v164, v72, v107, v164
 v_dot2_f32_bf16 v165, v72, v106, v165
 v_dot2_f32_bf16 v166, v73, v107, v166
 v_dot2_f32_bf16 v167, v73, v106, v167
 v_dot2_f32_bf16 v172, v74, v107, v172
 v_dot2_f32_bf16 v173, v74, v106, v173
 v_dot2_f32_bf16 v174, v75, v107, v174
 v_dot2_f32_bf16 v175, v75, v106, v175
 v_pk_mul_f32 v[164:165], v[164:165], v[14:15]
 v_pk_mul_f32 v[166:167], v[166:167], v[14:15]
 v_pk_mul_f32 v[172:173], v[172:173], v[14:15]
 v_pk_mul_f32 v[174:175], v[174:175], v[14:15]
 s_add_u32 m0, s32, 35840
 s_add_u32 s35, s48, 21632
 buffer_load_dwordx4 v31, s[44:47], s35 offen lds
 v_cvt_pk_bf16_f32 v72, v164, v165
 v_cvt_pk_bf16_f32 v73, v166, v167
 v_cvt_pk_bf16_f32 v74, v172, v173
 v_cvt_pk_bf16_f32 v75, v174, v175
 s_waitcnt vmcnt(16)
 v_dot2_f32_bf16 v180, v76, v107, v180
 v_dot2_f32_bf16 v181, v76, v106, v181
 v_dot2_f32_bf16 v182, v77, v107, v182
 v_dot2_f32_bf16 v183, v77, v106, v183
 v_dot2_f32_bf16 v188, v78, v107, v188
 v_dot2_f32_bf16 v189, v78, v106, v189
 v_dot2_f32_bf16 v190, v79, v107, v190
 v_dot2_f32_bf16 v191, v79, v106, v191
 v_pk_mul_f32 v[180:181], v[180:181], v[14:15]
 v_pk_mul_f32 v[182:183], v[182:183], v[14:15]
 v_pk_mul_f32 v[188:189], v[188:189], v[14:15]
 v_pk_mul_f32 v[190:191], v[190:191], v[14:15]
 s_add_u32 m0, s32, 36864
 s_add_u32 s35, s48, 28800
 buffer_load_dwordx4 v31, s[44:47], s35 offen lds
 v_cvt_pk_bf16_f32 v76, v180, v181
 v_cvt_pk_bf16_f32 v77, v182, v183
 v_cvt_pk_bf16_f32 v78, v188, v189
 v_cvt_pk_bf16_f32 v79, v190, v191
 s_waitcnt vmcnt(16)
 v_dot2_f32_bf16 v196, v120, v107, v196
 v_dot2_f32_bf16 v197, v120, v106, v197
 v_dot2_f32_bf16 v198, v121, v107, v198
 v_dot2_f32_bf16 v199, v121, v106, v199
 v_dot2_f32_bf16 v204, v122, v107, v204
 v_dot2_f32_bf16 v205, v122, v106, v205
 v_dot2_f32_bf16 v206, v123, v107, v206
 v_dot2_f32_bf16 v207, v123, v106, v207
 v_pk_mul_f32 v[196:197], v[196:197], v[14:15]
 v_pk_mul_f32 v[198:199], v[198:199], v[14:15]
 v_pk_mul_f32 v[204:205], v[204:205], v[14:15]
 v_pk_mul_f32 v[206:207], v[206:207], v[14:15]
 s_add_u32 m0, s32, 37888
 s_add_u32 s35, s48, 35968
 buffer_load_dwordx4 v31, s[44:47], s35 offen lds
 v_cvt_pk_bf16_f32 v80, v196, v197
 v_cvt_pk_bf16_f32 v81, v198, v199
 v_cvt_pk_bf16_f32 v82, v204, v205
 v_cvt_pk_bf16_f32 v83, v206, v207
 s_waitcnt vmcnt(16)
 v_dot2_f32_bf16 v212, v124, v107, v212
 v_dot2_f32_bf16 v213, v124, v106, v213
 v_dot2_f32_bf16 v214, v125, v107, v214
 v_dot2_f32_bf16 v215, v125, v106, v215
 v_dot2_f32_bf16 v220, v126, v107, v220
 v_dot2_f32_bf16 v221, v126, v106, v221
 v_dot2_f32_bf16 v222, v127, v107, v222
 v_dot2_f32_bf16 v223, v127, v106, v223
 v_pk_mul_f32 v[212:213], v[212:213], v[14:15]
 v_pk_mul_f32 v[214:215], v[214:215], v[14:15]
 v_pk_mul_f32 v[220:221], v[220:221], v[14:15]
 v_pk_mul_f32 v[222:223], v[222:223], v[14:15]
 s_add_u32 m0, s32, 38912
 s_add_u32 s35, s48, 43136
 buffer_load_dwordx4 v31, s[44:47], s35 offen lds
 v_cvt_pk_bf16_f32 v84, v212, v213
 v_cvt_pk_bf16_f32 v85, v214, v215
 v_cvt_pk_bf16_f32 v86, v220, v221
 v_cvt_pk_bf16_f32 v87, v222, v223
 s_waitcnt vmcnt(16)
 v_dot2_f32_bf16 v228, v16, v107, v228
 v_dot2_f32_bf16 v229, v16, v106, v229
 v_dot2_f32_bf16 v230, v17, v107, v230
 v_dot2_f32_bf16 v231, v17, v106, v231
 v_dot2_f32_bf16 v236, v18, v107, v236
 v_dot2_f32_bf16 v237, v18, v106, v237
 v_dot2_f32_bf16 v238, v19, v107, v238
 v_dot2_f32_bf16 v239, v19, v106, v239
 v_pk_mul_f32 v[228:229], v[228:229], v[14:15]
 v_pk_mul_f32 v[230:231], v[230:231], v[14:15]
 v_pk_mul_f32 v[236:237], v[236:237], v[14:15]
 v_pk_mul_f32 v[238:239], v[238:239], v[14:15]
 s_add_u32 m0, s32, 39936
 s_add_u32 s35, s48, 50304
 buffer_load_dwordx4 v31, s[44:47], s35 offen lds
 v_cvt_pk_bf16_f32 v88, v228, v229
 v_cvt_pk_bf16_f32 v89, v230, v231
 v_cvt_pk_bf16_f32 v90, v236, v237
 v_cvt_pk_bf16_f32 v91, v238, v239
 s_waitcnt vmcnt(16)
 v_dot2_f32_bf16 v244, v20, v107, v244
 v_dot2_f32_bf16 v245, v20, v106, v245
 v_dot2_f32_bf16 v246, v21, v107, v246
 v_dot2_f32_bf16 v247, v21, v106, v247
 v_dot2_f32_bf16 v252, v22, v107, v252
 v_dot2_f32_bf16 v253, v22, v106, v253
 v_dot2_f32_bf16 v254, v23, v107, v254
 v_dot2_f32_bf16 v255, v23, v106, v255
 v_pk_mul_f32 v[244:245], v[244:245], v[14:15]
 v_pk_mul_f32 v[246:247], v[246:247], v[14:15]
 v_pk_mul_f32 v[252:253], v[252:253], v[14:15]
 v_pk_mul_f32 v[254:255], v[254:255], v[14:15]
 v_cvt_pk_bf16_f32 v92, v244, v245
 v_cvt_pk_bf16_f32 v93, v246, v247
 v_cvt_pk_bf16_f32 v94, v252, v253
 v_cvt_pk_bf16_f32 v95, v254, v255
L_oproj:
 v_xor_b32 v120, 32, v119
 v_xor_b32 v121, 64, v119
 v_xor_b32 v122, 96, v119
 s_waitcnt vmcnt(8)
 s_barrier
 ds_read_b64_tr_b16 a[64:65], v119 offset:0
 ds_read_b64_tr_b16 a[66:67], v119 offset:2048
 ds_read_b64_tr_b16 a[68:69], v119 offset:4096
 ds_read_b64_tr_b16 a[70:71], v119 offset:6144
 ds_read_b64_tr_b16 a[72:73], v119 offset:8192
 ds_read_b64_tr_b16 a[74:75], v119 offset:10240
 ds_read_b64_tr_b16 a[76:77], v119 offset:12288
 ds_read_b64_tr_b16 a[78:79], v119 offset:14336
 ds_read_b64_tr_b16 a[80:81], v119 offset:16384
 ds_read_b64_tr_b16 a[82:83], v119 offset:18432
 ds_read_b64_tr_b16 a[84:85], v119 offset:20480
 ds_read_b64_tr_b16 a[86:87], v119 offset:22528
 ds_read_b64_tr_b16 a[88:89], v119 offset:24576
 ds_read_b64_tr_b16 a[90:91], v119 offset:26624
 ds_read_b64_tr_b16 a[92:93], v119 offset:28672
 ds_read_b64_tr_b16 a[94:95], v119 offset:30720
 s_waitcnt lgkmcnt(14)
 v_mfma_f32_16x16x32_bf16 v[128:131], a[64:67], v[32:35], 0
 s_waitcnt lgkmcnt(12)
 s_add_u32 m0, s32, 131072
 ds_read_b64_tr_b16 a[96:97], v120 offset:0
 ds_read_b64_tr_b16 a[98:99], v120 offset:2048
 v_mfma_f32_16x16x32_bf16 v[128:131], a[68:71], v[36:39], v[128:131]
 s_waitcnt lgkmcnt(12)
 s_add_u32 s35, s48, 256
 ds_read_b64_tr_b16 a[100:101], v120 offset:4096
 v_mfma_f32_16x16x32_bf16 v[128:131], a[72:75], v[40:43], v[128:131]
 s_waitcnt lgkmcnt(11)
 buffer_load_dwordx4 v31, s[44:47], s35 offen lds
 v_mfma_f32_16x16x32_bf16 v[128:131], a[76:79], v[44:47], v[128:131]
 s_waitcnt lgkmcnt(9)
 ds_read_b64_tr_b16 a[102:103], v120 offset:6144
 ds_read_b64_tr_b16 a[104:105], v120 offset:8192
 v_mfma_f32_16x16x32_bf16 v[128:131], a[80:83], v[48:51], v[128:131]
 s_waitcnt lgkmcnt(5)
 s_add_u32 m0, s32, 132096
 ds_read_b64_tr_b16 a[106:107], v120 offset:10240
 v_mfma_f32_16x16x32_bf16 v[128:131], a[84:87], v[52:55], v[128:131]
 s_add_u32 s35, s48, 7424
 ds_read_b64_tr_b16 a[108:109], v120 offset:12288
 v_mfma_f32_16x16x32_bf16 v[128:131], a[88:91], v[56:59], v[128:131]
 buffer_load_dwordx4 v31, s[44:47], s35 offen lds
 v_mfma_f32_16x16x32_bf16 v[128:131], a[92:95], v[60:63], v[128:131]
 ds_read_b64_tr_b16 a[110:111], v120 offset:14336
 ds_read_b64_tr_b16 a[112:113], v120 offset:16384
 v_mfma_f32_16x16x32_bf16 v[136:139], a[64:67], v[64:67], 0
 s_add_u32 m0, s32, 133120
 ds_read_b64_tr_b16 a[114:115], v120 offset:18432
 ds_read_b64_tr_b16 a[116:117], v120 offset:20480
 v_mfma_f32_16x16x32_bf16 v[136:139], a[68:71], v[68:71], v[136:139]
 s_add_u32 s35, s48, 14592
 ds_read_b64_tr_b16 a[118:119], v120 offset:22528
 v_mfma_f32_16x16x32_bf16 v[136:139], a[72:75], v[72:75], v[136:139]
 buffer_load_dwordx4 v31, s[44:47], s35 offen lds
 v_mfma_f32_16x16x32_bf16 v[136:139], a[76:79], v[76:79], v[136:139]
 ds_read_b64_tr_b16 a[120:121], v120 offset:24576
 ds_read_b64_tr_b16 a[122:123], v120 offset:26624
 v_mfma_f32_16x16x32_bf16 v[136:139], a[80:83], v[80:83], v[136:139]
 s_add_u32 m0, s32, 134144
 ds_read_b64_tr_b16 a[124:125], v120 offset:28672
 v_mfma_f32_16x16x32_bf16 v[136:139], a[84:87], v[84:87], v[136:139]
 s_add_u32 s35, s48, 21760
 ds_read_b64_tr_b16 a[126:127], v120 offset:30720
 v_mfma_f32_16x16x32_bf16 v[136:139], a[88:91], v[88:91], v[136:139]
 buffer_load_dwordx4 v31, s[44:47], s35 offen lds
 v_mfma_f32_16x16x32_bf16 v[136:139], a[92:95], v[92:95], v[136:139]
 s_waitcnt lgkmcnt(4)
 v_mfma_f32_16x16x32_bf16 v[132:135], a[96:99], v[32:35], 0
 s_add_u32 m0, s32, 135168
 ds_read_b64_tr_b16 a[64:65], v121 offset:0
 ds_read_b64_tr_b16 a[66:67], v121 offset:2048
 v_mfma_f32_16x16x32_bf16 v[132:135], a[100:103], v[36:39], v[132:135]
 s_add_u32 s35, s48, 28928
 ds_read_b64_tr_b16 a[68:69], v121 offset:4096
 v_mfma_f32_16x16x32_bf16 v[132:135], a[104:107], v[40:43], v[132:135]
 buffer_load_dwordx4 v31, s[44:47], s35 offen lds
 v_mfma_f32_16x16x32_bf16 v[132:135], a[108:111], v[44:47], v[132:135]
 ds_read_b64_tr_b16 a[70:71], v121 offset:6144
 ds_read_b64_tr_b16 a[72:73], v121 offset:8192
 v_mfma_f32_16x16x32_bf16 v[132:135], a[112:115], v[48:51], v[132:135]
 s_add_u32 m0, s32, 136192
 ds_read_b64_tr_b16 a[74:75], v121 offset:10240
 v_mfma_f32_16x16x32_bf16 v[132:135], a[116:119], v[52:55], v[132:135]
 s_waitcnt lgkmcnt(4)
 s_add_u32 s35, s48, 36096
 ds_read_b64_tr_b16 a[76:77], v121 offset:12288
 v_mfma_f32_16x16x32_bf16 v[132:135], a[120:123], v[56:59], v[132:135]
 buffer_load_dwordx4 v31, s[44:47], s35 offen lds
 v_mfma_f32_16x16x32_bf16 v[132:135], a[124:127], v[60:63], v[132:135]
 ds_read_b64_tr_b16 a[78:79], v121 offset:14336
 ds_read_b64_tr_b16 a[80:81], v121 offset:16384
 v_mfma_f32_16x16x32_bf16 v[140:143], a[96:99], v[64:67], 0
 s_add_u32 m0, s32, 137216
 ds_read_b64_tr_b16 a[82:83], v121 offset:18432
 ds_read_b64_tr_b16 a[84:85], v121 offset:20480
 v_mfma_f32_16x16x32_bf16 v[140:143], a[100:103], v[68:71], v[140:143]
 s_add_u32 s35, s48, 43264
 ds_read_b64_tr_b16 a[86:87], v121 offset:22528
 v_mfma_f32_16x16x32_bf16 v[140:143], a[104:107], v[72:75], v[140:143]
 buffer_load_dwordx4 v31, s[44:47], s35 offen lds
 v_mfma_f32_16x16x32_bf16 v[140:143], a[108:111], v[76:79], v[140:143]
 ds_read_b64_tr_b16 a[88:89], v121 offset:24576
 ds_read_b64_tr_b16 a[90:91], v121 offset:26624
 v_mfma_f32_16x16x32_bf16 v[140:143], a[112:115], v[80:83], v[140:143]
 s_add_u32 m0, s32, 138240
 ds_read_b64_tr_b16 a[92:93], v121 offset:28672
 v_cvt_pk_bf16_f32 v128, v128, v129
 v_mfma_f32_16x16x32_bf16 v[140:143], a[116:119], v[84:87], v[140:143]
 s_add_u32 s35, s48, 50432
 ds_read_b64_tr_b16 a[94:95], v121 offset:30720
 v_cvt_pk_bf16_f32 v129, v130, v131
 v_mfma_f32_16x16x32_bf16 v[140:143], a[120:123], v[88:91], v[140:143]
 buffer_load_dwordx4 v31, s[44:47], s35 offen lds
 v_mfma_f32_16x16x32_bf16 v[140:143], a[124:127], v[92:95], v[140:143]
 v_cvt_pk_bf16_f32 v130, v132, v133
 v_mfma_f32_16x16x32_bf16 v[144:147], a[64:67], v[32:35], 0
 s_waitcnt lgkmcnt(2)
 ds_read_b64_tr_b16 a[96:97], v122 offset:0
 ds_read_b64_tr_b16 a[98:99], v122 offset:2048
 v_mfma_f32_16x16x32_bf16 v[144:147], a[68:71], v[36:39], v[144:147]
 ds_read_b64_tr_b16 a[100:101], v122 offset:4096
 v_cvt_pk_bf16_f32 v131, v134, v135
 v_mfma_f32_16x16x32_bf16 v[144:147], a[72:75], v[40:43], v[144:147]
 s_add_u32 s38, s51, 0
 buffer_store_dwordx4 v[128:131], v1, s[16:19], s38 offen sc1
 v_mfma_f32_16x16x32_bf16 v[144:147], a[76:79], v[44:47], v[144:147]
 ds_read_b64_tr_b16 a[102:103], v122 offset:6144
 ds_read_b64_tr_b16 a[104:105], v122 offset:8192
 v_mfma_f32_16x16x32_bf16 v[144:147], a[80:83], v[48:51], v[144:147]
 ds_read_b64_tr_b16 a[106:107], v122 offset:10240
 v_cvt_pk_bf16_f32 v136, v136, v137
 v_mfma_f32_16x16x32_bf16 v[144:147], a[84:87], v[52:55], v[144:147]
 ds_read_b64_tr_b16 a[108:109], v122 offset:12288
 v_cvt_pk_bf16_f32 v137, v138, v139
 v_mfma_f32_16x16x32_bf16 v[144:147], a[88:91], v[56:59], v[144:147]
 s_waitcnt lgkmcnt(4)
 ds_read_b64_tr_b16 a[110:111], v122 offset:14336
 v_mfma_f32_16x16x32_bf16 v[144:147], a[92:95], v[60:63], v[144:147]
 ds_read_b64_tr_b16 a[112:113], v122 offset:16384
 ds_read_b64_tr_b16 a[114:115], v122 offset:18432
 v_mfma_f32_16x16x32_bf16 v[152:155], a[64:67], v[64:67], 0
 ds_read_b64_tr_b16 a[116:117], v122 offset:20480
 v_cvt_pk_bf16_f32 v138, v140, v141
 v_mfma_f32_16x16x32_bf16 v[152:155], a[68:71], v[68:71], v[152:155]
 ds_read_b64_tr_b16 a[118:119], v122 offset:22528
 v_cvt_pk_bf16_f32 v139, v142, v143
 v_mfma_f32_16x16x32_bf16 v[152:155], a[72:75], v[72:75], v[152:155]
 ds_read_b64_tr_b16 a[120:121], v122 offset:24576
 v_mfma_f32_16x16x32_bf16 v[152:155], a[76:79], v[76:79], v[152:155]
 s_add_u32 s38, s51, 14336
 buffer_store_dwordx4 v[136:139], v1, s[16:19], s38 offen sc1
 v_mfma_f32_16x16x32_bf16 v[152:155], a[80:83], v[80:83], v[152:155]
 ds_read_b64_tr_b16 a[122:123], v122 offset:26624
 ds_read_b64_tr_b16 a[124:125], v122 offset:28672
 v_mfma_f32_16x16x32_bf16 v[152:155], a[84:87], v[84:87], v[152:155]
 ds_read_b64_tr_b16 a[126:127], v122 offset:30720
 v_mfma_f32_16x16x32_bf16 v[152:155], a[88:91], v[88:91], v[152:155]
 v_add_u32 v119, 0x8000, v119
 v_mfma_f32_16x16x32_bf16 v[152:155], a[92:95], v[92:95], v[152:155]
 s_waitcnt vmcnt(10)
 s_barrier
 v_mfma_f32_16x16x32_bf16 v[148:151], a[96:99], v[32:35], 0
 s_waitcnt lgkmcnt(3)
 ds_read_b64_tr_b16 a[64:65], v119 offset:0
 ds_read_b64_tr_b16 a[66:67], v119 offset:2048
 v_mfma_f32_16x16x32_bf16 v[148:151], a[100:103], v[36:39], v[148:151]
 ds_read_b64_tr_b16 a[68:69], v119 offset:4096
 v_mfma_f32_16x16x32_bf16 v[148:151], a[104:107], v[40:43], v[148:151]
 s_add_u32 m0, s32, 65536
 ds_read_b64_tr_b16 a[70:71], v119 offset:6144
 v_mfma_f32_16x16x32_bf16 v[148:151], a[108:111], v[44:47], v[148:151]
 s_add_u32 s35, s48, 384
 ds_read_b64_tr_b16 a[72:73], v119 offset:8192
 v_mfma_f32_16x16x32_bf16 v[148:151], a[112:115], v[48:51], v[148:151]
 buffer_load_dwordx4 v31, s[44:47], s35 offen lds
 v_mfma_f32_16x16x32_bf16 v[148:151], a[116:119], v[52:55], v[148:151]
 s_waitcnt lgkmcnt(3)
 ds_read_b64_tr_b16 a[74:75], v119 offset:10240
 ds_read_b64_tr_b16 a[76:77], v119 offset:12288
 v_mfma_f32_16x16x32_bf16 v[148:151], a[120:123], v[56:59], v[148:151]
 s_add_u32 m0, s32, 66560
 ds_read_b64_tr_b16 a[78:79], v119 offset:14336
 v_mfma_f32_16x16x32_bf16 v[148:151], a[124:127], v[60:63], v[148:151]
 s_add_u32 s35, s48, 7552
 ds_read_b64_tr_b16 a[80:81], v119 offset:16384
 ds_read_b64_tr_b16 a[82:83], v119 offset:18432
 v_mfma_f32_16x16x32_bf16 v[156:159], a[96:99], v[64:67], 0
 buffer_load_dwordx4 v31, s[44:47], s35 offen lds
 v_mfma_f32_16x16x32_bf16 v[156:159], a[100:103], v[68:71], v[156:159]
 ds_read_b64_tr_b16 a[84:85], v119 offset:20480
 ds_read_b64_tr_b16 a[86:87], v119 offset:22528
 v_mfma_f32_16x16x32_bf16 v[156:159], a[104:107], v[72:75], v[156:159]
 s_add_u32 m0, s32, 67584
 ds_read_b64_tr_b16 a[88:89], v119 offset:24576
 v_mfma_f32_16x16x32_bf16 v[156:159], a[108:111], v[76:79], v[156:159]
 s_add_u32 s35, s48, 14720
 ds_read_b64_tr_b16 a[90:91], v119 offset:26624
 v_mfma_f32_16x16x32_bf16 v[156:159], a[112:115], v[80:83], v[156:159]
 s_mov_b32 s30, s24
 buffer_load_dwordx4 v31, s[44:47], s35 offen lds
 v_mfma_f32_16x16x32_bf16 v[156:159], a[116:119], v[84:87], v[156:159]
 ds_read_b64_tr_b16 a[92:93], v119 offset:28672
 ds_read_b64_tr_b16 a[94:95], v119 offset:30720
 v_mfma_f32_16x16x32_bf16 v[156:159], a[120:123], v[88:91], v[156:159]
 s_add_u32 m0, s32, 68608
 v_add_u32 v120, 0x8000, v120
 v_cvt_pk_bf16_f32 v144, v144, v145
 v_mfma_f32_16x16x32_bf16 v[156:159], a[124:127], v[92:95], v[156:159]
 s_add_u32 s35, s48, 21888
 v_cvt_pk_bf16_f32 v145, v146, v147
 v_mfma_f32_16x16x32_bf16 v[160:163], a[64:67], v[32:35], 0
 s_waitcnt lgkmcnt(2)
 s_mov_b32 s31, s50
 buffer_load_dwordx4 v31, s[44:47], s35 offen lds
 v_mfma_f32_16x16x32_bf16 v[160:163], a[68:71], v[36:39], v[160:163]
 s_cmp_lt_u32 s3, 2
 s_cselect_b32 s8, s8, s100
 s_cselect_b32 s9, s9, s101
 ds_read_b64_tr_b16 a[96:97], v120 offset:0
 ds_read_b64_tr_b16 a[98:99], v120 offset:2048
 v_mfma_f32_16x16x32_bf16 v[160:163], a[72:75], v[40:43], v[160:163]
 s_and_b32 s53, s53, 0xffff
 ds_read_b64_tr_b16 a[100:101], v120 offset:4096
 ds_read_b64_tr_b16 a[102:103], v120 offset:6144
 v_mfma_f32_16x16x32_bf16 v[160:163], a[76:79], v[44:47], v[160:163]
 ds_read_b64_tr_b16 a[104:105], v120 offset:8192
 v_cvt_pk_bf16_f32 v146, v148, v149
 v_cvt_pk_bf16_f32 v147, v150, v151
 v_mfma_f32_16x16x32_bf16 v[160:163], a[80:83], v[48:51], v[160:163]
 s_add_u32 s38, s51, 1024
 buffer_store_dwordx4 v[144:147], v1, s[16:19], s38 offen sc1
 v_mfma_f32_16x16x32_bf16 v[160:163], a[84:87], v[52:55], v[160:163]
 s_mov_b32 s54, 1835008
 ds_read_b64_tr_b16 a[106:107], v120 offset:10240
 ds_read_b64_tr_b16 a[108:109], v120 offset:12288
 v_mfma_f32_16x16x32_bf16 v[160:163], a[88:91], v[56:59], v[160:163]
 s_waitcnt lgkmcnt(5)
 s_mov_b32 s55, 0x00020000
 ds_read_b64_tr_b16 a[110:111], v120 offset:14336
 v_cvt_pk_bf16_f32 v152, v152, v153
 v_mfma_f32_16x16x32_bf16 v[160:163], a[92:95], v[60:63], v[160:163]
 ds_read_b64_tr_b16 a[112:113], v120 offset:16384
 ds_read_b64_tr_b16 a[114:115], v120 offset:18432
 v_mfma_f32_16x16x32_bf16 v[168:171], a[64:67], v[64:67], 0
 s_and_b32 s9, s9, 0xffff
 ds_read_b64_tr_b16 a[116:117], v120 offset:20480
 v_cvt_pk_bf16_f32 v153, v154, v155
 v_mfma_f32_16x16x32_bf16 v[168:171], a[68:71], v[68:71], v[168:171]
 ds_read_b64_tr_b16 a[118:119], v120 offset:22528
 v_cvt_pk_bf16_f32 v154, v156, v157
 v_mfma_f32_16x16x32_bf16 v[168:171], a[72:75], v[72:75], v[168:171]
 ds_read_b64_tr_b16 a[120:121], v120 offset:24576
 v_cvt_pk_bf16_f32 v155, v158, v159
 v_mfma_f32_16x16x32_bf16 v[168:171], a[76:79], v[76:79], v[168:171]
 s_mov_b32 s10, 1605632
 ds_read_b64_tr_b16 a[122:123], v120 offset:26624
 v_mfma_f32_16x16x32_bf16 v[168:171], a[80:83], v[80:83], v[168:171]
 ds_read_b64_tr_b16 a[124:125], v120 offset:28672
 v_mfma_f32_16x16x32_bf16 v[168:171], a[84:87], v[84:87], v[168:171]
 s_add_u32 s38, s51, 15360
 buffer_store_dwordx4 v[152:155], v1, s[16:19], s38 offen sc1
 ds_read_b64_tr_b16 a[126:127], v120 offset:30720
 v_mfma_f32_16x16x32_bf16 v[168:171], a[88:91], v[88:91], v[168:171]
 s_mov_b32 s11, 0x00020000
 v_add_u32 v121, 0x8000, v121
 v_mfma_f32_16x16x32_bf16 v[168:171], a[92:95], v[92:95], v[168:171]
 s_and_b32 s13, s13, 0xffff
 v_mfma_f32_16x16x32_bf16 v[164:167], a[96:99], v[32:35], 0
 s_waitcnt lgkmcnt(2)
 ds_read_b64_tr_b16 a[64:65], v121 offset:0
 ds_read_b64_tr_b16 a[66:67], v121 offset:2048
 v_mfma_f32_16x16x32_bf16 v[164:167], a[100:103], v[36:39], v[164:167]
 s_mov_b32 s14, 1605632
 ds_read_b64_tr_b16 a[68:69], v121 offset:4096
 v_mfma_f32_16x16x32_bf16 v[164:167], a[104:107], v[40:43], v[164:167]
 ds_read_b64_tr_b16 a[70:71], v121 offset:6144
 v_mfma_f32_16x16x32_bf16 v[164:167], a[108:111], v[44:47], v[164:167]
 s_mov_b32 s15, 0x00020000
 ds_read_b64_tr_b16 a[72:73], v121 offset:8192
 v_mfma_f32_16x16x32_bf16 v[164:167], a[112:115], v[48:51], v[164:167]
 s_add_u32 m0, s32, 69632
 ds_read_b64_tr_b16 a[74:75], v121 offset:10240
 v_mfma_f32_16x16x32_bf16 v[164:167], a[116:119], v[52:55], v[164:167]
 s_add_u32 s35, s48, 29056
 ds_read_b64_tr_b16 a[76:77], v121 offset:12288
 v_mfma_f32_16x16x32_bf16 v[164:167], a[120:123], v[56:59], v[164:167]
 s_waitcnt lgkmcnt(4)
 s_and_b32 s57, s57, 0xffff
 buffer_load_dwordx4 v31, s[44:47], s35 offen lds
 v_mfma_f32_16x16x32_bf16 v[164:167], a[124:127], v[60:63], v[164:167]
 s_mov_b32 s58, 1835008
 ds_read_b64_tr_b16 a[78:79], v121 offset:14336
 ds_read_b64_tr_b16 a[80:81], v121 offset:16384
 v_mfma_f32_16x16x32_bf16 v[172:175], a[96:99], v[64:67], 0
 s_add_u32 m0, s32, 70656
 ds_read_b64_tr_b16 a[82:83], v121 offset:18432
 ds_read_b64_tr_b16 a[84:85], v121 offset:20480
 v_mfma_f32_16x16x32_bf16 v[172:175], a[100:103], v[68:71], v[172:175]
 s_add_u32 s35, s48, 36224
 ds_read_b64_tr_b16 a[86:87], v121 offset:22528
 v_mfma_f32_16x16x32_bf16 v[172:175], a[104:107], v[72:75], v[172:175]
 s_mov_b32 s59, 0x00020000
 buffer_load_dwordx4 v31, s[44:47], s35 offen lds
 v_mfma_f32_16x16x32_bf16 v[172:175], a[108:111], v[76:79], v[172:175]
 ds_read_b64_tr_b16 a[88:89], v121 offset:24576
 ds_read_b64_tr_b16 a[90:91], v121 offset:26624
 v_mfma_f32_16x16x32_bf16 v[172:175], a[112:115], v[80:83], v[172:175]
 s_add_u32 m0, s32, 71680
 ds_read_b64_tr_b16 a[92:93], v121 offset:28672
 v_cvt_pk_bf16_f32 v160, v160, v161
 v_mfma_f32_16x16x32_bf16 v[172:175], a[116:119], v[84:87], v[172:175]
 s_add_u32 s35, s48, 43392
 ds_read_b64_tr_b16 a[94:95], v121 offset:30720
 v_mfma_f32_16x16x32_bf16 v[172:175], a[120:123], v[88:91], v[172:175]
 s_lshl_b32 s25, s31, 3
 buffer_load_dwordx4 v31, s[44:47], s35 offen lds
 v_add_u32 v122, 0x8000, v122
 v_mfma_f32_16x16x32_bf16 v[172:175], a[124:127], v[92:95], v[172:175]
 s_lshr_b32 s39, s30, 1
 v_cvt_pk_bf16_f32 v161, v162, v163
 v_mfma_f32_16x16x32_bf16 v[176:179], a[64:67], v[32:35], 0
 s_waitcnt lgkmcnt(2)
 s_add_u32 m0, s32, 72704
 ds_read_b64_tr_b16 a[96:97], v122 offset:0
 ds_read_b64_tr_b16 a[98:99], v122 offset:2048
 v_mfma_f32_16x16x32_bf16 v[176:179], a[68:71], v[36:39], v[176:179]
 s_add_u32 s35, s48, 50560
 ds_read_b64_tr_b16 a[100:101], v122 offset:4096
 v_cvt_pk_bf16_f32 v162, v164, v165
 v_mfma_f32_16x16x32_bf16 v[176:179], a[72:75], v[40:43], v[176:179]
 s_add_u32 s25, s25, s39
 buffer_load_dwordx4 v31, s[44:47], s35 offen lds
 v_mfma_f32_16x16x32_bf16 v[176:179], a[76:79], v[44:47], v[176:179]
 s_and_b32 s26, s30, 1
 ds_read_b64_tr_b16 a[102:103], v122 offset:6144
 ds_read_b64_tr_b16 a[104:105], v122 offset:8192
 v_mfma_f32_16x16x32_bf16 v[176:179], a[80:83], v[48:51], v[176:179]
 ds_read_b64_tr_b16 a[106:107], v122 offset:10240
 v_cvt_pk_bf16_f32 v163, v166, v167
 v_mfma_f32_16x16x32_bf16 v[176:179], a[84:87], v[52:55], v[176:179]
 ds_read_b64_tr_b16 a[108:109], v122 offset:12288
 v_cvt_pk_bf16_f32 v168, v168, v169
 v_mfma_f32_16x16x32_bf16 v[176:179], a[88:91], v[56:59], v[176:179]
 s_waitcnt lgkmcnt(4)
 s_add_u32 s38, s51, 2048
 buffer_store_dwordx4 v[160:163], v1, s[16:19], s38 offen sc1
 v_mfma_f32_16x16x32_bf16 v[176:179], a[92:95], v[60:63], v[176:179]
 ds_read_b64_tr_b16 a[110:111], v122 offset:14336
 ds_read_b64_tr_b16 a[112:113], v122 offset:16384
 v_mfma_f32_16x16x32_bf16 v[184:187], a[64:67], v[64:67], 0
 ds_read_b64_tr_b16 a[114:115], v122 offset:18432
 ds_read_b64_tr_b16 a[116:117], v122 offset:20480
 v_mfma_f32_16x16x32_bf16 v[184:187], a[68:71], v[68:71], v[184:187]
 ds_read_b64_tr_b16 a[118:119], v122 offset:22528
 v_cvt_pk_bf16_f32 v169, v170, v171
 v_mfma_f32_16x16x32_bf16 v[184:187], a[72:75], v[72:75], v[184:187]
 ds_read_b64_tr_b16 a[120:121], v122 offset:24576
 v_cvt_pk_bf16_f32 v170, v172, v173
 v_mfma_f32_16x16x32_bf16 v[184:187], a[76:79], v[76:79], v[184:187]
 ds_read_b64_tr_b16 a[122:123], v122 offset:26624
 v_and_b32 v14, 7, v0
 v_mfma_f32_16x16x32_bf16 v[184:187], a[80:83], v[80:83], v[184:187]
 ds_read_b64_tr_b16 a[124:125], v122 offset:28672
 v_mfma_f32_16x16x32_bf16 v[184:187], a[84:87], v[84:87], v[184:187]
 ds_read_b64_tr_b16 a[126:127], v122 offset:30720
 v_cvt_pk_bf16_f32 v171, v174, v175
 v_mfma_f32_16x16x32_bf16 v[184:187], a[88:91], v[88:91], v[184:187]
 v_add_u32 v119, 0x18000, v119
 v_bfe_u32 v15, v0, 3, 2
 v_mfma_f32_16x16x32_bf16 v[184:187], a[92:95], v[92:95], v[184:187]
 s_waitcnt vmcnt(13)
 s_barrier
 v_mfma_f32_16x16x32_bf16 v[180:183], a[96:99], v[32:35], 0
 s_waitcnt lgkmcnt(2)
 s_add_u32 s38, s51, 16384
 buffer_store_dwordx4 v[168:171], v1, s[16:19], s38 offen sc1
 v_mfma_f32_16x16x32_bf16 v[180:183], a[100:103], v[36:39], v[180:183]
 ds_read_b64_tr_b16 a[64:65], v119 offset:0
 ds_read_b64_tr_b16 a[66:67], v119 offset:2048
 v_mfma_f32_16x16x32_bf16 v[180:183], a[104:107], v[40:43], v[180:183]
 ds_read_b64_tr_b16 a[68:69], v119 offset:4096
 ds_read_b64_tr_b16 a[70:71], v119 offset:6144
 v_mfma_f32_16x16x32_bf16 v[180:183], a[108:111], v[44:47], v[180:183]
 ds_read_b64_tr_b16 a[72:73], v119 offset:8192
 v_mfma_f32_16x16x32_bf16 v[180:183], a[112:115], v[48:51], v[180:183]
 ds_read_b64_tr_b16 a[74:75], v119 offset:10240
 v_mfma_f32_16x16x32_bf16 v[180:183], a[116:119], v[52:55], v[180:183]
 ds_read_b64_tr_b16 a[76:77], v119 offset:12288
 v_lshrrev_b32 v26, 5, v0
 v_mfma_f32_16x16x32_bf16 v[180:183], a[120:123], v[56:59], v[180:183]
 s_waitcnt lgkmcnt(5)
 ds_read_b64_tr_b16 a[78:79], v119 offset:14336
 v_mfma_f32_16x16x32_bf16 v[180:183], a[124:127], v[60:63], v[180:183]
 s_add_u32 m0, s32, 98304
 ds_read_b64_tr_b16 a[80:81], v119 offset:16384
 ds_read_b64_tr_b16 a[82:83], v119 offset:18432
 v_mfma_f32_16x16x32_bf16 v[188:191], a[96:99], v[64:67], 0
 s_add_u32 s35, s48, 512
 ds_read_b64_tr_b16 a[84:85], v119 offset:20480
 v_mfma_f32_16x16x32_bf16 v[188:191], a[100:103], v[68:71], v[188:191]
 buffer_load_dwordx4 v31, s[44:47], s35 offen lds
 v_mfma_f32_16x16x32_bf16 v[188:191], a[104:107], v[72:75], v[188:191]
 ds_read_b64_tr_b16 a[86:87], v119 offset:22528
 ds_read_b64_tr_b16 a[88:89], v119 offset:24576
 v_mfma_f32_16x16x32_bf16 v[188:191], a[108:111], v[76:79], v[188:191]
 s_add_u32 m0, s32, 99328
 ds_read_b64_tr_b16 a[90:91], v119 offset:26624
 v_mfma_f32_16x16x32_bf16 v[188:191], a[112:115], v[80:83], v[188:191]
 s_add_u32 s35, s48, 7680
 ds_read_b64_tr_b16 a[92:93], v119 offset:28672
 v_cvt_pk_bf16_f32 v176, v176, v177
 v_mfma_f32_16x16x32_bf16 v[188:191], a[116:119], v[84:87], v[188:191]
 buffer_load_dwordx4 v31, s[44:47], s35 offen lds
 ds_read_b64_tr_b16 a[94:95], v119 offset:30720
 v_mfma_f32_16x16x32_bf16 v[188:191], a[120:123], v[88:91], v[188:191]
 s_lshl_b32 s39, s25, 4
 v_add_u32 v120, 0x18000, v120
 v_cvt_pk_bf16_f32 v177, v178, v179
 v_mfma_f32_16x16x32_bf16 v[188:191], a[124:127], v[92:95], v[188:191]
 v_cvt_pk_bf16_f32 v178, v180, v181
 v_cvt_pk_bf16_f32 v179, v182, v183
 v_mfma_f32_16x16x32_bf16 v[192:195], a[64:67], v[32:35], 0
 s_waitcnt lgkmcnt(2)
 s_lshl_b32 s37, s26, 3
 ds_read_b64_tr_b16 a[96:97], v120 offset:0
 ds_read_b64_tr_b16 a[98:99], v120 offset:2048
 v_mfma_f32_16x16x32_bf16 v[192:195], a[68:71], v[36:39], v[192:195]
 s_add_u32 s38, s51, 3072
 buffer_store_dwordx4 v[176:179], v1, s[16:19], s38 offen sc1
 v_mfma_f32_16x16x32_bf16 v[192:195], a[72:75], v[40:43], v[192:195]
 s_add_u32 s39, s39, s37
 ds_read_b64_tr_b16 a[100:101], v120 offset:4096
 ds_read_b64_tr_b16 a[102:103], v120 offset:6144
 v_mfma_f32_16x16x32_bf16 v[192:195], a[76:79], v[44:47], v[192:195]
 ds_read_b64_tr_b16 a[104:105], v120 offset:8192
 v_mfma_f32_16x16x32_bf16 v[192:195], a[80:83], v[48:51], v[192:195]
 ds_read_b64_tr_b16 a[106:107], v120 offset:10240
 v_cvt_pk_bf16_f32 v184, v184, v185
 v_mfma_f32_16x16x32_bf16 v[192:195], a[84:87], v[52:55], v[192:195]
 ds_read_b64_tr_b16 a[108:109], v120 offset:12288
 v_cvt_pk_bf16_f32 v185, v186, v187
 v_mfma_f32_16x16x32_bf16 v[192:195], a[88:91], v[56:59], v[192:195]
 s_waitcnt lgkmcnt(5)
 ds_read_b64_tr_b16 a[110:111], v120 offset:14336
 v_add_u32 v106, s39, v14
 v_mfma_f32_16x16x32_bf16 v[192:195], a[92:95], v[60:63], v[192:195]
 ds_read_b64_tr_b16 a[112:113], v120 offset:16384
 ds_read_b64_tr_b16 a[114:115], v120 offset:18432
 v_mfma_f32_16x16x32_bf16 v[200:203], a[64:67], v[64:67], 0
 ds_read_b64_tr_b16 a[116:117], v120 offset:20480
 v_cvt_pk_bf16_f32 v186, v188, v189
 v_mfma_f32_16x16x32_bf16 v[200:203], a[68:71], v[68:71], v[200:203]
 ds_read_b64_tr_b16 a[118:119], v120 offset:22528
 v_cvt_pk_bf16_f32 v187, v190, v191
 v_mfma_f32_16x16x32_bf16 v[200:203], a[72:75], v[72:75], v[200:203]
 s_add_u32 s38, s51, 17408
 buffer_store_dwordx4 v[184:187], v1, s[16:19], s38 offen sc1
 v_mfma_f32_16x16x32_bf16 v[200:203], a[76:79], v[76:79], v[200:203]
 ds_read_b64_tr_b16 a[120:121], v120 offset:24576
 ds_read_b64_tr_b16 a[122:123], v120 offset:26624
 v_mfma_f32_16x16x32_bf16 v[200:203], a[80:83], v[80:83], v[200:203]
 ds_read_b64_tr_b16 a[124:125], v120 offset:28672
 v_mfma_f32_16x16x32_bf16 v[200:203], a[84:87], v[84:87], v[200:203]
 ds_read_b64_tr_b16 a[126:127], v120 offset:30720
 v_mul_u32_u24 v106, 896, v106
 v_mfma_f32_16x16x32_bf16 v[200:203], a[88:91], v[88:91], v[200:203]
 v_add_u32 v121, 0x18000, v121
 v_mfma_f32_16x16x32_bf16 v[200:203], a[92:95], v[92:95], v[200:203]
 v_mfma_f32_16x16x32_bf16 v[196:199], a[96:99], v[32:35], 0
 s_waitcnt lgkmcnt(2)
 ds_read_b64_tr_b16 a[64:65], v121 offset:0
 ds_read_b64_tr_b16 a[66:67], v121 offset:2048
 v_mfma_f32_16x16x32_bf16 v[196:199], a[100:103], v[36:39], v[196:199]
 s_add_u32 m0, s32, 100352
 ds_read_b64_tr_b16 a[68:69], v121 offset:4096
 v_mfma_f32_16x16x32_bf16 v[196:199], a[104:107], v[40:43], v[196:199]
 s_add_u32 s35, s48, 14848
 ds_read_b64_tr_b16 a[70:71], v121 offset:6144
 v_mfma_f32_16x16x32_bf16 v[196:199], a[108:111], v[44:47], v[196:199]
 buffer_load_dwordx4 v31, s[44:47], s35 offen lds
 v_mfma_f32_16x16x32_bf16 v[196:199], a[112:115], v[48:51], v[196:199]
 ds_read_b64_tr_b16 a[72:73], v121 offset:8192
 ds_read_b64_tr_b16 a[74:75], v121 offset:10240
 v_mfma_f32_16x16x32_bf16 v[196:199], a[116:119], v[52:55], v[196:199]
 s_add_u32 m0, s32, 101376
 ds_read_b64_tr_b16 a[76:77], v121 offset:12288
 v_mfma_f32_16x16x32_bf16 v[196:199], a[120:123], v[56:59], v[196:199]
 s_waitcnt lgkmcnt(4)
 s_add_u32 s35, s48, 22016
 ds_read_b64_tr_b16 a[78:79], v121 offset:14336
 v_lshl_add_u32 v106, v15, 3, v106
 v_mfma_f32_16x16x32_bf16 v[196:199], a[124:127], v[60:63], v[196:199]
 buffer_load_dwordx4 v31, s[44:47], s35 offen lds
 v_mfma_f32_16x16x32_bf16 v[204:207], a[96:99], v[64:67], 0
 ds_read_b64_tr_b16 a[80:81], v121 offset:16384
 ds_read_b64_tr_b16 a[82:83], v121 offset:18432
 v_mfma_f32_16x16x32_bf16 v[204:207], a[100:103], v[68:71], v[204:207]
 s_add_u32 m0, s32, 102400
 ds_read_b64_tr_b16 a[84:85], v121 offset:20480
 ds_read_b64_tr_b16 a[86:87], v121 offset:22528
 v_mfma_f32_16x16x32_bf16 v[204:207], a[104:107], v[72:75], v[204:207]
 s_add_u32 s35, s48, 29184
 ds_read_b64_tr_b16 a[88:89], v121 offset:24576
 v_mfma_f32_16x16x32_bf16 v[204:207], a[108:111], v[76:79], v[204:207]
 buffer_load_dwordx4 v31, s[44:47], s35 offen lds
 v_mfma_f32_16x16x32_bf16 v[204:207], a[112:115], v[80:83], v[204:207]
 ds_read_b64_tr_b16 a[90:91], v121 offset:26624
 ds_read_b64_tr_b16 a[92:93], v121 offset:28672
 v_mfma_f32_16x16x32_bf16 v[204:207], a[116:119], v[84:87], v[204:207]
 s_add_u32 m0, s32, 103424
 ds_read_b64_tr_b16 a[94:95], v121 offset:30720
 v_mfma_f32_16x16x32_bf16 v[204:207], a[120:123], v[88:91], v[204:207]
 s_add_u32 s35, s48, 36352
 v_add_u32 v122, 0x18000, v122
 v_lshl_add_u32 v106, v26, 5, v106
 v_mfma_f32_16x16x32_bf16 v[204:207], a[124:127], v[92:95], v[204:207]
 buffer_load_dwordx4 v31, s[44:47], s35 offen lds
 v_mfma_f32_16x16x32_bf16 v[208:211], a[64:67], v[32:35], 0
 s_waitcnt lgkmcnt(3)
 ds_read_b64_tr_b16 a[96:97], v122 offset:0
 ds_read_b64_tr_b16 a[98:99], v122 offset:2048
 v_mfma_f32_16x16x32_bf16 v[208:211], a[68:71], v[36:39], v[208:211]
 s_add_u32 m0, s32, 104448
 ds_read_b64_tr_b16 a[100:101], v122 offset:4096
 v_cvt_pk_bf16_f32 v192, v192, v193
 v_mfma_f32_16x16x32_bf16 v[208:211], a[72:75], v[40:43], v[208:211]
 s_add_u32 s35, s48, 43520
 ds_read_b64_tr_b16 a[102:103], v122 offset:6144
 v_cvt_pk_bf16_f32 v193, v194, v195
 v_mfma_f32_16x16x32_bf16 v[208:211], a[76:79], v[44:47], v[208:211]
 buffer_load_dwordx4 v31, s[44:47], s35 offen lds
 v_mfma_f32_16x16x32_bf16 v[208:211], a[80:83], v[48:51], v[208:211]
 ds_read_b64_tr_b16 a[104:105], v122 offset:8192
 ds_read_b64_tr_b16 a[106:107], v122 offset:10240
 v_mfma_f32_16x16x32_bf16 v[208:211], a[84:87], v[52:55], v[208:211]
 s_waitcnt lgkmcnt(4)
 s_add_u32 m0, s32, 105472
 ds_read_b64_tr_b16 a[108:109], v122 offset:12288
 v_cvt_pk_bf16_f32 v194, v196, v197
 v_mfma_f32_16x16x32_bf16 v[208:211], a[88:91], v[56:59], v[208:211]
 s_add_u32 s35, s48, 50688
 ds_read_b64_tr_b16 a[110:111], v122 offset:14336
 v_mfma_f32_16x16x32_bf16 v[208:211], a[92:95], v[60:63], v[208:211]
 s_lshl_b32 s37, s3, 6
 buffer_load_dwordx4 v31, s[44:47], s35 offen lds
 v_mfma_f32_16x16x32_bf16 v[216:219], a[64:67], v[64:67], 0
 ds_read_b64_tr_b16 a[112:113], v122 offset:16384
 ds_read_b64_tr_b16 a[114:115], v122 offset:18432
 v_mfma_f32_16x16x32_bf16 v[216:219], a[68:71], v[68:71], v[216:219]
 ds_read_b64_tr_b16 a[116:117], v122 offset:20480
 ds_read_b64_tr_b16 a[118:119], v122 offset:22528
 v_add_u32 v106, s37, v106
 v_mfma_f32_16x16x32_bf16 v[216:219], a[72:75], v[72:75], v[216:219]
 ds_read_b64_tr_b16 a[120:121], v122 offset:24576
 v_cvt_pk_bf16_f32 v195, v198, v199
 v_mfma_f32_16x16x32_bf16 v[216:219], a[76:79], v[76:79], v[216:219]
 s_add_u32 s38, s51, 4096
 buffer_store_dwordx4 v[192:195], v1, s[16:19], s38 offen sc1
 v_mfma_f32_16x16x32_bf16 v[216:219], a[80:83], v[80:83], v[216:219]
 ds_read_b64_tr_b16 a[122:123], v122 offset:26624
 ds_read_b64_tr_b16 a[124:125], v122 offset:28672
 v_mfma_f32_16x16x32_bf16 v[216:219], a[84:87], v[84:87], v[216:219]
 ds_read_b64_tr_b16 a[126:127], v122 offset:30720
 v_cvt_pk_bf16_f32 v200, v200, v201
 v_mfma_f32_16x16x32_bf16 v[216:219], a[88:91], v[88:91], v[216:219]
 v_add_u32 v119, 0xffff0000, v119
 v_cvt_pk_bf16_f32 v201, v202, v203
 v_mfma_f32_16x16x32_bf16 v[216:219], a[92:95], v[92:95], v[216:219]
 s_waitcnt vmcnt(13)
 s_barrier
 v_cvt_pk_bf16_f32 v202, v204, v205
 v_mfma_f32_16x16x32_bf16 v[212:215], a[96:99], v[32:35], 0
 s_waitcnt lgkmcnt(3)
 ds_read_b64_tr_b16 a[64:65], v119 offset:0
 ds_read_b64_tr_b16 a[66:67], v119 offset:2048
 v_mfma_f32_16x16x32_bf16 v[212:215], a[100:103], v[36:39], v[212:215]
 ds_read_b64_tr_b16 a[68:69], v119 offset:4096
 v_cvt_pk_bf16_f32 v203, v206, v207
 v_mfma_f32_16x16x32_bf16 v[212:215], a[104:107], v[40:43], v[212:215]
 s_cmp_lt_u32 s3, 2
 s_cselect_b32 s28, 0, 1879048192
 s_cselect_b32 s29, 1.0, 0
 ds_read_b64_tr_b16 a[70:71], v119 offset:6144
 v_mfma_f32_16x16x32_bf16 v[212:215], a[108:111], v[44:47], v[212:215]
 ds_read_b64_tr_b16 a[72:73], v119 offset:8192
 v_mfma_f32_16x16x32_bf16 v[212:215], a[112:115], v[48:51], v[212:215]
 s_add_u32 s38, s51, 18432
 buffer_store_dwordx4 v[200:203], v1, s[16:19], s38 offen sc1
 v_mfma_f32_16x16x32_bf16 v[212:215], a[116:119], v[52:55], v[212:215]
 s_waitcnt lgkmcnt(3)
 s_mul_i32 s27, s25, 14336
 ds_read_b64_tr_b16 a[74:75], v119 offset:10240
 ds_read_b64_tr_b16 a[76:77], v119 offset:12288
 v_mfma_f32_16x16x32_bf16 v[212:215], a[120:123], v[56:59], v[212:215]
 s_lshl_b32 s39, s26, 7
 ds_read_b64_tr_b16 a[78:79], v119 offset:14336
 v_mfma_f32_16x16x32_bf16 v[212:215], a[124:127], v[60:63], v[212:215]
 s_add_u32 s27, s27, s39
 ds_read_b64_tr_b16 a[80:81], v119 offset:16384
 ds_read_b64_tr_b16 a[82:83], v119 offset:18432
 v_mfma_f32_16x16x32_bf16 v[220:223], a[96:99], v[64:67], 0
 s_lshl_b32 s39, s3, 10
 ds_read_b64_tr_b16 a[84:85], v119 offset:20480
 v_mfma_f32_16x16x32_bf16 v[220:223], a[100:103], v[68:71], v[220:223]
 s_add_u32 s27, s27, s39
 ds_read_b64_tr_b16 a[86:87], v119 offset:22528
 v_mfma_f32_16x16x32_bf16 v[220:223], a[104:107], v[72:75], v[220:223]
 s_add_u32 s27, s27, 50331648
 ds_read_b64_tr_b16 a[88:89], v119 offset:24576
 v_lshlrev_b32 v27, 4, v14
 v_mfma_f32_16x16x32_bf16 v[220:223], a[108:111], v[76:79], v[220:223]
 s_add_u32 m0, s32, 0
 ds_read_b64_tr_b16 a[90:91], v119 offset:26624
 v_lshl_add_u32 v27, v15, 8, v27
 v_mfma_f32_16x16x32_bf16 v[220:223], a[112:115], v[80:83], v[220:223]
 s_add_u32 s35, s48, 640
 ds_read_b64_tr_b16 a[92:93], v119 offset:28672
 v_cvt_pk_bf16_f32 v208, v208, v209
 v_mfma_f32_16x16x32_bf16 v[220:223], a[116:119], v[84:87], v[220:223]
 s_mov_b32 s39, 1835008
 buffer_load_dwordx4 v31, s[44:47], s35 offen lds
 ds_read_b64_tr_b16 a[94:95], v119 offset:30720
 v_mfma_f32_16x16x32_bf16 v[220:223], a[120:123], v[88:91], v[220:223]
 v_add_u32 v120, 0xffff0000, v120
 v_cvt_pk_bf16_f32 v209, v210, v211
 v_mfma_f32_16x16x32_bf16 v[220:223], a[124:127], v[92:95], v[220:223]
 v_cvt_pk_bf16_f32 v210, v212, v213
 v_cvt_pk_bf16_f32 v211, v214, v215
 v_mfma_f32_16x16x32_bf16 v[224:227], a[64:67], v[32:35], 0
 s_waitcnt lgkmcnt(2)
 ds_read_b64_tr_b16 a[96:97], v120 offset:0
 ds_read_b64_tr_b16 a[98:99], v120 offset:2048
 v_mfma_f32_16x16x32_bf16 v[224:227], a[68:71], v[36:39], v[224:227]
 s_add_u32 s38, s51, 5120
 buffer_store_dwordx4 v[208:211], v1, s[16:19], s38 offen sc1
 v_mfma_f32_16x16x32_bf16 v[224:227], a[72:75], v[40:43], v[224:227]
 ds_read_b64_tr_b16 a[100:101], v120 offset:4096
 ds_read_b64_tr_b16 a[102:103], v120 offset:6144
 v_mfma_f32_16x16x32_bf16 v[224:227], a[76:79], v[44:47], v[224:227]
 ds_read_b64_tr_b16 a[104:105], v120 offset:8192
 v_mad_u32_u24 v104, v26, s39, v27
 v_mfma_f32_16x16x32_bf16 v[224:227], a[80:83], v[48:51], v[224:227]
 s_mov_b32 s37, 4194304
 ds_read_b64_tr_b16 a[106:107], v120 offset:10240
 v_sub_u32 v105, 1, v26
 v_mfma_f32_16x16x32_bf16 v[224:227], a[84:87], v[52:55], v[224:227]
 ds_read_b64_tr_b16 a[108:109], v120 offset:12288
 v_mad_u32_u24 v105, v105, s37, v27
 v_mfma_f32_16x16x32_bf16 v[224:227], a[88:91], v[56:59], v[224:227]
 s_waitcnt lgkmcnt(5)
 ds_read_b64_tr_b16 a[110:111], v120 offset:14336
 v_lshlrev_b32 v107, 4, v14
 v_mfma_f32_16x16x32_bf16 v[224:227], a[92:95], v[60:63], v[224:227]
 ds_read_b64_tr_b16 a[112:113], v120 offset:16384
 ds_read_b64_tr_b16 a[114:115], v120 offset:18432
 v_mfma_f32_16x16x32_bf16 v[232:235], a[64:67], v[64:67], 0
 s_add_u32 m0, s32, 1024
 ds_read_b64_tr_b16 a[116:117], v120 offset:20480
 v_add_u32 v107, 28672, v107
 v_mfma_f32_16x16x32_bf16 v[232:235], a[68:71], v[68:71], v[232:235]
 s_add_u32 s35, s48, 7808
 ds_read_b64_tr_b16 a[118:119], v120 offset:22528
 v_mfma_f32_16x16x32_bf16 v[232:235], a[72:75], v[72:75], v[232:235]
 s_lshl_b32 s39, s3, 2
 buffer_load_dwordx4 v31, s[44:47], s35 offen lds
 v_mfma_f32_16x16x32_bf16 v[232:235], a[76:79], v[76:79], v[232:235]
 ds_read_b64_tr_b16 a[120:121], v120 offset:24576
 ds_read_b64_tr_b16 a[122:123], v120 offset:26624
 v_mfma_f32_16x16x32_bf16 v[232:235], a[80:83], v[80:83], v[232:235]
 s_add_u32 m0, s32, 2048
 ds_read_b64_tr_b16 a[124:125], v120 offset:28672
 v_add_u32 v108, s39, v107
 v_mfma_f32_16x16x32_bf16 v[232:235], a[84:87], v[84:87], v[232:235]
 s_add_u32 s35, s48, 14976
 ds_read_b64_tr_b16 a[126:127], v120 offset:30720
 v_mfma_f32_16x16x32_bf16 v[232:235], a[88:91], v[88:91], v[232:235]
 s_mov_b32 s33, 0x00003f80
 buffer_load_dwordx4 v31, s[44:47], s35 offen lds
 v_add_u32 v121, 0xffff0000, v121
 v_mfma_f32_16x16x32_bf16 v[232:235], a[92:95], v[92:95], v[232:235]
 s_mov_b32 s34, 0x3f800000
 v_and_b32 v14, 0x40000000, v25
 v_lshl_add_u32 v10, v0, 12, v14
 v_mfma_f32_16x16x32_bf16 v[228:231], a[96:99], v[32:35], 0
 s_waitcnt lgkmcnt(2)
 s_add_u32 m0, s32, 3072
 ds_read_b64_tr_b16 a[64:65], v121 offset:0
 ds_read_b64_tr_b16 a[66:67], v121 offset:2048
 v_mfma_f32_16x16x32_bf16 v[228:231], a[100:103], v[36:39], v[228:231]
 s_add_u32 s35, s48, 22144
 ds_read_b64_tr_b16 a[68:69], v121 offset:4096
 v_mfma_f32_16x16x32_bf16 v[228:231], a[104:107], v[40:43], v[228:231]
 s_lshl_b32 s39, 1, s24
 buffer_load_dwordx4 v31, s[44:47], s35 offen lds
 v_mfma_f32_16x16x32_bf16 v[228:231], a[108:111], v[44:47], v[228:231]
 ds_read_b64_tr_b16 a[70:71], v121 offset:6144
 ds_read_b64_tr_b16 a[72:73], v121 offset:8192
 v_mfma_f32_16x16x32_bf16 v[228:231], a[112:115], v[48:51], v[228:231]
 s_add_u32 m0, s32, 4096
 ds_read_b64_tr_b16 a[74:75], v121 offset:10240
 v_mov_b32 v11, s39
 v_mfma_f32_16x16x32_bf16 v[228:231], a[116:119], v[52:55], v[228:231]
 s_add_u32 s35, s48, 29312
 ds_read_b64_tr_b16 a[76:77], v121 offset:12288
 v_mfma_f32_16x16x32_bf16 v[228:231], a[120:123], v[56:59], v[228:231]
 s_waitcnt lgkmcnt(4)
 s_lshl_b32 s39, s3, 2
 buffer_load_dwordx4 v31, s[44:47], s35 offen lds
 v_mfma_f32_16x16x32_bf16 v[228:231], a[124:127], v[60:63], v[228:231]
 s_lshl_b32 s41, 15, s39
 ds_read_b64_tr_b16 a[78:79], v121 offset:14336
 ds_read_b64_tr_b16 a[80:81], v121 offset:16384
 v_mfma_f32_16x16x32_bf16 v[236:239], a[96:99], v[64:67], 0
 s_add_u32 m0, s32, 5120
 ds_read_b64_tr_b16 a[82:83], v121 offset:18432
 ds_read_b64_tr_b16 a[84:85], v121 offset:20480
 v_mfma_f32_16x16x32_bf16 v[236:239], a[100:103], v[68:71], v[236:239]
 s_add_u32 s35, s48, 36480
 ds_read_b64_tr_b16 a[86:87], v121 offset:22528
 v_mfma_f32_16x16x32_bf16 v[236:239], a[104:107], v[72:75], v[236:239]
 s_mov_b32 s37, 0x12492493
 s_and_b32 s39, s30, 1
 buffer_load_dwordx4 v31, s[44:47], s35 offen lds
 v_mfma_f32_16x16x32_bf16 v[236:239], a[108:111], v[76:79], v[236:239]
 s_lshl_b32 s39, s39, 1
 ds_read_b64_tr_b16 a[88:89], v121 offset:24576
 ds_read_b64_tr_b16 a[90:91], v121 offset:26624
 v_add_u32 v14, 0, v0
 v_mfma_f32_16x16x32_bf16 v[236:239], a[112:115], v[80:83], v[236:239]
 s_add_u32 m0, s32, 6144
 ds_read_b64_tr_b16 a[92:93], v121 offset:28672
 v_cvt_pk_bf16_f32 v216, v216, v217
 v_mul_hi_u32 v15, v14, s37
 v_mfma_f32_16x16x32_bf16 v[236:239], a[116:119], v[84:87], v[236:239]
 s_add_u32 s35, s48, 43648
 ds_read_b64_tr_b16 a[94:95], v121 offset:30720
 v_cvt_pk_bf16_f32 v217, v218, v219
 v_mfma_f32_16x16x32_bf16 v[236:239], a[120:123], v[88:91], v[236:239]
 buffer_load_dwordx4 v31, s[44:47], s35 offen lds
 v_add_u32 v122, 0xffff0000, v122
 v_mfma_f32_16x16x32_bf16 v[236:239], a[124:127], v[92:95], v[236:239]
 v_mul_u32_u24 v26, 14, v15
 v_sub_u32 v14, v14, v26
 v_add_u32 v14, s39, v14
 v_mfma_f32_16x16x32_bf16 v[240:243], a[64:67], v[32:35], 0
 s_waitcnt lgkmcnt(2)
 s_add_u32 m0, s32, 7168
 ds_read_b64_tr_b16 a[96:97], v122 offset:0
 ds_read_b64_tr_b16 a[98:99], v122 offset:2048
 v_mfma_f32_16x16x32_bf16 v[240:243], a[68:71], v[36:39], v[240:243]
 s_add_u32 s35, s48, 50816
 ds_read_b64_tr_b16 a[100:101], v122 offset:4096
 v_cvt_pk_bf16_f32 v218, v220, v221
 v_mfma_f32_16x16x32_bf16 v[240:243], a[72:75], v[40:43], v[240:243]
 buffer_load_dwordx4 v31, s[44:47], s35 offen lds
 v_subrev_u32 v26, 14, v14
 v_mfma_f32_16x16x32_bf16 v[240:243], a[76:79], v[44:47], v[240:243]
 ds_read_b64_tr_b16 a[102:103], v122 offset:6144
 ds_read_b64_tr_b16 a[104:105], v122 offset:8192
 v_min_u32 v14, v14, v26
 v_mfma_f32_16x16x32_bf16 v[240:243], a[80:83], v[48:51], v[240:243]
 ds_read_b64_tr_b16 a[106:107], v122 offset:10240
 v_cvt_pk_bf16_f32 v219, v222, v223
 v_mul_u32_u24 v15, 3584, v15
 v_mfma_f32_16x16x32_bf16 v[240:243], a[84:87], v[52:55], v[240:243]
 ds_read_b64_tr_b16 a[108:109], v122 offset:12288
 v_cvt_pk_bf16_f32 v224, v224, v225
 v_mfma_f32_16x16x32_bf16 v[240:243], a[88:91], v[56:59], v[240:243]
 s_waitcnt lgkmcnt(4)
 s_add_u32 s38, s51, 19456
 buffer_store_dwordx4 v[216:219], v1, s[16:19], s38 offen sc1
 v_mfma_f32_16x16x32_bf16 v[240:243], a[92:95], v[60:63], v[240:243]
 ds_read_b64_tr_b16 a[110:111], v122 offset:14336
 ds_read_b64_tr_b16 a[112:113], v122 offset:16384
 v_mfma_f32_16x16x32_bf16 v[248:251], a[64:67], v[64:67], 0
 ds_read_b64_tr_b16 a[114:115], v122 offset:18432
 ds_read_b64_tr_b16 a[116:117], v122 offset:20480
 v_mfma_f32_16x16x32_bf16 v[248:251], a[68:71], v[68:71], v[248:251]
 ds_read_b64_tr_b16 a[118:119], v122 offset:22528
 v_cvt_pk_bf16_f32 v225, v226, v227
 v_mfma_f32_16x16x32_bf16 v[248:251], a[72:75], v[72:75], v[248:251]
 ds_read_b64_tr_b16 a[120:121], v122 offset:24576
 v_cvt_pk_bf16_f32 v226, v228, v229
 v_mfma_f32_16x16x32_bf16 v[248:251], a[76:79], v[76:79], v[248:251]
 ds_read_b64_tr_b16 a[122:123], v122 offset:26624
 v_lshl_add_u32 v14, v14, 4, v15
 v_mfma_f32_16x16x32_bf16 v[248:251], a[80:83], v[80:83], v[248:251]
 ds_read_b64_tr_b16 a[124:125], v122 offset:28672
 v_subrev_u32 v2, 0, v14
 v_mfma_f32_16x16x32_bf16 v[248:251], a[84:87], v[84:87], v[248:251]
 ds_read_b64_tr_b16 a[126:127], v122 offset:30720
 v_cvt_pk_bf16_f32 v227, v230, v231
 v_mfma_f32_16x16x32_bf16 v[248:251], a[88:91], v[88:91], v[248:251]
 v_add_u32 v119, 0x8000, v119
 v_cvt_pk_bf16_f32 v232, v232, v233
 v_mfma_f32_16x16x32_bf16 v[248:251], a[92:95], v[92:95], v[248:251]
 s_waitcnt vmcnt(12)
 s_barrier
 v_add_u32 v14, 64, v0
 v_mfma_f32_16x16x32_bf16 v[244:247], a[96:99], v[32:35], 0
 s_waitcnt lgkmcnt(2)
 s_add_u32 s38, s51, 6144
 buffer_store_dwordx4 v[224:227], v1, s[16:19], s38 offen sc1
 v_mfma_f32_16x16x32_bf16 v[244:247], a[100:103], v[36:39], v[244:247]
 ds_read_b64_tr_b16 a[64:65], v119 offset:0
 ds_read_b64_tr_b16 a[66:67], v119 offset:2048
 v_mul_hi_u32 v15, v14, s37
 v_mfma_f32_16x16x32_bf16 v[244:247], a[104:107], v[40:43], v[244:247]
 ds_read_b64_tr_b16 a[68:69], v119 offset:4096
 ds_read_b64_tr_b16 a[70:71], v119 offset:6144
 v_mfma_f32_16x16x32_bf16 v[244:247], a[108:111], v[44:47], v[244:247]
 ds_read_b64_tr_b16 a[72:73], v119 offset:8192
 v_cvt_pk_bf16_f32 v233, v234, v235
 v_mfma_f32_16x16x32_bf16 v[244:247], a[112:115], v[48:51], v[244:247]
 ds_read_b64_tr_b16 a[74:75], v119 offset:10240
 v_cvt_pk_bf16_f32 v234, v236, v237
 v_mfma_f32_16x16x32_bf16 v[244:247], a[116:119], v[52:55], v[244:247]
 ds_read_b64_tr_b16 a[76:77], v119 offset:12288
 v_mul_u32_u24 v26, 14, v15
 v_sub_u32 v14, v14, v26
 v_mfma_f32_16x16x32_bf16 v[244:247], a[120:123], v[56:59], v[244:247]
 s_waitcnt lgkmcnt(5)
 ds_read_b64_tr_b16 a[78:79], v119 offset:14336
 v_cvt_pk_bf16_f32 v235, v238, v239
 v_mfma_f32_16x16x32_bf16 v[244:247], a[124:127], v[60:63], v[244:247]
 ds_read_b64_tr_b16 a[80:81], v119 offset:16384
 ds_read_b64_tr_b16 a[82:83], v119 offset:18432
 v_mfma_f32_16x16x32_bf16 v[252:255], a[96:99], v[64:67], 0
 ds_read_b64_tr_b16 a[84:85], v119 offset:20480
 v_add_u32 v14, s39, v14
 v_subrev_u32 v26, 14, v14
 v_mfma_f32_16x16x32_bf16 v[252:255], a[100:103], v[68:71], v[252:255]
 s_add_u32 s38, s51, 20480
 buffer_store_dwordx4 v[232:235], v1, s[16:19], s38 offen sc1
 v_mfma_f32_16x16x32_bf16 v[252:255], a[104:107], v[72:75], v[252:255]
 ds_read_b64_tr_b16 a[86:87], v119 offset:22528
 ds_read_b64_tr_b16 a[88:89], v119 offset:24576
 v_min_u32 v14, v14, v26
 v_mfma_f32_16x16x32_bf16 v[252:255], a[108:111], v[76:79], v[252:255]
 s_getpc_b64 s[20:21]
L_pcx30:
 s_add_u32 s20, s20, L_tail-L_pcx30
 s_addc_u32 s21, s21, 0
 ds_read_b64_tr_b16 a[90:91], v119 offset:26624
 v_mfma_f32_16x16x32_bf16 v[252:255], a[112:115], v[80:83], v[252:255]
 ds_read_b64_tr_b16 a[92:93], v119 offset:28672
 v_cvt_pk_bf16_f32 v240, v240, v241
 v_mfma_f32_16x16x32_bf16 v[252:255], a[116:119], v[84:87], v[252:255]
 ds_read_b64_tr_b16 a[94:95], v119 offset:30720
 v_cvt_pk_bf16_f32 v241, v242, v243
 v_mfma_f32_16x16x32_bf16 v[252:255], a[120:123], v[88:91], v[252:255]
 s_lshl_b32 s38, s3, 13
 v_lshl_add_u32 v12, v0, 7, s38
 v_add_u32 v120, 0x8000, v120
 v_mfma_f32_16x16x32_bf16 v[252:255], a[124:127], v[92:95], v[252:255]
 v_cvt_pk_bf16_f32 v242, v244, v245
 v_mul_u32_u24 v15, 3584, v15
 v_lshl_add_u32 v14, v14, 4, v15
 v_mfma_f32_16x16x32_bf16 v[128:131], a[64:67], v[32:35], 0
 s_waitcnt lgkmcnt(2)
 ds_read_b64_tr_b16 a[96:97], v120 offset:0
 ds_read_b64_tr_b16 a[98:99], v120 offset:2048
 v_subrev_u32 v3, 1024, v14
 v_mfma_f32_16x16x32_bf16 v[128:131], a[68:71], v[36:39], v[128:131]
 ds_read_b64_tr_b16 a[100:101], v120 offset:4096
 v_cvt_pk_bf16_f32 v243, v246, v247
 v_mfma_f32_16x16x32_bf16 v[128:131], a[72:75], v[40:43], v[128:131]
 s_add_u32 s38, s51, 7168
 buffer_store_dwordx4 v[240:243], v1, s[16:19], s38 offen sc1
 v_mfma_f32_16x16x32_bf16 v[128:131], a[76:79], v[44:47], v[128:131]
 ds_read_b64_tr_b16 a[102:103], v120 offset:6144
 ds_read_b64_tr_b16 a[104:105], v120 offset:8192
 v_mfma_f32_16x16x32_bf16 v[128:131], a[80:83], v[48:51], v[128:131]
 ds_read_b64_tr_b16 a[106:107], v120 offset:10240
 v_add_u32 v14, 128, v0
 v_mfma_f32_16x16x32_bf16 v[128:131], a[84:87], v[52:55], v[128:131]
 ds_read_b64_tr_b16 a[108:109], v120 offset:12288
 v_min_u32 v12, L_textend-L_tail-4, v12
 v_mfma_f32_16x16x32_bf16 v[128:131], a[88:91], v[56:59], v[128:131]
 s_waitcnt lgkmcnt(4)
 ds_read_b64_tr_b16 a[110:111], v120 offset:14336
 v_mul_hi_u32 v15, v14, s37
 v_mfma_f32_16x16x32_bf16 v[128:131], a[92:95], v[60:63], v[128:131]
 ds_read_b64_tr_b16 a[112:113], v120 offset:16384
 ds_read_b64_tr_b16 a[114:115], v120 offset:18432
 v_mfma_f32_16x16x32_bf16 v[136:139], a[64:67], v[64:67], 0
 ds_read_b64_tr_b16 a[116:117], v120 offset:20480
 v_mul_u32_u24 v26, 14, v15
 v_mfma_f32_16x16x32_bf16 v[136:139], a[68:71], v[68:71], v[136:139]
 s_add_u32 m0, s32, 32768
 ds_read_b64_tr_b16 a[118:119], v120 offset:22528
 v_sub_u32 v14, v14, v26
 v_mfma_f32_16x16x32_bf16 v[136:139], a[72:75], v[72:75], v[136:139]
 s_add_u32 s35, s48, 768
 ds_read_b64_tr_b16 a[120:121], v120 offset:24576
 v_add_u32 v14, s39, v14
 v_mfma_f32_16x16x32_bf16 v[136:139], a[76:79], v[76:79], v[136:139]
 buffer_load_dwordx4 v31, s[44:47], s35 offen lds
 v_mfma_f32_16x16x32_bf16 v[136:139], a[80:83], v[80:83], v[136:139]
 ds_read_b64_tr_b16 a[122:123], v120 offset:26624
 ds_read_b64_tr_b16 a[124:125], v120 offset:28672
 v_mfma_f32_16x16x32_bf16 v[136:139], a[84:87], v[84:87], v[136:139]
 s_add_u32 m0, s32, 33792
 ds_read_b64_tr_b16 a[126:127], v120 offset:30720
 v_subrev_u32 v26, 14, v14
 v_mfma_f32_16x16x32_bf16 v[136:139], a[88:91], v[88:91], v[136:139]
 s_add_u32 s35, s48, 7936
 v_add_u32 v121, 0x8000, v121
 v_min_u32 v14, v14, v26
 v_mfma_f32_16x16x32_bf16 v[136:139], a[92:95], v[92:95], v[136:139]
 buffer_load_dwordx4 v31, s[44:47], s35 offen lds
 global_load_dword v13, v12, s[20:21]
 v_mfma_f32_16x16x32_bf16 v[132:135], a[96:99], v[32:35], 0
 s_waitcnt lgkmcnt(3)
 ds_read_b64_tr_b16 a[64:65], v121 offset:0
 ds_read_b64_tr_b16 a[66:67], v121 offset:2048
 v_mfma_f32_16x16x32_bf16 v[132:135], a[100:103], v[36:39], v[132:135]
 s_add_u32 m0, s32, 34816
 ds_read_b64_tr_b16 a[68:69], v121 offset:4096
 v_mul_u32_u24 v15, 3584, v15
 v_mfma_f32_16x16x32_bf16 v[132:135], a[104:107], v[40:43], v[132:135]
 s_add_u32 s35, s48, 15104
 ds_read_b64_tr_b16 a[70:71], v121 offset:6144
 v_lshl_add_u32 v14, v14, 4, v15
 v_mfma_f32_16x16x32_bf16 v[132:135], a[108:111], v[44:47], v[132:135]
 buffer_load_dwordx4 v31, s[44:47], s35 offen lds
 v_mfma_f32_16x16x32_bf16 v[132:135], a[112:115], v[48:51], v[132:135]
 ds_read_b64_tr_b16 a[72:73], v121 offset:8192
 ds_read_b64_tr_b16 a[74:75], v121 offset:10240
 v_mfma_f32_16x16x32_bf16 v[132:135], a[116:119], v[52:55], v[132:135]
 s_waitcnt lgkmcnt(4)
 s_add_u32 m0, s32, 35840
 ds_read_b64_tr_b16 a[76:77], v121 offset:12288
 v_subrev_u32 v4, 2048, v14
 v_mfma_f32_16x16x32_bf16 v[132:135], a[120:123], v[56:59], v[132:135]
 s_add_u32 s35, s48, 22272
 ds_read_b64_tr_b16 a[78:79], v121 offset:14336
 v_add_u32 v14, 192, v0
 v_mfma_f32_16x16x32_bf16 v[132:135], a[124:127], v[60:63], v[132:135]
 buffer_load_dwordx4 v31, s[44:47], s35 offen lds
 v_mfma_f32_16x16x32_bf16 v[140:143], a[96:99], v[64:67], 0
 ds_read_b64_tr_b16 a[80:81], v121 offset:16384
 ds_read_b64_tr_b16 a[82:83], v121 offset:18432
 v_mfma_f32_16x16x32_bf16 v[140:143], a[100:103], v[68:71], v[140:143]
 s_add_u32 m0, s32, 36864
 ds_read_b64_tr_b16 a[84:85], v121 offset:20480
 ds_read_b64_tr_b16 a[86:87], v121 offset:22528
 v_mfma_f32_16x16x32_bf16 v[140:143], a[104:107], v[72:75], v[140:143]
 s_add_u32 s35, s48, 29440
 ds_read_b64_tr_b16 a[88:89], v121 offset:24576
 v_mul_hi_u32 v15, v14, s37
 v_mfma_f32_16x16x32_bf16 v[140:143], a[108:111], v[76:79], v[140:143]
 buffer_load_dwordx4 v31, s[44:47], s35 offen lds
 v_mfma_f32_16x16x32_bf16 v[140:143], a[112:115], v[80:83], v[140:143]
 ds_read_b64_tr_b16 a[90:91], v121 offset:26624
 ds_read_b64_tr_b16 a[92:93], v121 offset:28672
 v_mfma_f32_16x16x32_bf16 v[140:143], a[116:119], v[84:87], v[140:143]
 s_add_u32 m0, s32, 37888
 ds_read_b64_tr_b16 a[94:95], v121 offset:30720
 v_mul_u32_u24 v26, 14, v15
 v_mfma_f32_16x16x32_bf16 v[140:143], a[120:123], v[88:91], v[140:143]
 s_add_u32 s35, s48, 36608
 v_add_u32 v122, 0x8000, v122
 v_sub_u32 v14, v14, v26
 v_mfma_f32_16x16x32_bf16 v[140:143], a[124:127], v[92:95], v[140:143]
 buffer_load_dwordx4 v31, s[44:47], s35 offen lds
 v_add_u32 v14, s39, v14
 v_mfma_f32_16x16x32_bf16 v[144:147], a[64:67], v[32:35], 0
 s_waitcnt lgkmcnt(3)
 ds_read_b64_tr_b16 a[96:97], v122 offset:0
 ds_read_b64_tr_b16 a[98:99], v122 offset:2048
 v_subrev_u32 v26, 14, v14
 v_mfma_f32_16x16x32_bf16 v[144:147], a[68:71], v[36:39], v[144:147]
 s_add_u32 m0, s32, 38912
 ds_read_b64_tr_b16 a[100:101], v122 offset:4096
 v_cvt_pk_bf16_f32 v248, v248, v249
 v_mfma_f32_16x16x32_bf16 v[144:147], a[72:75], v[40:43], v[144:147]
 s_add_u32 s35, s48, 43776
 ds_read_b64_tr_b16 a[102:103], v122 offset:6144
 v_cvt_pk_bf16_f32 v249, v250, v251
 v_mfma_f32_16x16x32_bf16 v[144:147], a[76:79], v[44:47], v[144:147]
 buffer_load_dwordx4 v31, s[44:47], s35 offen lds
 v_mfma_f32_16x16x32_bf16 v[144:147], a[80:83], v[48:51], v[144:147]
 ds_read_b64_tr_b16 a[104:105], v122 offset:8192
 ds_read_b64_tr_b16 a[106:107], v122 offset:10240
 v_mfma_f32_16x16x32_bf16 v[144:147], a[84:87], v[52:55], v[144:147]
 s_waitcnt lgkmcnt(4)
 s_add_u32 m0, s32, 39936
 ds_read_b64_tr_b16 a[108:109], v122 offset:12288
 v_cvt_pk_bf16_f32 v250, v252, v253
 v_mfma_f32_16x16x32_bf16 v[144:147], a[88:91], v[56:59], v[144:147]
 s_add_u32 s35, s48, 50944
 ds_read_b64_tr_b16 a[110:111], v122 offset:14336
 v_min_u32 v14, v14, v26
 v_mfma_f32_16x16x32_bf16 v[144:147], a[92:95], v[60:63], v[144:147]
 buffer_load_dwordx4 v31, s[44:47], s35 offen lds
 v_mul_u32_u24 v15, 3584, v15
 v_mfma_f32_16x16x32_bf16 v[152:155], a[64:67], v[64:67], 0
 ds_read_b64_tr_b16 a[112:113], v122 offset:16384
 ds_read_b64_tr_b16 a[114:115], v122 offset:18432
 v_lshl_add_u32 v14, v14, 4, v15
 v_mfma_f32_16x16x32_bf16 v[152:155], a[68:71], v[68:71], v[152:155]
 ds_read_b64_tr_b16 a[116:117], v122 offset:20480
 ds_read_b64_tr_b16 a[118:119], v122 offset:22528
 v_subrev_u32 v5, 3072, v14
 v_mfma_f32_16x16x32_bf16 v[152:155], a[72:75], v[72:75], v[152:155]
 ds_read_b64_tr_b16 a[120:121], v122 offset:24576
 v_cvt_pk_bf16_f32 v251, v254, v255
 v_add_u32 v14, 256, v0
 v_mfma_f32_16x16x32_bf16 v[152:155], a[76:79], v[76:79], v[152:155]
 s_add_u32 s38, s51, 21504
 buffer_store_dwordx4 v[248:251], v1, s[16:19], s38 offen sc1
 v_mfma_f32_16x16x32_bf16 v[152:155], a[80:83], v[80:83], v[152:155]
 ds_read_b64_tr_b16 a[122:123], v122 offset:26624
 ds_read_b64_tr_b16 a[124:125], v122 offset:28672
 v_mul_hi_u32 v15, v14, s37
 v_mfma_f32_16x16x32_bf16 v[152:155], a[84:87], v[84:87], v[152:155]
 ds_read_b64_tr_b16 a[126:127], v122 offset:30720
 v_cvt_pk_bf16_f32 v128, v128, v129
 v_mul_u32_u24 v26, 14, v15
 v_mfma_f32_16x16x32_bf16 v[152:155], a[88:91], v[88:91], v[152:155]
 v_add_u32 v119, 0xfffe8000, v119
 v_cvt_pk_bf16_f32 v129, v130, v131
 v_sub_u32 v14, v14, v26
 v_mfma_f32_16x16x32_bf16 v[152:155], a[92:95], v[92:95], v[152:155]
 s_waitcnt vmcnt(14)
 s_barrier
 v_cvt_pk_bf16_f32 v130, v132, v133
 v_mfma_f32_16x16x32_bf16 v[148:151], a[96:99], v[32:35], 0
 s_waitcnt lgkmcnt(3)
 ds_read_b64_tr_b16 a[64:65], v119 offset:0
 ds_read_b64_tr_b16 a[66:67], v119 offset:2048
 v_add_u32 v14, s39, v14
 v_mfma_f32_16x16x32_bf16 v[148:151], a[100:103], v[36:39], v[148:151]
 ds_read_b64_tr_b16 a[68:69], v119 offset:4096
 v_cvt_pk_bf16_f32 v131, v134, v135
 v_mfma_f32_16x16x32_bf16 v[148:151], a[104:107], v[40:43], v[148:151]
 buffer_load_dwordx2 v[96:97], v106, s[52:55], 0 offen offset:0
 v_subrev_u32 v26, 14, v14
 v_mfma_f32_16x16x32_bf16 v[148:151], a[108:111], v[44:47], v[148:151]
 ds_read_b64_tr_b16 a[70:71], v119 offset:6144
 ds_read_b64_tr_b16 a[72:73], v119 offset:8192
 v_mfma_f32_16x16x32_bf16 v[148:151], a[112:115], v[48:51], v[148:151]
 s_add_u32 s38, s51, 8192
 buffer_store_dwordx4 v[128:131], v1, s[16:19], s38 offen sc1
 v_mfma_f32_16x16x32_bf16 v[148:151], a[116:119], v[52:55], v[148:151]
 s_waitcnt lgkmcnt(3)
 ds_read_b64_tr_b16 a[74:75], v119 offset:10240
 ds_read_b64_tr_b16 a[76:77], v119 offset:12288
 v_mfma_f32_16x16x32_bf16 v[148:151], a[120:123], v[56:59], v[148:151]
 ds_read_b64_tr_b16 a[78:79], v119 offset:14336
 v_cvt_pk_bf16_f32 v136, v136, v137
 v_mfma_f32_16x16x32_bf16 v[148:151], a[124:127], v[60:63], v[148:151]
 ds_read_b64_tr_b16 a[80:81], v119 offset:16384
 ds_read_b64_tr_b16 a[82:83], v119 offset:18432
 v_mfma_f32_16x16x32_bf16 v[156:159], a[96:99], v[64:67], 0
 ds_read_b64_tr_b16 a[84:85], v119 offset:20480
 v_cvt_pk_bf16_f32 v137, v138, v139
 v_mfma_f32_16x16x32_bf16 v[156:159], a[100:103], v[68:71], v[156:159]
 ds_read_b64_tr_b16 a[86:87], v119 offset:22528
 v_cvt_pk_bf16_f32 v138, v140, v141
 v_mfma_f32_16x16x32_bf16 v[156:159], a[104:107], v[72:75], v[156:159]
 ds_read_b64_tr_b16 a[88:89], v119 offset:24576
 v_cvt_pk_bf16_f32 v139, v142, v143
 v_mfma_f32_16x16x32_bf16 v[156:159], a[108:111], v[76:79], v[156:159]
 ds_read_b64_tr_b16 a[90:91], v119 offset:26624
 v_min_u32 v14, v14, v26
 v_mul_u32_u24 v15, 3584, v15
 v_mfma_f32_16x16x32_bf16 v[156:159], a[112:115], v[80:83], v[156:159]
 ds_read_b64_tr_b16 a[92:93], v119 offset:28672
 v_cvt_pk_bf16_f32 v144, v144, v145
 v_mfma_f32_16x16x32_bf16 v[156:159], a[116:119], v[84:87], v[156:159]
 s_add_u32 s38, s51, 22528
 buffer_store_dwordx4 v[136:139], v1, s[16:19], s38 offen sc1
 ds_read_b64_tr_b16 a[94:95], v119 offset:30720
 v_mfma_f32_16x16x32_bf16 v[156:159], a[120:123], v[88:91], v[156:159]
 v_add_u32 v120, 0xfffe8000, v120
 v_cvt_pk_bf16_f32 v145, v146, v147
 v_mfma_f32_16x16x32_bf16 v[156:159], a[124:127], v[92:95], v[156:159]
 v_lshl_add_u32 v14, v14, 4, v15
 v_subrev_u32 v6, 0, v14
 v_mfma_f32_16x16x32_bf16 v[160:163], a[64:67], v[32:35], 0
 s_waitcnt lgkmcnt(2)
 ds_read_b64_tr_b16 a[96:97], v120 offset:0
 ds_read_b64_tr_b16 a[98:99], v120 offset:2048
 v_mfma_f32_16x16x32_bf16 v[160:163], a[68:71], v[36:39], v[160:163]
 ds_read_b64_tr_b16 a[100:101], v120 offset:4096
 v_cvt_pk_bf16_f32 v146, v148, v149
 v_mfma_f32_16x16x32_bf16 v[160:163], a[72:75], v[40:43], v[160:163]
 ds_read_b64_tr_b16 a[102:103], v120 offset:6144
 v_add_u32 v14, 320, v0
 v_mfma_f32_16x16x32_bf16 v[160:163], a[76:79], v[44:47], v[160:163]
 ds_read_b64_tr_b16 a[104:105], v120 offset:8192
 v_cvt_pk_bf16_f32 v147, v150, v151
 v_mfma_f32_16x16x32_bf16 v[160:163], a[80:83], v[48:51], v[160:163]
 ds_read_b64_tr_b16 a[106:107], v120 offset:10240
 v_cvt_pk_bf16_f32 v152, v152, v153
 v_mfma_f32_16x16x32_bf16 v[160:163], a[84:87], v[52:55], v[160:163]
 ds_read_b64_tr_b16 a[108:109], v120 offset:12288
 v_mul_hi_u32 v15, v14, s37
 v_mul_u32_u24 v26, 14, v15
 v_mfma_f32_16x16x32_bf16 v[160:163], a[88:91], v[56:59], v[160:163]
 s_waitcnt lgkmcnt(4)
 s_add_u32 s38, s51, 9216
 buffer_store_dwordx4 v[144:147], v1, s[16:19], s38 offen sc1
 v_mfma_f32_16x16x32_bf16 v[160:163], a[92:95], v[60:63], v[160:163]
 ds_read_b64_tr_b16 a[110:111], v120 offset:14336
 ds_read_b64_tr_b16 a[112:113], v120 offset:16384
 v_sub_u32 v14, v14, v26
 v_mfma_f32_16x16x32_bf16 v[168:171], a[64:67], v[64:67], 0
 ds_read_b64_tr_b16 a[114:115], v120 offset:18432
 ds_read_b64_tr_b16 a[116:117], v120 offset:20480
 v_mfma_f32_16x16x32_bf16 v[168:171], a[68:71], v[68:71], v[168:171]
 ds_read_b64_tr_b16 a[118:119], v120 offset:22528
 v_cvt_pk_bf16_f32 v153, v154, v155
 v_mfma_f32_16x16x32_bf16 v[168:171], a[72:75], v[72:75], v[168:171]
 ds_read_b64_tr_b16 a[120:121], v120 offset:24576
 v_cvt_pk_bf16_f32 v154, v156, v157
 v_mfma_f32_16x16x32_bf16 v[168:171], a[76:79], v[76:79], v[168:171]
 ds_read_b64_tr_b16 a[122:123], v120 offset:26624
 v_add_u32 v14, s39, v14
 v_mfma_f32_16x16x32_bf16 v[168:171], a[80:83], v[80:83], v[168:171]
 ds_read_b64_tr_b16 a[124:125], v120 offset:28672
 v_cvt_pk_bf16_f32 v155, v158, v159
 v_mfma_f32_16x16x32_bf16 v[168:171], a[84:87], v[84:87], v[168:171]
 ds_read_b64_tr_b16 a[126:127], v120 offset:30720
 v_subrev_u32 v26, 14, v14
 v_mfma_f32_16x16x32_bf16 v[168:171], a[88:91], v[88:91], v[168:171]
 v_add_u32 v121, 0xfffe8000, v121
 v_min_u32 v14, v14, v26
 v_mfma_f32_16x16x32_bf16 v[168:171], a[92:95], v[92:95], v[168:171]
 s_add_u32 s38, s51, 23552
 buffer_store_dwordx4 v[152:155], v1, s[16:19], s38 offen sc1
 v_mfma_f32_16x16x32_bf16 v[164:167], a[96:99], v[32:35], 0
 s_waitcnt lgkmcnt(2)
 ds_read_b64_tr_b16 a[64:65], v121 offset:0
 ds_read_b64_tr_b16 a[66:67], v121 offset:2048
 v_mfma_f32_16x16x32_bf16 v[164:167], a[100:103], v[36:39], v[164:167]
 ds_read_b64_tr_b16 a[68:69], v121 offset:4096
 v_mul_u32_u24 v15, 3584, v15
 v_mfma_f32_16x16x32_bf16 v[164:167], a[104:107], v[40:43], v[164:167]
 ds_read_b64_tr_b16 a[70:71], v121 offset:6144
 v_lshl_add_u32 v14, v14, 4, v15
 v_mfma_f32_16x16x32_bf16 v[164:167], a[108:111], v[44:47], v[164:167]
 ds_read_b64_tr_b16 a[72:73], v121 offset:8192
 v_subrev_u32 v7, 1024, v14
 v_mfma_f32_16x16x32_bf16 v[164:167], a[112:115], v[48:51], v[164:167]
 ds_read_b64_tr_b16 a[74:75], v121 offset:10240
 v_add_u32 v14, 384, v0
 v_mfma_f32_16x16x32_bf16 v[164:167], a[116:119], v[52:55], v[164:167]
 ds_read_b64_tr_b16 a[76:77], v121 offset:12288
 v_mul_hi_u32 v15, v14, s37
 v_mfma_f32_16x16x32_bf16 v[164:167], a[120:123], v[56:59], v[164:167]
 s_waitcnt lgkmcnt(4)
 ds_read_b64_tr_b16 a[78:79], v121 offset:14336
 v_mul_u32_u24 v26, 14, v15
 v_mfma_f32_16x16x32_bf16 v[164:167], a[124:127], v[60:63], v[164:167]
 buffer_load_dwordx2 v[98:99], v106, s[52:55], 0 offen offset:256
 v_mfma_f32_16x16x32_bf16 v[172:175], a[96:99], v[64:67], 0
 ds_read_b64_tr_b16 a[80:81], v121 offset:16384
 ds_read_b64_tr_b16 a[82:83], v121 offset:18432
 v_mfma_f32_16x16x32_bf16 v[172:175], a[100:103], v[68:71], v[172:175]
 buffer_load_dwordx2 v[100:101], v106, s[52:55], 0 offen offset:512
 v_mfma_f32_16x16x32_bf16 v[172:175], a[104:107], v[72:75], v[172:175]
 ds_read_b64_tr_b16 a[84:85], v121 offset:20480
 ds_read_b64_tr_b16 a[86:87], v121 offset:22528
 v_mfma_f32_16x16x32_bf16 v[172:175], a[108:111], v[76:79], v[172:175]
 ds_read_b64_tr_b16 a[88:89], v121 offset:24576
 ds_read_b64_tr_b16 a[90:91], v121 offset:26624
 v_mfma_f32_16x16x32_bf16 v[172:175], a[112:115], v[80:83], v[172:175]
 ds_read_b64_tr_b16 a[92:93], v121 offset:28672
 v_cvt_pk_bf16_f32 v160, v160, v161
 v_mfma_f32_16x16x32_bf16 v[172:175], a[116:119], v[84:87], v[172:175]
 ds_read_b64_tr_b16 a[94:95], v121 offset:30720
 v_cvt_pk_bf16_f32 v161, v162, v163
 v_mfma_f32_16x16x32_bf16 v[172:175], a[120:123], v[88:91], v[172:175]
 v_add_u32 v122, 0xfffe8000, v122
 v_cvt_pk_bf16_f32 v162, v164, v165
 v_mfma_f32_16x16x32_bf16 v[172:175], a[124:127], v[92:95], v[172:175]
 v_cvt_pk_bf16_f32 v163, v166, v167
 v_sub_u32 v14, v14, v26
 v_add_u32 v14, s39, v14
 v_mfma_f32_16x16x32_bf16 v[176:179], a[64:67], v[32:35], 0
 s_waitcnt lgkmcnt(2)
 ds_read_b64_tr_b16 a[96:97], v122 offset:0
 ds_read_b64_tr_b16 a[98:99], v122 offset:2048
 v_mfma_f32_16x16x32_bf16 v[176:179], a[68:71], v[36:39], v[176:179]
 s_add_u32 s38, s51, 10240
 buffer_store_dwordx4 v[160:163], v1, s[16:19], s38 offen sc1
 v_mfma_f32_16x16x32_bf16 v[176:179], a[72:75], v[40:43], v[176:179]
 ds_read_b64_tr_b16 a[100:101], v122 offset:4096
 ds_read_b64_tr_b16 a[102:103], v122 offset:6144
 v_mfma_f32_16x16x32_bf16 v[176:179], a[76:79], v[44:47], v[176:179]
 ds_read_b64_tr_b16 a[104:105], v122 offset:8192
 v_subrev_u32 v26, 14, v14
 v_mfma_f32_16x16x32_bf16 v[176:179], a[80:83], v[48:51], v[176:179]
 ds_read_b64_tr_b16 a[106:107], v122 offset:10240
 v_cvt_pk_bf16_f32 v168, v168, v169
 v_mfma_f32_16x16x32_bf16 v[176:179], a[84:87], v[52:55], v[176:179]
 ds_read_b64_tr_b16 a[108:109], v122 offset:12288
 v_cvt_pk_bf16_f32 v169, v170, v171
 v_mfma_f32_16x16x32_bf16 v[176:179], a[88:91], v[56:59], v[176:179]
 s_waitcnt lgkmcnt(5)
 ds_read_b64_tr_b16 a[110:111], v122 offset:14336
 v_min_u32 v14, v14, v26
 v_mul_u32_u24 v15, 3584, v15
 v_mfma_f32_16x16x32_bf16 v[176:179], a[92:95], v[60:63], v[176:179]
 ds_read_b64_tr_b16 a[112:113], v122 offset:16384
 ds_read_b64_tr_b16 a[114:115], v122 offset:18432
 v_lshl_add_u32 v14, v14, 4, v15
 v_mfma_f32_16x16x32_bf16 v[184:187], a[64:67], v[64:67], 0
 ds_read_b64_tr_b16 a[116:117], v122 offset:20480
 v_cvt_pk_bf16_f32 v170, v172, v173
 v_mfma_f32_16x16x32_bf16 v[184:187], a[68:71], v[68:71], v[184:187]
 ds_read_b64_tr_b16 a[118:119], v122 offset:22528
 v_cvt_pk_bf16_f32 v171, v174, v175
 v_mfma_f32_16x16x32_bf16 v[184:187], a[72:75], v[72:75], v[184:187]
 s_add_u32 s38, s51, 24576
 buffer_store_dwordx4 v[168:171], v1, s[16:19], s38 offen sc1
 v_mfma_f32_16x16x32_bf16 v[184:187], a[76:79], v[76:79], v[184:187]
 ds_read_b64_tr_b16 a[120:121], v122 offset:24576
 ds_read_b64_tr_b16 a[122:123], v122 offset:26624
 v_mfma_f32_16x16x32_bf16 v[184:187], a[80:83], v[80:83], v[184:187]
 ds_read_b64_tr_b16 a[124:125], v122 offset:28672
 v_subrev_u32 v8, 2048, v14
 v_mfma_f32_16x16x32_bf16 v[184:187], a[84:87], v[84:87], v[184:187]
 s_and_b32 s39, s3, 1
 ds_read_b64_tr_b16 a[126:127], v122 offset:30720
 v_mfma_f32_16x16x32_bf16 v[184:187], a[88:91], v[88:91], v[184:187]
 s_mul_i32 s49, s39, 114688
 s_mul_i32 s39, s30, 224
 v_add_u32 v119, 0x8000, v119
 v_mfma_f32_16x16x32_bf16 v[184:187], a[92:95], v[92:95], v[184:187]
 s_waitcnt vmcnt(10)
 s_barrier
 v_mfma_f32_16x16x32_bf16 v[180:183], a[96:99], v[32:35], 0
 s_waitcnt lgkmcnt(2)
 s_add_u32 s49, s49, s39
 ds_read_b64_tr_b16 a[64:65], v119 offset:0
 ds_read_b64_tr_b16 a[66:67], v119 offset:2048
 v_lshrrev_b32 v14, 2, v0
 v_mfma_f32_16x16x32_bf16 v[180:183], a[100:103], v[36:39], v[180:183]
 ds_read_b64_tr_b16 a[68:69], v119 offset:4096
 v_mul_u32_u24 v14, 224, v14
 v_mfma_f32_16x16x32_bf16 v[180:183], a[104:107], v[40:43], v[180:183]
 buffer_load_dwordx2 v[102:103], v106, s[52:55], s28 offen offset:768
 v_mfma_f32_16x16x32_bf16 v[180:183], a[108:111], v[44:47], v[180:183]
 ds_read_b64_tr_b16 a[70:71], v119 offset:6144
 ds_read_b64_tr_b16 a[72:73], v119 offset:8192
 v_mfma_f32_16x16x32_bf16 v[180:183], a[112:115], v[48:51], v[180:183]
 ds_read_b64_tr_b16 a[74:75], v119 offset:10240
 v_and_b32 v15, 3, v0
 v_mfma_f32_16x16x32_bf16 v[180:183], a[116:119], v[52:55], v[180:183]
 ds_read_b64_tr_b16 a[76:77], v119 offset:12288
 v_lshl_add_u32 v14, v15, 3, v14
 v_mfma_f32_16x16x32_bf16 v[180:183], a[120:123], v[56:59], v[180:183]
 s_waitcnt lgkmcnt(4)
 ds_read_b64_tr_b16 a[78:79], v119 offset:14336
 v_add_u32 v9, 65536, v14
 v_mfma_f32_16x16x32_bf16 v[180:183], a[124:127], v[60:63], v[180:183]
 ds_read_b64_tr_b16 a[80:81], v119 offset:16384
 ds_read_b64_tr_b16 a[82:83], v119 offset:18432
 v_mfma_f32_16x16x32_bf16 v[188:191], a[96:99], v[64:67], 0
 ds_read_b64_tr_b16 a[84:85], v119 offset:20480
 v_add_u32 v23, s43, v14
 v_mfma_f32_16x16x32_bf16 v[188:191], a[100:103], v[68:71], v[188:191]
 ds_read_b64_tr_b16 a[86:87], v119 offset:22528
 v_add_u32 v24, 0x10000, v23
 v_mfma_f32_16x16x32_bf16 v[188:191], a[104:107], v[72:75], v[188:191]
 ds_read_b64_tr_b16 a[88:89], v119 offset:24576
 v_add_u32 v25, 0x20000, v23
 v_mfma_f32_16x16x32_bf16 v[188:191], a[108:111], v[76:79], v[188:191]
 ds_read_b64_tr_b16 a[90:91], v119 offset:26624
 v_mov_b32 v16, v112
 v_mfma_f32_16x16x32_bf16 v[188:191], a[112:115], v[80:83], v[188:191]
 ds_read_b64_tr_b16 a[92:93], v119 offset:28672
 v_cvt_pk_bf16_f32 v176, v176, v177
 v_mfma_f32_16x16x32_bf16 v[188:191], a[116:119], v[84:87], v[188:191]
 ds_read_b64_tr_b16 a[94:95], v119 offset:30720
 v_cvt_pk_bf16_f32 v177, v178, v179
 v_mfma_f32_16x16x32_bf16 v[188:191], a[120:123], v[88:91], v[188:191]
 v_add_u32 v120, 0x8000, v120
 v_cvt_pk_bf16_f32 v178, v180, v181
 v_mfma_f32_16x16x32_bf16 v[188:191], a[124:127], v[92:95], v[188:191]
 v_cvt_pk_bf16_f32 v179, v182, v183
 v_mov_b32 v17, v113
 v_mfma_f32_16x16x32_bf16 v[192:195], a[64:67], v[32:35], 0
 s_waitcnt lgkmcnt(2)
 ds_read_b64_tr_b16 a[96:97], v120 offset:0
 ds_read_b64_tr_b16 a[98:99], v120 offset:2048
 v_mfma_f32_16x16x32_bf16 v[192:195], a[68:71], v[36:39], v[192:195]
 s_add_u32 s38, s51, 11264
 buffer_store_dwordx4 v[176:179], v1, s[16:19], s38 offen sc1
 v_mfma_f32_16x16x32_bf16 v[192:195], a[72:75], v[40:43], v[192:195]
 ds_read_b64_tr_b16 a[100:101], v120 offset:4096
 ds_read_b64_tr_b16 a[102:103], v120 offset:6144
 v_mfma_f32_16x16x32_bf16 v[192:195], a[76:79], v[44:47], v[192:195]
 ds_read_b64_tr_b16 a[104:105], v120 offset:8192
 v_mov_b32 v18, v114
 v_mfma_f32_16x16x32_bf16 v[192:195], a[80:83], v[48:51], v[192:195]
 ds_read_b64_tr_b16 a[106:107], v120 offset:10240
 v_cvt_pk_bf16_f32 v184, v184, v185
 v_mfma_f32_16x16x32_bf16 v[192:195], a[84:87], v[52:55], v[192:195]
 ds_read_b64_tr_b16 a[108:109], v120 offset:12288
 v_cvt_pk_bf16_f32 v185, v186, v187
 v_mfma_f32_16x16x32_bf16 v[192:195], a[88:91], v[56:59], v[192:195]
 s_waitcnt lgkmcnt(5)
 ds_read_b64_tr_b16 a[110:111], v120 offset:14336
 v_mov_b32 v19, v115
 v_mov_b32 v20, v116
 v_mfma_f32_16x16x32_bf16 v[192:195], a[92:95], v[60:63], v[192:195]
 ds_read_b64_tr_b16 a[112:113], v120 offset:16384
 ds_read_b64_tr_b16 a[114:115], v120 offset:18432
 v_mov_b32 v21, v117
 v_mov_b32 v22, v118
 v_mfma_f32_16x16x32_bf16 v[200:203], a[64:67], v[64:67], 0
 s_lshl_b32 s23, s50, 8
 ds_read_b64_tr_b16 a[116:117], v120 offset:20480
 v_cvt_pk_bf16_f32 v186, v188, v189
 v_mfma_f32_16x16x32_bf16 v[200:203], a[68:71], v[68:71], v[200:203]
 s_add_u32 s23, s23, 150994944
 ds_read_b64_tr_b16 a[118:119], v120 offset:22528
 v_cvt_pk_bf16_f32 v187, v190, v191
 v_mfma_f32_16x16x32_bf16 v[200:203], a[72:75], v[72:75], v[200:203]
 s_add_u32 s38, s51, 25600
 buffer_store_dwordx4 v[184:187], v1, s[16:19], s38 offen sc1
 v_mfma_f32_16x16x32_bf16 v[200:203], a[76:79], v[76:79], v[200:203]
 ds_read_b64_tr_b16 a[120:121], v120 offset:24576
 ds_read_b64_tr_b16 a[122:123], v120 offset:26624
 v_mfma_f32_16x16x32_bf16 v[200:203], a[80:83], v[80:83], v[200:203]
 ds_read_b64_tr_b16 a[124:125], v120 offset:28672
 v_mfma_f32_16x16x32_bf16 v[200:203], a[84:87], v[84:87], v[200:203]
 ds_read_b64_tr_b16 a[126:127], v120 offset:30720
 v_mfma_f32_16x16x32_bf16 v[200:203], a[88:91], v[88:91], v[200:203]
 v_add_u32 v121, 0x8000, v121
 v_mfma_f32_16x16x32_bf16 v[200:203], a[92:95], v[92:95], v[200:203]
 s_lshl_b32 s22, s30, 4
 s_add_u32 s22, s22, s31
 s_lshl_b32 s22, s22, 8
 v_mfma_f32_16x16x32_bf16 v[196:199], a[96:99], v[32:35], 0
 s_waitcnt lgkmcnt(2)
 s_add_u32 s22, s22, 150994944
 ds_read_b64_tr_b16 a[64:65], v121 offset:0
 ds_read_b64_tr_b16 a[66:67], v121 offset:2048
 v_mfma_f32_16x16x32_bf16 v[196:199], a[100:103], v[36:39], v[196:199]
 s_add_u32 s20, s6, s22
 s_addc_u32 s21, s7, 0
 ds_read_b64_tr_b16 a[68:69], v121 offset:4096
 v_mfma_f32_16x16x32_bf16 v[196:199], a[104:107], v[40:43], v[196:199]
 s_and_b32 s39, s30, 3
 ds_read_b64_tr_b16 a[70:71], v121 offset:6144
 v_mfma_f32_16x16x32_bf16 v[196:199], a[108:111], v[44:47], v[196:199]
 s_mul_i32 s39, s39, 224
 ds_read_b64_tr_b16 a[72:73], v121 offset:8192
 v_mfma_f32_16x16x32_bf16 v[196:199], a[112:115], v[48:51], v[196:199]
 s_mul_i32 s42, s3, 401408
 ds_read_b64_tr_b16 a[74:75], v121 offset:10240
 v_mfma_f32_16x16x32_bf16 v[196:199], a[116:119], v[52:55], v[196:199]
 ds_read_b64_tr_b16 a[76:77], v121 offset:12288
 v_mfma_f32_16x16x32_bf16 v[196:199], a[120:123], v[56:59], v[196:199]
 s_waitcnt lgkmcnt(4)
 s_add_u32 s42, s42, s39
 ds_read_b64_tr_b16 a[78:79], v121 offset:14336
 v_mfma_f32_16x16x32_bf16 v[196:199], a[124:127], v[60:63], v[196:199]
 ds_read_b64_tr_b16 a[80:81], v121 offset:16384
 ds_read_b64_tr_b16 a[82:83], v121 offset:18432
 v_mfma_f32_16x16x32_bf16 v[204:207], a[96:99], v[64:67], 0
 ds_read_b64_tr_b16 a[84:85], v121 offset:20480
 v_mfma_f32_16x16x32_bf16 v[204:207], a[100:103], v[68:71], v[204:207]
 ds_read_b64_tr_b16 a[86:87], v121 offset:22528
 v_mfma_f32_16x16x32_bf16 v[204:207], a[104:107], v[72:75], v[204:207]
 s_load_dword s36, s[20:21], 16 glc
 ds_read_b64_tr_b16 a[88:89], v121 offset:24576
 v_mfma_f32_16x16x32_bf16 v[204:207], a[108:111], v[76:79], v[204:207]
 ds_read_b64_tr_b16 a[90:91], v121 offset:26624
 v_mfma_f32_16x16x32_bf16 v[204:207], a[112:115], v[80:83], v[204:207]
 ds_read_b64_tr_b16 a[92:93], v121 offset:28672
 v_cvt_pk_bf16_f32 v192, v192, v193
 v_mfma_f32_16x16x32_bf16 v[204:207], a[116:119], v[84:87], v[204:207]
 ds_read_b64_tr_b16 a[94:95], v121 offset:30720
 v_cvt_pk_bf16_f32 v193, v194, v195
 v_mfma_f32_16x16x32_bf16 v[204:207], a[120:123], v[88:91], v[204:207]
 v_add_u32 v122, 0x8000, v122
 v_cvt_pk_bf16_f32 v194, v196, v197
 v_mfma_f32_16x16x32_bf16 v[204:207], a[124:127], v[92:95], v[204:207]
 v_cvt_pk_bf16_f32 v195, v198, v199
 v_mfma_f32_16x16x32_bf16 v[208:211], a[64:67], v[32:35], 0
 s_waitcnt lgkmcnt(2)
 ds_read_b64_tr_b16 a[96:97], v122 offset:0
 ds_read_b64_tr_b16 a[98:99], v122 offset:2048
 v_mfma_f32_16x16x32_bf16 v[208:211], a[68:71], v[36:39], v[208:211]
 s_add_u32 s38, s51, 12288
 buffer_store_dwordx4 v[192:195], v1, s[16:19], s38 offen sc1
 v_mfma_f32_16x16x32_bf16 v[208:211], a[72:75], v[40:43], v[208:211]
 ds_read_b64_tr_b16 a[100:101], v122 offset:4096
 ds_read_b64_tr_b16 a[102:103], v122 offset:6144
 v_mfma_f32_16x16x32_bf16 v[208:211], a[76:79], v[44:47], v[208:211]
 ds_read_b64_tr_b16 a[104:105], v122 offset:8192
 v_mfma_f32_16x16x32_bf16 v[208:211], a[80:83], v[48:51], v[208:211]
 ds_read_b64_tr_b16 a[106:107], v122 offset:10240
 v_cvt_pk_bf16_f32 v200, v200, v201
 v_mfma_f32_16x16x32_bf16 v[208:211], a[84:87], v[52:55], v[208:211]
 ds_read_b64_tr_b16 a[108:109], v122 offset:12288
 v_cvt_pk_bf16_f32 v201, v202, v203
 v_mfma_f32_16x16x32_bf16 v[208:211], a[88:91], v[56:59], v[208:211]
 s_waitcnt lgkmcnt(5)
 ds_read_b64_tr_b16 a[110:111], v122 offset:14336
 v_mfma_f32_16x16x32_bf16 v[208:211], a[92:95], v[60:63], v[208:211]
 ds_read_b64_tr_b16 a[112:113], v122 offset:16384
 ds_read_b64_tr_b16 a[114:115], v122 offset:18432
 v_mfma_f32_16x16x32_bf16 v[216:219], a[64:67], v[64:67], 0
 ds_read_b64_tr_b16 a[116:117], v122 offset:20480
 v_cvt_pk_bf16_f32 v202, v204, v205
 v_mfma_f32_16x16x32_bf16 v[216:219], a[68:71], v[68:71], v[216:219]
 ds_read_b64_tr_b16 a[118:119], v122 offset:22528
 v_cvt_pk_bf16_f32 v203, v206, v207
 v_mfma_f32_16x16x32_bf16 v[216:219], a[72:75], v[72:75], v[216:219]
 s_add_u32 s38, s51, 26624
 buffer_store_dwordx4 v[200:203], v1, s[16:19], s38 offen sc1
 v_mfma_f32_16x16x32_bf16 v[216:219], a[76:79], v[76:79], v[216:219]
 ds_read_b64_tr_b16 a[120:121], v122 offset:24576
 ds_read_b64_tr_b16 a[122:123], v122 offset:26624
 v_mfma_f32_16x16x32_bf16 v[216:219], a[80:83], v[80:83], v[216:219]
 ds_read_b64_tr_b16 a[124:125], v122 offset:28672
 v_mfma_f32_16x16x32_bf16 v[216:219], a[84:87], v[84:87], v[216:219]
 ds_read_b64_tr_b16 a[126:127], v122 offset:30720
 v_mfma_f32_16x16x32_bf16 v[216:219], a[88:91], v[88:91], v[216:219]
 v_mfma_f32_16x16x32_bf16 v[216:219], a[92:95], v[92:95], v[216:219]
 v_mfma_f32_16x16x32_bf16 v[212:215], a[96:99], v[32:35], 0
 s_waitcnt lgkmcnt(2)
 v_mfma_f32_16x16x32_bf16 v[212:215], a[100:103], v[36:39], v[212:215]
 v_mfma_f32_16x16x32_bf16 v[212:215], a[104:107], v[40:43], v[212:215]
 v_mfma_f32_16x16x32_bf16 v[212:215], a[108:111], v[44:47], v[212:215]
 v_mfma_f32_16x16x32_bf16 v[212:215], a[112:115], v[48:51], v[212:215]
 v_mfma_f32_16x16x32_bf16 v[212:215], a[116:119], v[52:55], v[212:215]
 v_mfma_f32_16x16x32_bf16 v[212:215], a[120:123], v[56:59], v[212:215]
 s_waitcnt lgkmcnt(0)
 v_mfma_f32_16x16x32_bf16 v[212:215], a[124:127], v[60:63], v[212:215]
 v_mfma_f32_16x16x32_bf16 v[220:223], a[96:99], v[64:67], 0
 v_mfma_f32_16x16x32_bf16 v[220:223], a[100:103], v[68:71], v[220:223]
 v_mfma_f32_16x16x32_bf16 v[220:223], a[104:107], v[72:75], v[220:223]
 v_mfma_f32_16x16x32_bf16 v[220:223], a[108:111], v[76:79], v[220:223]
 v_mfma_f32_16x16x32_bf16 v[220:223], a[112:115], v[80:83], v[220:223]
 v_mfma_f32_16x16x32_bf16 v[220:223], a[116:119], v[84:87], v[220:223]
 v_mfma_f32_16x16x32_bf16 v[220:223], a[120:123], v[88:91], v[220:223]
 v_mfma_f32_16x16x32_bf16 v[220:223], a[124:127], v[92:95], v[220:223]
 v_cvt_pk_bf16_f32 v208, v208, v209
 v_cvt_pk_bf16_f32 v209, v210, v211
 v_cvt_pk_bf16_f32 v210, v212, v213
 v_cvt_pk_bf16_f32 v211, v214, v215
 s_add_u32 s38, s51, 13312
 buffer_store_dwordx4 v[208:211], v1, s[16:19], s38 offen sc1
 v_cvt_pk_bf16_f32 v216, v216, v217
 v_cvt_pk_bf16_f32 v217, v218, v219
 v_cvt_pk_bf16_f32 v218, v220, v221
 v_cvt_pk_bf16_f32 v219, v222, v223
 s_add_u32 s38, s51, 27648
 buffer_store_dwordx4 v[216:219], v1, s[16:19], s38 offen sc1
L_tail:
 s_mov_b32 s51, 0x5555
 s_lshr_b32 s37, s36, 1
 s_and_b32 s37, s37, s36
 s_and_b32 s37, s37, s51
 s_bcnt1_i32_b32 s38, s37
 s_cmp_ge_u32 s38, 3
 s_cselect_b32 s40, 1, 0
 s_cbranch_scc1 L_tfast
 s_add_u32 m0, s43, 65536
 s_add_u32 s35, s49, 0
 buffer_load_dwordx4 v2, s[8:11], s35 offen offset:0 lds
 buffer_load_dwordx4 v3, s[8:11], s35 offen offset:1024 lds
 buffer_load_dwordx4 v4, s[8:11], s35 offen offset:2048 lds
 buffer_load_dwordx4 v5, s[8:11], s35 offen offset:3072 lds
 s_add_u32 m0, s43, 69632
 s_add_u32 s35, s49, 0
 buffer_load_dwordx4 v6, s[8:11], s35 offen offset:0 lds
 buffer_load_dwordx4 v7, s[8:11], s35 offen offset:1024 lds
 buffer_load_dwordx4 v8, s[8:11], s35 offen offset:2048 lds
 s_waitcnt vmcnt(7)
 s_barrier
 buffer_atomic_add v11, v10, s[16:19], s23 offen offset:16 sc1
 s_cmp_lg_u32 s37, 0
 s_cbranch_scc0 L_ypoll0
L_ygot0:
 s_ff1_i32_b32 s36, s37
 s_bitset0_b32 s37, s36
 s_bitset0_b32 s51, s36
 s_mul_i32 s36, s36, 1835008
 s_add_u32 s36, s36, s27
 s_add_u32 s38, s36, 0
 buffer_load_dwordx4 v[128:131], v104, s[16:19], s38 offen sc1
 s_add_u32 s38, s36, 4096
 buffer_load_dwordx4 v[132:135], v104, s[16:19], s38 offen sc1
 s_add_u32 s38, s36, 8192
 buffer_load_dwordx4 v[136:139], v104, s[16:19], s38 offen sc1
 s_add_u32 s36, s36, s28
 s_add_u32 s38, s36, 12288
 buffer_load_dwordx4 v[140:143], v104, s[16:19], s38 offen sc1
 s_cmp_lg_u32 s37, 0
 s_cbranch_scc0 L_ypoll1
L_ygot1:
 s_ff1_i32_b32 s36, s37
 s_bitset0_b32 s37, s36
 s_bitset0_b32 s51, s36
 s_mul_i32 s36, s36, 1835008
 s_add_u32 s36, s36, s27
 s_add_u32 s38, s36, 0
 buffer_load_dwordx4 v[144:147], v104, s[16:19], s38 offen sc1
 s_add_u32 s38, s36, 4096
 buffer_load_dwordx4 v[148:151], v104, s[16:19], s38 offen sc1
 s_add_u32 s38, s36, 8192
 buffer_load_dwordx4 v[152:155], v104, s[16:19], s38 offen sc1
 s_add_u32 s36, s36, s28
 s_add_u32 s38, s36, 12288
 buffer_load_dwordx4 v[156:159], v104, s[16:19], s38 offen sc1
 s_cmp_lg_u32 s37, 0
 s_cbranch_scc0 L_ypoll2
L_ygot2:
 s_ff1_i32_b32 s36, s37
 s_bitset0_b32 s37, s36
 s_bitset0_b32 s51, s36
 s_mul_i32 s36, s36, 1835008
 s_add_u32 s36, s36, s27
 s_add_u32 s38, s36, 0
 buffer_load_dwordx4 v[160:163], v104, s[16:19], s38 offen sc1
 s_add_u32 s38, s36, 4096
 buffer_load_dwordx4 v[164:167], v104, s[16:19], s38 offen sc1
 s_add_u32 s38, s36, 8192
 buffer_load_dwordx4 v[168:171], v104, s[16:19], s38 offen sc1
 s_add_u32 s36, s36, s28
 s_add_u32 s38, s36, 12288
 buffer_load_dwordx4 v[172:175], v104, s[16:19], s38 offen sc1
L_tjoin:
 s_cmp_lg_u32 s37, 0
 s_cbranch_scc0 L_ypoll3
L_ygot3:
 s_ff1_i32_b32 s36, s37
 s_bitset0_b32 s37, s36
 s_bitset0_b32 s51, s36
 s_mul_i32 s36, s36, 1835008
 s_add_u32 s36, s36, s27
 s_add_u32 s38, s36, 0
 buffer_load_dwordx4 v[176:179], v104, s[16:19], s38 offen sc1
 s_add_u32 s38, s36, 4096
 buffer_load_dwordx4 v[180:183], v104, s[16:19], s38 offen sc1
 s_add_u32 s38, s36, 8192
 buffer_load_dwordx4 v[184:187], v104, s[16:19], s38 offen sc1
 s_add_u32 s36, s36, s28
 s_add_u32 s38, s36, 12288
 buffer_load_dwordx4 v[188:191], v104, s[16:19], s38 offen sc1
 s_waitcnt vmcnt(15)
 v_lshlrev_b32 v32, 16, v128
 v_and_b32 v33, 0xffff0000, v128
 v_lshlrev_b32 v34, 16, v129
 v_and_b32 v35, 0xffff0000, v129
 v_lshlrev_b32 v36, 16, v130
 v_and_b32 v37, 0xffff0000, v130
 v_lshlrev_b32 v38, 16, v131
 v_and_b32 v39, 0xffff0000, v131
 s_waitcnt vmcnt(14)
 v_lshlrev_b32 v40, 16, v132
 v_and_b32 v41, 0xffff0000, v132
 v_lshlrev_b32 v42, 16, v133
 v_and_b32 v43, 0xffff0000, v133
 v_lshlrev_b32 v44, 16, v134
 v_and_b32 v45, 0xffff0000, v134
 v_lshlrev_b32 v46, 16, v135
 v_and_b32 v47, 0xffff0000, v135
 s_waitcnt vmcnt(13)
 v_lshlrev_b32 v48, 16, v136
 v_and_b32 v49, 0xffff0000, v136
 v_lshlrev_b32 v50, 16, v137
 v_and_b32 v51, 0xffff0000, v137
 v_lshlrev_b32 v52, 16, v138
 v_and_b32 v53, 0xffff0000, v138
 v_lshlrev_b32 v54, 16, v139
 v_and_b32 v55, 0xffff0000, v139
 s_waitcnt vmcnt(12)
 v_lshlrev_b32 v56, 16, v140
 v_and_b32 v57, 0xffff0000, v140
 v_lshlrev_b32 v58, 16, v141
 v_and_b32 v59, 0xffff0000, v141
 v_lshlrev_b32 v60, 16, v142
 v_and_b32 v61, 0xffff0000, v142
 v_lshlrev_b32 v62, 16, v143
 v_and_b32 v63, 0xffff0000, v143
 s_cmp_lg_u32 s37, 0
 s_cbranch_scc0 L_ypoll4
L_ygot4:
 s_ff1_i32_b32 s36, s37
 s_bitset0_b32 s37, s36
 s_bitset0_b32 s51, s36
 s_mul_i32 s36, s36, 1835008
 s_add_u32 s36, s36, s27
 s_add_u32 s38, s36, 0
 buffer_load_dwordx4 v[192:195], v104, s[16:19], s38 offen sc1
 s_add_u32 s38, s36, 4096
 buffer_load_dwordx4 v[196:199], v104, s[16:19], s38 offen sc1
 s_add_u32 s38, s36, 8192
 buffer_load_dwordx4 v[200:203], v104, s[16:19], s38 offen sc1
 s_add_u32 s36, s36, s28
 s_add_u32 s38, s36, 12288
 buffer_load_dwordx4 v[204:207], v104, s[16:19], s38 offen sc1
 s_waitcnt vmcnt(15)
 v_dot2_f32_bf16 v32, v144, s33, v32
 v_dot2_f32_bf16 v33, v144, s34, v33
 v_dot2_f32_bf16 v34, v145, s33, v34
 v_dot2_f32_bf16 v35, v145, s34, v35
 v_dot2_f32_bf16 v36, v146, s33, v36
 v_dot2_f32_bf16 v37, v146, s34, v37
 v_dot2_f32_bf16 v38, v147, s33, v38
 v_dot2_f32_bf16 v39, v147, s34, v39
 s_waitcnt vmcnt(14)
 v_dot2_f32_bf16 v40, v148, s33, v40
 v_dot2_f32_bf16 v41, v148, s34, v41
 v_dot2_f32_bf16 v42, v149, s33, v42
 v_dot2_f32_bf16 v43, v149, s34, v43
 v_dot2_f32_bf16 v44, v150, s33, v44
 v_dot2_f32_bf16 v45, v150, s34, v45
 v_dot2_f32_bf16 v46, v151, s33, v46
 v_dot2_f32_bf16 v47, v151, s34, v47
 s_waitcnt vmcnt(13)
 v_dot2_f32_bf16 v48, v152, s33, v48
 v_dot2_f32_bf16 v49, v152, s34, v49
 v_dot2_f32_bf16 v50, v153, s33, v50
 v_dot2_f32_bf16 v51, v153, s34, v51
 v_dot2_f32_bf16 v52, v154, s33, v52
 v_dot2_f32_bf16 v53, v154, s34, v53
 v_dot2_f32_bf16 v54, v155, s33, v54
 v_dot2_f32_bf16 v55, v155, s34, v55
 s_waitcnt vmcnt(12)
 v_dot2_f32_bf16 v56, v156, s33, v56
 v_dot2_f32_bf16 v57, v156, s34, v57
 v_dot2_f32_bf16 v58, v157, s33, v58
 v_dot2_f32_bf16 v59, v157, s34, v59
 v_dot2_f32_bf16 v60, v158, s33, v60
 v_dot2_f32_bf16 v61, v158, s34, v61
 v_dot2_f32_bf16 v62, v159, s33, v62
 v_dot2_f32_bf16 v63, v159, s34, v63
 s_cmp_lg_u32 s37, 0
 s_cbranch_scc0 L_ypoll5
L_ygot5:
 s_ff1_i32_b32 s36, s37
 s_bitset0_b32 s37, s36
 s_bitset0_b32 s51, s36
 s_mul_i32 s36, s36, 1835008
 s_add_u32 s36, s36, s27
 s_add_u32 s38, s36, 0
 buffer_load_dwordx4 v[208:211], v104, s[16:19], s38 offen sc1
 s_add_u32 s38, s36, 4096
 buffer_load_dwordx4 v[212:215], v104, s[16:19], s38 offen sc1
 s_add_u32 s38, s36, 8192
 buffer_load_dwordx4 v[216:219], v104, s[16:19], s38 offen sc1
 s_add_u32 s36, s36, s28
 s_add_u32 s38, s36, 12288
 buffer_load_dwordx4 v[220:223], v104, s[16:19], s38 offen sc1
 s_waitcnt vmcnt(15)
 v_dot2_f32_bf16 v32, v160, s33, v32
 v_dot2_f32_bf16 v33, v160, s34, v33
 v_dot2_f32_bf16 v34, v161, s33, v34
 v_dot2_f32_bf16 v35, v161, s34, v35
 v_dot2_f32_bf16 v36, v162, s33, v36
 v_dot2_f32_bf16 v37, v162, s34, v37
 v_dot2_f32_bf16 v38, v163, s33, v38
 v_dot2_f32_bf16 v39, v163, s34, v39
 s_waitcnt vmcnt(14)
 v_dot2_f32_bf16 v40, v164, s33, v40
 v_dot2_f32_bf16 v41, v164, s34, v41
 v_dot2_f32_bf16 v42, v165, s33, v42
 v_dot2_f32_bf16 v43, v165, s34, v43
 v_dot2_f32_bf16 v44, v166, s33, v44
 v_dot2_f32_bf16 v45, v166, s34, v45
 v_dot2_f32_bf16 v46, v167, s33, v46
 v_dot2_f32_bf16 v47, v167, s34, v47
 s_waitcnt vmcnt(13)
 v_dot2_f32_bf16 v48, v168, s33, v48
 v_dot2_f32_bf16 v49, v168, s34, v49
 v_dot2_f32_bf16 v50, v169, s33, v50
 v_dot2_f32_bf16 v51, v169, s34, v51
 v_dot2_f32_bf16 v52, v170, s33, v52
 v_dot2_f32_bf16 v53, v170, s34, v53
 v_dot2_f32_bf16 v54, v171, s33, v54
 v_dot2_f32_bf16 v55, v171, s34, v55
 s_waitcnt vmcnt(12)
 v_dot2_f32_bf16 v56, v172, s33, v56
 v_dot2_f32_bf16 v57, v172, s34, v57
 v_dot2_f32_bf16 v58, v173, s33, v58
 v_dot2_f32_bf16 v59, v173, s34, v59
 v_dot2_f32_bf16 v60, v174, s33, v60
 v_dot2_f32_bf16 v61, v174, s34, v61
 v_dot2_f32_bf16 v62, v175, s33, v62
 v_dot2_f32_bf16 v63, v175, s34, v63
 s_cmp_lg_u32 s37, 0
 s_cbranch_scc0 L_ypoll6
L_ygot6:
 s_ff1_i32_b32 s36, s37
 s_bitset0_b32 s37, s36
 s_bitset0_b32 s51, s36
 s_mul_i32 s36, s36, 1835008
 s_add_u32 s36, s36, s27
 s_add_u32 s38, s36, 0
 buffer_load_dwordx4 v[224:227], v104, s[16:19], s38 offen sc1
 s_add_u32 s38, s36, 4096
 buffer_load_dwordx4 v[228:231], v104, s[16:19], s38 offen sc1
 s_add_u32 s38, s36, 8192
 buffer_load_dwordx4 v[232:235], v104, s[16:19], s38 offen sc1
 s_add_u32 s36, s36, s28
 s_add_u32 s38, s36, 12288
 buffer_load_dwordx4 v[236:239], v104, s[16:19], s38 offen sc1
 s_waitcnt vmcnt(15)
 v_dot2_f32_bf16 v32, v176, s33, v32
 v_dot2_f32_bf16 v33, v176, s34, v33
 v_dot2_f32_bf16 v34, v177, s33, v34
 v_dot2_f32_bf16 v35, v177, s34, v35
 v_dot2_f32_bf16 v36, v178, s33, v36
 v_dot2_f32_bf16 v37, v178, s34, v37
 v_dot2_f32_bf16 v38, v179, s33, v38
 v_dot2_f32_bf16 v39, v179, s34, v39
 s_waitcnt vmcnt(14)
 v_dot2_f32_bf16 v40, v180, s33, v40
 v_dot2_f32_bf16 v41, v180, s34, v41
 v_dot2_f32_bf16 v42, v181, s33, v42
 v_dot2_f32_bf16 v43, v181, s34, v43
 v_dot2_f32_bf16 v44, v182, s33, v44
 v_dot2_f32_bf16 v45, v182, s34, v45
 v_dot2_f32_bf16 v46, v183, s33, v46
 v_dot2_f32_bf16 v47, v183, s34, v47
 s_waitcnt vmcnt(13)
 v_dot2_f32_bf16 v48, v184, s33, v48
 v_dot2_f32_bf16 v49, v184, s34, v49
 v_dot2_f32_bf16 v50, v185, s33, v50
 v_dot2_f32_bf16 v51, v185, s34, v51
 v_dot2_f32_bf16 v52, v186, s33, v52
 v_dot2_f32_bf16 v53, v186, s34, v53
 v_dot2_f32_bf16 v54, v187, s33, v54
 v_dot2_f32_bf16 v55, v187, s34, v55
 s_waitcnt vmcnt(12)
 v_dot2_f32_bf16 v56, v188, s33, v56
 v_dot2_f32_bf16 v57, v188, s34, v57
 v_dot2_f32_bf16 v58, v189, s33, v58
 v_dot2_f32_bf16 v59, v189, s34, v59
 v_dot2_f32_bf16 v60, v190, s33, v60
 v_dot2_f32_bf16 v61, v190, s34, v61
 v_dot2_f32_bf16 v62, v191, s33, v62
 v_dot2_f32_bf16 v63, v191, s34, v63
 s_cmp_lg_u32 s37, 0
 s_cbranch_scc0 L_ypoll7
L_ygot7:
 s_ff1_i32_b32 s36, s37
 s_bitset0_b32 s37, s36
 s_bitset0_b32 s51, s36
 s_mul_i32 s36, s36, 1835008
 s_add_u32 s36, s36, s27
 s_add_u32 s38, s36, 0
 buffer_load_dwordx4 v[240:243], v104, s[16:19], s38 offen sc1
 s_add_u32 s38, s36, 4096
 buffer_load_dwordx4 v[244:247], v104, s[16:19], s38 offen sc1
 s_add_u32 s38, s36, 8192
 buffer_load_dwordx4 v[248:251], v104, s[16:19], s38 offen sc1
 s_add_u32 s36, s36, s28
 s_add_u32 s38, s36, 12288
 buffer_load_dwordx4 v[252:255], v104, s[16:19], s38 offen sc1
 s_sub_u32 s27, s27, 50331648
 s_mov_b32 s24, s30
 s_mov_b32 s50, s31
 s_lshl_b32 s23, s50, 8
 s_add_u32 s23, s23, 150994944
 s_lshl_b32 s38, 1, s24
 v_mov_b32 v11, s38
 s_cmp_eq_u32 s40, 1
 s_cbranch_scc1 L_tfb0
L_tfb0r:
 s_waitcnt vmcnt(15)
 v_dot2_f32_bf16 v32, v192, s33, v32
 v_dot2_f32_bf16 v33, v192, s34, v33
 v_dot2_f32_bf16 v34, v193, s33, v34
 v_dot2_f32_bf16 v35, v193, s34, v35
 v_dot2_f32_bf16 v36, v194, s33, v36
 v_dot2_f32_bf16 v37, v194, s34, v37
 v_dot2_f32_bf16 v38, v195, s33, v38
 v_dot2_f32_bf16 v39, v195, s34, v39
 s_waitcnt vmcnt(14)
 v_dot2_f32_bf16 v40, v196, s33, v40
 v_dot2_f32_bf16 v41, v196, s34, v41
 v_dot2_f32_bf16 v42, v197, s33, v42
 v_dot2_f32_bf16 v43, v197, s34, v43
 v_dot2_f32_bf16 v44, v198, s33, v44
 v_dot2_f32_bf16 v45, v198, s34, v45
 v_dot2_f32_bf16 v46, v199, s33, v46
 s_add_u32 m0, s43, 98304
 s_add_u32 s35, s49, 229376
 buffer_load_dwordx4 v2, s[8:11], s35 offen offset:0 lds
 v_dot2_f32_bf16 v47, v199, s34, v47
 s_waitcnt vmcnt(14)
 v_dot2_f32_bf16 v48, v200, s33, v48
 v_dot2_f32_bf16 v49, v200, s34, v49
 v_dot2_f32_bf16 v50, v201, s33, v50
 v_dot2_f32_bf16 v51, v201, s34, v51
 v_dot2_f32_bf16 v52, v202, s33, v52
 v_dot2_f32_bf16 v53, v202, s34, v53
 v_dot2_f32_bf16 v54, v203, s33, v54
 v_dot2_f32_bf16 v55, v203, s34, v55
 s_waitcnt vmcnt(13)
 v_dot2_f32_bf16 v56, v204, s33, v56
 v_dot2_f32_bf16 v57, v204, s34, v57
 v_dot2_f32_bf16 v58, v205, s33, v58
 v_dot2_f32_bf16 v59, v205, s34, v59
 v_dot2_f32_bf16 v60, v206, s33, v60
 v_dot2_f32_bf16 v61, v206, s34, v61
 buffer_load_dwordx4 v3, s[8:11], s35 offen offset:1024 lds
 v_dot2_f32_bf16 v62, v207, s33, v62
 v_dot2_f32_bf16 v63, v207, s34, v63
 s_waitcnt vmcnt(13)
 v_dot2_f32_bf16 v32, v208, s33, v32
 v_dot2_f32_bf16 v33, v208, s34, v33
 v_dot2_f32_bf16 v34, v209, s33, v34
 v_dot2_f32_bf16 v35, v209, s34, v35
 v_dot2_f32_bf16 v36, v210, s33, v36
 v_dot2_f32_bf16 v37, v210, s34, v37
 v_dot2_f32_bf16 v38, v211, s33, v38
 v_dot2_f32_bf16 v39, v211, s34, v39
 s_waitcnt vmcnt(12)
 v_dot2_f32_bf16 v40, v212, s33, v40
 v_dot2_f32_bf16 v41, v212, s34, v41
 v_dot2_f32_bf16 v42, v213, s33, v42
 v_dot2_f32_bf16 v43, v213, s34, v43
 v_dot2_f32_bf16 v44, v214, s33, v44
 buffer_load_dwordx4 v4, s[8:11], s35 offen offset:2048 lds
 v_dot2_f32_bf16 v45, v214, s34, v45
 v_dot2_f32_bf16 v46, v215, s33, v46
 v_dot2_f32_bf16 v47, v215, s34, v47
 s_waitcnt vmcnt(12)
 v_dot2_f32_bf16 v48, v216, s33, v48
 v_dot2_f32_bf16 v49, v216, s34, v49
 v_dot2_f32_bf16 v50, v217, s33, v50
 v_dot2_f32_bf16 v51, v217, s34, v51
 v_dot2_f32_bf16 v52, v218, s33, v52
 v_dot2_f32_bf16 v53, v218, s34, v53
 v_dot2_f32_bf16 v54, v219, s33, v54
 v_dot2_f32_bf16 v55, v219, s34, v55
 s_waitcnt vmcnt(11)
 v_dot2_f32_bf16 v56, v220, s33, v56
 v_dot2_f32_bf16 v57, v220, s34, v57
 v_dot2_f32_bf16 v58, v221, s33, v58
 v_dot2_f32_bf16 v59, v221, s34, v59
 buffer_load_dwordx4 v5, s[8:11], s35 offen offset:3072 lds
 v_dot2_f32_bf16 v60, v222, s33, v60
 v_dot2_f32_bf16 v61, v222, s34, v61
 v_dot2_f32_bf16 v62, v223, s33, v62
 v_dot2_f32_bf16 v63, v223, s34, v63
 s_waitcnt vmcnt(11)
 v_dot2_f32_bf16 v32, v224, s33, v32
 v_dot2_f32_bf16 v33, v224, s34, v33
 v_dot2_f32_bf16 v34, v225, s33, v34
 v_dot2_f32_bf16 v35, v225, s34, v35
 v_dot2_f32_bf16 v36, v226, s33, v36
 v_dot2_f32_bf16 v37, v226, s34, v37
 v_dot2_f32_bf16 v38, v227, s33, v38
 v_dot2_f32_bf16 v39, v227, s34, v39
 s_waitcnt vmcnt(10)
 v_dot2_f32_bf16 v40, v228, s33, v40
 v_dot2_f32_bf16 v41, v228, s34, v41
 v_dot2_f32_bf16 v42, v229, s33, v42
 s_add_u32 m0, s43, 102400
 s_add_u32 s35, s49, 229376
 buffer_load_dwordx4 v6, s[8:11], s35 offen offset:0 lds
 v_dot2_f32_bf16 v43, v229, s34, v43
 v_dot2_f32_bf16 v44, v230, s33, v44
 v_dot2_f32_bf16 v45, v230, s34, v45
 v_dot2_f32_bf16 v46, v231, s33, v46
 v_dot2_f32_bf16 v47, v231, s34, v47
 s_waitcnt vmcnt(10)
 v_dot2_f32_bf16 v48, v232, s33, v48
 v_dot2_f32_bf16 v49, v232, s34, v49
 v_dot2_f32_bf16 v50, v233, s33, v50
 v_dot2_f32_bf16 v51, v233, s34, v51
 v_dot2_f32_bf16 v52, v234, s33, v52
 v_dot2_f32_bf16 v53, v234, s34, v53
 v_dot2_f32_bf16 v54, v235, s33, v54
 v_dot2_f32_bf16 v55, v235, s34, v55
 s_waitcnt vmcnt(9)
 v_dot2_f32_bf16 v56, v236, s33, v56
 v_dot2_f32_bf16 v57, v236, s34, v57
 buffer_load_dwordx4 v7, s[8:11], s35 offen offset:1024 lds
 v_dot2_f32_bf16 v58, v237, s33, v58
 v_dot2_f32_bf16 v59, v237, s34, v59
 v_dot2_f32_bf16 v60, v238, s33, v60
 v_dot2_f32_bf16 v61, v238, s34, v61
 v_dot2_f32_bf16 v62, v239, s33, v62
 v_dot2_f32_bf16 v63, v239, s34, v63
 s_waitcnt vmcnt(9)
 v_dot2_f32_bf16 v32, v240, s33, v32
 v_dot2_f32_bf16 v33, v240, s34, v33
 v_dot2_f32_bf16 v34, v241, s33, v34
 v_dot2_f32_bf16 v35, v241, s34, v35
 v_dot2_f32_bf16 v36, v242, s33, v36
 v_dot2_f32_bf16 v37, v242, s34, v37
 v_dot2_f32_bf16 v38, v243, s33, v38
 v_dot2_f32_bf16 v39, v243, s34, v39
 s_waitcnt vmcnt(8)
 v_dot2_f32_bf16 v40, v244, s33, v40
 buffer_load_dwordx4 v8, s[8:11], s35 offen offset:2048 lds
 v_dot2_f32_bf16 v41, v244, s34, v41
 v_dot2_f32_bf16 v42, v245, s33, v42
 v_dot2_f32_bf16 v43, v245, s34, v43
 v_dot2_f32_bf16 v44, v246, s33, v44
 v_dot2_f32_bf16 v45, v246, s34, v45
 v_dot2_f32_bf16 v46, v247, s33, v46
 v_dot2_f32_bf16 v47, v247, s34, v47
 s_waitcnt vmcnt(8)
 v_dot2_f32_bf16 v48, v248, s33, v48
 v_dot2_f32_bf16 v49, v248, s34, v49
 v_dot2_f32_bf16 v50, v249, s33, v50
 v_dot2_f32_bf16 v51, v249, s34, v51
 v_dot2_f32_bf16 v52, v250, s33, v52
 v_dot2_f32_bf16 v53, v250, s34, v53
 v_dot2_f32_bf16 v54, v251, s33, v54
 v_dot2_f32_bf16 v55, v251, s34, v55
 s_waitcnt vmcnt(7)
 v_dot2_f32_bf16 v56, v252, s33, v56
 v_dot2_f32_bf16 v57, v252, s34, v57
 v_dot2_f32_bf16 v58, v253, s33, v58
 v_dot2_f32_bf16 v59, v253, s34, v59
 v_dot2_f32_bf16 v60, v254, s33, v60
 v_dot2_f32_bf16 v61, v254, s34, v61
 v_dot2_f32_bf16 v62, v255, s33, v62
 v_dot2_f32_bf16 v63, v255, s34, v63
 v_permlane32_swap_b32 v32, v36
 v_permlane32_swap_b32 v33, v37
 v_permlane32_swap_b32 v34, v38
 v_permlane32_swap_b32 v35, v39
 v_permlane32_swap_b32 v40, v44
 v_permlane32_swap_b32 v41, v45
 v_permlane32_swap_b32 v42, v46
 v_permlane32_swap_b32 v43, v47
 v_permlane32_swap_b32 v48, v52
 v_permlane32_swap_b32 v49, v53
 v_permlane32_swap_b32 v50, v54
 v_permlane32_swap_b32 v51, v55
 v_permlane32_swap_b32 v56, v60
 v_permlane32_swap_b32 v57, v61
 v_permlane32_swap_b32 v58, v62
 s_add_u32 m0, s43, 32768
 s_add_u32 s35, s42, 0
 buffer_load_dwordx4 v16, s[12:15], s35 offen offset:0 lds
 v_permlane32_swap_b32 v59, v63
 v_pk_add_f32 v[64:65], v[32:33], v[36:37]
 v_pk_add_f32 v[66:67], v[34:35], v[38:39]
 v_pk_add_f32 v[68:69], v[40:41], v[44:45]
 v_pk_add_f32 v[70:71], v[42:43], v[46:47]
 v_pk_add_f32 v[72:73], v[48:49], v[52:53]
 v_pk_add_f32 v[74:75], v[50:51], v[54:55]
 v_pk_add_f32 v[76:77], v[56:57], v[60:61]
 v_pk_add_f32 v[78:79], v[58:59], v[62:63]
 v_cvt_pk_bf16_f32 v32, v64, v65
 v_cvt_pk_bf16_f32 v33, v66, v67
 v_cvt_pk_bf16_f32 v34, v68, v69
 v_cvt_pk_bf16_f32 v35, v70, v71
 v_cvt_pk_bf16_f32 v36, v72, v73
 v_cvt_pk_bf16_f32 v37, v74, v75
 buffer_load_dwordx4 v17, s[12:15], s35 offen offset:1024 lds
 v_cvt_pk_bf16_f32 v38, v76, v77
 v_cvt_pk_bf16_f32 v39, v78, v79
 v_lshlrev_b32 v64, 16, v96
 v_and_b32 v65, 0xffff0000, v96
 v_lshlrev_b32 v66, 16, v97
 v_and_b32 v67, 0xffff0000, v97
 v_lshlrev_b32 v68, 16, v98
 v_and_b32 v69, 0xffff0000, v98
 v_lshlrev_b32 v70, 16, v99
 v_and_b32 v71, 0xffff0000, v99
 v_lshlrev_b32 v72, 16, v100
 v_and_b32 v73, 0xffff0000, v100
 v_lshlrev_b32 v74, 16, v101
 v_and_b32 v75, 0xffff0000, v101
 v_lshlrev_b32 v76, 16, v102
 buffer_load_dwordx4 v18, s[12:15], s35 offen offset:2048 lds
 v_and_b32 v77, 0xffff0000, v102
 v_lshlrev_b32 v78, 16, v103
 v_and_b32 v79, 0xffff0000, v103
 v_dot2_f32_bf16 v64, v32, s33, v64
 v_dot2_f32_bf16 v65, v32, s34, v65
 v_dot2_f32_bf16 v66, v33, s33, v66
 v_dot2_f32_bf16 v67, v33, s34, v67
 v_dot2_f32_bf16 v68, v34, s33, v68
 v_dot2_f32_bf16 v69, v34, s34, v69
 v_dot2_f32_bf16 v70, v35, s33, v70
 v_dot2_f32_bf16 v71, v35, s34, v71
 v_dot2_f32_bf16 v72, v36, s33, v72
 v_dot2_f32_bf16 v73, v36, s34, v73
 v_dot2_f32_bf16 v74, v37, s33, v74
 v_dot2_f32_bf16 v75, v37, s34, v75
 buffer_load_dwordx4 v19, s[12:15], s35 offen offset:3072 lds
 v_dot2_f32_bf16 v76, v38, s33, v76
 v_dot2_f32_bf16 v77, v38, s34, v77
 v_dot2_f32_bf16 v78, v39, s33, v78
 v_dot2_f32_bf16 v79, v39, s34, v79
 v_cvt_pk_bf16_f32 v82, v64, v65
 v_cvt_pk_bf16_f32 v83, v66, v67
 v_cvt_pk_bf16_f32 v86, v68, v69
 v_cvt_pk_bf16_f32 v87, v70, v71
 v_cvt_pk_bf16_f32 v90, v72, v73
 v_cvt_pk_bf16_f32 v91, v74, v75
 v_cvt_pk_bf16_f32 v94, v76, v77
 v_cvt_pk_bf16_f32 v95, v78, v79
 v_lshlrev_b32 v64, 16, v82
 v_and_b32 v65, 0xffff0000, v82
 v_lshlrev_b32 v66, 16, v83
 s_add_u32 m0, s43, 36864
 s_add_u32 s35, s42, 0
 buffer_load_dwordx4 v20, s[12:15], s35 offen offset:0 lds
 v_and_b32 v67, 0xffff0000, v83
 v_lshlrev_b32 v68, 16, v86
 v_and_b32 v69, 0xffff0000, v86
 v_lshlrev_b32 v70, 16, v87
 v_and_b32 v71, 0xffff0000, v87
 v_lshlrev_b32 v72, 16, v90
 v_and_b32 v73, 0xffff0000, v90
 v_lshlrev_b32 v74, 16, v91
 v_and_b32 v75, 0xffff0000, v91
 v_lshlrev_b32 v76, 16, v94
 v_and_b32 v77, 0xffff0000, v94
 v_lshlrev_b32 v78, 16, v95
 v_and_b32 v79, 0xffff0000, v95
 v_pk_add_f32 v[32:33], v[64:65], v[66:67]
 v_pk_add_f32 v[32:33], v[32:33], v[68:69]
 buffer_load_dwordx4 v21, s[12:15], s35 offen offset:1024 lds
 v_pk_add_f32 v[32:33], v[32:33], v[70:71]
 v_pk_add_f32 v[32:33], v[32:33], v[72:73]
 v_pk_add_f32 v[32:33], v[32:33], v[74:75]
 v_pk_add_f32 v[32:33], v[32:33], v[76:77]
 v_pk_add_f32 v[32:33], v[32:33], v[78:79]
 v_add_f32 v32, v32, v33
 s_nop 1
 v_add_f32_dpp v32, v32, v32 row_ror:8 row_mask:0xf bank_mask:0xf
 v_mov_b32 v12, v32
 s_nop 1
 v_permlane16_swap_b32 v32, v12
 v_add_f32 v32, v32, v12
 v_mov_b32 v12, v32
 s_nop 1
 v_permlane32_swap_b32 v32, v12
 v_add_f32 v32, v32, v12
 ds_write_b32 v108, v32 offset:0
 s_waitcnt lgkmcnt(0)
 buffer_load_dwordx4 v22, s[12:15], s35 offen offset:2048 lds
 s_barrier
 ds_read_b128 v[12:15], v107 offset:0
 s_waitcnt lgkmcnt(0)
 v_pk_add_f32 v[12:13], v[12:13], v[14:15]
 v_add_f32 v32, v12, v13
 v_mul_f32 v32, 0xbb124925, v32
 v_mov_b32 v33, v32
 v_mul_f32 v34, s29, v32
 v_mov_b32 v35, v34
 v_pk_add_f32 v[64:65], v[64:65], v[32:33]
 v_pk_add_f32 v[66:67], v[66:67], v[32:33]
 v_pk_add_f32 v[68:69], v[68:69], v[32:33]
 v_pk_add_f32 v[70:71], v[70:71], v[32:33]
 v_pk_add_f32 v[72:73], v[72:73], v[32:33]
 v_pk_add_f32 v[74:75], v[74:75], v[32:33]
 v_pk_add_f32 v[76:77], v[76:77], v[34:35]
 s_add_u32 m0, s43, 131072
 s_add_u32 s35, s42, 28672
 buffer_load_dwordx4 v16, s[12:15], s35 offen offset:0 lds
 v_pk_add_f32 v[78:79], v[78:79], v[34:35]
 v_pk_mul_f32 v[36:37], v[64:65], v[64:65]
 v_pk_fma_f32 v[36:37], v[66:67], v[66:67], v[36:37]
 v_pk_fma_f32 v[36:37], v[68:69], v[68:69], v[36:37]
 v_pk_fma_f32 v[36:37], v[70:71], v[70:71], v[36:37]
 v_pk_fma_f32 v[36:37], v[72:73], v[72:73], v[36:37]
 v_pk_fma_f32 v[36:37], v[74:75], v[74:75], v[36:37]
 v_pk_fma_f32 v[36:37], v[76:77], v[76:77], v[36:37]
 v_pk_fma_f32 v[36:37], v[78:79], v[78:79], v[36:37]
 v_add_f32 v36, v36, v37
 s_nop 1
 v_add_f32_dpp v36, v36, v36 row_ror:8 row_mask:0xf bank_mask:0xf
 v_mov_b32 v12, v36
 s_nop 1
 v_permlane16_swap_b32 v36, v12
 v_add_f32 v36, v36, v12
 v_mov_b32 v12, v36
 buffer_load_dwordx4 v17, s[12:15], s35 offen offset:1024 lds
 s_nop 0
 v_permlane32_swap_b32 v36, v12
 v_add_f32 v36, v36, v12
 ds_write_b32 v108, v36 offset:256
 s_waitcnt lgkmcnt(0)
 s_barrier
 ds_read_b128 v[12:15], v107 offset:256
 s_waitcnt lgkmcnt(0)
 v_pk_add_f32 v[12:13], v[12:13], v[14:15]
 v_add_f32 v36, v12, v13
 v_mov_b32 v37, 0x3727c5ac
 v_fmac_f32 v37, 0x3b124925, v36
 v_rsq_f32 v36, v37
 s_nop 0
 v_mov_b32 v37, v36
 v_pk_mul_f32 v[64:65], v[64:65], v[36:37]
 v_pk_mul_f32 v[66:67], v[66:67], v[36:37]
 v_pk_mul_f32 v[68:69], v[68:69], v[36:37]
 buffer_load_dwordx4 v18, s[12:15], s35 offen offset:2048 lds
 v_pk_mul_f32 v[70:71], v[70:71], v[36:37]
 v_pk_mul_f32 v[72:73], v[72:73], v[36:37]
 v_pk_mul_f32 v[74:75], v[74:75], v[36:37]
 v_pk_mul_f32 v[76:77], v[76:77], v[36:37]
 v_pk_mul_f32 v[78:79], v[78:79], v[36:37]
 v_cvt_pk_bf16_f32 v80, v64, v65
 v_cvt_pk_bf16_f32 v81, v66, v67
 v_cvt_pk_bf16_f32 v84, v68, v69
 v_cvt_pk_bf16_f32 v85, v70, v71
 v_cvt_pk_bf16_f32 v88, v72, v73
 v_cvt_pk_bf16_f32 v89, v74, v75
 v_cvt_pk_bf16_f32 v92, v76, v77
 v_cvt_pk_bf16_f32 v93, v78, v79
 s_add_u32 s36, s27, 125829120
 v_permlane32_swap_b32 v80, v82
 buffer_load_dwordx4 v19, s[12:15], s35 offen offset:3072 lds
 v_permlane32_swap_b32 v81, v83
 v_permlane32_swap_b32 v84, v86
 v_permlane32_swap_b32 v85, v87
 v_permlane32_swap_b32 v88, v90
 v_permlane32_swap_b32 v89, v91
 v_permlane32_swap_b32 v92, v94
 v_permlane32_swap_b32 v93, v95
 s_add_u32 s38, s36, 0
 buffer_store_dwordx4 v[80:83], v105, s[16:19], s38 offen sc1
 s_add_u32 s38, s36, 4096
 buffer_store_dwordx4 v[84:87], v105, s[16:19], s38 offen sc1
 s_add_u32 s38, s36, 8192
 buffer_store_dwordx4 v[88:91], v105, s[16:19], s38 offen sc1
 s_add_u32 s36, s36, s28
 s_add_u32 s38, s36, 12288
 buffer_store_dwordx4 v[92:95], v105, s[16:19], s38 offen sc1
 s_add_u32 m0, s43, 135168
 s_add_u32 s35, s42, 28672
 buffer_load_dwordx4 v20, s[12:15], s35 offen offset:0 lds
 buffer_load_dwordx4 v21, s[12:15], s35 offen offset:1024 lds
 buffer_load_dwordx4 v22, s[12:15], s35 offen offset:2048 lds
 s_add_u32 m0, s43, 0
 s_add_u32 s35, s42, 57344
 buffer_load_dwordx4 v16, s[12:15], s35 offen offset:0 lds
 buffer_load_dwordx4 v17, s[12:15], s35 offen offset:1024 lds
 buffer_load_dwordx4 v18, s[12:15], s35 offen offset:2048 lds
 buffer_load_dwordx4 v19, s[12:15], s35 offen offset:3072 lds
 s_add_u32 m0, s43, 4096
 s_add_u32 s35, s42, 57344
 buffer_load_dwordx4 v20, s[12:15], s35 offen offset:0 lds
 buffer_load_dwordx4 v21, s[12:15], s35 offen offset:1024 lds
 buffer_load_dwordx4 v22, s[12:15], s35 offen offset:2048 lds
 s_lshl_b32 s25, s50, 3
 s_lshl_b32 s38, s3, 1
 s_add_u32 s25, s25, s38
 s_mul_i32 s36, s25, 14336
 s_add_u32 s36, s36, 130023424
 s_lshr_b32 s37, s25, 1
 s_mul_i32 s37, s37, 114688
 s_lshr_b32 s38, s24, 1
 s_mul_i32 s38, s38, 14336
 s_add_u32 s37, s37, s38
 s_add_u32 s37, s37, 134217728
 s_and_b32 s38, s24, 1
 s_lshl_b32 s39, s38, 13
 s_add_u32 s26, s37, s39
 s_lshl_b32 s38, s38, 10
 s_add_u32 s27, s37, s38
 s_add_u32 s27, s27, 6144
 s_and_b32 s28, s24, 3
 s_lshr_b32 s29, s24, 2
 s_lshl_b32 s38, s50, 2
 s_add_u32 s29, s29, s38
 s_mul_i32 s34, s29, 114688
 s_mul_i32 s38, s3, 28672
 s_add_u32 s34, s34, s38
 s_add_u32 s34, s34, 134217728
 s_waitcnt vmcnt(10)
 s_barrier
 buffer_atomic_add v11, v10, s[16:19], s23 offen offset:20 sc1
 ds_read_b64_tr_b16 a[176:177], v23 offset:32768
 ds_read_b64_tr_b16 a[178:179], v23 offset:36352
 ds_read_b64_tr_b16 a[180:181], v23 offset:32800
 ds_read_b64_tr_b16 a[182:183], v23 offset:36384
 ds_read_b64_tr_b16 a[184:185], v23 offset:32832
 ds_read_b64_tr_b16 a[186:187], v23 offset:36416
 ds_read_b64_tr_b16 a[188:189], v23 offset:32864
 ds_read_b64_tr_b16 a[190:191], v23 offset:36448
 ds_read_b64_tr_b16 a[192:193], v23 offset:32896
 ds_read_b64_tr_b16 a[194:195], v23 offset:36480
 ds_read_b64_tr_b16 a[196:197], v23 offset:32928
 ds_read_b64_tr_b16 a[198:199], v23 offset:36512
 ds_read_b64_tr_b16 a[200:201], v23 offset:32960
 ds_read_b64_tr_b16 a[202:203], v23 offset:36544
 s_waitcnt vmcnt(8)
 ds_read_b64_tr_b16 a[204:205], v25 offset:0
 ds_read_b64_tr_b16 a[206:207], v25 offset:3584
 ds_read_b64_tr_b16 a[208:209], v25 offset:32
 ds_read_b64_tr_b16 a[210:211], v25 offset:3616
 ds_read_b64_tr_b16 a[212:213], v25 offset:64
 ds_read_b64_tr_b16 a[214:215], v25 offset:3648
 ds_read_b64_tr_b16 a[216:217], v25 offset:96
 ds_read_b64_tr_b16 a[218:219], v25 offset:3680
 ds_read_b64_tr_b16 a[220:221], v25 offset:128
 ds_read_b64_tr_b16 a[222:223], v25 offset:3712
 ds_read_b64_tr_b16 a[224:225], v25 offset:160
 ds_read_b64_tr_b16 a[226:227], v25 offset:3744
 ds_read_b64_tr_b16 a[228:229], v25 offset:192
 ds_read_b64_tr_b16 a[230:231], v25 offset:3776
 s_waitcnt lgkmcnt(0)
 s_add_u32 m0, s43, 32768
 s_add_u32 s35, s42, 86016
 buffer_load_dwordx4 v16, s[12:15], s35 offen offset:0 lds
 buffer_load_dwordx4 v17, s[12:15], s35 offen offset:1024 lds
 buffer_load_dwordx4 v18, s[12:15], s35 offen offset:2048 lds
 buffer_load_dwordx4 v19, s[12:15], s35 offen offset:3072 lds
 s_add_u32 m0, s43, 36864
 s_add_u32 s35, s42, 86016
 buffer_load_dwordx4 v20, s[12:15], s35 offen offset:0 lds
 buffer_load_dwordx4 v21, s[12:15], s35 offen offset:1024 lds
 buffer_load_dwordx4 v22, s[12:15], s35 offen offset:2048 lds
 s_add_u32 m0, s43, 131072
 s_add_u32 s35, s42, 114688
 buffer_load_dwordx4 v16, s[12:15], s35 offen offset:0 lds
 buffer_load_dwordx4 v17, s[12:15], s35 offen offset:1024 lds
 buffer_load_dwordx4 v18, s[12:15], s35 offen offset:2048 lds
 buffer_load_dwordx4 v19, s[12:15], s35 offen offset:3072 lds
 s_add_u32 m0, s43, 135168
 s_add_u32 s35, s42, 114688
 buffer_load_dwordx4 v20, s[12:15], s35 offen offset:0 lds
 buffer_load_dwordx4 v21, s[12:15], s35 offen offset:1024 lds
 buffer_load_dwordx4 v22, s[12:15], s35 offen offset:2048 lds
 s_waitcnt vmcnt(15)
 ds_read_b64_tr_b16 a[232:233], v23 offset:0
 ds_read_b64_tr_b16 a[234:235], v23 offset:3584
 ds_read_b64_tr_b16 a[236:237], v23 offset:32
 ds_read_b64_tr_b16 a[238:239], v23 offset:3616
 ds_read_b64_tr_b16 a[240:241], v23 offset:64
 ds_read_b64_tr_b16 a[242:243], v23 offset:3648
 ds_read_b64_tr_b16 a[244:245], v23 offset:96
 ds_read_b64_tr_b16 a[246:247], v23 offset:3680
 ds_read_b64_tr_b16 a[248:249], v23 offset:128
 ds_read_b64_tr_b16 a[250:251], v23 offset:3712
 ds_read_b64_tr_b16 a[252:253], v23 offset:160
 ds_read_b64_tr_b16 a[254:255], v23 offset:3744
 ds_read_b64_tr_b16 v[152:153], v23 offset:192
 ds_read_b64_tr_b16 v[154:155], v23 offset:3776
 ds_read_b64_tr_b16 a[0:1], v9 offset:0
 ds_read_b64_tr_b16 a[2:3], v9 offset:3584
 ds_read_b64_tr_b16 a[4:5], v9 offset:7168
 ds_read_b64_tr_b16 a[6:7], v9 offset:10752
 ds_read_b64_tr_b16 a[8:9], v9 offset:14336
 ds_read_b64_tr_b16 a[10:11], v9 offset:17920
 ds_read_b64_tr_b16 a[12:13], v9 offset:21504
 ds_read_b64_tr_b16 a[14:15], v9 offset:25088
 ds_read_b64_tr_b16 a[16:17], v9 offset:32
 ds_read_b64_tr_b16 a[18:19], v9 offset:3616
 ds_read_b64_tr_b16 a[20:21], v9 offset:7200
 ds_read_b64_tr_b16 a[22:23], v9 offset:10784
 ds_read_b64_tr_b16 a[24:25], v9 offset:14368
 ds_read_b64_tr_b16 a[26:27], v9 offset:17952
 ds_read_b64_tr_b16 a[28:29], v9 offset:21536
 ds_read_b64_tr_b16 a[30:31], v9 offset:25120
 s_load_dword s38, s[20:21], 20 glc
 s_waitcnt lgkmcnt(0)
 s_andn2_b32 s38, s41, s38
 s_cbranch_scc1 L_tspin1
L_tspun1:
 s_add_u32 s38, s36, 0
 buffer_load_dwordx4 a[64:67], v1, s[16:19], s38 offen sc1
 s_add_u32 s38, s36, 14336
 buffer_load_dwordx4 a[120:123], v1, s[16:19], s38 offen sc1
 s_add_u32 s38, s36, 1024
 buffer_load_dwordx4 a[68:71], v1, s[16:19], s38 offen sc1
 s_add_u32 s38, s36, 15360
 buffer_load_dwordx4 a[124:127], v1, s[16:19], s38 offen sc1
 s_add_u32 s38, s36, 2048
 buffer_load_dwordx4 a[72:75], v1, s[16:19], s38 offen sc1
 s_add_u32 s38, s36, 16384
 buffer_load_dwordx4 a[128:131], v1, s[16:19], s38 offen sc1
 s_add_u32 s38, s36, 3072
 buffer_load_dwordx4 a[76:79], v1, s[16:19], s38 offen sc1
 s_add_u32 s38, s36, 17408
 buffer_load_dwordx4 a[132:135], v1, s[16:19], s38 offen sc1
 s_add_u32 m0, s43, 0
 s_add_u32 s35, s49, 458752
 buffer_load_dwordx4 v2, s[8:11], s35 offen offset:0 lds
 buffer_load_dwordx4 v3, s[8:11], s35 offen offset:1024 lds
 buffer_load_dwordx4 v4, s[8:11], s35 offen offset:2048 lds
 buffer_load_dwordx4 v5, s[8:11], s35 offen offset:3072 lds
 s_add_u32 m0, s43, 4096
 s_add_u32 s35, s49, 458752
 buffer_load_dwordx4 v6, s[8:11], s35 offen offset:0 lds
 buffer_load_dwordx4 v7, s[8:11], s35 offen offset:1024 lds
 buffer_load_dwordx4 v8, s[8:11], s35 offen offset:2048 lds
 s_waitcnt vmcnt(22)
 ds_read_b64_tr_b16 v[156:157], v23 offset:32768
 ds_read_b64_tr_b16 v[158:159], v23 offset:36352
 ds_read_b64_tr_b16 v[160:161], v23 offset:32800
 ds_read_b64_tr_b16 v[162:163], v23 offset:36384
 ds_read_b64_tr_b16 v[164:165], v23 offset:32832
 ds_read_b64_tr_b16 v[166:167], v23 offset:36416
 ds_read_b64_tr_b16 v[168:169], v23 offset:32864
 ds_read_b64_tr_b16 v[170:171], v23 offset:36448
 ds_read_b64_tr_b16 v[172:173], v23 offset:32896
 ds_read_b64_tr_b16 v[174:175], v23 offset:36480
 ds_read_b64_tr_b16 v[176:177], v23 offset:32928
 ds_read_b64_tr_b16 v[178:179], v23 offset:36512
 ds_read_b64_tr_b16 v[180:181], v23 offset:32960
 ds_read_b64_tr_b16 v[182:183], v23 offset:36544
 s_waitcnt vmcnt(15)
 ds_read_b64_tr_b16 v[184:185], v25 offset:0
 ds_read_b64_tr_b16 v[186:187], v25 offset:3584
 ds_read_b64_tr_b16 v[188:189], v25 offset:32
 ds_read_b64_tr_b16 v[190:191], v25 offset:3616
 ds_read_b64_tr_b16 v[192:193], v25 offset:64
 ds_read_b64_tr_b16 v[194:195], v25 offset:3648
 ds_read_b64_tr_b16 v[196:197], v25 offset:96
 ds_read_b64_tr_b16 v[198:199], v25 offset:3680
 ds_read_b64_tr_b16 v[200:201], v25 offset:128
 ds_read_b64_tr_b16 v[202:203], v25 offset:3712
 ds_read_b64_tr_b16 v[204:205], v25 offset:160
 ds_read_b64_tr_b16 v[206:207], v25 offset:3744
 ds_read_b64_tr_b16 v[208:209], v25 offset:192
 ds_read_b64_tr_b16 v[210:211], v25 offset:3776
 s_waitcnt lgkmcnt(0)
 s_waitcnt vmcnt(14)
 v_mfma_f32_16x16x32_bf16 v[32:35], a[0:3], a[64:67], 0
 s_add_u32 s38, s36, 4096
 buffer_load_dwordx4 a[80:83], v1, s[16:19], s38 offen sc1
 s_waitcnt vmcnt(13)
 v_mfma_f32_16x16x32_bf16 v[32:35], a[4:7], a[68:71], v[32:35]
 ds_read_b64_tr_b16 a[32:33], v9 offset:64
 ds_read_b64_tr_b16 a[34:35], v9 offset:3648
 v_mfma_f32_16x16x32_bf16 v[36:39], a[0:3], a[120:123], 0
 s_mov_b32 s30, 0xbfb8aa3b
 ds_read_b64_tr_b16 a[36:37], v9 offset:7232
 ds_read_b64_tr_b16 a[38:39], v9 offset:10816
 s_waitcnt vmcnt(12)
 v_mfma_f32_16x16x32_bf16 v[36:39], a[4:7], a[124:127], v[36:39]
 s_mov_b32 s31, 0xbfb8aa3b
 ds_read_b64_tr_b16 a[40:41], v9 offset:14400
 v_mfma_f32_16x16x32_bf16 v[88:91], a[8:11], a[64:67], 0
 s_add_u32 s38, s36, 18432
 buffer_load_dwordx4 a[136:139], v1, s[16:19], s38 offen sc1
 v_mfma_f32_16x16x32_bf16 v[88:91], a[12:15], a[68:71], v[88:91]
 ds_read_b64_tr_b16 a[42:43], v9 offset:17984
 ds_read_b64_tr_b16 a[44:45], v9 offset:21568
 v_mfma_f32_16x16x32_bf16 v[92:95], a[8:11], a[120:123], 0
 ds_read_b64_tr_b16 a[46:47], v9 offset:25152
 v_mfma_f32_16x16x32_bf16 v[92:95], a[12:15], a[124:127], v[92:95]
 v_mfma_f32_16x16x32_bf16 v[40:43], a[16:19], a[64:67], 0
 s_add_u32 s38, s36, 5120
 buffer_load_dwordx4 a[84:87], v1, s[16:19], s38 offen sc1
 v_mfma_f32_16x16x32_bf16 v[40:43], a[20:23], a[68:71], v[40:43]
 ds_read_b64_tr_b16 a[48:49], v9 offset:96
 ds_read_b64_tr_b16 a[50:51], v9 offset:3680
 v_mfma_f32_16x16x32_bf16 v[44:47], a[16:19], a[120:123], 0
 ds_read_b64_tr_b16 a[52:53], v9 offset:7264
 ds_read_b64_tr_b16 a[54:55], v9 offset:10848
 v_mfma_f32_16x16x32_bf16 v[44:47], a[20:23], a[124:127], v[44:47]
 ds_read_b64_tr_b16 a[56:57], v9 offset:14432
 v_mfma_f32_16x16x32_bf16 v[96:99], a[24:27], a[64:67], 0
 s_add_u32 s38, s36, 19456
 buffer_load_dwordx4 a[140:143], v1, s[16:19], s38 offen sc1
 v_mfma_f32_16x16x32_bf16 v[96:99], a[28:31], a[68:71], v[96:99]
 ds_read_b64_tr_b16 a[58:59], v9 offset:18016
 ds_read_b64_tr_b16 a[60:61], v9 offset:21600
 v_mfma_f32_16x16x32_bf16 v[100:103], a[24:27], a[120:123], 0
 ds_read_b64_tr_b16 a[62:63], v9 offset:25184
 v_mfma_f32_16x16x32_bf16 v[100:103], a[28:31], a[124:127], v[100:103]
 s_waitcnt lgkmcnt(4)
 v_mfma_f32_16x16x32_bf16 v[48:51], a[32:35], a[64:67], 0
 s_add_u32 m0, s43, 32768
 s_add_u32 s35, s49, 688128
 ds_read_b64_tr_b16 a[0:1], v9 offset:128
 v_mfma_f32_16x16x32_bf16 v[48:51], a[36:39], a[68:71], v[48:51]
 buffer_load_dwordx4 v2, s[8:11], s35 offen offset:0 lds
 v_mfma_f32_16x16x32_bf16 v[52:55], a[32:35], a[120:123], 0
 ds_read_b64_tr_b16 a[2:3], v9 offset:3712
 ds_read_b64_tr_b16 a[4:5], v9 offset:7296
 v_mfma_f32_16x16x32_bf16 v[52:55], a[36:39], a[124:127], v[52:55]
 ds_read_b64_tr_b16 a[6:7], v9 offset:10880
 ds_read_b64_tr_b16 a[8:9], v9 offset:14464
 v_mfma_f32_16x16x32_bf16 v[104:107], a[40:43], a[64:67], 0
 ds_read_b64_tr_b16 a[10:11], v9 offset:18048
 v_mfma_f32_16x16x32_bf16 v[104:107], a[44:47], a[68:71], v[104:107]
 buffer_load_dwordx4 v3, s[8:11], s35 offen offset:1024 lds
 v_mfma_f32_16x16x32_bf16 v[108:111], a[40:43], a[120:123], 0
 ds_read_b64_tr_b16 a[12:13], v9 offset:21632
 ds_read_b64_tr_b16 a[14:15], v9 offset:25216
 v_mfma_f32_16x16x32_bf16 v[108:111], a[44:47], a[124:127], v[108:111]
 v_mfma_f32_16x16x32_bf16 v[56:59], a[48:51], a[64:67], 0
 ds_read_b64_tr_b16 a[16:17], v9 offset:160
 ds_read_b64_tr_b16 a[18:19], v9 offset:3744
 v_mfma_f32_16x16x32_bf16 v[56:59], a[52:55], a[68:71], v[56:59]
 buffer_load_dwordx4 v4, s[8:11], s35 offen offset:2048 lds
 v_mfma_f32_16x16x32_bf16 v[60:63], a[48:51], a[120:123], 0
 ds_read_b64_tr_b16 a[20:21], v9 offset:7328
 ds_read_b64_tr_b16 a[22:23], v9 offset:10912
 v_mfma_f32_16x16x32_bf16 v[60:63], a[52:55], a[124:127], v[60:63]
 s_waitcnt lgkmcnt(4)
 ds_read_b64_tr_b16 a[24:25], v9 offset:14496
 v_mfma_f32_16x16x32_bf16 v[112:115], a[56:59], a[64:67], 0
 ds_read_b64_tr_b16 a[26:27], v9 offset:18080
 v_mfma_f32_16x16x32_bf16 v[112:115], a[60:63], a[68:71], v[112:115]
 buffer_load_dwordx4 v5, s[8:11], s35 offen offset:3072 lds
 v_mfma_f32_16x16x32_bf16 v[116:119], a[56:59], a[120:123], 0
 ds_read_b64_tr_b16 a[28:29], v9 offset:21664
 ds_read_b64_tr_b16 a[30:31], v9 offset:25248
 v_mfma_f32_16x16x32_bf16 v[116:119], a[60:63], a[124:127], v[116:119]
 v_mfma_f32_16x16x32_bf16 v[64:67], a[0:3], a[64:67], 0
 ds_read_b64_tr_b16 a[32:33], v9 offset:192
 ds_read_b64_tr_b16 a[34:35], v9 offset:3776
 v_mfma_f32_16x16x32_bf16 v[64:67], a[4:7], a[68:71], v[64:67]
 s_add_u32 m0, s43, 36864
 ds_read_b64_tr_b16 a[36:37], v9 offset:7360
 v_mfma_f32_16x16x32_bf16 v[68:71], a[0:3], a[120:123], 0
 s_add_u32 s35, s49, 688128
 buffer_load_dwordx4 v6, s[8:11], s35 offen offset:0 lds
 v_mfma_f32_16x16x32_bf16 v[68:71], a[4:7], a[124:127], v[68:71]
 ds_read_b64_tr_b16 a[38:39], v9 offset:10944
 ds_read_b64_tr_b16 a[40:41], v9 offset:14528
 v_mfma_f32_16x16x32_bf16 v[120:123], a[8:11], a[64:67], 0
 ds_read_b64_tr_b16 a[42:43], v9 offset:18112
 v_mfma_f32_16x16x32_bf16 v[120:123], a[12:15], a[68:71], v[120:123]
 ds_read_b64_tr_b16 a[44:45], v9 offset:21696
 v_mfma_f32_16x16x32_bf16 v[124:127], a[8:11], a[120:123], 0
 buffer_load_dwordx4 v7, s[8:11], s35 offen offset:1024 lds
 ds_read_b64_tr_b16 a[46:47], v9 offset:25280
 v_mfma_f32_16x16x32_bf16 v[124:127], a[12:15], a[124:127], v[124:127]
 s_waitcnt lgkmcnt(5)
 v_add_u32 v9, 0x8000, v9
 v_mfma_f32_16x16x32_bf16 v[72:75], a[16:19], a[64:67], 0
 ds_read_b64_tr_b16 a[48:49], v9 offset:0
 ds_read_b64_tr_b16 a[50:51], v9 offset:3584
 v_mfma_f32_16x16x32_bf16 v[72:75], a[20:23], a[68:71], v[72:75]
 ds_read_b64_tr_b16 a[52:53], v9 offset:7168
 v_mfma_f32_16x16x32_bf16 v[76:79], a[16:19], a[120:123], 0
 buffer_load_dwordx4 v8, s[8:11], s35 offen offset:2048 lds
 v_mfma_f32_16x16x32_bf16 v[76:79], a[20:23], a[124:127], v[76:79]
 ds_read_b64_tr_b16 a[54:55], v9 offset:10752
 ds_read_b64_tr_b16 a[56:57], v9 offset:14336
 v_mfma_f32_16x16x32_bf16 v[128:131], a[24:27], a[64:67], 0
 ds_read_b64_tr_b16 a[58:59], v9 offset:17920
 v_mfma_f32_16x16x32_bf16 v[128:131], a[28:31], a[68:71], v[128:131]
 ds_read_b64_tr_b16 a[60:61], v9 offset:21504
 v_mfma_f32_16x16x32_bf16 v[132:135], a[24:27], a[120:123], 0
 s_add_u32 s38, s36, 6144
 buffer_load_dwordx4 a[88:91], v1, s[16:19], s38 offen sc1
 ds_read_b64_tr_b16 a[62:63], v9 offset:25088
 v_mfma_f32_16x16x32_bf16 v[132:135], a[28:31], a[124:127], v[132:135]
 v_mfma_f32_16x16x32_bf16 v[80:83], a[32:35], a[64:67], 0
 s_waitcnt lgkmcnt(3)
 ds_read_b64_tr_b16 a[0:1], v9 offset:32
 ds_read_b64_tr_b16 a[2:3], v9 offset:3616
 v_mfma_f32_16x16x32_bf16 v[80:83], a[36:39], a[68:71], v[80:83]
 ds_read_b64_tr_b16 a[4:5], v9 offset:7200
 v_mfma_f32_16x16x32_bf16 v[84:87], a[32:35], a[120:123], 0
 s_add_u32 s38, s36, 20480
 buffer_load_dwordx4 a[144:147], v1, s[16:19], s38 offen sc1
 v_mfma_f32_16x16x32_bf16 v[84:87], a[36:39], a[124:127], v[84:87]
 ds_read_b64_tr_b16 a[6:7], v9 offset:10784
 ds_read_b64_tr_b16 a[8:9], v9 offset:14368
 v_mfma_f32_16x16x32_bf16 v[136:139], a[40:43], a[64:67], 0
 ds_read_b64_tr_b16 a[10:11], v9 offset:17952
 v_mfma_f32_16x16x32_bf16 v[136:139], a[44:47], a[68:71], v[136:139]
 ds_read_b64_tr_b16 a[12:13], v9 offset:21536
 v_mfma_f32_16x16x32_bf16 v[140:143], a[40:43], a[120:123], 0
 ds_read_b64_tr_b16 a[14:15], v9 offset:25120
 v_mfma_f32_16x16x32_bf16 v[140:143], a[44:47], a[124:127], v[140:143]
 s_add_u32 s38, s36, 7168
 buffer_load_dwordx4 a[92:95], v1, s[16:19], s38 offen sc1
 s_waitcnt vmcnt(24)
 v_mfma_f32_16x16x32_bf16 v[32:35], a[48:51], a[72:75], v[32:35]
 ds_read_b64_tr_b16 a[16:17], v9 offset:64
 ds_read_b64_tr_b16 a[18:19], v9 offset:3648
 s_waitcnt vmcnt(22)
 v_mfma_f32_16x16x32_bf16 v[32:35], a[52:55], a[76:79], v[32:35]
 ds_read_b64_tr_b16 a[20:21], v9 offset:7232
 v_mfma_f32_16x16x32_bf16 v[36:39], a[48:51], a[128:131], v[36:39]
 ds_read_b64_tr_b16 a[22:23], v9 offset:10816
 s_waitcnt vmcnt(21)
 v_mfma_f32_16x16x32_bf16 v[36:39], a[52:55], a[132:135], v[36:39]
 s_waitcnt lgkmcnt(4)
 s_add_u32 s38, s36, 21504
 buffer_load_dwordx4 a[148:151], v1, s[16:19], s38 offen sc1
 v_mfma_f32_16x16x32_bf16 v[88:91], a[56:59], a[72:75], v[88:91]
 ds_read_b64_tr_b16 a[24:25], v9 offset:14400
 ds_read_b64_tr_b16 a[26:27], v9 offset:17984
 v_mfma_f32_16x16x32_bf16 v[88:91], a[60:63], a[76:79], v[88:91]
 ds_read_b64_tr_b16 a[28:29], v9 offset:21568
 v_mfma_f32_16x16x32_bf16 v[92:95], a[56:59], a[128:131], v[92:95]
 ds_read_b64_tr_b16 a[30:31], v9 offset:25152
 v_mfma_f32_16x16x32_bf16 v[92:95], a[60:63], a[132:135], v[92:95]
 s_add_u32 m0, s43, 131072
 s_add_u32 s35, s49, 917504
 v_mfma_f32_16x16x32_bf16 v[40:43], a[0:3], a[72:75], v[40:43]
 buffer_load_dwordx4 v2, s[8:11], s35 offen offset:0 lds
 v_mfma_f32_16x16x32_bf16 v[40:43], a[4:7], a[76:79], v[40:43]
 ds_read_b64_tr_b16 a[32:33], v9 offset:96
 ds_read_b64_tr_b16 a[34:35], v9 offset:3680
 v_mfma_f32_16x16x32_bf16 v[44:47], a[0:3], a[128:131], v[44:47]
 ds_read_b64_tr_b16 a[36:37], v9 offset:7264
 ds_read_b64_tr_b16 a[38:39], v9 offset:10848
 v_mfma_f32_16x16x32_bf16 v[44:47], a[4:7], a[132:135], v[44:47]
 ds_read_b64_tr_b16 a[40:41], v9 offset:14432
 v_mfma_f32_16x16x32_bf16 v[96:99], a[8:11], a[72:75], v[96:99]
 buffer_load_dwordx4 v3, s[8:11], s35 offen offset:1024 lds
 v_mfma_f32_16x16x32_bf16 v[96:99], a[12:15], a[76:79], v[96:99]
 ds_read_b64_tr_b16 a[42:43], v9 offset:18016
 ds_read_b64_tr_b16 a[44:45], v9 offset:21600
 v_mfma_f32_16x16x32_bf16 v[100:103], a[8:11], a[128:131], v[100:103]
 ds_read_b64_tr_b16 a[46:47], v9 offset:25184
 v_mfma_f32_16x16x32_bf16 v[100:103], a[12:15], a[132:135], v[100:103]
 s_waitcnt lgkmcnt(4)
 v_mfma_f32_16x16x32_bf16 v[48:51], a[16:19], a[72:75], v[48:51]
 buffer_load_dwordx4 v4, s[8:11], s35 offen offset:2048 lds
 v_mfma_f32_16x16x32_bf16 v[48:51], a[20:23], a[76:79], v[48:51]
 ds_read_b64_tr_b16 a[48:49], v9 offset:128
 ds_read_b64_tr_b16 a[50:51], v9 offset:3712
 v_mfma_f32_16x16x32_bf16 v[52:55], a[16:19], a[128:131], v[52:55]
 ds_read_b64_tr_b16 a[52:53], v9 offset:7296
 ds_read_b64_tr_b16 a[54:55], v9 offset:10880
 v_mfma_f32_16x16x32_bf16 v[52:55], a[20:23], a[132:135], v[52:55]
 ds_read_b64_tr_b16 a[56:57], v9 offset:14464
 v_mfma_f32_16x16x32_bf16 v[104:107], a[24:27], a[72:75], v[104:107]
 buffer_load_dwordx4 v5, s[8:11], s35 offen offset:3072 lds
 v_mfma_f32_16x16x32_bf16 v[104:107], a[28:31], a[76:79], v[104:107]
 ds_read_b64_tr_b16 a[58:59], v9 offset:18048
 ds_read_b64_tr_b16 a[60:61], v9 offset:21632
 v_mfma_f32_16x16x32_bf16 v[108:111], a[24:27], a[128:131], v[108:111]
 ds_read_b64_tr_b16 a[62:63], v9 offset:25216
 v_mfma_f32_16x16x32_bf16 v[108:111], a[28:31], a[132:135], v[108:111]
 v_mfma_f32_16x16x32_bf16 v[56:59], a[32:35], a[72:75], v[56:59]
 s_add_u32 m0, s43, 135168
 s_add_u32 s35, s49, 917504
 ds_read_b64_tr_b16 a[0:1], v9 offset:160
 v_mfma_f32_16x16x32_bf16 v[56:59], a[36:39], a[76:79], v[56:59]
 buffer_load_dwordx4 v6, s[8:11], s35 offen offset:0 lds
 v_mfma_f32_16x16x32_bf16 v[60:63], a[32:35], a[128:131], v[60:63]
 ds_read_b64_tr_b16 a[2:3], v9 offset:3744
 ds_read_b64_tr_b16 a[4:5], v9 offset:7328
 v_mfma_f32_16x16x32_bf16 v[60:63], a[36:39], a[132:135], v[60:63]
 s_waitcnt lgkmcnt(3)
 ds_read_b64_tr_b16 a[6:7], v9 offset:10912
 ds_read_b64_tr_b16 a[8:9], v9 offset:14496
 v_mfma_f32_16x16x32_bf16 v[112:115], a[40:43], a[72:75], v[112:115]
 ds_read_b64_tr_b16 a[10:11], v9 offset:18080
 v_mfma_f32_16x16x32_bf16 v[112:115], a[44:47], a[76:79], v[112:115]
 buffer_load_dwordx4 v7, s[8:11], s35 offen offset:1024 lds
 v_mfma_f32_16x16x32_bf16 v[116:119], a[40:43], a[128:131], v[116:119]
 ds_read_b64_tr_b16 a[12:13], v9 offset:21664
 ds_read_b64_tr_b16 a[14:15], v9 offset:25248
 v_mfma_f32_16x16x32_bf16 v[116:119], a[44:47], a[132:135], v[116:119]
 v_mfma_f32_16x16x32_bf16 v[64:67], a[48:51], a[72:75], v[64:67]
 ds_read_b64_tr_b16 a[16:17], v9 offset:192
 ds_read_b64_tr_b16 a[18:19], v9 offset:3776
 v_mfma_f32_16x16x32_bf16 v[64:67], a[52:55], a[76:79], v[64:67]
 buffer_load_dwordx4 v8, s[8:11], s35 offen offset:2048 lds
 v_mfma_f32_16x16x32_bf16 v[68:71], a[48:51], a[128:131], v[68:71]
 ds_read_b64_tr_b16 a[20:21], v9 offset:7360
 ds_read_b64_tr_b16 a[22:23], v9 offset:10944
 v_mfma_f32_16x16x32_bf16 v[68:71], a[52:55], a[132:135], v[68:71]
 ds_read_b64_tr_b16 a[24:25], v9 offset:14528
 v_mfma_f32_16x16x32_bf16 v[120:123], a[56:59], a[72:75], v[120:123]
 ds_read_b64_tr_b16 a[26:27], v9 offset:18112
 v_mfma_f32_16x16x32_bf16 v[120:123], a[60:63], a[76:79], v[120:123]
 s_add_u32 s38, s36, 8192
 buffer_load_dwordx4 a[96:99], v1, s[16:19], s38 offen sc1
 v_mfma_f32_16x16x32_bf16 v[124:127], a[56:59], a[128:131], v[124:127]
 ds_read_b64_tr_b16 a[28:29], v9 offset:21696
 ds_read_b64_tr_b16 a[30:31], v9 offset:25280
 v_mfma_f32_16x16x32_bf16 v[124:127], a[60:63], a[132:135], v[124:127]
 s_waitcnt vmcnt(23)
 s_barrier
 v_add_u32 v9, 0xfffe8000, v9
 s_waitcnt lgkmcnt(4)
 v_mfma_f32_16x16x32_bf16 v[72:75], a[0:3], a[72:75], v[72:75]
 ds_read_b64_tr_b16 a[32:33], v9 offset:0
 ds_read_b64_tr_b16 a[34:35], v9 offset:3584
 v_mfma_f32_16x16x32_bf16 v[72:75], a[4:7], a[76:79], v[72:75]
 s_add_u32 s38, s36, 22528
 buffer_load_dwordx4 a[152:155], v1, s[16:19], s38 offen sc1
 v_mfma_f32_16x16x32_bf16 v[76:79], a[0:3], a[128:131], v[76:79]
 ds_read_b64_tr_b16 a[36:37], v9 offset:7168
 ds_read_b64_tr_b16 a[38:39], v9 offset:10752
 v_mfma_f32_16x16x32_bf16 v[76:79], a[4:7], a[132:135], v[76:79]
 ds_read_b64_tr_b16 a[40:41], v9 offset:14336
 v_mfma_f32_16x16x32_bf16 v[128:131], a[8:11], a[72:75], v[128:131]
 ds_read_b64_tr_b16 a[42:43], v9 offset:17920
 v_mfma_f32_16x16x32_bf16 v[128:131], a[12:15], a[76:79], v[128:131]
 s_add_u32 s38, s36, 9216
 buffer_load_dwordx4 a[100:103], v1, s[16:19], s38 offen sc1
 v_mfma_f32_16x16x32_bf16 v[132:135], a[8:11], a[128:131], v[132:135]
 ds_read_b64_tr_b16 a[44:45], v9 offset:21504
 ds_read_b64_tr_b16 a[46:47], v9 offset:25088
 v_mfma_f32_16x16x32_bf16 v[132:135], a[12:15], a[132:135], v[132:135]
 v_mfma_f32_16x16x32_bf16 v[80:83], a[16:19], a[72:75], v[80:83]
 ds_read_b64_tr_b16 a[48:49], v9 offset:32
 ds_read_b64_tr_b16 a[50:51], v9 offset:3616
 v_mfma_f32_16x16x32_bf16 v[80:83], a[20:23], a[76:79], v[80:83]
 s_add_u32 s38, s36, 23552
 buffer_load_dwordx4 a[156:159], v1, s[16:19], s38 offen sc1
 v_mfma_f32_16x16x32_bf16 v[84:87], a[16:19], a[128:131], v[84:87]
 ds_read_b64_tr_b16 a[52:53], v9 offset:7200
 ds_read_b64_tr_b16 a[54:55], v9 offset:10784
 v_mfma_f32_16x16x32_bf16 v[84:87], a[20:23], a[132:135], v[84:87]
 s_waitcnt lgkmcnt(4)
 ds_read_b64_tr_b16 a[56:57], v9 offset:14368
 v_mfma_f32_16x16x32_bf16 v[136:139], a[24:27], a[72:75], v[136:139]
 ds_read_b64_tr_b16 a[58:59], v9 offset:17952
 v_mfma_f32_16x16x32_bf16 v[136:139], a[28:31], a[76:79], v[136:139]
 ds_read_b64_tr_b16 a[60:61], v9 offset:21536
 v_mfma_f32_16x16x32_bf16 v[140:143], a[24:27], a[128:131], v[140:143]
 ds_read_b64_tr_b16 a[62:63], v9 offset:25120
 v_mfma_f32_16x16x32_bf16 v[140:143], a[28:31], a[132:135], v[140:143]
 s_waitcnt vmcnt(25)
 v_mfma_f32_16x16x32_bf16 v[32:35], a[32:35], a[80:83], v[32:35]
 s_add_u32 m0, s43, 65536
 s_add_u32 s35, s49, 1146880
 ds_read_b64_tr_b16 a[0:1], v9 offset:64
 s_waitcnt vmcnt(23)
 v_mfma_f32_16x16x32_bf16 v[32:35], a[36:39], a[84:87], v[32:35]
 buffer_load_dwordx4 v2, s[8:11], s35 offen offset:0 lds
 v_mfma_f32_16x16x32_bf16 v[36:39], a[32:35], a[136:139], v[36:39]
 ds_read_b64_tr_b16 a[2:3], v9 offset:3648
 ds_read_b64_tr_b16 a[4:5], v9 offset:7232
 s_waitcnt vmcnt(23)
 v_mfma_f32_16x16x32_bf16 v[36:39], a[36:39], a[140:143], v[36:39]
 ds_read_b64_tr_b16 a[6:7], v9 offset:10816
 ds_read_b64_tr_b16 a[8:9], v9 offset:14400
 v_mfma_f32_16x16x32_bf16 v[88:91], a[40:43], a[80:83], v[88:91]
 ds_read_b64_tr_b16 a[10:11], v9 offset:17984
 v_mfma_f32_16x16x32_bf16 v[88:91], a[44:47], a[84:87], v[88:91]
 buffer_load_dwordx4 v3, s[8:11], s35 offen offset:1024 lds
 v_mfma_f32_16x16x32_bf16 v[92:95], a[40:43], a[136:139], v[92:95]
 ds_read_b64_tr_b16 a[12:13], v9 offset:21568
 ds_read_b64_tr_b16 a[14:15], v9 offset:25152
 v_mfma_f32_16x16x32_bf16 v[92:95], a[44:47], a[140:143], v[92:95]
 s_waitcnt lgkmcnt(5)
 v_mfma_f32_16x16x32_bf16 v[40:43], a[48:51], a[80:83], v[40:43]
 ds_read_b64_tr_b16 a[16:17], v9 offset:96
 ds_read_b64_tr_b16 a[18:19], v9 offset:3680
 v_mfma_f32_16x16x32_bf16 v[40:43], a[52:55], a[84:87], v[40:43]
 buffer_load_dwordx4 v4, s[8:11], s35 offen offset:2048 lds
 v_mfma_f32_16x16x32_bf16 v[44:47], a[48:51], a[136:139], v[44:47]
 ds_read_b64_tr_b16 a[20:21], v9 offset:7264
 ds_read_b64_tr_b16 a[22:23], v9 offset:10848
 v_mfma_f32_16x16x32_bf16 v[44:47], a[52:55], a[140:143], v[44:47]
 ds_read_b64_tr_b16 a[24:25], v9 offset:14432
 v_mfma_f32_16x16x32_bf16 v[96:99], a[56:59], a[80:83], v[96:99]
 ds_read_b64_tr_b16 a[26:27], v9 offset:18016
 v_mfma_f32_16x16x32_bf16 v[96:99], a[60:63], a[84:87], v[96:99]
 buffer_load_dwordx4 v5, s[8:11], s35 offen offset:3072 lds
 v_mfma_f32_16x16x32_bf16 v[100:103], a[56:59], a[136:139], v[100:103]
 ds_read_b64_tr_b16 a[28:29], v9 offset:21600
 ds_read_b64_tr_b16 a[30:31], v9 offset:25184
 v_mfma_f32_16x16x32_bf16 v[100:103], a[60:63], a[140:143], v[100:103]
 v_mfma_f32_16x16x32_bf16 v[48:51], a[0:3], a[80:83], v[48:51]
 s_waitcnt lgkmcnt(3)
 ds_read_b64_tr_b16 a[32:33], v9 offset:128
 ds_read_b64_tr_b16 a[34:35], v9 offset:3712
 v_mfma_f32_16x16x32_bf16 v[48:51], a[4:7], a[84:87], v[48:51]
 s_add_u32 m0, s43, 69632
 ds_read_b64_tr_b16 a[36:37], v9 offset:7296
 v_mfma_f32_16x16x32_bf16 v[52:55], a[0:3], a[136:139], v[52:55]
 s_add_u32 s35, s49, 1146880
 buffer_load_dwordx4 v6, s[8:11], s35 offen offset:0 lds
 v_mfma_f32_16x16x32_bf16 v[52:55], a[4:7], a[140:143], v[52:55]
 ds_read_b64_tr_b16 a[38:39], v9 offset:10880
 ds_read_b64_tr_b16 a[40:41], v9 offset:14464
 v_mfma_f32_16x16x32_bf16 v[104:107], a[8:11], a[80:83], v[104:107]
 ds_read_b64_tr_b16 a[42:43], v9 offset:18048
 v_mfma_f32_16x16x32_bf16 v[104:107], a[12:15], a[84:87], v[104:107]
 ds_read_b64_tr_b16 a[44:45], v9 offset:21632
 v_mfma_f32_16x16x32_bf16 v[108:111], a[8:11], a[136:139], v[108:111]
 buffer_load_dwordx4 v7, s[8:11], s35 offen offset:1024 lds
 ds_read_b64_tr_b16 a[46:47], v9 offset:25216
 v_mfma_f32_16x16x32_bf16 v[108:111], a[12:15], a[140:143], v[108:111]
 v_mfma_f32_16x16x32_bf16 v[56:59], a[16:19], a[80:83], v[56:59]
 ds_read_b64_tr_b16 a[48:49], v9 offset:160
 ds_read_b64_tr_b16 a[50:51], v9 offset:3744
 v_mfma_f32_16x16x32_bf16 v[56:59], a[20:23], a[84:87], v[56:59]
 ds_read_b64_tr_b16 a[52:53], v9 offset:7328
 v_mfma_f32_16x16x32_bf16 v[60:63], a[16:19], a[136:139], v[60:63]
 ds_read_b64_tr_b16 a[54:55], v9 offset:10912
 v_mfma_f32_16x16x32_bf16 v[60:63], a[20:23], a[140:143], v[60:63]
 s_waitcnt lgkmcnt(4)
 buffer_load_dwordx4 v8, s[8:11], s35 offen offset:2048 lds
 v_mfma_f32_16x16x32_bf16 v[112:115], a[24:27], a[80:83], v[112:115]
 ds_read_b64_tr_b16 a[56:57], v9 offset:14496
 ds_read_b64_tr_b16 a[58:59], v9 offset:18080
 v_mfma_f32_16x16x32_bf16 v[112:115], a[28:31], a[84:87], v[112:115]
 ds_read_b64_tr_b16 a[60:61], v9 offset:21664
 v_mfma_f32_16x16x32_bf16 v[116:119], a[24:27], a[136:139], v[116:119]
 ds_read_b64_tr_b16 a[62:63], v9 offset:25248
 v_mfma_f32_16x16x32_bf16 v[116:119], a[28:31], a[140:143], v[116:119]
 s_add_u32 s38, s36, 10240
 buffer_load_dwordx4 a[104:107], v1, s[16:19], s38 offen sc1
 v_mfma_f32_16x16x32_bf16 v[64:67], a[32:35], a[80:83], v[64:67]
 ds_read_b64_tr_b16 a[0:1], v9 offset:192
 ds_read_b64_tr_b16 a[2:3], v9 offset:3776
 v_mfma_f32_16x16x32_bf16 v[64:67], a[36:39], a[84:87], v[64:67]
 ds_read_b64_tr_b16 a[4:5], v9 offset:7360
 v_mfma_f32_16x16x32_bf16 v[68:71], a[32:35], a[136:139], v[68:71]
 ds_read_b64_tr_b16 a[6:7], v9 offset:10944
 v_mfma_f32_16x16x32_bf16 v[68:71], a[36:39], a[140:143], v[68:71]
 s_add_u32 s38, s36, 24576
 buffer_load_dwordx4 a[160:163], v1, s[16:19], s38 offen sc1
 v_mfma_f32_16x16x32_bf16 v[120:123], a[40:43], a[80:83], v[120:123]
 ds_read_b64_tr_b16 a[8:9], v9 offset:14528
 ds_read_b64_tr_b16 a[10:11], v9 offset:18112
 v_mfma_f32_16x16x32_bf16 v[120:123], a[44:47], a[84:87], v[120:123]
 ds_read_b64_tr_b16 a[12:13], v9 offset:21696
 v_mfma_f32_16x16x32_bf16 v[124:127], a[40:43], a[136:139], v[124:127]
 ds_read_b64_tr_b16 a[14:15], v9 offset:25280
 v_mfma_f32_16x16x32_bf16 v[124:127], a[44:47], a[140:143], v[124:127]
 s_waitcnt vmcnt(24)
 s_barrier
 v_add_u32 v9, 0x8000, v9
 s_waitcnt lgkmcnt(4)
 v_mfma_f32_16x16x32_bf16 v[72:75], a[48:51], a[80:83], v[72:75]
 s_add_u32 s38, s36, 11264
 buffer_load_dwordx4 a[108:111], v1, s[16:19], s38 offen sc1
 v_mfma_f32_16x16x32_bf16 v[72:75], a[52:55], a[84:87], v[72:75]
 ds_read_b64_tr_b16 a[16:17], v9 offset:0
 ds_read_b64_tr_b16 a[18:19], v9 offset:3584
 v_mfma_f32_16x16x32_bf16 v[76:79], a[48:51], a[136:139], v[76:79]
 ds_read_b64_tr_b16 a[20:21], v9 offset:7168
 ds_read_b64_tr_b16 a[22:23], v9 offset:10752
 v_mfma_f32_16x16x32_bf16 v[76:79], a[52:55], a[140:143], v[76:79]
 ds_read_b64_tr_b16 a[24:25], v9 offset:14336
 v_mfma_f32_16x16x32_bf16 v[128:131], a[56:59], a[80:83], v[128:131]
 s_add_u32 s38, s36, 25600
 buffer_load_dwordx4 a[164:167], v1, s[16:19], s38 offen sc1
 v_mfma_f32_16x16x32_bf16 v[128:131], a[60:63], a[84:87], v[128:131]
 ds_read_b64_tr_b16 a[26:27], v9 offset:17920
 ds_read_b64_tr_b16 a[28:29], v9 offset:21504
 v_mfma_f32_16x16x32_bf16 v[132:135], a[56:59], a[136:139], v[132:135]
 ds_read_b64_tr_b16 a[30:31], v9 offset:25088
 v_mfma_f32_16x16x32_bf16 v[132:135], a[60:63], a[140:143], v[132:135]
 v_mfma_f32_16x16x32_bf16 v[80:83], a[0:3], a[80:83], v[80:83]
 ds_read_b64_tr_b16 a[32:33], v9 offset:32
 ds_read_b64_tr_b16 a[34:35], v9 offset:3616
 v_mfma_f32_16x16x32_bf16 v[80:83], a[4:7], a[84:87], v[80:83]
 ds_read_b64_tr_b16 a[36:37], v9 offset:7200
 v_mfma_f32_16x16x32_bf16 v[84:87], a[0:3], a[136:139], v[84:87]
 ds_read_b64_tr_b16 a[38:39], v9 offset:10784
 v_mfma_f32_16x16x32_bf16 v[84:87], a[4:7], a[140:143], v[84:87]
 s_waitcnt lgkmcnt(4)
 ds_read_b64_tr_b16 a[40:41], v9 offset:14368
 v_mfma_f32_16x16x32_bf16 v[136:139], a[8:11], a[80:83], v[136:139]
 ds_read_b64_tr_b16 a[42:43], v9 offset:17952
 v_mfma_f32_16x16x32_bf16 v[136:139], a[12:15], a[84:87], v[136:139]
 ds_read_b64_tr_b16 a[44:45], v9 offset:21536
 v_mfma_f32_16x16x32_bf16 v[140:143], a[8:11], a[136:139], v[140:143]
 ds_read_b64_tr_b16 a[46:47], v9 offset:25120
 v_mfma_f32_16x16x32_bf16 v[140:143], a[12:15], a[140:143], v[140:143]
 s_waitcnt vmcnt(25)
 v_mfma_f32_16x16x32_bf16 v[32:35], a[16:19], a[88:91], v[32:35]
 s_add_u32 m0, s43, 98304
 s_add_u32 s35, s49, 1376256
 ds_read_b64_tr_b16 a[48:49], v9 offset:64
 s_waitcnt vmcnt(23)
 v_mfma_f32_16x16x32_bf16 v[32:35], a[20:23], a[92:95], v[32:35]
 buffer_load_dwordx4 v2, s[8:11], s35 offen offset:0 lds
 v_mfma_f32_16x16x32_bf16 v[36:39], a[16:19], a[144:147], v[36:39]
 ds_read_b64_tr_b16 a[50:51], v9 offset:3648
 ds_read_b64_tr_b16 a[52:53], v9 offset:7232
 s_waitcnt vmcnt(23)
 v_mfma_f32_16x16x32_bf16 v[36:39], a[20:23], a[148:151], v[36:39]
 ds_read_b64_tr_b16 a[54:55], v9 offset:10816
 ds_read_b64_tr_b16 a[56:57], v9 offset:14400
 v_mfma_f32_16x16x32_bf16 v[88:91], a[24:27], a[88:91], v[88:91]
 ds_read_b64_tr_b16 a[58:59], v9 offset:17984
 v_mfma_f32_16x16x32_bf16 v[88:91], a[28:31], a[92:95], v[88:91]
 buffer_load_dwordx4 v3, s[8:11], s35 offen offset:1024 lds
 v_mfma_f32_16x16x32_bf16 v[92:95], a[24:27], a[144:147], v[92:95]
 ds_read_b64_tr_b16 a[60:61], v9 offset:21568
 ds_read_b64_tr_b16 a[62:63], v9 offset:25152
 v_mfma_f32_16x16x32_bf16 v[92:95], a[28:31], a[148:151], v[92:95]
 s_waitcnt lgkmcnt(5)
 v_mfma_f32_16x16x32_bf16 v[40:43], a[32:35], a[88:91], v[40:43]
 ds_read_b64_tr_b16 a[0:1], v9 offset:96
 ds_read_b64_tr_b16 a[2:3], v9 offset:3680
 v_mfma_f32_16x16x32_bf16 v[40:43], a[36:39], a[92:95], v[40:43]
 buffer_load_dwordx4 v4, s[8:11], s35 offen offset:2048 lds
 v_mfma_f32_16x16x32_bf16 v[44:47], a[32:35], a[144:147], v[44:47]
 ds_read_b64_tr_b16 a[4:5], v9 offset:7264
 ds_read_b64_tr_b16 a[6:7], v9 offset:10848
 v_mfma_f32_16x16x32_bf16 v[44:47], a[36:39], a[148:151], v[44:47]
 ds_read_b64_tr_b16 a[8:9], v9 offset:14432
 v_mfma_f32_16x16x32_bf16 v[96:99], a[40:43], a[88:91], v[96:99]
 ds_read_b64_tr_b16 a[10:11], v9 offset:18016
 v_mfma_f32_16x16x32_bf16 v[96:99], a[44:47], a[92:95], v[96:99]
 buffer_load_dwordx4 v5, s[8:11], s35 offen offset:3072 lds
 v_mfma_f32_16x16x32_bf16 v[100:103], a[40:43], a[144:147], v[100:103]
 ds_read_b64_tr_b16 a[12:13], v9 offset:21600
 ds_read_b64_tr_b16 a[14:15], v9 offset:25184
 v_mfma_f32_16x16x32_bf16 v[100:103], a[44:47], a[148:151], v[100:103]
 v_mfma_f32_16x16x32_bf16 v[48:51], a[48:51], a[88:91], v[48:51]
 s_waitcnt lgkmcnt(3)
 ds_read_b64_tr_b16 a[16:17], v9 offset:128
 ds_read_b64_tr_b16 a[18:19], v9 offset:3712
 v_mfma_f32_16x16x32_bf16 v[48:51], a[52:55], a[92:95], v[48:51]
 s_add_u32 m0, s43, 102400
 ds_read_b64_tr_b16 a[20:21], v9 offset:7296
 v_mfma_f32_16x16x32_bf16 v[52:55], a[48:51], a[144:147], v[52:55]
 s_add_u32 s35, s49, 1376256
 buffer_load_dwordx4 v6, s[8:11], s35 offen offset:0 lds
 v_mfma_f32_16x16x32_bf16 v[52:55], a[52:55], a[148:151], v[52:55]
 ds_read_b64_tr_b16 a[22:23], v9 offset:10880
 ds_read_b64_tr_b16 a[24:25], v9 offset:14464
 v_mfma_f32_16x16x32_bf16 v[104:107], a[56:59], a[88:91], v[104:107]
 ds_read_b64_tr_b16 a[26:27], v9 offset:18048
 v_mfma_f32_16x16x32_bf16 v[104:107], a[60:63], a[92:95], v[104:107]
 ds_read_b64_tr_b16 a[28:29], v9 offset:21632
 v_mfma_f32_16x16x32_bf16 v[108:111], a[56:59], a[144:147], v[108:111]
 buffer_load_dwordx4 v7, s[8:11], s35 offen offset:1024 lds
 ds_read_b64_tr_b16 a[30:31], v9 offset:25216
 v_mfma_f32_16x16x32_bf16 v[108:111], a[60:63], a[148:151], v[108:111]
 v_mfma_f32_16x16x32_bf16 v[56:59], a[0:3], a[88:91], v[56:59]
 ds_read_b64_tr_b16 a[32:33], v9 offset:160
 ds_read_b64_tr_b16 a[34:35], v9 offset:3744
 v_mfma_f32_16x16x32_bf16 v[56:59], a[4:7], a[92:95], v[56:59]
 ds_read_b64_tr_b16 a[36:37], v9 offset:7328
 v_mfma_f32_16x16x32_bf16 v[60:63], a[0:3], a[144:147], v[60:63]
 ds_read_b64_tr_b16 a[38:39], v9 offset:10912
 v_mfma_f32_16x16x32_bf16 v[60:63], a[4:7], a[148:151], v[60:63]
 s_waitcnt lgkmcnt(4)
 buffer_load_dwordx4 v8, s[8:11], s35 offen offset:2048 lds
 v_mfma_f32_16x16x32_bf16 v[112:115], a[8:11], a[88:91], v[112:115]
 ds_read_b64_tr_b16 a[40:41], v9 offset:14496
 ds_read_b64_tr_b16 a[42:43], v9 offset:18080
 v_mfma_f32_16x16x32_bf16 v[112:115], a[12:15], a[92:95], v[112:115]
 ds_read_b64_tr_b16 a[44:45], v9 offset:21664
 v_mfma_f32_16x16x32_bf16 v[116:119], a[8:11], a[144:147], v[116:119]
 ds_read_b64_tr_b16 a[46:47], v9 offset:25248
 v_mfma_f32_16x16x32_bf16 v[116:119], a[12:15], a[148:151], v[116:119]
 s_add_u32 s38, s36, 12288
 buffer_load_dwordx4 a[112:115], v1, s[16:19], s38 offen sc1
 v_mfma_f32_16x16x32_bf16 v[64:67], a[16:19], a[88:91], v[64:67]
 ds_read_b64_tr_b16 a[48:49], v9 offset:192
 ds_read_b64_tr_b16 a[50:51], v9 offset:3776
 v_mfma_f32_16x16x32_bf16 v[64:67], a[20:23], a[92:95], v[64:67]
 ds_read_b64_tr_b16 a[52:53], v9 offset:7360
 v_mfma_f32_16x16x32_bf16 v[68:71], a[16:19], a[144:147], v[68:71]
 ds_read_b64_tr_b16 a[54:55], v9 offset:10944
 v_mfma_f32_16x16x32_bf16 v[68:71], a[20:23], a[148:151], v[68:71]
 s_add_u32 s38, s36, 26624
 buffer_load_dwordx4 a[168:171], v1, s[16:19], s38 offen sc1
 v_mfma_f32_16x16x32_bf16 v[120:123], a[24:27], a[88:91], v[120:123]
 ds_read_b64_tr_b16 a[56:57], v9 offset:14528
 ds_read_b64_tr_b16 a[58:59], v9 offset:18112
 v_mfma_f32_16x16x32_bf16 v[120:123], a[28:31], a[92:95], v[120:123]
 ds_read_b64_tr_b16 a[60:61], v9 offset:21696
 v_mfma_f32_16x16x32_bf16 v[124:127], a[24:27], a[144:147], v[124:127]
 ds_read_b64_tr_b16 a[62:63], v9 offset:25280
 v_mfma_f32_16x16x32_bf16 v[124:127], a[28:31], a[148:151], v[124:127]
 s_waitcnt vmcnt(24)
 s_barrier
 v_add_u32 v9, 0x18000, v9
 s_waitcnt lgkmcnt(4)
 v_mfma_f32_16x16x32_bf16 v[72:75], a[32:35], a[88:91], v[72:75]
 s_add_u32 s38, s36, 13312
 buffer_load_dwordx4 a[116:119], v1, s[16:19], s38 offen sc1
 v_mfma_f32_16x16x32_bf16 v[72:75], a[36:39], a[92:95], v[72:75]
 ds_read_b64_tr_b16 a[0:1], v9 offset:0
 ds_read_b64_tr_b16 a[2:3], v9 offset:3584
 v_mfma_f32_16x16x32_bf16 v[76:79], a[32:35], a[144:147], v[76:79]
 ds_read_b64_tr_b16 a[4:5], v9 offset:7168
 ds_read_b64_tr_b16 a[6:7], v9 offset:10752
 v_mfma_f32_16x16x32_bf16 v[76:79], a[36:39], a[148:151], v[76:79]
 ds_read_b64_tr_b16 a[8:9], v9 offset:14336
 v_mfma_f32_16x16x32_bf16 v[128:131], a[40:43], a[88:91], v[128:131]
 s_add_u32 s38, s36, 27648
 buffer_load_dwordx4 a[172:175], v1, s[16:19], s38 offen sc1
 v_mfma_f32_16x16x32_bf16 v[128:131], a[44:47], a[92:95], v[128:131]
 ds_read_b64_tr_b16 a[10:11], v9 offset:17920
 ds_read_b64_tr_b16 a[12:13], v9 offset:21504
 v_mfma_f32_16x16x32_bf16 v[132:135], a[40:43], a[144:147], v[132:135]
 ds_read_b64_tr_b16 a[14:15], v9 offset:25088
 v_mfma_f32_16x16x32_bf16 v[132:135], a[44:47], a[148:151], v[132:135]
 v_mfma_f32_16x16x32_bf16 v[80:83], a[48:51], a[88:91], v[80:83]
 ds_read_b64_tr_b16 a[16:17], v9 offset:32
 ds_read_b64_tr_b16 a[18:19], v9 offset:3616
 v_mfma_f32_16x16x32_bf16 v[80:83], a[52:55], a[92:95], v[80:83]
 ds_read_b64_tr_b16 a[20:21], v9 offset:7200
 v_mfma_f32_16x16x32_bf16 v[84:87], a[48:51], a[144:147], v[84:87]
 ds_read_b64_tr_b16 a[22:23], v9 offset:10784
 v_mfma_f32_16x16x32_bf16 v[84:87], a[52:55], a[148:151], v[84:87]
 s_waitcnt lgkmcnt(4)
 ds_read_b64_tr_b16 a[24:25], v9 offset:14368
 v_mfma_f32_16x16x32_bf16 v[136:139], a[56:59], a[88:91], v[136:139]
 ds_read_b64_tr_b16 a[26:27], v9 offset:17952
 v_mfma_f32_16x16x32_bf16 v[136:139], a[60:63], a[92:95], v[136:139]
 ds_read_b64_tr_b16 a[28:29], v9 offset:21536
 v_mfma_f32_16x16x32_bf16 v[140:143], a[56:59], a[144:147], v[140:143]
 ds_read_b64_tr_b16 a[30:31], v9 offset:25120
 v_mfma_f32_16x16x32_bf16 v[140:143], a[60:63], a[148:151], v[140:143]
 s_waitcnt vmcnt(25)
 v_mfma_f32_16x16x32_bf16 v[32:35], a[0:3], a[96:99], v[32:35]
 s_add_u32 m0, s43, 0
 s_add_u32 s35, s42, 143360
 ds_read_b64_tr_b16 a[32:33], v9 offset:64
 s_waitcnt vmcnt(23)
 v_mfma_f32_16x16x32_bf16 v[32:35], a[4:7], a[100:103], v[32:35]
 buffer_load_dwordx4 v16, s[12:15], s35 offen offset:0 lds
 v_mfma_f32_16x16x32_bf16 v[36:39], a[0:3], a[152:155], v[36:39]
 ds_read_b64_tr_b16 a[34:35], v9 offset:3648
 ds_read_b64_tr_b16 a[36:37], v9 offset:7232
 s_waitcnt vmcnt(23)
 v_mfma_f32_16x16x32_bf16 v[36:39], a[4:7], a[156:159], v[36:39]
 ds_read_b64_tr_b16 a[38:39], v9 offset:10816
 ds_read_b64_tr_b16 a[40:41], v9 offset:14400
 v_mfma_f32_16x16x32_bf16 v[88:91], a[8:11], a[96:99], v[88:91]
 ds_read_b64_tr_b16 a[42:43], v9 offset:17984
 v_mfma_f32_16x16x32_bf16 v[88:91], a[12:15], a[100:103], v[88:91]
 ds_read_b64_tr_b16 a[44:45], v9 offset:21568
 v_mfma_f32_16x16x32_bf16 v[92:95], a[8:11], a[152:155], v[92:95]
 buffer_load_dwordx4 v17, s[12:15], s35 offen offset:1024 lds
 ds_read_b64_tr_b16 a[46:47], v9 offset:25152
 v_mfma_f32_16x16x32_bf16 v[92:95], a[12:15], a[156:159], v[92:95]
 s_waitcnt lgkmcnt(5)
 v_mfma_f32_16x16x32_bf16 v[40:43], a[16:19], a[96:99], v[40:43]
 ds_read_b64_tr_b16 a[48:49], v9 offset:96
 ds_read_b64_tr_b16 a[50:51], v9 offset:3680
 v_mfma_f32_16x16x32_bf16 v[40:43], a[20:23], a[100:103], v[40:43]
 ds_read_b64_tr_b16 a[52:53], v9 offset:7264
 v_mfma_f32_16x16x32_bf16 v[44:47], a[16:19], a[152:155], v[44:47]
 ds_read_b64_tr_b16 a[54:55], v9 offset:10848
 v_mfma_f32_16x16x32_bf16 v[44:47], a[20:23], a[156:159], v[44:47]
 buffer_load_dwordx4 v18, s[12:15], s35 offen offset:2048 lds
 v_mfma_f32_16x16x32_bf16 v[96:99], a[24:27], a[96:99], v[96:99]
 ds_read_b64_tr_b16 a[56:57], v9 offset:14432
 ds_read_b64_tr_b16 a[58:59], v9 offset:18016
 v_mfma_f32_16x16x32_bf16 v[96:99], a[28:31], a[100:103], v[96:99]
 ds_read_b64_tr_b16 a[60:61], v9 offset:21600
 v_mfma_f32_16x16x32_bf16 v[100:103], a[24:27], a[152:155], v[100:103]
 ds_read_b64_tr_b16 a[62:63], v9 offset:25184
 v_mfma_f32_16x16x32_bf16 v[100:103], a[28:31], a[156:159], v[100:103]
 v_mfma_f32_16x16x32_bf16 v[48:51], a[32:35], a[96:99], v[48:51]
 s_waitcnt lgkmcnt(4)
 buffer_load_dwordx4 v19, s[12:15], s35 offen offset:3072 lds
 v_mfma_f32_16x16x32_bf16 v[48:51], a[36:39], a[100:103], v[48:51]
 ds_read_b64_tr_b16 a[0:1], v9 offset:128
 ds_read_b64_tr_b16 a[2:3], v9 offset:3712
 v_mfma_f32_16x16x32_bf16 v[52:55], a[32:35], a[152:155], v[52:55]
 ds_read_b64_tr_b16 a[4:5], v9 offset:7296
 ds_read_b64_tr_b16 a[6:7], v9 offset:10880
 v_mfma_f32_16x16x32_bf16 v[52:55], a[36:39], a[156:159], v[52:55]
 ds_read_b64_tr_b16 a[8:9], v9 offset:14464
 v_mfma_f32_16x16x32_bf16 v[104:107], a[40:43], a[96:99], v[104:107]
 ds_read_b64_tr_b16 a[10:11], v9 offset:18048
 v_mfma_f32_16x16x32_bf16 v[104:107], a[44:47], a[100:103], v[104:107]
 s_add_u32 m0, s43, 4096
 ds_read_b64_tr_b16 a[12:13], v9 offset:21632
 v_mfma_f32_16x16x32_bf16 v[108:111], a[40:43], a[152:155], v[108:111]
 s_add_u32 s35, s42, 143360
 buffer_load_dwordx4 v20, s[12:15], s35 offen offset:0 lds
 ds_read_b64_tr_b16 a[14:15], v9 offset:25216
 v_mfma_f32_16x16x32_bf16 v[108:111], a[44:47], a[156:159], v[108:111]
 v_mfma_f32_16x16x32_bf16 v[56:59], a[48:51], a[96:99], v[56:59]
 ds_read_b64_tr_b16 a[16:17], v9 offset:160
 ds_read_b64_tr_b16 a[18:19], v9 offset:3744
 v_mfma_f32_16x16x32_bf16 v[56:59], a[52:55], a[100:103], v[56:59]
 ds_read_b64_tr_b16 a[20:21], v9 offset:7328
 v_mfma_f32_16x16x32_bf16 v[60:63], a[48:51], a[152:155], v[60:63]
 ds_read_b64_tr_b16 a[22:23], v9 offset:10912
 v_mfma_f32_16x16x32_bf16 v[60:63], a[52:55], a[156:159], v[60:63]
 s_waitcnt lgkmcnt(4)
 buffer_load_dwordx4 v21, s[12:15], s35 offen offset:1024 lds
 v_mfma_f32_16x16x32_bf16 v[112:115], a[56:59], a[96:99], v[112:115]
 ds_read_b64_tr_b16 a[24:25], v9 offset:14496
 ds_read_b64_tr_b16 a[26:27], v9 offset:18080
 v_mfma_f32_16x16x32_bf16 v[112:115], a[60:63], a[100:103], v[112:115]
 ds_read_b64_tr_b16 a[28:29], v9 offset:21664
 v_mfma_f32_16x16x32_bf16 v[116:119], a[56:59], a[152:155], v[116:119]
 ds_read_b64_tr_b16 a[30:31], v9 offset:25248
 v_mfma_f32_16x16x32_bf16 v[116:119], a[60:63], a[156:159], v[116:119]
 v_mfma_f32_16x16x32_bf16 v[64:67], a[0:3], a[96:99], v[64:67]
 buffer_load_dwordx4 v22, s[12:15], s35 offen offset:2048 lds
 v_mfma_f32_16x16x32_bf16 v[64:67], a[4:7], a[100:103], v[64:67]
 ds_read_b64_tr_b16 a[32:33], v9 offset:192
 ds_read_b64_tr_b16 a[34:35], v9 offset:3776
 v_mfma_f32_16x16x32_bf16 v[68:71], a[0:3], a[152:155], v[68:71]
 ds_read_b64_tr_b16 a[36:37], v9 offset:7360
 ds_read_b64_tr_b16 a[38:39], v9 offset:10944
 v_mfma_f32_16x16x32_bf16 v[68:71], a[4:7], a[156:159], v[68:71]
 ds_read_b64_tr_b16 a[40:41], v9 offset:14528
 v_mfma_f32_16x16x32_bf16 v[120:123], a[8:11], a[96:99], v[120:123]
 ds_read_b64_tr_b16 a[42:43], v9 offset:18112
 v_mfma_f32_16x16x32_bf16 v[120:123], a[12:15], a[100:103], v[120:123]
 ds_read_b64_tr_b16 a[44:45], v9 offset:21696
 v_mfma_f32_16x16x32_bf16 v[124:127], a[8:11], a[152:155], v[124:127]
 ds_read_b64_tr_b16 a[46:47], v9 offset:25280
 v_mfma_f32_16x16x32_bf16 v[124:127], a[12:15], a[156:159], v[124:127]
 s_waitcnt vmcnt(22)
 s_barrier
 v_add_u32 v9, 0xffff0000, v9
 s_waitcnt lgkmcnt(4)
 v_mfma_f32_16x16x32_bf16 v[72:75], a[16:19], a[96:99], v[72:75]
 ds_read_b64_tr_b16 a[48:49], v9 offset:0
 ds_read_b64_tr_b16 a[50:51], v9 offset:3584
 v_mfma_f32_16x16x32_bf16 v[72:75], a[20:23], a[100:103], v[72:75]
 ds_read_b64_tr_b16 a[52:53], v9 offset:7168
 v_mfma_f32_16x16x32_bf16 v[76:79], a[16:19], a[152:155], v[76:79]
 ds_read_b64_tr_b16 a[54:55], v9 offset:10752
 v_mfma_f32_16x16x32_bf16 v[76:79], a[20:23], a[156:159], v[76:79]
 ds_read_b64_tr_b16 a[56:57], v9 offset:14336
 v_mfma_f32_16x16x32_bf16 v[128:131], a[24:27], a[96:99], v[128:131]
 ds_read_b64_tr_b16 a[58:59], v9 offset:17920
 v_mfma_f32_16x16x32_bf16 v[128:131], a[28:31], a[100:103], v[128:131]
 ds_read_b64_tr_b16 a[60:61], v9 offset:21504
 v_mfma_f32_16x16x32_bf16 v[132:135], a[24:27], a[152:155], v[132:135]
 ds_read_b64_tr_b16 a[62:63], v9 offset:25088
 v_mfma_f32_16x16x32_bf16 v[132:135], a[28:31], a[156:159], v[132:135]
 v_mfma_f32_16x16x32_bf16 v[80:83], a[32:35], a[96:99], v[80:83]
 ds_read_b64_tr_b16 a[0:1], v9 offset:32
 ds_read_b64_tr_b16 a[2:3], v9 offset:3616
 v_mfma_f32_16x16x32_bf16 v[80:83], a[36:39], a[100:103], v[80:83]
 ds_read_b64_tr_b16 a[4:5], v9 offset:7200
 v_mfma_f32_16x16x32_bf16 v[84:87], a[32:35], a[152:155], v[84:87]
 ds_read_b64_tr_b16 a[6:7], v9 offset:10784
 v_mfma_f32_16x16x32_bf16 v[84:87], a[36:39], a[156:159], v[84:87]
 s_waitcnt lgkmcnt(4)
 ds_read_b64_tr_b16 a[8:9], v9 offset:14368
 v_mfma_f32_16x16x32_bf16 v[136:139], a[40:43], a[96:99], v[136:139]
 ds_read_b64_tr_b16 a[10:11], v9 offset:17952
 v_mfma_f32_16x16x32_bf16 v[136:139], a[44:47], a[100:103], v[136:139]
 ds_read_b64_tr_b16 a[12:13], v9 offset:21536
 v_mfma_f32_16x16x32_bf16 v[140:143], a[40:43], a[152:155], v[140:143]
 ds_read_b64_tr_b16 a[14:15], v9 offset:25120
 v_mfma_f32_16x16x32_bf16 v[140:143], a[44:47], a[156:159], v[140:143]
 s_waitcnt vmcnt(21)
 v_mfma_f32_16x16x32_bf16 v[32:35], a[48:51], a[104:107], v[32:35]
 s_add_u32 m0, s43, 32768
 s_add_u32 s35, s42, 172032
 ds_read_b64_tr_b16 a[16:17], v9 offset:64
 s_waitcnt vmcnt(19)
 v_mfma_f32_16x16x32_bf16 v[32:35], a[52:55], a[108:111], v[32:35]
 buffer_load_dwordx4 v16, s[12:15], s35 offen offset:0 lds
 v_mfma_f32_16x16x32_bf16 v[36:39], a[48:51], a[160:163], v[36:39]
 ds_read_b64_tr_b16 a[18:19], v9 offset:3648
 ds_read_b64_tr_b16 a[20:21], v9 offset:7232
 s_waitcnt vmcnt(19)
 v_mfma_f32_16x16x32_bf16 v[36:39], a[52:55], a[164:167], v[36:39]
 ds_read_b64_tr_b16 a[22:23], v9 offset:10816
 ds_read_b64_tr_b16 a[24:25], v9 offset:14400
 v_mfma_f32_16x16x32_bf16 v[88:91], a[56:59], a[104:107], v[88:91]
 ds_read_b64_tr_b16 a[26:27], v9 offset:17984
 v_mfma_f32_16x16x32_bf16 v[88:91], a[60:63], a[108:111], v[88:91]
 ds_read_b64_tr_b16 a[28:29], v9 offset:21568
 v_mfma_f32_16x16x32_bf16 v[92:95], a[56:59], a[160:163], v[92:95]
 buffer_load_dwordx4 v17, s[12:15], s35 offen offset:1024 lds
 ds_read_b64_tr_b16 a[30:31], v9 offset:25152
 v_mfma_f32_16x16x32_bf16 v[92:95], a[60:63], a[164:167], v[92:95]
 s_waitcnt lgkmcnt(5)
 v_mfma_f32_16x16x32_bf16 v[40:43], a[0:3], a[104:107], v[40:43]
 ds_read_b64_tr_b16 a[32:33], v9 offset:96
 ds_read_b64_tr_b16 a[34:35], v9 offset:3680
 v_mfma_f32_16x16x32_bf16 v[40:43], a[4:7], a[108:111], v[40:43]
 ds_read_b64_tr_b16 a[36:37], v9 offset:7264
 v_mfma_f32_16x16x32_bf16 v[44:47], a[0:3], a[160:163], v[44:47]
 ds_read_b64_tr_b16 a[38:39], v9 offset:10848
 v_mfma_f32_16x16x32_bf16 v[44:47], a[4:7], a[164:167], v[44:47]
 buffer_load_dwordx4 v18, s[12:15], s35 offen offset:2048 lds
 v_mfma_f32_16x16x32_bf16 v[96:99], a[8:11], a[104:107], v[96:99]
 ds_read_b64_tr_b16 a[40:41], v9 offset:14432
 ds_read_b64_tr_b16 a[42:43], v9 offset:18016
 v_mfma_f32_16x16x32_bf16 v[96:99], a[12:15], a[108:111], v[96:99]
 ds_read_b64_tr_b16 a[44:45], v9 offset:21600
 v_mfma_f32_16x16x32_bf16 v[100:103], a[8:11], a[160:163], v[100:103]
 ds_read_b64_tr_b16 a[46:47], v9 offset:25184
 v_mfma_f32_16x16x32_bf16 v[100:103], a[12:15], a[164:167], v[100:103]
 v_mfma_f32_16x16x32_bf16 v[48:51], a[16:19], a[104:107], v[48:51]
 s_waitcnt lgkmcnt(4)
 buffer_load_dwordx4 v19, s[12:15], s35 offen offset:3072 lds
 v_mfma_f32_16x16x32_bf16 v[48:51], a[20:23], a[108:111], v[48:51]
 ds_read_b64_tr_b16 a[48:49], v9 offset:128
 ds_read_b64_tr_b16 a[50:51], v9 offset:3712
 v_mfma_f32_16x16x32_bf16 v[52:55], a[16:19], a[160:163], v[52:55]
 ds_read_b64_tr_b16 a[52:53], v9 offset:7296
 ds_read_b64_tr_b16 a[54:55], v9 offset:10880
 v_mfma_f32_16x16x32_bf16 v[52:55], a[20:23], a[164:167], v[52:55]
 ds_read_b64_tr_b16 a[56:57], v9 offset:14464
 v_mfma_f32_16x16x32_bf16 v[104:107], a[24:27], a[104:107], v[104:107]
 ds_read_b64_tr_b16 a[58:59], v9 offset:18048
 v_mfma_f32_16x16x32_bf16 v[104:107], a[28:31], a[108:111], v[104:107]
 s_add_u32 m0, s43, 36864
 ds_read_b64_tr_b16 a[60:61], v9 offset:21632
 v_mfma_f32_16x16x32_bf16 v[108:111], a[24:27], a[160:163], v[108:111]
 s_add_u32 s35, s42, 172032
 buffer_load_dwordx4 v20, s[12:15], s35 offen offset:0 lds
 ds_read_b64_tr_b16 a[62:63], v9 offset:25216
 v_mfma_f32_16x16x32_bf16 v[108:111], a[28:31], a[164:167], v[108:111]
 v_mfma_f32_16x16x32_bf16 v[56:59], a[32:35], a[104:107], v[56:59]
 ds_read_b64_tr_b16 a[0:1], v9 offset:160
 ds_read_b64_tr_b16 a[2:3], v9 offset:3744
 v_mfma_f32_16x16x32_bf16 v[56:59], a[36:39], a[108:111], v[56:59]
 ds_read_b64_tr_b16 a[4:5], v9 offset:7328
 v_mfma_f32_16x16x32_bf16 v[60:63], a[32:35], a[160:163], v[60:63]
 ds_read_b64_tr_b16 a[6:7], v9 offset:10912
 v_mfma_f32_16x16x32_bf16 v[60:63], a[36:39], a[164:167], v[60:63]
 s_waitcnt lgkmcnt(4)
 buffer_load_dwordx4 v21, s[12:15], s35 offen offset:1024 lds
 v_mfma_f32_16x16x32_bf16 v[112:115], a[40:43], a[104:107], v[112:115]
 ds_read_b64_tr_b16 a[8:9], v9 offset:14496
 ds_read_b64_tr_b16 a[10:11], v9 offset:18080
 v_mfma_f32_16x16x32_bf16 v[112:115], a[44:47], a[108:111], v[112:115]
 ds_read_b64_tr_b16 a[12:13], v9 offset:21664
 v_mfma_f32_16x16x32_bf16 v[116:119], a[40:43], a[160:163], v[116:119]
 ds_read_b64_tr_b16 a[14:15], v9 offset:25248
 v_mfma_f32_16x16x32_bf16 v[116:119], a[44:47], a[164:167], v[116:119]
 v_mfma_f32_16x16x32_bf16 v[64:67], a[48:51], a[104:107], v[64:67]
 buffer_load_dwordx4 v22, s[12:15], s35 offen offset:2048 lds
 v_mfma_f32_16x16x32_bf16 v[64:67], a[52:55], a[108:111], v[64:67]
 ds_read_b64_tr_b16 a[16:17], v9 offset:192
 ds_read_b64_tr_b16 a[18:19], v9 offset:3776
 v_mfma_f32_16x16x32_bf16 v[68:71], a[48:51], a[160:163], v[68:71]
 ds_read_b64_tr_b16 a[20:21], v9 offset:7360
 ds_read_b64_tr_b16 a[22:23], v9 offset:10944
 v_mfma_f32_16x16x32_bf16 v[68:71], a[52:55], a[164:167], v[68:71]
 ds_read_b64_tr_b16 a[24:25], v9 offset:14528
 v_mfma_f32_16x16x32_bf16 v[120:123], a[56:59], a[104:107], v[120:123]
 ds_read_b64_tr_b16 a[26:27], v9 offset:18112
 v_mfma_f32_16x16x32_bf16 v[120:123], a[60:63], a[108:111], v[120:123]
 ds_read_b64_tr_b16 a[28:29], v9 offset:21696
 v_mfma_f32_16x16x32_bf16 v[124:127], a[56:59], a[160:163], v[124:127]
 ds_read_b64_tr_b16 a[30:31], v9 offset:25280
 v_mfma_f32_16x16x32_bf16 v[124:127], a[60:63], a[164:167], v[124:127]
 s_waitcnt vmcnt(18)
 s_barrier
 v_add_u32 v9, 0x8000, v9
 s_waitcnt lgkmcnt(4)
 v_mfma_f32_16x16x32_bf16 v[72:75], a[0:3], a[104:107], v[72:75]
 ds_read_b64_tr_b16 a[32:33], v9 offset:0
 ds_read_b64_tr_b16 a[34:35], v9 offset:3584
 v_mfma_f32_16x16x32_bf16 v[72:75], a[4:7], a[108:111], v[72:75]
 ds_read_b64_tr_b16 a[36:37], v9 offset:7168
 v_mfma_f32_16x16x32_bf16 v[76:79], a[0:3], a[160:163], v[76:79]
 ds_read_b64_tr_b16 a[38:39], v9 offset:10752
 v_mfma_f32_16x16x32_bf16 v[76:79], a[4:7], a[164:167], v[76:79]
 ds_read_b64_tr_b16 a[40:41], v9 offset:14336
 v_mfma_f32_16x16x32_bf16 v[128:131], a[8:11], a[104:107], v[128:131]
 ds_read_b64_tr_b16 a[42:43], v9 offset:17920
 v_mfma_f32_16x16x32_bf16 v[128:131], a[12:15], a[108:111], v[128:131]
 ds_read_b64_tr_b16 a[44:45], v9 offset:21504
 v_mfma_f32_16x16x32_bf16 v[132:135], a[8:11], a[160:163], v[132:135]
 ds_read_b64_tr_b16 a[46:47], v9 offset:25088
 v_mfma_f32_16x16x32_bf16 v[132:135], a[12:15], a[164:167], v[132:135]
 v_mfma_f32_16x16x32_bf16 v[80:83], a[16:19], a[104:107], v[80:83]
 ds_read_b64_tr_b16 a[48:49], v9 offset:32
 ds_read_b64_tr_b16 a[50:51], v9 offset:3616
 v_mfma_f32_16x16x32_bf16 v[80:83], a[20:23], a[108:111], v[80:83]
 ds_read_b64_tr_b16 a[52:53], v9 offset:7200
 v_mfma_f32_16x16x32_bf16 v[84:87], a[16:19], a[160:163], v[84:87]
 ds_read_b64_tr_b16 a[54:55], v9 offset:10784
 v_mfma_f32_16x16x32_bf16 v[84:87], a[20:23], a[164:167], v[84:87]
 s_waitcnt lgkmcnt(4)
 ds_read_b64_tr_b16 a[56:57], v9 offset:14368
 v_mfma_f32_16x16x32_bf16 v[136:139], a[24:27], a[104:107], v[136:139]
 ds_read_b64_tr_b16 a[58:59], v9 offset:17952
 v_mfma_f32_16x16x32_bf16 v[136:139], a[28:31], a[108:111], v[136:139]
 ds_read_b64_tr_b16 a[60:61], v9 offset:21536
 v_mfma_f32_16x16x32_bf16 v[140:143], a[24:27], a[160:163], v[140:143]
 ds_read_b64_tr_b16 a[62:63], v9 offset:25120
 v_mfma_f32_16x16x32_bf16 v[140:143], a[28:31], a[164:167], v[140:143]
 s_waitcnt vmcnt(17)
 v_mfma_f32_16x16x32_bf16 v[32:35], a[32:35], a[112:115], v[32:35]
 s_add_u32 m0, s43, 131072
 s_add_u32 s35, s42, 200704
 ds_read_b64_tr_b16 a[0:1], v9 offset:64
 s_waitcnt vmcnt(15)
 v_mfma_f32_16x16x32_bf16 v[32:35], a[36:39], a[116:119], v[32:35]
 buffer_load_dwordx4 v16, s[12:15], s35 offen offset:0 lds
 v_mfma_f32_16x16x32_bf16 v[36:39], a[32:35], a[168:171], v[36:39]
 ds_read_b64_tr_b16 a[2:3], v9 offset:3648
 ds_read_b64_tr_b16 a[4:5], v9 offset:7232
 s_waitcnt vmcnt(15)
 v_mfma_f32_16x16x32_bf16 v[36:39], a[36:39], a[172:175], v[36:39]
 ds_read_b64_tr_b16 a[6:7], v9 offset:10816
 ds_read_b64_tr_b16 a[8:9], v9 offset:14400
 v_mfma_f32_16x16x32_bf16 v[88:91], a[40:43], a[112:115], v[88:91]
 ds_read_b64_tr_b16 a[10:11], v9 offset:17984
 v_mfma_f32_16x16x32_bf16 v[88:91], a[44:47], a[116:119], v[88:91]
 ds_read_b64_tr_b16 a[12:13], v9 offset:21568
 v_mfma_f32_16x16x32_bf16 v[92:95], a[40:43], a[168:171], v[92:95]
 buffer_load_dwordx4 v17, s[12:15], s35 offen offset:1024 lds
 ds_read_b64_tr_b16 a[14:15], v9 offset:25152
 v_mfma_f32_16x16x32_bf16 v[92:95], a[44:47], a[172:175], v[92:95]
 s_waitcnt lgkmcnt(5)
 v_mfma_f32_16x16x32_bf16 v[40:43], a[48:51], a[112:115], v[40:43]
 ds_read_b64_tr_b16 a[16:17], v9 offset:96
 ds_read_b64_tr_b16 a[18:19], v9 offset:3680
 v_mfma_f32_16x16x32_bf16 v[40:43], a[52:55], a[116:119], v[40:43]
 ds_read_b64_tr_b16 a[20:21], v9 offset:7264
 v_mfma_f32_16x16x32_bf16 v[44:47], a[48:51], a[168:171], v[44:47]
 ds_read_b64_tr_b16 a[22:23], v9 offset:10848
 v_mfma_f32_16x16x32_bf16 v[44:47], a[52:55], a[172:175], v[44:47]
 buffer_load_dwordx4 v18, s[12:15], s35 offen offset:2048 lds
 v_mfma_f32_16x16x32_bf16 v[96:99], a[56:59], a[112:115], v[96:99]
 ds_read_b64_tr_b16 a[24:25], v9 offset:14432
 ds_read_b64_tr_b16 a[26:27], v9 offset:18016
 v_mfma_f32_16x16x32_bf16 v[96:99], a[60:63], a[116:119], v[96:99]
 ds_read_b64_tr_b16 a[28:29], v9 offset:21600
 v_mul_f32 v144, s30, v32
 v_mfma_f32_16x16x32_bf16 v[100:103], a[56:59], a[168:171], v[100:103]
 ds_read_b64_tr_b16 a[30:31], v9 offset:25184
 v_mul_f32 v145, s30, v33
 v_mfma_f32_16x16x32_bf16 v[100:103], a[60:63], a[172:175], v[100:103]
 v_mul_f32 v146, s30, v34
 v_mul_f32 v147, s30, v35
 v_mfma_f32_16x16x32_bf16 v[48:51], a[0:3], a[112:115], v[48:51]
 s_waitcnt lgkmcnt(4)
 buffer_load_dwordx4 v19, s[12:15], s35 offen offset:3072 lds
 v_mfma_f32_16x16x32_bf16 v[48:51], a[4:7], a[116:119], v[48:51]
 ds_read_b64_tr_b16 a[32:33], v9 offset:128
 ds_read_b64_tr_b16 a[34:35], v9 offset:3712
 v_mfma_f32_16x16x32_bf16 v[52:55], a[0:3], a[168:171], v[52:55]
 ds_read_b64_tr_b16 a[36:37], v9 offset:7296
 ds_read_b64_tr_b16 a[38:39], v9 offset:10880
 v_mfma_f32_16x16x32_bf16 v[52:55], a[4:7], a[172:175], v[52:55]
 ds_read_b64_tr_b16 a[40:41], v9 offset:14464
 v_exp_f32 v144, v144
 v_mfma_f32_16x16x32_bf16 v[104:107], a[8:11], a[112:115], v[104:107]
 ds_read_b64_tr_b16 a[42:43], v9 offset:18048
 v_mfma_f32_16x16x32_bf16 v[104:107], a[12:15], a[116:119], v[104:107]
 s_add_u32 m0, s43, 135168
 ds_read_b64_tr_b16 a[44:45], v9 offset:21632
 v_mfma_f32_16x16x32_bf16 v[108:111], a[8:11], a[168:171], v[108:111]
 s_add_u32 s35, s42, 200704
 buffer_load_dwordx4 v20, s[12:15], s35 offen offset:0 lds
 ds_read_b64_tr_b16 a[46:47], v9 offset:25216
 v_mfma_f32_16x16x32_bf16 v[108:111], a[12:15], a[172:175], v[108:111]
 v_exp_f32 v145, v145
 v_mfma_f32_16x16x32_bf16 v[56:59], a[16:19], a[112:115], v[56:59]
 ds_read_b64_tr_b16 a[48:49], v9 offset:160
 ds_read_b64_tr_b16 a[50:51], v9 offset:3744
 v_mfma_f32_16x16x32_bf16 v[56:59], a[20:23], a[116:119], v[56:59]
 ds_read_b64_tr_b16 a[52:53], v9 offset:7328
 v_exp_f32 v146, v146
 v_mfma_f32_16x16x32_bf16 v[60:63], a[16:19], a[168:171], v[60:63]
 ds_read_b64_tr_b16 a[54:55], v9 offset:10912
 v_exp_f32 v147, v147
 v_mfma_f32_16x16x32_bf16 v[60:63], a[20:23], a[172:175], v[60:63]
 s_waitcnt lgkmcnt(4)
 buffer_load_dwordx4 v21, s[12:15], s35 offen offset:1024 lds
 v_mfma_f32_16x16x32_bf16 v[112:115], a[24:27], a[112:115], v[112:115]
 ds_read_b64_tr_b16 a[56:57], v9 offset:14496
 ds_read_b64_tr_b16 a[58:59], v9 offset:18080
 v_mfma_f32_16x16x32_bf16 v[112:115], a[28:31], a[116:119], v[112:115]
 ds_read_b64_tr_b16 a[60:61], v9 offset:21664
 v_mul_f32 v88, v32, v88
 v_mfma_f32_16x16x32_bf16 v[116:119], a[24:27], a[168:171], v[116:119]
 ds_read_b64_tr_b16 a[62:63], v9 offset:25248
 v_mul_f32 v89, v33, v89
 v_mfma_f32_16x16x32_bf16 v[116:119], a[28:31], a[172:175], v[116:119]
 v_mul_f32 v90, v34, v90
 v_mul_f32 v91, v35, v91
 v_add_f32 v144, 1.0, v144
 v_mfma_f32_16x16x32_bf16 v[64:67], a[32:35], a[112:115], v[64:67]
 buffer_load_dwordx4 v22, s[12:15], s35 offen offset:2048 lds
 v_mfma_f32_16x16x32_bf16 v[64:67], a[36:39], a[116:119], v[64:67]
 ds_read_b64_tr_b16 a[0:1], v9 offset:192
 ds_read_b64_tr_b16 a[2:3], v9 offset:3776
 v_mfma_f32_16x16x32_bf16 v[68:71], a[32:35], a[168:171], v[68:71]
 ds_read_b64_tr_b16 a[4:5], v9 offset:7360
 ds_read_b64_tr_b16 a[6:7], v9 offset:10944
 v_mfma_f32_16x16x32_bf16 v[68:71], a[36:39], a[172:175], v[68:71]
 ds_read_b64_tr_b16 a[8:9], v9 offset:14528
 v_add_f32 v145, 1.0, v145
 v_mfma_f32_16x16x32_bf16 v[120:123], a[40:43], a[112:115], v[120:123]
 ds_read_b64_tr_b16 a[10:11], v9 offset:18112
 v_add_f32 v146, 1.0, v146
 v_mfma_f32_16x16x32_bf16 v[120:123], a[44:47], a[116:119], v[120:123]
 ds_read_b64_tr_b16 a[12:13], v9 offset:21696
 v_add_f32 v147, 1.0, v147
 v_mfma_f32_16x16x32_bf16 v[124:127], a[40:43], a[168:171], v[124:127]
 ds_read_b64_tr_b16 a[14:15], v9 offset:25280
 v_rcp_f32 v144, v144
 v_mfma_f32_16x16x32_bf16 v[124:127], a[44:47], a[172:175], v[124:127]
 s_waitcnt lgkmcnt(4)
 v_rcp_f32 v145, v145
 v_mfma_f32_16x16x32_bf16 v[72:75], a[48:51], a[112:115], v[72:75]
 v_rcp_f32 v146, v146
 v_mfma_f32_16x16x32_bf16 v[72:75], a[52:55], a[116:119], v[72:75]
 v_rcp_f32 v147, v147
 v_mfma_f32_16x16x32_bf16 v[76:79], a[48:51], a[168:171], v[76:79]
 v_mul_f32 v88, v88, v144
 v_mul_f32 v89, v89, v145
 v_mfma_f32_16x16x32_bf16 v[76:79], a[52:55], a[172:175], v[76:79]
 v_mul_f32 v90, v90, v146
 v_mul_f32 v91, v91, v147
 v_mfma_f32_16x16x32_bf16 v[128:131], a[56:59], a[112:115], v[128:131]
 v_cvt_pk_bf16_f32 v32, v88, v89
 v_cvt_pk_bf16_f32 v33, v90, v91
 v_mfma_f32_16x16x32_bf16 v[128:131], a[60:63], a[116:119], v[128:131]
 v_mul_f32 v148, s30, v36
 v_mul_f32 v149, s30, v37
 v_mfma_f32_16x16x32_bf16 v[132:135], a[56:59], a[168:171], v[132:135]
 v_mul_f32 v150, s30, v38
 v_mfma_f32_16x16x32_bf16 v[132:135], a[60:63], a[172:175], v[132:135]
 v_mul_f32 v151, s30, v39
 v_mfma_f32_16x16x32_bf16 v[80:83], a[0:3], a[112:115], v[80:83]
 v_exp_f32 v148, v148
 v_mfma_f32_16x16x32_bf16 v[80:83], a[4:7], a[116:119], v[80:83]
 v_mfma_f32_16x16x32_bf16 v[84:87], a[0:3], a[168:171], v[84:87]
 v_exp_f32 v149, v149
 v_mfma_f32_16x16x32_bf16 v[84:87], a[4:7], a[172:175], v[84:87]
 s_waitcnt lgkmcnt(0)
 v_mfma_f32_16x16x32_bf16 v[136:139], a[8:11], a[112:115], v[136:139]
 v_exp_f32 v150, v150
 v_mfma_f32_16x16x32_bf16 v[136:139], a[12:15], a[116:119], v[136:139]
 v_mfma_f32_16x16x32_bf16 v[140:143], a[8:11], a[168:171], v[140:143]
 v_exp_f32 v151, v151
 v_mfma_f32_16x16x32_bf16 v[140:143], a[12:15], a[172:175], v[140:143]
 s_barrier
 v_mul_f32 v92, v36, v92
 v_mul_f32 v93, v37, v93
 v_mul_f32 v94, v38, v94
 v_mul_f32 v95, v39, v95
 v_add_f32 v148, 1.0, v148
 v_add_f32 v149, 1.0, v149
 v_add_f32 v150, 1.0, v150
 v_add_f32 v151, 1.0, v151
 v_rcp_f32 v148, v148
 v_rcp_f32 v149, v149
 v_rcp_f32 v150, v150
 v_rcp_f32 v151, v151
 v_mul_f32 v92, v92, v148
 v_mul_f32 v93, v93, v149
 v_mul_f32 v94, v94, v150
 v_mul_f32 v95, v95, v151
 s_add_u32 m0, s43, 65536
 s_add_u32 s35, s42, 229376
 buffer_load_dwordx4 v16, s[12:15], s35 offen offset:0 lds
 v_cvt_pk_bf16_f32 v36, v92, v93
 v_cvt_pk_bf16_f32 v37, v94, v95
 v_pk_mul_f32 v[144:145], v[40:41], s[30:31]
 v_pk_mul_f32 v[146:147], v[42:43], s[30:31]
 v_exp_f32 v144, v144
 v_exp_f32 v145, v145
 v_exp_f32 v146, v146
 v_exp_f32 v147, v147
 v_pk_mul_f32 v[96:97], v[40:41], v[96:97]
 v_pk_mul_f32 v[98:99], v[42:43], v[98:99]
 v_pk_add_f32 v[144:145], v[144:145], 1.0 op_sel_hi:[1,0]
 v_pk_add_f32 v[146:147], v[146:147], 1.0 op_sel_hi:[1,0]
 v_rcp_f32 v144, v144
 v_rcp_f32 v145, v145
 v_rcp_f32 v146, v146
 v_rcp_f32 v147, v147
 buffer_load_dwordx4 v17, s[12:15], s35 offen offset:1024 lds
 v_pk_mul_f32 v[96:97], v[96:97], v[144:145]
 v_pk_mul_f32 v[98:99], v[98:99], v[146:147]
 v_cvt_pk_bf16_f32 v34, v96, v97
 v_cvt_pk_bf16_f32 v35, v98, v99
 s_add_u32 s38, s26, 0
 buffer_store_dwordx4 v[32:35], v1, s[16:19], s38 offen sc1
 v_pk_mul_f32 v[148:149], v[44:45], s[30:31]
 v_pk_mul_f32 v[150:151], v[46:47], s[30:31]
 v_exp_f32 v148, v148
 v_exp_f32 v149, v149
 v_exp_f32 v150, v150
 v_exp_f32 v151, v151
 v_pk_mul_f32 v[100:101], v[44:45], v[100:101]
 v_pk_mul_f32 v[102:103], v[46:47], v[102:103]
 v_pk_add_f32 v[148:149], v[148:149], 1.0 op_sel_hi:[1,0]
 v_pk_add_f32 v[150:151], v[150:151], 1.0 op_sel_hi:[1,0]
 v_rcp_f32 v148, v148
 buffer_load_dwordx4 v18, s[12:15], s35 offen offset:2048 lds
 v_rcp_f32 v149, v149
 v_rcp_f32 v150, v150
 v_rcp_f32 v151, v151
 v_pk_mul_f32 v[100:101], v[100:101], v[148:149]
 v_pk_mul_f32 v[102:103], v[102:103], v[150:151]
 v_cvt_pk_bf16_f32 v38, v100, v101
 v_cvt_pk_bf16_f32 v39, v102, v103
 s_add_u32 s38, s26, 1024
 buffer_store_dwordx4 v[36:39], v1, s[16:19], s38 offen sc1
 v_pk_mul_f32 v[144:145], v[48:49], s[30:31]
 v_pk_mul_f32 v[146:147], v[50:51], s[30:31]
 v_exp_f32 v144, v144
 v_exp_f32 v145, v145
 v_exp_f32 v146, v146
 v_exp_f32 v147, v147
 v_pk_mul_f32 v[104:105], v[48:49], v[104:105]
 v_pk_mul_f32 v[106:107], v[50:51], v[106:107]
 buffer_load_dwordx4 v19, s[12:15], s35 offen offset:3072 lds
 v_pk_add_f32 v[144:145], v[144:145], 1.0 op_sel_hi:[1,0]
 v_pk_add_f32 v[146:147], v[146:147], 1.0 op_sel_hi:[1,0]
 v_rcp_f32 v144, v144
 v_rcp_f32 v145, v145
 v_rcp_f32 v146, v146
 v_rcp_f32 v147, v147
 v_pk_mul_f32 v[104:105], v[104:105], v[144:145]
 v_pk_mul_f32 v[106:107], v[106:107], v[146:147]
 v_cvt_pk_bf16_f32 v48, v104, v105
 v_cvt_pk_bf16_f32 v49, v106, v107
 v_pk_mul_f32 v[148:149], v[52:53], s[30:31]
 v_pk_mul_f32 v[150:151], v[54:55], s[30:31]
 v_exp_f32 v148, v148
 v_exp_f32 v149, v149
 v_exp_f32 v150, v150
 v_exp_f32 v151, v151
 s_add_u32 m0, s43, 69632
 s_add_u32 s35, s42, 229376
 buffer_load_dwordx4 v20, s[12:15], s35 offen offset:0 lds
 v_pk_mul_f32 v[108:109], v[52:53], v[108:109]
 v_pk_mul_f32 v[110:111], v[54:55], v[110:111]
 v_pk_add_f32 v[148:149], v[148:149], 1.0 op_sel_hi:[1,0]
 v_pk_add_f32 v[150:151], v[150:151], 1.0 op_sel_hi:[1,0]
 v_rcp_f32 v148, v148
 v_rcp_f32 v149, v149
 v_rcp_f32 v150, v150
 v_rcp_f32 v151, v151
 v_pk_mul_f32 v[108:109], v[108:109], v[148:149]
 v_pk_mul_f32 v[110:111], v[110:111], v[150:151]
 v_cvt_pk_bf16_f32 v52, v108, v109
 v_cvt_pk_bf16_f32 v53, v110, v111
 v_pk_mul_f32 v[144:145], v[56:57], s[30:31]
 v_pk_mul_f32 v[146:147], v[58:59], s[30:31]
 v_exp_f32 v144, v144
 v_exp_f32 v145, v145
 buffer_load_dwordx4 v21, s[12:15], s35 offen offset:1024 lds
 v_exp_f32 v146, v146
 v_exp_f32 v147, v147
 v_pk_mul_f32 v[112:113], v[56:57], v[112:113]
 v_pk_mul_f32 v[114:115], v[58:59], v[114:115]
 v_pk_add_f32 v[144:145], v[144:145], 1.0 op_sel_hi:[1,0]
 v_pk_add_f32 v[146:147], v[146:147], 1.0 op_sel_hi:[1,0]
 v_rcp_f32 v144, v144
 v_rcp_f32 v145, v145
 v_rcp_f32 v146, v146
 v_rcp_f32 v147, v147
 v_pk_mul_f32 v[112:113], v[112:113], v[144:145]
 v_pk_mul_f32 v[114:115], v[114:115], v[146:147]
 v_cvt_pk_bf16_f32 v50, v112, v113
 v_cvt_pk_bf16_f32 v51, v114, v115
 s_add_u32 s38, s26, 2048
 buffer_store_dwordx4 v[48:51], v1, s[16:19], s38 offen sc1
 v_pk_mul_f32 v[148:149], v[60:61], s[30:31]
 buffer_load_dwordx4 v22, s[12:15], s35 offen offset:2048 lds
 v_pk_mul_f32 v[150:151], v[62:63], s[30:31]
 v_exp_f32 v148, v148
 v_exp_f32 v149, v149
 v_exp_f32 v150, v150
 v_exp_f32 v151, v151
 v_pk_mul_f32 v[116:117], v[60:61], v[116:117]
 v_pk_mul_f32 v[118:119], v[62:63], v[118:119]
 v_pk_add_f32 v[148:149], v[148:149], 1.0 op_sel_hi:[1,0]
 v_pk_add_f32 v[150:151], v[150:151], 1.0 op_sel_hi:[1,0]
 v_rcp_f32 v148, v148
 v_rcp_f32 v149, v149
 v_rcp_f32 v150, v150
 v_rcp_f32 v151, v151
 v_pk_mul_f32 v[116:117], v[116:117], v[148:149]
 v_pk_mul_f32 v[118:119], v[118:119], v[150:151]
 v_cvt_pk_bf16_f32 v54, v116, v117
 s_add_u32 m0, s43, 98304
 s_add_u32 s35, s42, 258048
 buffer_load_dwordx4 v16, s[12:15], s35 offen offset:0 lds
 v_cvt_pk_bf16_f32 v55, v118, v119
 s_add_u32 s38, s26, 3072
 buffer_store_dwordx4 v[52:55], v1, s[16:19], s38 offen sc1
 v_pk_mul_f32 v[144:145], v[64:65], s[30:31]
 v_pk_mul_f32 v[146:147], v[66:67], s[30:31]
 v_exp_f32 v144, v144
 v_exp_f32 v145, v145
 v_exp_f32 v146, v146
 v_exp_f32 v147, v147
 v_pk_mul_f32 v[120:121], v[64:65], v[120:121]
 v_pk_mul_f32 v[122:123], v[66:67], v[122:123]
 v_pk_add_f32 v[144:145], v[144:145], 1.0 op_sel_hi:[1,0]
 v_pk_add_f32 v[146:147], v[146:147], 1.0 op_sel_hi:[1,0]
 v_rcp_f32 v144, v144
 v_rcp_f32 v145, v145
 v_rcp_f32 v146, v146
 v_rcp_f32 v147, v147
 buffer_load_dwordx4 v17, s[12:15], s35 offen offset:1024 lds
 v_pk_mul_f32 v[120:121], v[120:121], v[144:145]
 v_pk_mul_f32 v[122:123], v[122:123], v[146:147]
 v_cvt_pk_bf16_f32 v64, v120, v121
 v_cvt_pk_bf16_f32 v65, v122, v123
 v_pk_mul_f32 v[148:149], v[68:69], s[30:31]
 v_pk_mul_f32 v[150:151], v[70:71], s[30:31]
 v_exp_f32 v148, v148
 v_exp_f32 v149, v149
 v_exp_f32 v150, v150
 v_exp_f32 v151, v151
 v_pk_mul_f32 v[124:125], v[68:69], v[124:125]
 v_pk_mul_f32 v[126:127], v[70:71], v[126:127]
 v_pk_add_f32 v[148:149], v[148:149], 1.0 op_sel_hi:[1,0]
 v_pk_add_f32 v[150:151], v[150:151], 1.0 op_sel_hi:[1,0]
 v_rcp_f32 v148, v148
 v_rcp_f32 v149, v149
 buffer_load_dwordx4 v18, s[12:15], s35 offen offset:2048 lds
 v_rcp_f32 v150, v150
 v_rcp_f32 v151, v151
 v_pk_mul_f32 v[124:125], v[124:125], v[148:149]
 v_pk_mul_f32 v[126:127], v[126:127], v[150:151]
 v_cvt_pk_bf16_f32 v68, v124, v125
 v_cvt_pk_bf16_f32 v69, v126, v127
 v_pk_mul_f32 v[144:145], v[72:73], s[30:31]
 v_pk_mul_f32 v[146:147], v[74:75], s[30:31]
 v_exp_f32 v144, v144
 v_exp_f32 v145, v145
 v_exp_f32 v146, v146
 v_exp_f32 v147, v147
 v_pk_mul_f32 v[128:129], v[72:73], v[128:129]
 v_pk_mul_f32 v[130:131], v[74:75], v[130:131]
 v_pk_add_f32 v[144:145], v[144:145], 1.0 op_sel_hi:[1,0]
 v_pk_add_f32 v[146:147], v[146:147], 1.0 op_sel_hi:[1,0]
 buffer_load_dwordx4 v19, s[12:15], s35 offen offset:3072 lds
 v_rcp_f32 v144, v144
 v_rcp_f32 v145, v145
 v_rcp_f32 v146, v146
 v_rcp_f32 v147, v147
 v_pk_mul_f32 v[128:129], v[128:129], v[144:145]
 v_pk_mul_f32 v[130:131], v[130:131], v[146:147]
 v_cvt_pk_bf16_f32 v66, v128, v129
 v_cvt_pk_bf16_f32 v67, v130, v131
 s_add_u32 s38, s26, 4096
 buffer_store_dwordx4 v[64:67], v1, s[16:19], s38 offen sc1
 v_pk_mul_f32 v[148:149], v[76:77], s[30:31]
 v_pk_mul_f32 v[150:151], v[78:79], s[30:31]
 v_exp_f32 v148, v148
 v_exp_f32 v149, v149
 v_exp_f32 v150, v150
 v_exp_f32 v151, v151
 v_pk_mul_f32 v[132:133], v[76:77], v[132:133]
 s_add_u32 m0, s43, 102400
 s_add_u32 s35, s42, 258048
 buffer_load_dwordx4 v20, s[12:15], s35 offen offset:0 lds
 v_pk_mul_f32 v[134:135], v[78:79], v[134:135]
 v_pk_add_f32 v[148:149], v[148:149], 1.0 op_sel_hi:[1,0]
 v_pk_add_f32 v[150:151], v[150:151], 1.0 op_sel_hi:[1,0]
 v_rcp_f32 v148, v148
 v_rcp_f32 v149, v149
 v_rcp_f32 v150, v150
 v_rcp_f32 v151, v151
 v_pk_mul_f32 v[132:133], v[132:133], v[148:149]
 v_pk_mul_f32 v[134:135], v[134:135], v[150:151]
 v_cvt_pk_bf16_f32 v70, v132, v133
 v_cvt_pk_bf16_f32 v71, v134, v135
 s_add_u32 s38, s26, 5120
 buffer_store_dwordx4 v[68:71], v1, s[16:19], s38 offen sc1
 v_pk_mul_f32 v[144:145], v[80:81], s[30:31]
 v_pk_mul_f32 v[146:147], v[82:83], s[30:31]
 v_exp_f32 v144, v144
 v_exp_f32 v145, v145
 buffer_load_dwordx4 v21, s[12:15], s35 offen offset:1024 lds
 v_exp_f32 v146, v146
 v_exp_f32 v147, v147
 v_pk_mul_f32 v[136:137], v[80:81], v[136:137]
 v_pk_mul_f32 v[138:139], v[82:83], v[138:139]
 v_pk_add_f32 v[144:145], v[144:145], 1.0 op_sel_hi:[1,0]
 v_pk_add_f32 v[146:147], v[146:147], 1.0 op_sel_hi:[1,0]
 v_rcp_f32 v144, v144
 v_rcp_f32 v145, v145
 v_rcp_f32 v146, v146
 v_rcp_f32 v147, v147
 v_pk_mul_f32 v[136:137], v[136:137], v[144:145]
 v_pk_mul_f32 v[138:139], v[138:139], v[146:147]
 v_cvt_pk_bf16_f32 v28, v136, v137
 v_cvt_pk_bf16_f32 v29, v138, v139
 v_pk_mul_f32 v[148:149], v[84:85], s[30:31]
 v_pk_mul_f32 v[150:151], v[86:87], s[30:31]
 buffer_load_dwordx4 v22, s[12:15], s35 offen offset:2048 lds
 v_exp_f32 v148, v148
 v_exp_f32 v149, v149
 v_exp_f32 v150, v150
 v_exp_f32 v151, v151
 v_pk_mul_f32 v[140:141], v[84:85], v[140:141]
 v_pk_mul_f32 v[142:143], v[86:87], v[142:143]
 v_pk_add_f32 v[148:149], v[148:149], 1.0 op_sel_hi:[1,0]
 v_pk_add_f32 v[150:151], v[150:151], 1.0 op_sel_hi:[1,0]
 v_rcp_f32 v148, v148
 v_rcp_f32 v149, v149
 v_rcp_f32 v150, v150
 v_rcp_f32 v151, v151
 v_pk_mul_f32 v[140:141], v[140:141], v[148:149]
 v_pk_mul_f32 v[142:143], v[142:143], v[150:151]
 v_cvt_pk_bf16_f32 v30, v140, v141
 v_cvt_pk_bf16_f32 v31, v142, v143
 buffer_store_dwordx4 v[28:31], v1, s[16:19], s27 offen sc1
 s_waitcnt vmcnt(35)
 ds_read_b64_tr_b16 v[212:213], v23 offset:0
 ds_read_b64_tr_b16 v[214:215], v23 offset:3584
 ds_read_b64_tr_b16 v[216:217], v23 offset:32
 ds_read_b64_tr_b16 v[218:219], v23 offset:3616
 ds_read_b64_tr_b16 v[220:221], v23 offset:64
 ds_read_b64_tr_b16 v[222:223], v23 offset:3648
 ds_read_b64_tr_b16 v[224:225], v23 offset:96
 ds_read_b64_tr_b16 v[226:227], v23 offset:3680
 ds_read_b64_tr_b16 v[228:229], v23 offset:128
 ds_read_b64_tr_b16 v[230:231], v23 offset:3712
 ds_read_b64_tr_b16 v[232:233], v23 offset:160
 ds_read_b64_tr_b16 v[234:235], v23 offset:3744
 ds_read_b64_tr_b16 v[236:237], v23 offset:192
 ds_read_b64_tr_b16 v[238:239], v23 offset:3776
 s_waitcnt vmcnt(28)
 ds_read_b64_tr_b16 a[0:1], v23 offset:32768
 ds_read_b64_tr_b16 a[2:3], v23 offset:36352
 ds_read_b64_tr_b16 a[4:5], v23 offset:32800
 ds_read_b64_tr_b16 a[6:7], v23 offset:36384
 ds_read_b64_tr_b16 a[8:9], v23 offset:32832
 ds_read_b64_tr_b16 a[10:11], v23 offset:36416
 ds_read_b64_tr_b16 a[12:13], v23 offset:32864
 ds_read_b64_tr_b16 a[14:15], v23 offset:36448
 ds_read_b64_tr_b16 a[16:17], v23 offset:32896
 ds_read_b64_tr_b16 a[18:19], v23 offset:36480
 ds_read_b64_tr_b16 a[20:21], v23 offset:32928
 ds_read_b64_tr_b16 a[22:23], v23 offset:36512
 ds_read_b64_tr_b16 a[24:25], v23 offset:32960
 ds_read_b64_tr_b16 a[26:27], v23 offset:36544
 s_waitcnt vmcnt(21)
 ds_read_b64_tr_b16 a[28:29], v25 offset:0
 ds_read_b64_tr_b16 a[30:31], v25 offset:3584
 ds_read_b64_tr_b16 a[32:33], v25 offset:32
 ds_read_b64_tr_b16 a[34:35], v25 offset:3616
 ds_read_b64_tr_b16 a[36:37], v25 offset:64
 ds_read_b64_tr_b16 a[38:39], v25 offset:3648
 ds_read_b64_tr_b16 a[40:41], v25 offset:96
 ds_read_b64_tr_b16 a[42:43], v25 offset:3680
 ds_read_b64_tr_b16 a[44:45], v25 offset:128
 ds_read_b64_tr_b16 a[46:47], v25 offset:3712
 ds_read_b64_tr_b16 a[48:49], v25 offset:160
 ds_read_b64_tr_b16 a[50:51], v25 offset:3744
 ds_read_b64_tr_b16 a[52:53], v25 offset:192
 ds_read_b64_tr_b16 a[54:55], v25 offset:3776
 s_and_b32 s25, s3, 1
 s_lshr_b32 s26, s3, 1
 s_mul_i32 s38, s28, 7
 s_add_u32 s26, s26, s38
 s_lshl_b32 s27, s29, 1
 s_add_u32 s27, s27, s25
 s_mul_i32 s36, s27, 14336
 s_add_u32 s36, s36, 125829120
 s_lshr_b32 s38, s26, 1
 s_lshl_b32 s38, s38, 10
 s_add_u32 s36, s36, s38
 s_and_b32 s38, s26, 1
 s_lshl_b32 s38, s38, 3
 s_add_u32 s36, s36, s38
 s_lshl_b32 s27, s27, 4
 v_and_b32 v12, 15, v0
 v_add_u32 v12, s27, v12
 v_mul_u32_u24 v12, 896, v12
 v_lshrrev_b32 v13, 4, v0
 v_lshl_add_u32 v12, v13, 3, v12
 s_lshl_b32 s38, s26, 5
 v_add_u32 v12, s38, v12
 s_waitcnt lgkmcnt(0)
 s_add_u32 m0, s43, 0
 s_add_u32 s35, s42, 286720
 buffer_load_dwordx4 v16, s[12:15], s35 offen offset:0 lds
 buffer_load_dwordx4 v17, s[12:15], s35 offen offset:1024 lds
 buffer_load_dwordx4 v18, s[12:15], s35 offen offset:2048 lds
 buffer_load_dwordx4 v19, s[12:15], s35 offen offset:3072 lds
 s_add_u32 m0, s43, 4096
 s_add_u32 s35, s42, 286720
 buffer_load_dwordx4 v20, s[12:15], s35 offen offset:0 lds
 buffer_load_dwordx4 v21, s[12:15], s35 offen offset:1024 lds
 buffer_load_dwordx4 v22, s[12:15], s35 offen offset:2048 lds
 s_waitcnt vmcnt(7)
 s_barrier
 buffer_atomic_add v11, v10, s[16:19], s23 offen offset:24 sc1
 ds_read_b64_tr_b16 a[56:57], v24 offset:0
 ds_read_b64_tr_b16 a[58:59], v24 offset:3584
 ds_read_b64_tr_b16 a[60:61], v24 offset:32
 ds_read_b64_tr_b16 a[62:63], v24 offset:3616
 ds_read_b64_tr_b16 a[64:65], v24 offset:64
 ds_read_b64_tr_b16 a[66:67], v24 offset:3648
 ds_read_b64_tr_b16 a[68:69], v24 offset:96
 ds_read_b64_tr_b16 a[70:71], v24 offset:3680
 ds_read_b64_tr_b16 a[72:73], v24 offset:128
 ds_read_b64_tr_b16 a[74:75], v24 offset:3712
 ds_read_b64_tr_b16 a[76:77], v24 offset:160
 ds_read_b64_tr_b16 a[78:79], v24 offset:3744
 ds_read_b64_tr_b16 a[80:81], v24 offset:192
 ds_read_b64_tr_b16 a[82:83], v24 offset:3776
 s_add_u32 m0, s43, 32768
 s_add_u32 s35, s42, 315392
 buffer_load_dwordx4 v16, s[12:15], s35 offen offset:0 lds
 buffer_load_dwordx4 v17, s[12:15], s35 offen offset:1024 lds
 buffer_load_dwordx4 v18, s[12:15], s35 offen offset:2048 lds
 buffer_load_dwordx4 v19, s[12:15], s35 offen offset:3072 lds
 s_add_u32 m0, s43, 36864
 s_add_u32 s35, s42, 315392
 buffer_load_dwordx4 v20, s[12:15], s35 offen offset:0 lds
 buffer_load_dwordx4 v21, s[12:15], s35 offen offset:1024 lds
 buffer_load_dwordx4 v22, s[12:15], s35 offen offset:2048 lds
 s_add_u32 m0, s43, 131072
 s_add_u32 s35, s42, 344064
 buffer_load_dwordx4 v16, s[12:15], s35 offen offset:0 lds
 buffer_load_dwordx4 v17, s[12:15], s35 offen offset:1024 lds
 buffer_load_dwordx4 v18, s[12:15], s35 offen offset:2048 lds
 buffer_load_dwordx4 v19, s[12:15], s35 offen offset:3072 lds
 s_add_u32 m0, s43, 135168
 s_add_u32 s35, s42, 344064
 buffer_load_dwordx4 v20, s[12:15], s35 offen offset:0 lds
 buffer_load_dwordx4 v21, s[12:15], s35 offen offset:1024 lds
 buffer_load_dwordx4 v22, s[12:15], s35 offen offset:2048 lds
 s_waitcnt lgkmcnt(0)
 s_add_u32 m0, s43, 65536
 s_add_u32 s35, s42, 372736
 buffer_load_dwordx4 v16, s[12:15], s35 offen offset:0 lds
 buffer_load_dwordx4 v17, s[12:15], s35 offen offset:1024 lds
 buffer_load_dwordx4 v18, s[12:15], s35 offen offset:2048 lds
 buffer_load_dwordx4 v19, s[12:15], s35 offen offset:3072 lds
 s_add_u32 m0, s43, 69632
 s_add_u32 s35, s42, 372736
 buffer_load_dwordx4 v20, s[12:15], s35 offen offset:0 lds
 buffer_load_dwordx4 v21, s[12:15], s35 offen offset:1024 lds
 buffer_load_dwordx4 v22, s[12:15], s35 offen offset:2048 lds
 buffer_load_dwordx2 v[2:3], v1, s[16:19], s36 offen offset:0 sc1
 buffer_load_dwordx2 v[4:5], v1, s[16:19], s36 offen offset:1024 sc1
 buffer_load_dwordx2 v[6:7], v1, s[16:19], s36 offen offset:2048 sc1
 buffer_load_dwordx2 v[8:9], v1, s[16:19], s36 offen offset:3072 sc1
 s_load_dword s38, s[20:21], 24 glc
 s_waitcnt lgkmcnt(0)
 s_andn2_b32 s38, s41, s38
 s_cbranch_scc1 L_tspin2
L_tspun2:
 s_add_u32 s38, s34, 0
 buffer_load_dwordx4 a[84:87], v1, s[16:19], s38 offen sc1
 s_add_u32 s38, s34, 1024
 buffer_load_dwordx4 a[88:91], v1, s[16:19], s38 offen sc1
 s_add_u32 s38, s34, 2048
 buffer_load_dwordx4 a[92:95], v1, s[16:19], s38 offen sc1
 s_add_u32 s38, s34, 3072
 buffer_load_dwordx4 a[96:99], v1, s[16:19], s38 offen sc1
 s_add_u32 s38, s34, 4096
 buffer_load_dwordx4 a[100:103], v1, s[16:19], s38 offen sc1
 s_add_u32 s38, s34, 5120
 buffer_load_dwordx4 a[104:107], v1, s[16:19], s38 offen sc1
 s_add_u32 s38, s34, 6144
 buffer_load_dwordx4 v[88:91], v1, s[16:19], s38 offen sc1
 s_add_u32 s38, s34, 7168
 buffer_load_dwordx4 v[92:95], v1, s[16:19], s38 offen sc1
 s_add_u32 s38, s34, 8192
 buffer_load_dwordx4 a[108:111], v1, s[16:19], s38 offen sc1
 s_add_u32 s38, s34, 9216
 buffer_load_dwordx4 a[112:115], v1, s[16:19], s38 offen sc1
 s_add_u32 s38, s34, 10240
 buffer_load_dwordx4 a[116:119], v1, s[16:19], s38 offen sc1
 s_add_u32 s38, s34, 11264
 buffer_load_dwordx4 a[120:123], v1, s[16:19], s38 offen sc1
 s_waitcnt vmcnt(11)
 v_mfma_f32_16x16x32_bf16 v[32:35], a[176:179], a[84:87], 0
 s_add_u32 s38, s34, 12288
 buffer_load_dwordx4 a[124:127], v1, s[16:19], s38 offen sc1
 s_waitcnt vmcnt(11)
 v_mfma_f32_16x16x32_bf16 v[36:39], a[176:179], a[88:91], 0
 v_mfma_f32_16x16x32_bf16 v[40:43], a[180:183], a[84:87], 0
 v_mfma_f32_16x16x32_bf16 v[44:47], a[180:183], a[88:91], 0
 v_mfma_f32_16x16x32_bf16 v[48:51], a[184:187], a[84:87], 0
 s_add_u32 s38, s34, 13312
 buffer_load_dwordx4 a[128:131], v1, s[16:19], s38 offen sc1
 v_mfma_f32_16x16x32_bf16 v[52:55], a[184:187], a[88:91], 0
 v_mfma_f32_16x16x32_bf16 v[56:59], a[188:191], a[84:87], 0
 v_mfma_f32_16x16x32_bf16 v[60:63], a[188:191], a[88:91], 0
 v_mfma_f32_16x16x32_bf16 v[64:67], a[192:195], a[84:87], 0
 s_add_u32 s38, s34, 14336
 buffer_load_dwordx4 a[132:135], v1, s[16:19], s38 offen sc1
 v_mfma_f32_16x16x32_bf16 v[68:71], a[192:195], a[88:91], 0
 v_mfma_f32_16x16x32_bf16 v[72:75], a[196:199], a[84:87], 0
 v_mfma_f32_16x16x32_bf16 v[76:79], a[196:199], a[88:91], 0
 v_mfma_f32_16x16x32_bf16 v[80:83], a[200:203], a[84:87], 0
 s_add_u32 s38, s34, 15360
 buffer_load_dwordx4 a[136:139], v1, s[16:19], s38 offen sc1
 v_mfma_f32_16x16x32_bf16 v[84:87], a[200:203], a[88:91], 0
 s_waitcnt vmcnt(13)
 v_mfma_f32_16x16x32_bf16 v[32:35], a[204:207], a[92:95], v[32:35]
 s_waitcnt vmcnt(12)
 v_mfma_f32_16x16x32_bf16 v[36:39], a[204:207], a[96:99], v[36:39]
 v_mfma_f32_16x16x32_bf16 v[40:43], a[208:211], a[92:95], v[40:43]
 s_add_u32 s38, s34, 16384
 buffer_load_dwordx4 a[140:143], v1, s[16:19], s38 offen sc1
 v_mfma_f32_16x16x32_bf16 v[44:47], a[208:211], a[96:99], v[44:47]
 v_mfma_f32_16x16x32_bf16 v[48:51], a[212:215], a[92:95], v[48:51]
 v_mfma_f32_16x16x32_bf16 v[52:55], a[212:215], a[96:99], v[52:55]
 v_mfma_f32_16x16x32_bf16 v[56:59], a[216:219], a[92:95], v[56:59]
 s_add_u32 s38, s34, 17408
 buffer_load_dwordx4 a[144:147], v1, s[16:19], s38 offen sc1
 v_mfma_f32_16x16x32_bf16 v[60:63], a[216:219], a[96:99], v[60:63]
 v_mfma_f32_16x16x32_bf16 v[64:67], a[220:223], a[92:95], v[64:67]
 v_mfma_f32_16x16x32_bf16 v[68:71], a[220:223], a[96:99], v[68:71]
 v_mfma_f32_16x16x32_bf16 v[72:75], a[224:227], a[92:95], v[72:75]
 s_add_u32 s38, s34, 18432
 buffer_load_dwordx4 a[148:151], v1, s[16:19], s38 offen sc1
 v_mfma_f32_16x16x32_bf16 v[76:79], a[224:227], a[96:99], v[76:79]
 v_mfma_f32_16x16x32_bf16 v[80:83], a[228:231], a[92:95], v[80:83]
 v_mfma_f32_16x16x32_bf16 v[84:87], a[228:231], a[96:99], v[84:87]
 s_waitcnt vmcnt(14)
 v_mfma_f32_16x16x32_bf16 v[32:35], a[232:235], a[100:103], v[32:35]
 s_add_u32 s38, s34, 19456
 buffer_load_dwordx4 a[152:155], v1, s[16:19], s38 offen sc1
 s_waitcnt vmcnt(14)
 v_mfma_f32_16x16x32_bf16 v[36:39], a[232:235], a[104:107], v[36:39]
 v_mfma_f32_16x16x32_bf16 v[40:43], a[236:239], a[100:103], v[40:43]
 v_mfma_f32_16x16x32_bf16 v[44:47], a[236:239], a[104:107], v[44:47]
 v_mfma_f32_16x16x32_bf16 v[48:51], a[240:243], a[100:103], v[48:51]
 v_mfma_f32_16x16x32_bf16 v[52:55], a[240:243], a[104:107], v[52:55]
 s_add_u32 s38, s34, 20480
 buffer_load_dwordx4 v[96:99], v1, s[16:19], s38 offen sc1
 v_mfma_f32_16x16x32_bf16 v[56:59], a[244:247], a[100:103], v[56:59]
 v_mfma_f32_16x16x32_bf16 v[60:63], a[244:247], a[104:107], v[60:63]
 v_mfma_f32_16x16x32_bf16 v[64:67], a[248:251], a[100:103], v[64:67]
 v_mfma_f32_16x16x32_bf16 v[68:71], a[248:251], a[104:107], v[68:71]
 s_add_u32 s38, s34, 21504
 buffer_load_dwordx4 v[100:103], v1, s[16:19], s38 offen sc1
 v_mfma_f32_16x16x32_bf16 v[72:75], a[252:255], a[100:103], v[72:75]
 v_mfma_f32_16x16x32_bf16 v[76:79], a[252:255], a[104:107], v[76:79]
 s_waitcnt vmcnt(14)
 v_swap_b32 v90, v92
 v_swap_b32 v91, v93
 v_mfma_f32_16x16x32_bf16 v[80:83], v[152:155], a[100:103], v[80:83]
 v_mfma_f32_16x16x32_bf16 v[84:87], v[152:155], a[104:107], v[84:87]
 s_add_u32 s38, s34, 22528
 buffer_load_dwordx4 a[156:159], v1, s[16:19], s38 offen sc1
 v_mfma_f32_16x16x32_bf16 v[32:35], v[156:159], v[88:91], v[32:35]
 v_mfma_f32_16x16x32_bf16 v[36:39], v[156:159], v[92:95], v[36:39]
 v_mfma_f32_16x16x32_bf16 v[40:43], v[160:163], v[88:91], v[40:43]
 v_mfma_f32_16x16x32_bf16 v[44:47], v[160:163], v[92:95], v[44:47]
 s_add_u32 s38, s34, 23552
 buffer_load_dwordx4 a[160:163], v1, s[16:19], s38 offen sc1
 v_mfma_f32_16x16x32_bf16 v[48:51], v[164:167], v[88:91], v[48:51]
 v_mfma_f32_16x16x32_bf16 v[52:55], v[164:167], v[92:95], v[52:55]
 v_mfma_f32_16x16x32_bf16 v[56:59], v[168:171], v[88:91], v[56:59]
 v_mfma_f32_16x16x32_bf16 v[60:63], v[168:171], v[92:95], v[60:63]
 s_add_u32 s38, s34, 24576
 buffer_load_dwordx4 a[164:167], v1, s[16:19], s38 offen sc1
 v_mfma_f32_16x16x32_bf16 v[64:67], v[172:175], v[88:91], v[64:67]
 v_mfma_f32_16x16x32_bf16 v[68:71], v[172:175], v[92:95], v[68:71]
 v_mfma_f32_16x16x32_bf16 v[72:75], v[176:179], v[88:91], v[72:75]
 v_mfma_f32_16x16x32_bf16 v[76:79], v[176:179], v[92:95], v[76:79]
 s_add_u32 s38, s34, 25600
 buffer_load_dwordx4 a[168:171], v1, s[16:19], s38 offen sc1
 v_mfma_f32_16x16x32_bf16 v[80:83], v[180:183], v[88:91], v[80:83]
 v_mfma_f32_16x16x32_bf16 v[84:87], v[180:183], v[92:95], v[84:87]
 s_waitcnt vmcnt(17)
 v_mfma_f32_16x16x32_bf16 v[32:35], v[184:187], a[108:111], v[32:35]
 s_waitcnt vmcnt(16)
 v_mfma_f32_16x16x32_bf16 v[36:39], v[184:187], a[112:115], v[36:39]
 s_add_u32 s38, s34, 26624
 buffer_load_dwordx4 a[172:175], v1, s[16:19], s38 offen sc1
 v_mfma_f32_16x16x32_bf16 v[40:43], v[188:191], a[108:111], v[40:43]
 v_mfma_f32_16x16x32_bf16 v[44:47], v[188:191], a[112:115], v[44:47]
 v_mfma_f32_16x16x32_bf16 v[48:51], v[192:195], a[108:111], v[48:51]
 v_mfma_f32_16x16x32_bf16 v[52:55], v[192:195], a[112:115], v[52:55]
 s_add_u32 s38, s34, 27648
 buffer_load_dwordx4 v[104:107], v1, s[16:19], s38 offen sc1
 v_mfma_f32_16x16x32_bf16 v[56:59], v[196:199], a[108:111], v[56:59]
 v_mfma_f32_16x16x32_bf16 v[60:63], v[196:199], a[112:115], v[60:63]
 v_mfma_f32_16x16x32_bf16 v[64:67], v[200:203], a[108:111], v[64:67]
 v_mfma_f32_16x16x32_bf16 v[68:71], v[200:203], a[112:115], v[68:71]
 v_mfma_f32_16x16x32_bf16 v[72:75], v[204:207], a[108:111], v[72:75]
 v_mfma_f32_16x16x32_bf16 v[76:79], v[204:207], a[112:115], v[76:79]
 v_mfma_f32_16x16x32_bf16 v[80:83], v[208:211], a[108:111], v[80:83]
 v_mfma_f32_16x16x32_bf16 v[84:87], v[208:211], a[112:115], v[84:87]
 s_waitcnt vmcnt(17)
 v_mfma_f32_16x16x32_bf16 v[32:35], v[212:215], a[116:119], v[32:35]
 ds_read_b64_tr_b16 a[176:177], v24 offset:32768
 ds_read_b64_tr_b16 a[178:179], v24 offset:36352
 s_waitcnt vmcnt(16)
 v_mfma_f32_16x16x32_bf16 v[36:39], v[212:215], a[120:123], v[36:39]
 ds_read_b64_tr_b16 a[180:181], v24 offset:32800
 v_mfma_f32_16x16x32_bf16 v[40:43], v[216:219], a[116:119], v[40:43]
 ds_read_b64_tr_b16 a[182:183], v24 offset:36384
 v_mfma_f32_16x16x32_bf16 v[44:47], v[216:219], a[120:123], v[44:47]
 ds_read_b64_tr_b16 a[184:185], v24 offset:32832
 v_mfma_f32_16x16x32_bf16 v[48:51], v[220:223], a[116:119], v[48:51]
 ds_read_b64_tr_b16 a[186:187], v24 offset:36416
 v_mfma_f32_16x16x32_bf16 v[52:55], v[220:223], a[120:123], v[52:55]
 ds_read_b64_tr_b16 a[188:189], v24 offset:32864
 v_mfma_f32_16x16x32_bf16 v[56:59], v[224:227], a[116:119], v[56:59]
 ds_read_b64_tr_b16 a[190:191], v24 offset:36448
 v_mfma_f32_16x16x32_bf16 v[60:63], v[224:227], a[120:123], v[60:63]
 ds_read_b64_tr_b16 a[192:193], v24 offset:32896
 v_mfma_f32_16x16x32_bf16 v[64:67], v[228:231], a[116:119], v[64:67]
 ds_read_b64_tr_b16 a[194:195], v24 offset:36480
 v_mfma_f32_16x16x32_bf16 v[68:71], v[228:231], a[120:123], v[68:71]
 ds_read_b64_tr_b16 a[196:197], v24 offset:32928
 v_mfma_f32_16x16x32_bf16 v[72:75], v[232:235], a[116:119], v[72:75]
 ds_read_b64_tr_b16 a[198:199], v24 offset:36512
 v_mfma_f32_16x16x32_bf16 v[76:79], v[232:235], a[120:123], v[76:79]
 ds_read_b64_tr_b16 a[200:201], v24 offset:32960
 v_mfma_f32_16x16x32_bf16 v[80:83], v[236:239], a[116:119], v[80:83]
 ds_read_b64_tr_b16 a[202:203], v24 offset:36544
 v_mfma_f32_16x16x32_bf16 v[84:87], v[236:239], a[120:123], v[84:87]
 s_waitcnt vmcnt(15)
 v_mfma_f32_16x16x32_bf16 v[32:35], a[0:3], a[124:127], v[32:35]
 ds_read_b64_tr_b16 a[204:205], v23 offset:0
 ds_read_b64_tr_b16 a[206:207], v23 offset:3584
 s_waitcnt vmcnt(14)
 v_mfma_f32_16x16x32_bf16 v[36:39], a[0:3], a[128:131], v[36:39]
 ds_read_b64_tr_b16 a[208:209], v23 offset:32
 v_mfma_f32_16x16x32_bf16 v[40:43], a[4:7], a[124:127], v[40:43]
 ds_read_b64_tr_b16 a[210:211], v23 offset:3616
 v_mfma_f32_16x16x32_bf16 v[44:47], a[4:7], a[128:131], v[44:47]
 ds_read_b64_tr_b16 a[212:213], v23 offset:64
 v_mfma_f32_16x16x32_bf16 v[48:51], a[8:11], a[124:127], v[48:51]
 ds_read_b64_tr_b16 a[214:215], v23 offset:3648
 v_mfma_f32_16x16x32_bf16 v[52:55], a[8:11], a[128:131], v[52:55]
 ds_read_b64_tr_b16 a[216:217], v23 offset:96
 v_mfma_f32_16x16x32_bf16 v[56:59], a[12:15], a[124:127], v[56:59]
 ds_read_b64_tr_b16 a[218:219], v23 offset:3680
 v_mfma_f32_16x16x32_bf16 v[60:63], a[12:15], a[128:131], v[60:63]
 ds_read_b64_tr_b16 a[220:221], v23 offset:128
 v_mfma_f32_16x16x32_bf16 v[64:67], a[16:19], a[124:127], v[64:67]
 ds_read_b64_tr_b16 a[222:223], v23 offset:3712
 v_mfma_f32_16x16x32_bf16 v[68:71], a[16:19], a[128:131], v[68:71]
 ds_read_b64_tr_b16 a[224:225], v23 offset:160
 v_mfma_f32_16x16x32_bf16 v[72:75], a[20:23], a[124:127], v[72:75]
 ds_read_b64_tr_b16 a[226:227], v23 offset:3744
 v_mfma_f32_16x16x32_bf16 v[76:79], a[20:23], a[128:131], v[76:79]
 ds_read_b64_tr_b16 a[228:229], v23 offset:192
 v_mfma_f32_16x16x32_bf16 v[80:83], a[24:27], a[124:127], v[80:83]
 ds_read_b64_tr_b16 a[230:231], v23 offset:3776
 v_mfma_f32_16x16x32_bf16 v[84:87], a[24:27], a[128:131], v[84:87]
 s_waitcnt vmcnt(13)
 v_mfma_f32_16x16x32_bf16 v[32:35], a[28:31], a[132:135], v[32:35]
 ds_read_b64_tr_b16 a[232:233], v23 offset:32768
 ds_read_b64_tr_b16 a[234:235], v23 offset:36352
 s_waitcnt vmcnt(12)
 v_mfma_f32_16x16x32_bf16 v[36:39], a[28:31], a[136:139], v[36:39]
 ds_read_b64_tr_b16 a[236:237], v23 offset:32800
 v_mfma_f32_16x16x32_bf16 v[40:43], a[32:35], a[132:135], v[40:43]
 ds_read_b64_tr_b16 a[238:239], v23 offset:36384
 v_mfma_f32_16x16x32_bf16 v[44:47], a[32:35], a[136:139], v[44:47]
 ds_read_b64_tr_b16 a[240:241], v23 offset:32832
 v_mfma_f32_16x16x32_bf16 v[48:51], a[36:39], a[132:135], v[48:51]
 ds_read_b64_tr_b16 a[242:243], v23 offset:36416
 v_mfma_f32_16x16x32_bf16 v[52:55], a[36:39], a[136:139], v[52:55]
 ds_read_b64_tr_b16 a[244:245], v23 offset:32864
 v_mfma_f32_16x16x32_bf16 v[56:59], a[40:43], a[132:135], v[56:59]
 ds_read_b64_tr_b16 a[246:247], v23 offset:36448
 v_mfma_f32_16x16x32_bf16 v[60:63], a[40:43], a[136:139], v[60:63]
 ds_read_b64_tr_b16 a[248:249], v23 offset:32896
 v_mfma_f32_16x16x32_bf16 v[64:67], a[44:47], a[132:135], v[64:67]
 ds_read_b64_tr_b16 a[250:251], v23 offset:36480
 v_mfma_f32_16x16x32_bf16 v[68:71], a[44:47], a[136:139], v[68:71]
 ds_read_b64_tr_b16 a[252:253], v23 offset:32928
 v_mfma_f32_16x16x32_bf16 v[72:75], a[48:51], a[132:135], v[72:75]
 ds_read_b64_tr_b16 a[254:255], v23 offset:36512
 v_mfma_f32_16x16x32_bf16 v[76:79], a[48:51], a[136:139], v[76:79]
 ds_read_b64_tr_b16 v[152:153], v23 offset:32960
 v_mfma_f32_16x16x32_bf16 v[80:83], a[52:55], a[132:135], v[80:83]
 ds_read_b64_tr_b16 v[154:155], v23 offset:36544
 v_mfma_f32_16x16x32_bf16 v[84:87], a[52:55], a[136:139], v[84:87]
 s_waitcnt vmcnt(11)
 v_mfma_f32_16x16x32_bf16 v[32:35], a[56:59], a[140:143], v[32:35]
 ds_read_b64_tr_b16 v[156:157], v25 offset:0
 ds_read_b64_tr_b16 v[158:159], v25 offset:3584
 s_waitcnt vmcnt(10)
 v_mfma_f32_16x16x32_bf16 v[36:39], a[56:59], a[144:147], v[36:39]
 ds_read_b64_tr_b16 v[160:161], v25 offset:32
 v_mfma_f32_16x16x32_bf16 v[40:43], a[60:63], a[140:143], v[40:43]
 ds_read_b64_tr_b16 v[162:163], v25 offset:3616
 v_mfma_f32_16x16x32_bf16 v[44:47], a[60:63], a[144:147], v[44:47]
 ds_read_b64_tr_b16 v[164:165], v25 offset:64
 v_mfma_f32_16x16x32_bf16 v[48:51], a[64:67], a[140:143], v[48:51]
 ds_read_b64_tr_b16 v[166:167], v25 offset:3648
 v_mfma_f32_16x16x32_bf16 v[52:55], a[64:67], a[144:147], v[52:55]
 ds_read_b64_tr_b16 v[168:169], v25 offset:96
 v_mfma_f32_16x16x32_bf16 v[56:59], a[68:71], a[140:143], v[56:59]
 ds_read_b64_tr_b16 v[170:171], v25 offset:3680
 v_mfma_f32_16x16x32_bf16 v[60:63], a[68:71], a[144:147], v[60:63]
 ds_read_b64_tr_b16 v[172:173], v25 offset:128
 v_mfma_f32_16x16x32_bf16 v[64:67], a[72:75], a[140:143], v[64:67]
 ds_read_b64_tr_b16 v[174:175], v25 offset:3712
 v_mfma_f32_16x16x32_bf16 v[68:71], a[72:75], a[144:147], v[68:71]
 ds_read_b64_tr_b16 v[176:177], v25 offset:160
 v_mfma_f32_16x16x32_bf16 v[72:75], a[76:79], a[140:143], v[72:75]
 ds_read_b64_tr_b16 v[178:179], v25 offset:3744
 v_mfma_f32_16x16x32_bf16 v[76:79], a[76:79], a[144:147], v[76:79]
 ds_read_b64_tr_b16 v[180:181], v25 offset:192
 v_mfma_f32_16x16x32_bf16 v[80:83], a[80:83], a[140:143], v[80:83]
 ds_read_b64_tr_b16 v[182:183], v25 offset:3776
 v_mfma_f32_16x16x32_bf16 v[84:87], a[80:83], a[144:147], v[84:87]
 s_waitcnt vmcnt(9) lgkmcnt(4)
 v_mfma_f32_16x16x32_bf16 v[32:35], a[176:179], a[148:151], v[32:35]
 ds_read_b64_tr_b16 v[184:185], v24 offset:0
 ds_read_b64_tr_b16 v[186:187], v24 offset:3584
 s_waitcnt vmcnt(8)
 v_mfma_f32_16x16x32_bf16 v[36:39], a[176:179], a[152:155], v[36:39]
 ds_read_b64_tr_b16 v[188:189], v24 offset:32
 v_mfma_f32_16x16x32_bf16 v[40:43], a[180:183], a[148:151], v[40:43]
 ds_read_b64_tr_b16 v[190:191], v24 offset:3616
 v_mfma_f32_16x16x32_bf16 v[44:47], a[180:183], a[152:155], v[44:47]
 ds_read_b64_tr_b16 v[192:193], v24 offset:64
 v_mfma_f32_16x16x32_bf16 v[48:51], a[184:187], a[148:151], v[48:51]
 ds_read_b64_tr_b16 v[194:195], v24 offset:3648
 v_mfma_f32_16x16x32_bf16 v[52:55], a[184:187], a[152:155], v[52:55]
 ds_read_b64_tr_b16 v[196:197], v24 offset:96
 v_mfma_f32_16x16x32_bf16 v[56:59], a[188:191], a[148:151], v[56:59]
 ds_read_b64_tr_b16 v[198:199], v24 offset:3680
 v_mfma_f32_16x16x32_bf16 v[60:63], a[188:191], a[152:155], v[60:63]
 ds_read_b64_tr_b16 v[200:201], v24 offset:128
 v_mfma_f32_16x16x32_bf16 v[64:67], a[192:195], a[148:151], v[64:67]
 ds_read_b64_tr_b16 v[202:203], v24 offset:3712
 v_mfma_f32_16x16x32_bf16 v[68:71], a[192:195], a[152:155], v[68:71]
 ds_read_b64_tr_b16 v[204:205], v24 offset:160
 v_mfma_f32_16x16x32_bf16 v[72:75], a[196:199], a[148:151], v[72:75]
 ds_read_b64_tr_b16 v[206:207], v24 offset:3744
 v_mfma_f32_16x16x32_bf16 v[76:79], a[196:199], a[152:155], v[76:79]
 s_waitcnt vmcnt(6)
 v_swap_b32 v98, v100
 v_swap_b32 v99, v101
 v_mfma_f32_16x16x32_bf16 v[80:83], a[200:203], a[148:151], v[80:83]
 ds_read_b64_tr_b16 v[208:209], v24 offset:192
 ds_read_b64_tr_b16 v[210:211], v24 offset:3776
 v_mfma_f32_16x16x32_bf16 v[84:87], a[200:203], a[152:155], v[84:87]
 v_mfma_f32_16x16x32_bf16 v[32:35], a[204:207], v[96:99], v[32:35]
 v_mfma_f32_16x16x32_bf16 v[36:39], a[204:207], v[100:103], v[36:39]
 v_mfma_f32_16x16x32_bf16 v[40:43], a[208:211], v[96:99], v[40:43]
 v_mfma_f32_16x16x32_bf16 v[44:47], a[208:211], v[100:103], v[44:47]
 v_mfma_f32_16x16x32_bf16 v[48:51], a[212:215], v[96:99], v[48:51]
 v_mfma_f32_16x16x32_bf16 v[52:55], a[212:215], v[100:103], v[52:55]
 v_mfma_f32_16x16x32_bf16 v[56:59], a[216:219], v[96:99], v[56:59]
 v_mfma_f32_16x16x32_bf16 v[60:63], a[216:219], v[100:103], v[60:63]
 v_mfma_f32_16x16x32_bf16 v[64:67], a[220:223], v[96:99], v[64:67]
 v_mfma_f32_16x16x32_bf16 v[68:71], a[220:223], v[100:103], v[68:71]
 v_mfma_f32_16x16x32_bf16 v[72:75], a[224:227], v[96:99], v[72:75]
 v_add_u32 v13, s43, v1
 v_mfma_f32_16x16x32_bf16 v[76:79], a[224:227], v[100:103], v[76:79]
 v_mfma_f32_16x16x32_bf16 v[80:83], a[228:231], v[96:99], v[80:83]
 v_mfma_f32_16x16x32_bf16 v[84:87], a[228:231], v[100:103], v[84:87]
 s_waitcnt lgkmcnt(0)
 s_waitcnt vmcnt(5)
 v_mfma_f32_16x16x32_bf16 v[32:35], a[232:235], a[156:159], v[32:35]
 s_waitcnt vmcnt(3)
 v_mfma_f32_16x16x32_bf16 v[32:35], v[156:159], a[164:167], v[32:35]
 s_waitcnt vmcnt(1)
 v_mfma_f32_16x16x32_bf16 v[32:35], v[184:187], a[172:175], v[32:35]
 v_mfma_f32_16x16x32_bf16 v[36:39], a[232:235], a[160:163], v[36:39]
 v_mfma_f32_16x16x32_bf16 v[36:39], v[156:159], a[168:171], v[36:39]
 s_waitcnt vmcnt(0)
 v_mfma_f32_16x16x32_bf16 v[36:39], v[184:187], v[104:107], v[36:39]
 v_mfma_f32_16x16x32_bf16 v[40:43], a[236:239], a[156:159], v[40:43]
 v_mfma_f32_16x16x32_bf16 v[40:43], v[160:163], a[164:167], v[40:43]
 v_mfma_f32_16x16x32_bf16 v[40:43], v[188:191], a[172:175], v[40:43]
 v_mfma_f32_16x16x32_bf16 v[44:47], a[236:239], a[160:163], v[44:47]
 v_mfma_f32_16x16x32_bf16 v[44:47], v[160:163], a[168:171], v[44:47]
 ds_write_b128 v13, v[32:35] offset:0
 v_mfma_f32_16x16x32_bf16 v[44:47], v[188:191], v[104:107], v[44:47]
 v_mfma_f32_16x16x32_bf16 v[48:51], a[240:243], a[156:159], v[48:51]
 v_mfma_f32_16x16x32_bf16 v[48:51], v[164:167], a[164:167], v[48:51]
 ds_write_b128 v13, v[36:39] offset:1024
 v_mfma_f32_16x16x32_bf16 v[48:51], v[192:195], a[172:175], v[48:51]
 v_mfma_f32_16x16x32_bf16 v[52:55], a[240:243], a[160:163], v[52:55]
 v_mfma_f32_16x16x32_bf16 v[52:55], v[164:167], a[168:171], v[52:55]
 ds_write_b128 v13, v[40:43] offset:2048
 v_mfma_f32_16x16x32_bf16 v[52:55], v[192:195], v[104:107], v[52:55]
 v_mfma_f32_16x16x32_bf16 v[56:59], a[244:247], a[156:159], v[56:59]
 v_mfma_f32_16x16x32_bf16 v[56:59], v[168:171], a[164:167], v[56:59]
 ds_write_b128 v13, v[44:47] offset:3072
 v_mfma_f32_16x16x32_bf16 v[56:59], v[196:199], a[172:175], v[56:59]
 v_mfma_f32_16x16x32_bf16 v[60:63], a[244:247], a[160:163], v[60:63]
 v_mfma_f32_16x16x32_bf16 v[60:63], v[168:171], a[168:171], v[60:63]
 ds_write_b128 v13, v[48:51] offset:4096
 v_mfma_f32_16x16x32_bf16 v[60:63], v[196:199], v[104:107], v[60:63]
 v_mfma_f32_16x16x32_bf16 v[64:67], a[248:251], a[156:159], v[64:67]
 v_mfma_f32_16x16x32_bf16 v[64:67], v[172:175], a[164:167], v[64:67]
 ds_write_b128 v13, v[52:55] offset:5120
 v_mfma_f32_16x16x32_bf16 v[64:67], v[200:203], a[172:175], v[64:67]
 v_mfma_f32_16x16x32_bf16 v[68:71], a[248:251], a[160:163], v[68:71]
 v_mfma_f32_16x16x32_bf16 v[68:71], v[172:175], a[168:171], v[68:71]
 ds_write_b128 v13, v[56:59] offset:6144
 v_mfma_f32_16x16x32_bf16 v[68:71], v[200:203], v[104:107], v[68:71]
 v_mfma_f32_16x16x32_bf16 v[72:75], a[252:255], a[156:159], v[72:75]
 v_mfma_f32_16x16x32_bf16 v[72:75], v[176:179], a[164:167], v[72:75]
 ds_write_b128 v13, v[60:63] offset:32768
 v_mfma_f32_16x16x32_bf16 v[72:75], v[204:207], a[172:175], v[72:75]
 v_mfma_f32_16x16x32_bf16 v[76:79], a[252:255], a[160:163], v[76:79]
 v_mfma_f32_16x16x32_bf16 v[76:79], v[176:179], a[168:171], v[76:79]
 ds_write_b128 v13, v[64:67] offset:33792
 v_mfma_f32_16x16x32_bf16 v[76:79], v[204:207], v[104:107], v[76:79]
 v_mfma_f32_16x16x32_bf16 v[80:83], v[152:155], a[156:159], v[80:83]
 v_mfma_f32_16x16x32_bf16 v[80:83], v[180:183], a[164:167], v[80:83]
 ds_write_b128 v13, v[68:71] offset:34816
 v_mfma_f32_16x16x32_bf16 v[80:83], v[208:211], a[172:175], v[80:83]
 v_mfma_f32_16x16x32_bf16 v[84:87], v[152:155], a[160:163], v[84:87]
 v_mfma_f32_16x16x32_bf16 v[84:87], v[180:183], a[168:171], v[84:87]
 ds_write_b128 v13, v[72:75] offset:35840
 v_mfma_f32_16x16x32_bf16 v[84:87], v[208:211], v[104:107], v[84:87]
 ds_write_b128 v13, v[76:79] offset:36864
 s_nop 2
 ds_write_b128 v13, v[80:83] offset:37888
 s_nop 2
 ds_write_b128 v13, v[84:87] offset:38912
 s_lshl_b32 s38, s3, 10
 v_add_u32 v15, s38, v1
 s_cmp_eq_u32 s3, 3
 s_cselect_b32 s38, 25600, 0
 v_add_u32 v14, s38, v15
 s_waitcnt lgkmcnt(0)
 s_barrier
 ds_read_b128 v[128:131], v15 offset:0
 ds_read_b128 v[132:135], v15 offset:7168
 ds_read_b128 v[136:139], v15 offset:14336
 ds_read_b128 v[140:143], v15 offset:21504
 ds_read_b128 v[144:147], v14 offset:4096
 ds_read_b128 v[148:151], v14 offset:11264
 ds_read_b128 v[152:155], v14 offset:18432
 ds_read_b128 v[156:159], v14 offset:25600
 ds_read_b128 v[160:163], v15 offset:33792
 ds_read_b128 v[164:167], v15 offset:40960
 ds_read_b128 v[168:171], v15 offset:48128
 ds_read_b128 v[172:175], v15 offset:55296
 ds_read_b128 v[176:179], v15 offset:37888
 ds_read_b128 v[180:183], v15 offset:45056
 ds_read_b128 v[184:187], v15 offset:52224
 ds_read_b128 v[188:191], v15 offset:59392
 s_mov_b32 s33, 0x00003f80
 s_mov_b32 s34, 0x3f800000
 v_lshlrev_b32 v32, 16, v2
 v_and_b32 v33, 0xffff0000, v2
 v_lshlrev_b32 v34, 16, v3
 v_and_b32 v35, 0xffff0000, v3
 s_waitcnt lgkmcnt(14)
 v_pk_add_f32 v[128:129], v[128:129], v[132:133]
 v_pk_add_f32 v[130:131], v[130:131], v[134:135]
 s_waitcnt lgkmcnt(13)
 v_pk_add_f32 v[128:129], v[128:129], v[136:137]
 v_pk_add_f32 v[130:131], v[130:131], v[138:139]
 s_waitcnt lgkmcnt(12)
 v_pk_add_f32 v[128:129], v[128:129], v[140:141]
 v_pk_add_f32 v[130:131], v[130:131], v[142:143]
 v_cvt_pk_bf16_f32 v132, v128, v129
 v_cvt_pk_bf16_f32 v133, v130, v131
 v_dot2_f32_bf16 v32, v132, s33, v32
 v_dot2_f32_bf16 v33, v132, s34, v33
 v_dot2_f32_bf16 v34, v133, s33, v34
 v_dot2_f32_bf16 v35, v133, s34, v35
 v_lshlrev_b32 v36, 16, v4
 v_and_b32 v37, 0xffff0000, v4
 v_lshlrev_b32 v38, 16, v5
 v_and_b32 v39, 0xffff0000, v5
 s_waitcnt lgkmcnt(10)
 v_pk_add_f32 v[144:145], v[144:145], v[148:149]
 v_pk_add_f32 v[146:147], v[146:147], v[150:151]
 s_waitcnt lgkmcnt(9)
 v_pk_add_f32 v[144:145], v[144:145], v[152:153]
 v_pk_add_f32 v[146:147], v[146:147], v[154:155]
 s_waitcnt lgkmcnt(8)
 v_pk_add_f32 v[144:145], v[144:145], v[156:157]
 v_pk_add_f32 v[146:147], v[146:147], v[158:159]
 v_cvt_pk_bf16_f32 v148, v144, v145
 v_cvt_pk_bf16_f32 v149, v146, v147
 v_dot2_f32_bf16 v36, v148, s33, v36
 v_dot2_f32_bf16 v37, v148, s34, v37
 v_dot2_f32_bf16 v38, v149, s33, v38
 v_dot2_f32_bf16 v39, v149, s34, v39
 v_lshlrev_b32 v40, 16, v6
 v_and_b32 v41, 0xffff0000, v6
 v_lshlrev_b32 v42, 16, v7
 v_and_b32 v43, 0xffff0000, v7
 s_waitcnt lgkmcnt(6)
 v_pk_add_f32 v[160:161], v[160:161], v[164:165]
 v_pk_add_f32 v[162:163], v[162:163], v[166:167]
 s_waitcnt lgkmcnt(5)
 v_pk_add_f32 v[160:161], v[160:161], v[168:169]
 v_pk_add_f32 v[162:163], v[162:163], v[170:171]
 s_waitcnt lgkmcnt(4)
 v_pk_add_f32 v[160:161], v[160:161], v[172:173]
 v_pk_add_f32 v[162:163], v[162:163], v[174:175]
 v_cvt_pk_bf16_f32 v164, v160, v161
 v_cvt_pk_bf16_f32 v165, v162, v163
 v_dot2_f32_bf16 v40, v164, s33, v40
 v_dot2_f32_bf16 v41, v164, s34, v41
 v_dot2_f32_bf16 v42, v165, s33, v42
 v_dot2_f32_bf16 v43, v165, s34, v43
 v_lshlrev_b32 v44, 16, v8
 v_and_b32 v45, 0xffff0000, v8
 v_lshlrev_b32 v46, 16, v9
 v_and_b32 v47, 0xffff0000, v9
 s_waitcnt lgkmcnt(2)
 v_pk_add_f32 v[176:177], v[176:177], v[180:181]
 v_pk_add_f32 v[178:179], v[178:179], v[182:183]
 s_waitcnt lgkmcnt(1)
 v_pk_add_f32 v[176:177], v[176:177], v[184:185]
 v_pk_add_f32 v[178:179], v[178:179], v[186:187]
 s_waitcnt lgkmcnt(0)
 v_pk_add_f32 v[176:177], v[176:177], v[188:189]
 v_pk_add_f32 v[178:179], v[178:179], v[190:191]
 v_cvt_pk_bf16_f32 v180, v176, v177
 v_cvt_pk_bf16_f32 v181, v178, v179
 v_dot2_f32_bf16 v44, v180, s33, v44
 v_dot2_f32_bf16 v45, v180, s34, v45
 v_dot2_f32_bf16 v46, v181, s33, v46
 v_dot2_f32_bf16 v47, v181, s34, v47
 v_cvt_pk_bf16_f32 v132, v32, v33
 v_cvt_pk_bf16_f32 v133, v34, v35
 buffer_store_dwordx2 v[132:133], v12, s[56:59], 0 offen offset:0
 v_cvt_pk_bf16_f32 v148, v36, v37
 v_cvt_pk_bf16_f32 v149, v38, v39
 buffer_store_dwordx2 v[148:149], v12, s[56:59], 0 offen offset:64
 v_cvt_pk_bf16_f32 v164, v40, v41
 v_cvt_pk_bf16_f32 v165, v42, v43
 buffer_store_dwordx2 v[164:165], v12, s[56:59], 0 offen offset:128
 v_cvt_pk_bf16_f32 v180, v44, v45
 v_cvt_pk_bf16_f32 v181, v46, v47
 s_cmp_lt_u32 s3, 2
 s_cselect_b32 s38, 0, 1879048192
 buffer_store_dwordx2 v[180:181], v12, s[56:59], s38 offen offset:192
L_end:
 s_endpgm
L_hook:
 s_mov_b32 s23, 5
 s_cmp_eq_u32 s3, 0
 s_cbranch_scc0 L_hook_ret
 s_add_u32 s20, s4, s2
 s_addc_u32 s21, s5, 0
 s_mov_b32 exec_lo, 0
 s_mov_b32 exec_hi, 0x80000000
 v_readlane_b32 s38, v0, 63
 v_readlane_b32 s30, v1, 63
 v_mov_b32 v0, 0
 v_mov_b32 v1, 1
 global_store_byte v0, v1, s[20:21] sc1
 s_nop 1
 v_mov_b32 v0, s38
 v_mov_b32 v1, s30
 s_mov_b64 exec, -1
L_hook_ret:
 s_cmp_eq_u32 s26, 0
 s_cbranch_scc1 L_loopK
 s_branch L_loopV
L_loopK_spin:
 s_mov_b32 s30, 0
L_loopK_spin_l:
 s_add_u32 s30, s30, 1
 s_cmp_gt_u32 s30, 100000
 s_cbranch_scc1 L_loopK_spun
 s_sleep 1
 global_load_dword v3, v6, s[4:5] sc1
 s_waitcnt vmcnt(0)
 v_cmp_ne_u32 vcc, 0x01010101, v3
 s_nop 4
 s_cbranch_vccnz L_loopK_spin_l
 s_branch L_loopK_spun
L_loopK_xspin:
 s_mov_b32 s30, 0
L_loopK_xspin_l:
 s_add_u32 s30, s30, 1
 s_cmp_gt_u32 s30, 100000
 s_cbranch_scc1 L_loopK_xspun
 s_sleep 16
 s_load_dwordx4 s[52:55], s[4:5], s38 glc
 s_waitcnt lgkmcnt(0)
 s_and_b64 s[52:53], s[52:53], s[54:55]
 s_and_b32 s52, s52, s53
 s_cmp_eq_u32 s52, 0x01010101
 s_cbranch_scc0 L_loopK_xspin_l
 s_branch L_loopK_xspun
L_loopV_spin:
 s_mov_b32 s30, 0
L_loopV_spin_l:
 s_add_u32 s30, s30, 1
 s_cmp_gt_u32 s30, 100000
 s_cbranch_scc1 L_loopV_spun
 s_sleep 1
 global_load_dword v3, v6, s[4:5] sc1
 s_waitcnt vmcnt(0)
 v_cmp_ne_u32 vcc, 0x01010101, v3
 s_nop 4
 s_cbranch_vccnz L_loopV_spin_l
 s_branch L_loopV_spun
L_loopV_xspin:
 s_mov_b32 s30, 0
L_loopV_xspin_l:
 s_add_u32 s30, s30, 1
 s_cmp_gt_u32 s30, 100000
 s_cbranch_scc1 L_loopV_xspun
 s_sleep 16
 s_load_dwordx4 s[52:55], s[4:5], s38 glc
 s_waitcnt lgkmcnt(0)
 s_and_b64 s[52:53], s[52:53], s[54:55]
 s_and_b32 s52, s52, s53
 s_cmp_eq_u32 s52, 0x01010101
 s_cbranch_scc0 L_loopV_xspin_l
 s_branch L_loopV_xspun
L_spin1:
 s_mov_b32 s39, 0
 s_add_u32 s20, s6, s22
 s_addc_u32 s21, s7, 0
L_spin1_l:
 s_load_dword s38, s[20:21], 0 glc
 s_waitcnt lgkmcnt(0)
 s_cmp_ge_u32 s38, 16
 s_cbranch_scc1 L_spun1
 s_add_u32 s39, s39, 1
 s_cmp_gt_u32 s39, 100000
 s_cbranch_scc1 L_spun1
 s_sleep 2
 s_branch L_spin1_l
L_spin2:
 s_mov_b32 s39, 0
 s_add_u32 s20, s6, s22
 s_addc_u32 s21, s7, 0
L_spin2_l:
 s_load_dword s38, s[20:21], 4 glc
 s_waitcnt lgkmcnt(0)
 s_cmp_ge_u32 s38, 16
 s_cbranch_scc1 L_spun2
 s_add_u32 s39, s39, 1
 s_cmp_gt_u32 s39, 100000
 s_cbranch_scc1 L_spun2
 s_sleep 2
 s_branch L_spin2_l
L_tfast:
 s_ff1_i32_b32 s36, s37
 s_bitset0_b32 s37, s36
 s_bitset0_b32 s51, s36
 s_mul_i32 s36, s36, 1835008
 s_add_u32 s36, s36, s27
 s_add_u32 s38, s36, 0
 buffer_load_dwordx4 v[128:131], v104, s[16:19], s38 offen sc1
 s_add_u32 s38, s36, 4096
 buffer_load_dwordx4 v[132:135], v104, s[16:19], s38 offen sc1
 s_add_u32 s38, s36, 8192
 buffer_load_dwordx4 v[136:139], v104, s[16:19], s38 offen sc1
 s_add_u32 s36, s36, s28
 s_add_u32 s38, s36, 12288
 buffer_load_dwordx4 v[140:143], v104, s[16:19], s38 offen sc1
 s_ff1_i32_b32 s36, s37
 s_bitset0_b32 s37, s36
 s_bitset0_b32 s51, s36
 s_mul_i32 s36, s36, 1835008
 s_add_u32 s36, s36, s27
 s_add_u32 s38, s36, 0
 buffer_load_dwordx4 v[144:147], v104, s[16:19], s38 offen sc1
 s_add_u32 s38, s36, 4096
 buffer_load_dwordx4 v[148:151], v104, s[16:19], s38 offen sc1
 s_add_u32 s38, s36, 8192
 buffer_load_dwordx4 v[152:155], v104, s[16:19], s38 offen sc1
 s_add_u32 s36, s36, s28
 s_add_u32 s38, s36, 12288
 buffer_load_dwordx4 v[156:159], v104, s[16:19], s38 offen sc1
 s_ff1_i32_b32 s36, s37
 s_bitset0_b32 s37, s36
 s_bitset0_b32 s51, s36
 s_mul_i32 s36, s36, 1835008
 s_add_u32 s36, s36, s27
 s_add_u32 s38, s36, 0
 buffer_load_dwordx4 v[160:163], v104, s[16:19], s38 offen sc1
 s_add_u32 s38, s36, 4096
 buffer_load_dwordx4 v[164:167], v104, s[16:19], s38 offen sc1
 s_add_u32 s38, s36, 8192
 buffer_load_dwordx4 v[168:171], v104, s[16:19], s38 offen sc1
 s_add_u32 s36, s36, s28
 s_add_u32 s38, s36, 12288
 buffer_load_dwordx4 v[172:175], v104, s[16:19], s38 offen sc1
 s_waitcnt vmcnt(12)
 s_barrier
 buffer_atomic_add v11, v10, s[16:19], s23 offen offset:16 sc1
 s_branch L_tjoin
L_tfb0:
 s_add_u32 m0, s43, 65536
 s_add_u32 s35, s49, 0
 buffer_load_dwordx4 v2, s[8:11], s35 offen offset:0 lds
 buffer_load_dwordx4 v3, s[8:11], s35 offen offset:1024 lds
 buffer_load_dwordx4 v4, s[8:11], s35 offen offset:2048 lds
 buffer_load_dwordx4 v5, s[8:11], s35 offen offset:3072 lds
 s_add_u32 m0, s43, 69632
 s_add_u32 s35, s49, 0
 buffer_load_dwordx4 v6, s[8:11], s35 offen offset:0 lds
 buffer_load_dwordx4 v7, s[8:11], s35 offen offset:1024 lds
 buffer_load_dwordx4 v8, s[8:11], s35 offen offset:2048 lds
 s_branch L_tfb0r
L_ypoll0:
 s_mov_b32 s39, 0
L_ypoll0_l:
 s_load_dword s38, s[20:21], 16 glc
 s_add_u32 s39, s39, 1
 s_waitcnt lgkmcnt(0)
 s_lshr_b32 s37, s38, 1
 s_and_b32 s37, s37, s38
 s_cmp_gt_u32 s39, 100000
 s_cselect_b32 s37, -1, s37
 s_and_b32 s37, s37, s51
 s_cbranch_scc1 L_ygot0
 s_sleep 2
 s_branch L_ypoll0_l
L_ypoll1:
 s_mov_b32 s39, 0
L_ypoll1_l:
 s_load_dword s38, s[20:21], 16 glc
 s_add_u32 s39, s39, 1
 s_waitcnt lgkmcnt(0)
 s_lshr_b32 s37, s38, 1
 s_and_b32 s37, s37, s38
 s_cmp_gt_u32 s39, 100000
 s_cselect_b32 s37, -1, s37
 s_and_b32 s37, s37, s51
 s_cbranch_scc1 L_ygot1
 s_sleep 2
 s_branch L_ypoll1_l
L_ypoll2:
 s_mov_b32 s39, 0
L_ypoll2_l:
 s_load_dword s38, s[20:21], 16 glc
 s_add_u32 s39, s39, 1
 s_waitcnt lgkmcnt(0)
 s_lshr_b32 s37, s38, 1
 s_and_b32 s37, s37, s38
 s_cmp_gt_u32 s39, 100000
 s_cselect_b32 s37, -1, s37
 s_and_b32 s37, s37, s51
 s_cbranch_scc1 L_ygot2
 s_sleep 2
 s_branch L_ypoll2_l
L_ypoll3:
 s_mov_b32 s39, 0
L_ypoll3_l:
 s_load_dword s38, s[20:21], 16 glc
 s_add_u32 s39, s39, 1
 s_waitcnt lgkmcnt(0)
 s_lshr_b32 s37, s38, 1
 s_and_b32 s37, s37, s38
 s_cmp_gt_u32 s39, 100000
 s_cselect_b32 s37, -1, s37
 s_and_b32 s37, s37, s51
 s_cbranch_scc1 L_ygot3
 s_sleep 2
 s_branch L_ypoll3_l
L_ypoll4:
 s_mov_b32 s39, 0
L_ypoll4_l:
 s_load_dword s38, s[20:21], 16 glc
 s_add_u32 s39, s39, 1
 s_waitcnt lgkmcnt(0)
 s_lshr_b32 s37, s38, 1
 s_and_b32 s37, s37, s38
 s_cmp_gt_u32 s39, 100000
 s_cselect_b32 s37, -1, s37
 s_and_b32 s37, s37, s51
 s_cbranch_scc1 L_ygot4
 s_sleep 2
 s_branch L_ypoll4_l
L_ypoll5:
 s_mov_b32 s39, 0
L_ypoll5_l:
 s_load_dword s38, s[20:21], 16 glc
 s_add_u32 s39, s39, 1
 s_waitcnt lgkmcnt(0)
 s_lshr_b32 s37, s38, 1
 s_and_b32 s37, s37, s38
 s_cmp_gt_u32 s39, 100000
 s_cselect_b32 s37, -1, s37
 s_and_b32 s37, s37, s51
 s_cbranch_scc1 L_ygot5
 s_sleep 2
 s_branch L_ypoll5_l
L_ypoll6:
 s_mov_b32 s39, 0
L_ypoll6_l:
 s_load_dword s38, s[20:21], 16 glc
 s_add_u32 s39, s39, 1
 s_waitcnt lgkmcnt(0)
 s_lshr_b32 s37, s38, 1
 s_and_b32 s37, s37, s38
 s_cmp_gt_u32 s39, 100000
 s_cselect_b32 s37, -1, s37
 s_and_b32 s37, s37, s51
 s_cbranch_scc1 L_ygot6
 s_sleep 2
 s_branch L_ypoll6_l
L_ypoll7:
 s_mov_b32 s39, 0
L_ypoll7_l:
 s_load_dword s38, s[20:21], 16 glc
 s_add_u32 s39, s39, 1
 s_waitcnt lgkmcnt(0)
 s_lshr_b32 s37, s38, 1
 s_and_b32 s37, s37, s38
 s_cmp_gt_u32 s39, 100000
 s_cselect_b32 s37, -1, s37
 s_and_b32 s37, s37, s51
 s_cbranch_scc1 L_ygot7
 s_sleep 2
 s_branch L_ypoll7_l
L_tspin1:
 s_mov_b32 s39, 0
L_tspin1_l:
 s_add_u32 s39, s39, 1
 s_cmp_gt_u32 s39, 100000
 s_cbranch_scc1 L_tspun1
 s_load_dword s38, s[20:21], 20 glc
 s_waitcnt lgkmcnt(0)
 s_andn2_b32 s38, s41, s38
 s_cbranch_scc0 L_tspun1
 s_sleep 2
 s_branch L_tspin1_l
L_tspin2:
 s_mov_b32 s39, 0
L_tspin2_l:
 s_add_u32 s39, s39, 1
 s_cmp_gt_u32 s39, 100000
 s_cbranch_scc1 L_tspun2
 s_load_dword s38, s[20:21], 24 glc
 s_waitcnt lgkmcnt(0)
 s_andn2_b32 s38, s41, s38
 s_cbranch_scc0 L_tspun2
 s_sleep 2
 s_branch L_tspin2_l
.section .rodata,"a"
.p2align 6
.amdhsa_kernel sequential_preLN__compressed_kv_cla__glu_gated_swiglu__prompt_kernel
  .amdhsa_next_free_vgpr 512
  .amdhsa_next_free_sgpr 102
  .amdhsa_accum_offset 256
  .amdhsa_group_segment_fixed_size 0
  .amdhsa_kernarg_size 104
  .amdhsa_user_sgpr_count 2
  .amdhsa_user_sgpr_kernarg_segment_ptr 1
  .amdhsa_system_sgpr_workgroup_id_x 1
  .amdhsa_float_denorm_mode_32 3
  .amdhsa_float_denorm_mode_16_64 3
  .amdhsa_ieee_mode 0
  .amdhsa_dx10_clamp 0
.end_amdhsa_kernel
.text
.p2align 2
L_textend:
```
